```python
import torch

def _softmax(x, axis=-1):
    return torch.softmax(x, dim=axis)
def _gelu(x):
    return torch.nn.functional.gelu(x, approximate="tanh")
def _silu(x):
    return torch.nn.functional.silu(x)
def _sigmoid(x):
    return torch.sigmoid(x)
def _layernorm(x, axis=-1, eps=1e-5):
    m = x.mean(dim=axis, keepdim=True)
    v = x.var(dim=axis, keepdim=True, unbiased=False)
    return (x - m) / torch.sqrt(v + eps)
def _scatter_add(tgt, idx, src, axis=0):
    return tgt.clone().index_add_(axis, idx, src)
def _segment_sum(src, seg, n):
    out = torch.zeros((n,) + src.shape[1:], dtype=src.dtype)
    return out.index_add_(0, seg, src)
def _pad(x, pw):
    flat = tuple(v for pair in reversed(pw) for v in pair)
    return torch.nn.functional.pad(x, flat)

kernel_name = 'standalone__gqa_softmax__near_ridge'

def setup_inputs():

    _w = (lambda a: (lambda t: t.to(torch.bfloat16) if t.is_floating_point() else t)(torch.as_tensor(a)))
    B, Hq, Hkv, Sq, Sk, D = 16, 16, 8, 384, 384, 256
    return {
        "q": _w((lambda *s: torch.randn(*s, dtype=torch.bfloat16) * 0.8)(B, Hq, Sq, D)),
        "k": _w((lambda *s: torch.randn(*s, dtype=torch.bfloat16) * 0.8)(B, Hkv, Sk, D)),
        "v": _w((lambda *s: torch.randn(*s, dtype=torch.bfloat16) * 0.05)(B, Hkv, Sk, D)),
    }

def reference(q, k, v):
    B, Hq, Sq, D = q.shape
    Hkv = k.shape[1]
    rep = Hq // Hkv
    k = (lambda x, n, axis: torch.repeat_interleave(x, n, dim=axis))(k, rep, axis=1)
    v = (lambda x, n, axis: torch.repeat_interleave(x, n, dim=axis))(v, rep, axis=1)
    scale = D ** -0.5
    scores = torch.einsum("bhqd,bhkd->bhqk", q, k) * scale
    p = _softmax(scores, axis=-1)
    return torch.einsum("bhqk,bhkd->bhqd", p, v)
```

```asm
; @launch grid=(256,1,1) block=(256,1,1) lds=163840
.amdgcn_target "amdgcn-amd-amdhsa--gfx950"
.text
.globl standalone__gqa_softmax__near_ridge_kernel
.p2align 8
.type standalone__gqa_softmax__near_ridge_kernel,@function
standalone__gqa_softmax__near_ridge_kernel:
  s_cmp_ge_u32 s2, 256
  s_cbranch_scc1 L_finf
L_go:
  s_load_dwordx4 s[4:7], s[0:1], 0
  s_load_dwordx4 s[48:51], s[0:1], 16
  v_lshrrev_b32 v4, 6, v0
  v_and_b32 v5, 63, v0
  v_readfirstlane_b32 s24, v4
  s_getpc_b64 s[30:31]
  L_pcf:
  v_and_b32 v1, 3, v5
  s_and_b32 s57, s2, 0xf8
  s_lshl_b32 s57, s57, 1
  s_lshl_b32 s58, s24, 2
  s_add_u32 s57, s57, s58
  v_add_u32 v1, s57, v1
  v_lshlrev_b32 v1, 7, v1
  v_min_u32 v1, L_finf-L_pcf, v1
  global_load_dword v3, v1, s[30:31]
  s_and_b32 s54, s2, 7
  s_lshr_b32 s55, s2, 3
  s_lshr_b32 s56, s55, 1
  s_lshl_b32 s54, s54, 4
  s_add_u32 s54, s54, s56
  s_and_b32 s55, s55, 1
  s_lshl_b32 s56, s54, 1
  s_add_u32 s56, s56, s55
  s_mul_i32 s56, s56, 196608
  s_mul_i32 s54, s54, 196608
  s_mov_b32 s25, 0x3db8aa3b
  s_mul_i32 s26, s24, 2112
  s_mul_i32 s27, s24, 25344
  s_add_u32 s27, s27, 59136
  s_mul_i32 s28, s24, 49152
  s_lshl_b32 s29, s24, 10
  v_lshrrev_b32 v6, 5, v5
  v_and_b32 v7, 31, v5
  v_xor_b32 v7, v7, v6
  v_lshlrev_b32 v7, 4, v7
  v_lshl_add_u32 v120, v6, 9, v7
  s_lshl_b32 s57, s24, 11
  v_add_u32 v118, s57, v120
  s_mov_b32 s10, 196608
  s_mov_b32 s11, 0x20000
  s_mov_b32 s14, 196608
  s_mov_b32 s15, 0x20000
  s_mov_b32 s18, 196608
  s_mov_b32 s19, 0x20000
  s_mov_b32 s22, 196608
  s_mov_b32 s23, 0x20000
  s_waitcnt lgkmcnt(0)
  s_add_u32 s8, s4, s56
  s_addc_u32 s9, s5, 0
  s_mov_b32 s33, 0
  s_add_u32 m0, s26, 0
  s_nop 0
  buffer_load_dwordx4 v118, s[8:11], s33 offen offset:0 nt lds
  s_add_u32 m0, s26, 32
  s_nop 0
  buffer_load_dwordx4 v118, s[8:11], s33 offen offset:1024 nt lds
  s_mov_b32 s34, 8192
  s_add_u32 m0, s26, 8448
  s_nop 0
  buffer_load_dwordx4 v118, s[8:11], s34 offen offset:0 nt lds
  s_add_u32 m0, s26, 8480
  s_nop 0
  buffer_load_dwordx4 v118, s[8:11], s34 offen offset:1024 nt lds
  s_mov_b32 s35, 16384
  s_add_u32 m0, s26, 16896
  s_nop 0
  buffer_load_dwordx4 v118, s[8:11], s35 offen offset:0 nt lds
  s_add_u32 m0, s26, 16928
  s_nop 0
  buffer_load_dwordx4 v118, s[8:11], s35 offen offset:1024 nt lds
  s_add_u32 s12, s6, s54
  s_addc_u32 s13, s7, 0
  s_add_u32 s16, s48, s54
  s_addc_u32 s17, s49, 0
  s_add_u32 s20, s50, s56
  s_addc_u32 s21, s51, 0
  s_add_u32 s36, s28, 0
  s_add_u32 m0, s27, 0
  s_nop 0
  buffer_load_dwordx4 v120, s[12:15], s36 offen offset:0 nt lds
  s_add_u32 m0, s27, 32
  s_nop 0
  buffer_load_dwordx4 v120, s[12:15], s36 offen offset:1024 nt lds
  s_add_u32 m0, s27, 64
  s_nop 0
  buffer_load_dwordx4 v120, s[12:15], s36 offen offset:2048 nt lds
  s_add_u32 m0, s27, 96
  s_nop 0
  buffer_load_dwordx4 v120, s[12:15], s36 offen offset:3072 nt lds
  s_add_u32 s37, s28, 4096
  s_add_u32 m0, s27, 4224
  s_nop 0
  buffer_load_dwordx4 v120, s[12:15], s37 offen offset:0 nt lds
  s_add_u32 m0, s27, 4256
  s_nop 0
  buffer_load_dwordx4 v120, s[12:15], s37 offen offset:1024 nt lds
  s_add_u32 m0, s27, 4288
  s_nop 0
  buffer_load_dwordx4 v120, s[12:15], s37 offen offset:2048 nt lds
  s_add_u32 m0, s27, 4320
  s_nop 0
  buffer_load_dwordx4 v120, s[12:15], s37 offen offset:3072 nt lds
  v_and_b32 v9, 15, v5
  v_lshrrev_b32 v10, 4, v5
  v_and_b32 v11, 1, v9
  v_xor_b32 v12, v10, v11
  v_lshlrev_b32 v12, 4, v12
  v_lshl_add_u32 v12, v11, 9, v12
  v_lshrrev_b32 v13, 1, v9
  v_mul_u32_u24 v13, 1056, v13
  v_add_u32 v112, v12, v13
  v_add_u32 v121, s27, v112
  v_lshlrev_b32 v15, 4, v5
  s_mul_i32 s57, s24, 3072
  s_add_u32 s57, s57, 59136
  v_add_u32 v113, s57, v15
  v_add_u32 v114, 49152, v113
  s_mul_i32 s57, s24, 12288
  s_add_u32 s57, s57, 59136
  v_add_u32 v115, s57, v15
  v_mov_b32 v117, 157440
  s_lshl_b32 s57, s24, 2
  v_add_u32 v116, s57, v117
  v_lshrrev_b32 v16, 3, v5
  v_and_b32 v17, 6, v16
  v_and_b32 v18, 7, v5
  v_xor_b32 v17, v17, v18
  v_lshlrev_b32 v17, 4, v17
  v_lshl_add_u32 v17, v16, 9, v17
  s_lshl_b32 s57, s24, 12
  v_add_u32 v119, s57, v17
  s_add_u32 s38, s28, 8192
  s_add_u32 m0, s27, 8448
  s_nop 0
  buffer_load_dwordx4 v120, s[12:15], s38 offen offset:0 nt lds
  s_add_u32 m0, s27, 8480
  s_nop 0
  buffer_load_dwordx4 v120, s[12:15], s38 offen offset:1024 nt lds
  s_add_u32 m0, s27, 8512
  s_nop 0
  buffer_load_dwordx4 v120, s[12:15], s38 offen offset:2048 nt lds
  s_add_u32 m0, s27, 8544
  s_nop 0
  buffer_load_dwordx4 v120, s[12:15], s38 offen offset:3072 nt lds
  s_add_u32 s39, s28, 12288
  s_add_u32 m0, s27, 12672
  s_nop 0
  buffer_load_dwordx4 v120, s[12:15], s39 offen offset:0 nt lds
  s_add_u32 m0, s27, 12704
  s_nop 0
  buffer_load_dwordx4 v120, s[12:15], s39 offen offset:1024 nt lds
  s_add_u32 m0, s27, 12736
  s_nop 0
  buffer_load_dwordx4 v120, s[12:15], s39 offen offset:2048 nt lds
  s_add_u32 m0, s27, 12768
  s_nop 0
  buffer_load_dwordx4 v120, s[12:15], s39 offen offset:3072 nt lds
  s_waitcnt vmcnt(16)
  s_barrier
  ds_read_b128 a[0:3], v112 offset:0
  ds_read_b128 a[4:7], v112 offset:64
  ds_read_b128 a[8:11], v112 offset:128
  ds_read_b128 a[12:15], v112 offset:192
  ds_read_b128 a[16:19], v112 offset:256
  ds_read_b128 a[20:23], v112 offset:320
  ds_read_b128 a[24:27], v112 offset:384
  ds_read_b128 a[28:31], v112 offset:448
  ds_read_b128 a[32:35], v112 offset:8448
  ds_read_b128 a[36:39], v112 offset:8512
  ds_read_b128 a[40:43], v112 offset:8576
  ds_read_b128 a[44:47], v112 offset:8640
  ds_read_b128 a[48:51], v112 offset:8704
  ds_read_b128 a[52:55], v112 offset:8768
  ds_read_b128 a[56:59], v112 offset:8832
  ds_read_b128 a[60:63], v112 offset:8896
  ds_read_b128 a[64:67], v112 offset:16896
  ds_read_b128 a[68:71], v112 offset:16960
  ds_read_b128 a[72:75], v112 offset:17024
  ds_read_b128 a[76:79], v112 offset:17088
  ds_read_b128 a[80:83], v112 offset:17152
  ds_read_b128 a[84:87], v112 offset:17216
  ds_read_b128 a[88:91], v112 offset:17280
  ds_read_b128 a[92:95], v112 offset:17344
  s_waitcnt vmcnt(8)
  ds_read_b128 a[192:195], v121 offset:0
  ds_read_b128 a[196:199], v121 offset:64
  ds_read_b128 a[200:203], v121 offset:128
  ds_read_b128 a[204:207], v121 offset:192
  ds_read_b128 a[208:211], v121 offset:256
  ds_read_b128 a[212:215], v121 offset:320
  ds_read_b128 a[216:219], v121 offset:384
  ds_read_b128 a[220:223], v121 offset:448
  s_waitcnt lgkmcnt(7)
  v_mfma_f32_16x16x32_bf16 v[0:3], a[192:195], a[0:3], 0
  s_mov_b32 s40, 24576
  s_add_u32 m0, s26, 25344
  s_nop 0
  buffer_load_dwordx4 v118, s[8:11], s40 offen offset:0 nt lds
  v_mfma_f32_16x16x32_bf16 v[8:11], a[192:195], a[32:35], 0
  v_mfma_f32_16x16x32_bf16 v[16:19], a[192:195], a[64:67], 0
  s_waitcnt lgkmcnt(6)
  v_mfma_f32_16x16x32_bf16 v[0:3], a[196:199], a[4:7], v[0:3]
  s_add_u32 m0, s26, 25376
  s_nop 0
  buffer_load_dwordx4 v118, s[8:11], s40 offen offset:1024 nt lds
  v_mfma_f32_16x16x32_bf16 v[8:11], a[196:199], a[36:39], v[8:11]
  v_mfma_f32_16x16x32_bf16 v[16:19], a[196:199], a[68:71], v[16:19]
  s_waitcnt lgkmcnt(5)
  v_mfma_f32_16x16x32_bf16 v[0:3], a[200:203], a[8:11], v[0:3]
  s_mov_b32 s41, 32768
  s_add_u32 m0, s26, 33792
  s_nop 0
  buffer_load_dwordx4 v118, s[8:11], s41 offen offset:0 nt lds
  v_mfma_f32_16x16x32_bf16 v[8:11], a[200:203], a[40:43], v[8:11]
  v_mfma_f32_16x16x32_bf16 v[16:19], a[200:203], a[72:75], v[16:19]
  s_waitcnt lgkmcnt(4)
  v_mfma_f32_16x16x32_bf16 v[0:3], a[204:207], a[12:15], v[0:3]
  s_add_u32 m0, s26, 33824
  s_nop 0
  buffer_load_dwordx4 v118, s[8:11], s41 offen offset:1024 nt lds
  v_mfma_f32_16x16x32_bf16 v[8:11], a[204:207], a[44:47], v[8:11]
  v_mfma_f32_16x16x32_bf16 v[16:19], a[204:207], a[76:79], v[16:19]
  s_waitcnt lgkmcnt(3)
  v_mfma_f32_16x16x32_bf16 v[0:3], a[208:211], a[16:19], v[0:3]
  s_mov_b32 s42, 40960
  s_add_u32 m0, s26, 42240
  s_nop 0
  buffer_load_dwordx4 v118, s[8:11], s42 offen offset:0 nt lds
  v_mfma_f32_16x16x32_bf16 v[8:11], a[208:211], a[48:51], v[8:11]
  v_mfma_f32_16x16x32_bf16 v[16:19], a[208:211], a[80:83], v[16:19]
  s_waitcnt lgkmcnt(2)
  v_mfma_f32_16x16x32_bf16 v[0:3], a[212:215], a[20:23], v[0:3]
  s_add_u32 m0, s26, 42272
  s_nop 0
  buffer_load_dwordx4 v118, s[8:11], s42 offen offset:1024 nt lds
  v_mfma_f32_16x16x32_bf16 v[8:11], a[212:215], a[52:55], v[8:11]
  v_mfma_f32_16x16x32_bf16 v[16:19], a[212:215], a[84:87], v[16:19]
  s_waitcnt lgkmcnt(1)
  v_mfma_f32_16x16x32_bf16 v[0:3], a[216:219], a[24:27], v[0:3]
  s_add_u32 s43, s28, 16384
  s_add_u32 m0, s27, 16896
  s_nop 0
  buffer_load_dwordx4 v120, s[12:15], s43 offen offset:0 nt lds
  v_mfma_f32_16x16x32_bf16 v[8:11], a[216:219], a[56:59], v[8:11]
  v_mfma_f32_16x16x32_bf16 v[16:19], a[216:219], a[88:91], v[16:19]
  s_waitcnt lgkmcnt(0)
  v_mfma_f32_16x16x32_bf16 v[0:3], a[220:223], a[28:31], v[0:3]
  s_add_u32 m0, s27, 16928
  s_nop 0
  buffer_load_dwordx4 v120, s[12:15], s43 offen offset:1024 nt lds
  v_mfma_f32_16x16x32_bf16 v[8:11], a[220:223], a[60:63], v[8:11]
  v_mfma_f32_16x16x32_bf16 v[16:19], a[220:223], a[92:95], v[16:19]
  s_waitcnt vmcnt(8)
  ds_read_b128 a[224:227], v121 offset:8448
  ds_read_b128 a[228:231], v121 offset:8512
  ds_read_b128 a[232:235], v121 offset:8576
  ds_read_b128 a[236:239], v121 offset:8640
  ds_read_b128 a[240:243], v121 offset:8704
  ds_read_b128 a[244:247], v121 offset:8768
  ds_read_b128 a[248:251], v121 offset:8832
  ds_read_b128 a[252:255], v121 offset:8896
  s_waitcnt lgkmcnt(7)
  v_mfma_f32_16x16x32_bf16 v[52:55], a[224:227], a[0:3], 0
  s_add_u32 m0, s27, 16960
  s_nop 0
  buffer_load_dwordx4 v120, s[12:15], s43 offen offset:2048 nt lds
  v_mfma_f32_16x16x32_bf16 v[60:63], a[224:227], a[32:35], 0
  v_mfma_f32_16x16x32_bf16 v[68:71], a[224:227], a[64:67], 0
  s_waitcnt lgkmcnt(6)
  v_mfma_f32_16x16x32_bf16 v[52:55], a[228:231], a[4:7], v[52:55]
  s_add_u32 m0, s27, 16992
  s_nop 0
  buffer_load_dwordx4 v120, s[12:15], s43 offen offset:3072 nt lds
  v_mfma_f32_16x16x32_bf16 v[60:63], a[228:231], a[36:39], v[60:63]
  v_mfma_f32_16x16x32_bf16 v[68:71], a[228:231], a[68:71], v[68:71]
  s_waitcnt lgkmcnt(5)
  v_mfma_f32_16x16x32_bf16 v[52:55], a[232:235], a[8:11], v[52:55]
  s_add_u32 s44, s28, 20480
  s_add_u32 m0, s27, 21120
  s_nop 0
  buffer_load_dwordx4 v120, s[12:15], s44 offen offset:0 nt lds
  v_mfma_f32_16x16x32_bf16 v[60:63], a[232:235], a[40:43], v[60:63]
  v_mfma_f32_16x16x32_bf16 v[68:71], a[232:235], a[72:75], v[68:71]
  s_waitcnt lgkmcnt(4)
  v_mfma_f32_16x16x32_bf16 v[52:55], a[236:239], a[12:15], v[52:55]
  s_add_u32 m0, s27, 21152
  s_nop 0
  buffer_load_dwordx4 v120, s[12:15], s44 offen offset:1024 nt lds
  v_mfma_f32_16x16x32_bf16 v[60:63], a[236:239], a[44:47], v[60:63]
  v_mfma_f32_16x16x32_bf16 v[68:71], a[236:239], a[76:79], v[68:71]
  s_waitcnt lgkmcnt(3)
  v_mfma_f32_16x16x32_bf16 v[52:55], a[240:243], a[16:19], v[52:55]
  s_add_u32 m0, s27, 21184
  s_nop 0
  buffer_load_dwordx4 v120, s[12:15], s44 offen offset:2048 nt lds
  v_mfma_f32_16x16x32_bf16 v[60:63], a[240:243], a[48:51], v[60:63]
  v_mfma_f32_16x16x32_bf16 v[68:71], a[240:243], a[80:83], v[68:71]
  s_waitcnt lgkmcnt(2)
  v_mfma_f32_16x16x32_bf16 v[52:55], a[244:247], a[20:23], v[52:55]
  s_add_u32 m0, s27, 21216
  s_nop 0
  buffer_load_dwordx4 v120, s[12:15], s44 offen offset:3072 nt lds
  v_mfma_f32_16x16x32_bf16 v[60:63], a[244:247], a[52:55], v[60:63]
  v_mfma_f32_16x16x32_bf16 v[68:71], a[244:247], a[84:87], v[68:71]
  s_waitcnt lgkmcnt(1)
  v_mfma_f32_16x16x32_bf16 v[52:55], a[248:251], a[24:27], v[52:55]
  s_add_u32 s45, s28, 24576
  s_add_u32 m0, s27, 0
  s_nop 0
  buffer_load_dwordx4 v120, s[12:15], s45 offen offset:0 nt lds
  v_mfma_f32_16x16x32_bf16 v[60:63], a[248:251], a[56:59], v[60:63]
  v_mfma_f32_16x16x32_bf16 v[68:71], a[248:251], a[88:91], v[68:71]
  s_waitcnt lgkmcnt(0)
  v_mfma_f32_16x16x32_bf16 v[52:55], a[252:255], a[28:31], v[52:55]
  s_add_u32 m0, s27, 32
  s_nop 0
  buffer_load_dwordx4 v120, s[12:15], s45 offen offset:1024 nt lds
  v_mfma_f32_16x16x32_bf16 v[60:63], a[252:255], a[60:63], v[60:63]
  v_mfma_f32_16x16x32_bf16 v[68:71], a[252:255], a[92:95], v[68:71]
  s_waitcnt vmcnt(10)
  s_barrier
  ds_read_b128 a[96:99], v112 offset:25344
  ds_read_b128 a[100:103], v112 offset:25408
  ds_read_b128 a[104:107], v112 offset:25472
  ds_read_b128 a[108:111], v112 offset:25536
  ds_read_b128 a[112:115], v112 offset:25600
  ds_read_b128 a[116:119], v112 offset:25664
  ds_read_b128 a[120:123], v112 offset:25728
  ds_read_b128 a[124:127], v112 offset:25792
  ds_read_b128 a[128:131], v112 offset:33792
  ds_read_b128 a[132:135], v112 offset:33856
  ds_read_b128 a[136:139], v112 offset:33920
  ds_read_b128 a[140:143], v112 offset:33984
  ds_read_b128 a[144:147], v112 offset:34048
  ds_read_b128 a[148:151], v112 offset:34112
  ds_read_b128 a[152:155], v112 offset:34176
  ds_read_b128 a[156:159], v112 offset:34240
  ds_read_b128 a[160:163], v112 offset:42240
  ds_read_b128 a[164:167], v112 offset:42304
  ds_read_b128 a[168:171], v112 offset:42368
  ds_read_b128 a[172:175], v112 offset:42432
  ds_read_b128 a[176:179], v112 offset:42496
  ds_read_b128 a[180:183], v112 offset:42560
  ds_read_b128 a[184:187], v112 offset:42624
  ds_read_b128 a[188:191], v112 offset:42688
  s_waitcnt lgkmcnt(15)
  v_mfma_f32_16x16x32_bf16 v[24:27], a[192:195], a[96:99], 0
  s_waitcnt lgkmcnt(15)
  s_add_u32 m0, s27, 64
  s_nop 0
  buffer_load_dwordx4 v120, s[12:15], s45 offen offset:2048 nt lds
  v_mul_f32 v0, s25, v0
  v_mul_f32 v1, s25, v1
  v_mfma_f32_16x16x32_bf16 v[32:35], a[192:195], a[128:131], 0
  s_waitcnt lgkmcnt(7)
  v_exp_f32 v0, v0
  v_mul_f32 v2, s25, v2
  v_mfma_f32_16x16x32_bf16 v[40:43], a[192:195], a[160:163], 0
  v_exp_f32 v1, v1
  v_mul_f32 v3, s25, v3
  v_mfma_f32_16x16x32_bf16 v[76:79], a[224:227], a[96:99], 0
  v_exp_f32 v2, v2
  v_cvt_pk_bf16_f32 v0, v0, v1
  v_mfma_f32_16x16x32_bf16 v[84:87], a[224:227], a[128:131], 0
  v_mfma_f32_16x16x32_bf16 v[92:95], a[224:227], a[160:163], 0
  v_mfma_f32_16x16x32_bf16 v[24:27], a[196:199], a[100:103], v[24:27]
  s_add_u32 m0, s27, 96
  s_nop 0
  buffer_load_dwordx4 v120, s[12:15], s45 offen offset:3072 nt lds
  v_mul_f32 v52, s25, v52
  v_exp_f32 v3, v3
  v_mfma_f32_16x16x32_bf16 v[32:35], a[196:199], a[132:135], v[32:35]
  s_waitcnt lgkmcnt(6)
  v_mul_f32 v53, s25, v53
  v_exp_f32 v52, v52
  v_mfma_f32_16x16x32_bf16 v[40:43], a[196:199], a[164:167], v[40:43]
  v_cvt_pk_bf16_f32 v1, v2, v3
  v_mul_f32 v54, s25, v54
  v_mfma_f32_16x16x32_bf16 v[76:79], a[228:231], a[100:103], v[76:79]
  v_exp_f32 v53, v53
  v_mul_f32 v55, s25, v55
  v_mfma_f32_16x16x32_bf16 v[84:87], a[228:231], a[132:135], v[84:87]
  v_mfma_f32_16x16x32_bf16 v[92:95], a[228:231], a[164:167], v[92:95]
  v_mfma_f32_16x16x32_bf16 v[24:27], a[200:203], a[104:107], v[24:27]
  s_add_u32 s46, s28, 28672
  s_add_u32 m0, s27, 4224
  s_nop 0
  buffer_load_dwordx4 v120, s[12:15], s46 offen offset:0 nt lds
  v_exp_f32 v54, v54
  v_cvt_pk_bf16_f32 v2, v52, v53
  v_mfma_f32_16x16x32_bf16 v[32:35], a[200:203], a[136:139], v[32:35]
  s_waitcnt lgkmcnt(5)
  v_exp_f32 v55, v55
  s_nop 0
  v_mfma_f32_16x16x32_bf16 v[40:43], a[200:203], a[168:171], v[40:43]
  v_cvt_pk_bf16_f32 v3, v54, v55
  v_mul_f32 v8, s25, v8
  v_mfma_f32_16x16x32_bf16 v[76:79], a[232:235], a[104:107], v[76:79]
  v_mul_f32 v9, s25, v9
  v_exp_f32 v8, v8
  v_mfma_f32_16x16x32_bf16 v[84:87], a[232:235], a[136:139], v[84:87]
  v_mfma_f32_16x16x32_bf16 v[92:95], a[232:235], a[168:171], v[92:95]
  v_mfma_f32_16x16x32_bf16 v[24:27], a[204:207], a[108:111], v[24:27]
  s_add_u32 m0, s27, 4256
  s_nop 0
  buffer_load_dwordx4 v120, s[12:15], s46 offen offset:1024 nt lds
  v_mul_f32 v10, s25, v10
  v_exp_f32 v9, v9
  v_mfma_f32_16x16x32_bf16 v[32:35], a[204:207], a[140:143], v[32:35]
  s_waitcnt lgkmcnt(4)
  v_mul_f32 v11, s25, v11
  v_exp_f32 v10, v10
  v_mfma_f32_16x16x32_bf16 v[40:43], a[204:207], a[172:175], v[40:43]
  v_cvt_pk_bf16_f32 v8, v8, v9
  v_mul_f32 v60, s25, v60
  v_mfma_f32_16x16x32_bf16 v[76:79], a[236:239], a[108:111], v[76:79]
  v_exp_f32 v11, v11
  v_mul_f32 v61, s25, v61
  v_mfma_f32_16x16x32_bf16 v[84:87], a[236:239], a[140:143], v[84:87]
  v_mfma_f32_16x16x32_bf16 v[92:95], a[236:239], a[172:175], v[92:95]
  v_mfma_f32_16x16x32_bf16 v[24:27], a[208:211], a[112:115], v[24:27]
  s_add_u32 m0, s27, 4288
  s_nop 0
  buffer_load_dwordx4 v120, s[12:15], s46 offen offset:2048 nt lds
  v_exp_f32 v60, v60
  v_cvt_pk_bf16_f32 v9, v10, v11
  v_mfma_f32_16x16x32_bf16 v[32:35], a[208:211], a[144:147], v[32:35]
  s_waitcnt lgkmcnt(3)
  v_mul_f32 v62, s25, v62
  v_exp_f32 v61, v61
  v_mfma_f32_16x16x32_bf16 v[40:43], a[208:211], a[176:179], v[40:43]
  v_mul_f32 v63, s25, v63
  v_exp_f32 v62, v62
  v_mfma_f32_16x16x32_bf16 v[76:79], a[240:243], a[112:115], v[76:79]
  v_cvt_pk_bf16_f32 v10, v60, v61
  v_exp_f32 v63, v63
  v_mfma_f32_16x16x32_bf16 v[84:87], a[240:243], a[144:147], v[84:87]
  v_mfma_f32_16x16x32_bf16 v[92:95], a[240:243], a[176:179], v[92:95]
  v_mfma_f32_16x16x32_bf16 v[24:27], a[212:215], a[116:119], v[24:27]
  s_add_u32 m0, s27, 4320
  s_nop 0
  buffer_load_dwordx4 v120, s[12:15], s46 offen offset:3072 nt lds
  s_nop 0
  v_cvt_pk_bf16_f32 v11, v62, v63
  v_mfma_f32_16x16x32_bf16 v[32:35], a[212:215], a[148:151], v[32:35]
  s_waitcnt lgkmcnt(2)
  v_mul_f32 v16, s25, v16
  v_mul_f32 v17, s25, v17
  v_mfma_f32_16x16x32_bf16 v[40:43], a[212:215], a[180:183], v[40:43]
  v_exp_f32 v16, v16
  v_mul_f32 v18, s25, v18
  v_mfma_f32_16x16x32_bf16 v[76:79], a[244:247], a[116:119], v[76:79]
  v_exp_f32 v17, v17
  v_mul_f32 v19, s25, v19
  v_mfma_f32_16x16x32_bf16 v[84:87], a[244:247], a[148:151], v[84:87]
  v_mfma_f32_16x16x32_bf16 v[92:95], a[244:247], a[180:183], v[92:95]
  v_mfma_f32_16x16x32_bf16 v[24:27], a[216:219], a[120:123], v[24:27]
  s_add_u32 s47, s28, 32768
  s_add_u32 m0, s27, 8448
  s_nop 0
  buffer_load_dwordx4 v120, s[12:15], s47 offen offset:0 nt lds
  v_exp_f32 v18, v18
  v_cvt_pk_bf16_f32 v16, v16, v17
  v_mfma_f32_16x16x32_bf16 v[32:35], a[216:219], a[152:155], v[32:35]
  s_waitcnt lgkmcnt(1)
  v_mul_f32 v68, s25, v68
  v_exp_f32 v19, v19
  v_mfma_f32_16x16x32_bf16 v[40:43], a[216:219], a[184:187], v[40:43]
  v_mul_f32 v69, s25, v69
  v_exp_f32 v68, v68
  v_mfma_f32_16x16x32_bf16 v[76:79], a[248:251], a[120:123], v[76:79]
  v_cvt_pk_bf16_f32 v17, v18, v19
  v_mul_f32 v70, s25, v70
  v_mfma_f32_16x16x32_bf16 v[84:87], a[248:251], a[152:155], v[84:87]
  v_mfma_f32_16x16x32_bf16 v[92:95], a[248:251], a[184:187], v[92:95]
  v_mfma_f32_16x16x32_bf16 v[24:27], a[220:223], a[124:127], v[24:27]
  s_add_u32 m0, s27, 8480
  s_nop 0
  buffer_load_dwordx4 v120, s[12:15], s47 offen offset:1024 nt lds
  v_exp_f32 v69, v69
  v_mul_f32 v71, s25, v71
  v_mfma_f32_16x16x32_bf16 v[32:35], a[220:223], a[156:159], v[32:35]
  s_waitcnt lgkmcnt(0)
  v_exp_f32 v70, v70
  v_cvt_pk_bf16_f32 v18, v68, v69
  v_mfma_f32_16x16x32_bf16 v[40:43], a[220:223], a[188:191], v[40:43]
  v_exp_f32 v71, v71
  s_nop 0
  v_mfma_f32_16x16x32_bf16 v[76:79], a[252:255], a[124:127], v[76:79]
  v_cvt_pk_bf16_f32 v19, v70, v71
  v_mfma_f32_16x16x32_bf16 v[84:87], a[252:255], a[156:159], v[84:87]
  v_mfma_f32_16x16x32_bf16 v[92:95], a[252:255], a[188:191], v[92:95]
  s_waitcnt vmcnt(10)
  ds_read_b128 v[128:131], v121 offset:16896
  ds_read_b128 v[144:147], v121 offset:16960
  ds_read_b128 v[160:163], v121 offset:17024
  ds_read_b128 v[176:179], v121 offset:17088
  ds_read_b128 v[192:195], v121 offset:17152
  ds_read_b128 v[208:211], v121 offset:17216
  ds_read_b128 v[224:227], v121 offset:17280
  ds_read_b128 v[240:243], v121 offset:17344
  s_waitcnt lgkmcnt(7)
  v_mfma_f32_16x16x32_bf16 v[4:7], v[128:131], a[0:3], 0
  s_add_u32 m0, s27, 8512
  s_nop 0
  buffer_load_dwordx4 v120, s[12:15], s47 offen offset:2048 nt lds
  v_mul_f32 v24, s25, v24
  v_mul_f32 v25, s25, v25
  v_mfma_f32_16x16x32_bf16 v[12:15], v[128:131], a[32:35], 0
  v_exp_f32 v24, v24
  v_mul_f32 v26, s25, v26
  v_mfma_f32_16x16x32_bf16 v[20:23], v[128:131], a[64:67], 0
  v_exp_f32 v25, v25
  v_mul_f32 v27, s25, v27
  v_mfma_f32_16x16x32_bf16 v[28:31], v[128:131], a[96:99], 0
  v_exp_f32 v26, v26
  v_cvt_pk_bf16_f32 v24, v24, v25
  v_mfma_f32_16x16x32_bf16 v[36:39], v[128:131], a[128:131], 0
  v_mfma_f32_16x16x32_bf16 v[44:47], v[128:131], a[160:163], 0
  s_waitcnt lgkmcnt(6)
  v_mfma_f32_16x16x32_bf16 v[4:7], v[144:147], a[4:7], v[4:7]
  s_add_u32 m0, s27, 8544
  s_nop 0
  buffer_load_dwordx4 v120, s[12:15], s47 offen offset:3072 nt lds
  v_mul_f32 v76, s25, v76
  v_exp_f32 v27, v27
  v_mfma_f32_16x16x32_bf16 v[12:15], v[144:147], a[36:39], v[12:15]
  v_mul_f32 v77, s25, v77
  v_exp_f32 v76, v76
  v_mfma_f32_16x16x32_bf16 v[20:23], v[144:147], a[68:71], v[20:23]
  v_cvt_pk_bf16_f32 v25, v26, v27
  v_mul_f32 v78, s25, v78
  v_mfma_f32_16x16x32_bf16 v[28:31], v[144:147], a[100:103], v[28:31]
  v_exp_f32 v77, v77
  v_mul_f32 v79, s25, v79
  v_mfma_f32_16x16x32_bf16 v[36:39], v[144:147], a[132:135], v[36:39]
  v_mfma_f32_16x16x32_bf16 v[44:47], v[144:147], a[164:167], v[44:47]
  s_waitcnt lgkmcnt(5)
  v_mfma_f32_16x16x32_bf16 v[4:7], v[160:163], a[8:11], v[4:7]
  s_add_u32 s32, s28, 36864
  s_add_u32 m0, s27, 12672
  s_nop 0
  buffer_load_dwordx4 v120, s[12:15], s32 offen offset:0 nt lds
  v_exp_f32 v78, v78
  v_cvt_pk_bf16_f32 v26, v76, v77
  v_mfma_f32_16x16x32_bf16 v[12:15], v[160:163], a[40:43], v[12:15]
  v_exp_f32 v79, v79
  s_nop 0
  v_mfma_f32_16x16x32_bf16 v[20:23], v[160:163], a[72:75], v[20:23]
  v_cvt_pk_bf16_f32 v27, v78, v79
  v_mul_f32 v32, s25, v32
  v_mfma_f32_16x16x32_bf16 v[28:31], v[160:163], a[104:107], v[28:31]
  v_mul_f32 v33, s25, v33
  v_exp_f32 v32, v32
  v_mfma_f32_16x16x32_bf16 v[36:39], v[160:163], a[136:139], v[36:39]
  v_mfma_f32_16x16x32_bf16 v[44:47], v[160:163], a[168:171], v[44:47]
  s_waitcnt lgkmcnt(4)
  v_mfma_f32_16x16x32_bf16 v[4:7], v[176:179], a[12:15], v[4:7]
  s_add_u32 m0, s27, 12704
  s_nop 0
  buffer_load_dwordx4 v120, s[12:15], s32 offen offset:1024 nt lds
  v_mul_f32 v34, s25, v34
  v_exp_f32 v33, v33
  v_mfma_f32_16x16x32_bf16 v[12:15], v[176:179], a[44:47], v[12:15]
  v_mul_f32 v35, s25, v35
  v_exp_f32 v34, v34
  v_mfma_f32_16x16x32_bf16 v[20:23], v[176:179], a[76:79], v[20:23]
  v_cvt_pk_bf16_f32 v32, v32, v33
  v_mul_f32 v84, s25, v84
  v_mfma_f32_16x16x32_bf16 v[28:31], v[176:179], a[108:111], v[28:31]
  v_exp_f32 v35, v35
  v_mul_f32 v85, s25, v85
  v_mfma_f32_16x16x32_bf16 v[36:39], v[176:179], a[140:143], v[36:39]
  v_mfma_f32_16x16x32_bf16 v[44:47], v[176:179], a[172:175], v[44:47]
  s_waitcnt lgkmcnt(3)
  v_mfma_f32_16x16x32_bf16 v[4:7], v[192:195], a[16:19], v[4:7]
  s_add_u32 m0, s27, 12736
  s_nop 0
  buffer_load_dwordx4 v120, s[12:15], s32 offen offset:2048 nt lds
  v_exp_f32 v84, v84
  v_cvt_pk_bf16_f32 v33, v34, v35
  v_mfma_f32_16x16x32_bf16 v[12:15], v[192:195], a[48:51], v[12:15]
  v_mul_f32 v86, s25, v86
  v_exp_f32 v85, v85
  v_mfma_f32_16x16x32_bf16 v[20:23], v[192:195], a[80:83], v[20:23]
  v_mul_f32 v87, s25, v87
  v_exp_f32 v86, v86
  v_mfma_f32_16x16x32_bf16 v[28:31], v[192:195], a[112:115], v[28:31]
  v_cvt_pk_bf16_f32 v34, v84, v85
  v_exp_f32 v87, v87
  v_mfma_f32_16x16x32_bf16 v[36:39], v[192:195], a[144:147], v[36:39]
  v_mfma_f32_16x16x32_bf16 v[44:47], v[192:195], a[176:179], v[44:47]
  s_waitcnt lgkmcnt(2)
  v_mfma_f32_16x16x32_bf16 v[4:7], v[208:211], a[20:23], v[4:7]
  s_add_u32 m0, s27, 12768
  s_nop 0
  buffer_load_dwordx4 v120, s[12:15], s32 offen offset:3072 nt lds
  s_nop 0
  v_cvt_pk_bf16_f32 v35, v86, v87
  v_mfma_f32_16x16x32_bf16 v[12:15], v[208:211], a[52:55], v[12:15]
  v_mul_f32 v40, s25, v40
  v_mul_f32 v41, s25, v41
  v_mfma_f32_16x16x32_bf16 v[20:23], v[208:211], a[84:87], v[20:23]
  v_exp_f32 v40, v40
  v_mul_f32 v42, s25, v42
  v_mfma_f32_16x16x32_bf16 v[28:31], v[208:211], a[116:119], v[28:31]
  v_exp_f32 v41, v41
  v_mul_f32 v43, s25, v43
  v_mfma_f32_16x16x32_bf16 v[36:39], v[208:211], a[148:151], v[36:39]
  v_mfma_f32_16x16x32_bf16 v[44:47], v[208:211], a[180:183], v[44:47]
  s_waitcnt lgkmcnt(1)
  v_mfma_f32_16x16x32_bf16 v[4:7], v[224:227], a[24:27], v[4:7]
  s_waitcnt lgkmcnt(0)
  s_add_u32 s33, s28, 40960
  s_add_u32 m0, s27, 16896
  s_nop 0
  buffer_load_dwordx4 v120, s[12:15], s33 offen offset:0 nt lds
  v_exp_f32 v42, v42
  v_cvt_pk_bf16_f32 v40, v40, v41
  v_mfma_f32_16x16x32_bf16 v[12:15], v[224:227], a[56:59], v[12:15]
  v_mul_f32 v92, s25, v92
  v_exp_f32 v43, v43
  v_mfma_f32_16x16x32_bf16 v[20:23], v[224:227], a[88:91], v[20:23]
  v_mul_f32 v93, s25, v93
  v_exp_f32 v92, v92
  v_mfma_f32_16x16x32_bf16 v[28:31], v[224:227], a[120:123], v[28:31]
  v_cvt_pk_bf16_f32 v41, v42, v43
  v_mul_f32 v94, s25, v94
  v_mfma_f32_16x16x32_bf16 v[36:39], v[224:227], a[152:155], v[36:39]
  v_mfma_f32_16x16x32_bf16 v[44:47], v[224:227], a[184:187], v[44:47]
  v_mfma_f32_16x16x32_bf16 v[4:7], v[240:243], a[28:31], v[4:7]
  s_add_u32 m0, s27, 16928
  s_nop 0
  buffer_load_dwordx4 v120, s[12:15], s33 offen offset:1024 nt lds
  v_exp_f32 v93, v93
  v_mul_f32 v95, s25, v95
  v_mfma_f32_16x16x32_bf16 v[12:15], v[240:243], a[60:63], v[12:15]
  v_exp_f32 v94, v94
  v_cvt_pk_bf16_f32 v42, v92, v93
  v_mfma_f32_16x16x32_bf16 v[20:23], v[240:243], a[92:95], v[20:23]
  v_exp_f32 v95, v95
  s_nop 0
  v_mfma_f32_16x16x32_bf16 v[28:31], v[240:243], a[124:127], v[28:31]
  v_cvt_pk_bf16_f32 v43, v94, v95
  v_mfma_f32_16x16x32_bf16 v[36:39], v[240:243], a[156:159], v[36:39]
  v_mfma_f32_16x16x32_bf16 v[44:47], v[240:243], a[188:191], v[44:47]
  s_waitcnt vmcnt(10)
  ds_read_b128 v[132:135], v121 offset:0
  ds_read_b128 v[148:151], v121 offset:64
  ds_read_b128 v[164:167], v121 offset:128
  ds_read_b128 v[180:183], v121 offset:192
  ds_read_b128 v[196:199], v121 offset:256
  ds_read_b128 v[212:215], v121 offset:320
  ds_read_b128 v[228:231], v121 offset:384
  ds_read_b128 v[244:247], v121 offset:448
  s_waitcnt lgkmcnt(7)
  v_mfma_f32_16x16x32_bf16 v[52:55], v[132:135], a[0:3], 0
  s_add_u32 m0, s27, 16960
  s_nop 0
  buffer_load_dwordx4 v120, s[12:15], s33 offen offset:2048 nt lds
  v_mfma_f32_16x16x32_bf16 v[60:63], v[132:135], a[32:35], 0
  v_mfma_f32_16x16x32_bf16 v[68:71], v[132:135], a[64:67], 0
  v_mfma_f32_16x16x32_bf16 v[76:79], v[132:135], a[96:99], 0
  v_mfma_f32_16x16x32_bf16 v[84:87], v[132:135], a[128:131], 0
  v_mfma_f32_16x16x32_bf16 v[92:95], v[132:135], a[160:163], 0
  s_waitcnt lgkmcnt(6)
  v_mfma_f32_16x16x32_bf16 v[52:55], v[148:151], a[4:7], v[52:55]
  s_add_u32 m0, s27, 16992
  s_nop 0
  buffer_load_dwordx4 v120, s[12:15], s33 offen offset:3072 nt lds
  v_mfma_f32_16x16x32_bf16 v[60:63], v[148:151], a[36:39], v[60:63]
  v_mfma_f32_16x16x32_bf16 v[68:71], v[148:151], a[68:71], v[68:71]
  v_mfma_f32_16x16x32_bf16 v[76:79], v[148:151], a[100:103], v[76:79]
  v_mfma_f32_16x16x32_bf16 v[84:87], v[148:151], a[132:135], v[84:87]
  v_mfma_f32_16x16x32_bf16 v[92:95], v[148:151], a[164:167], v[92:95]
  s_waitcnt lgkmcnt(5)
  v_mfma_f32_16x16x32_bf16 v[52:55], v[164:167], a[8:11], v[52:55]
  s_add_u32 s34, s28, 45056
  s_add_u32 m0, s27, 21120
  s_nop 0
  buffer_load_dwordx4 v120, s[12:15], s34 offen offset:0 nt lds
  v_mfma_f32_16x16x32_bf16 v[60:63], v[164:167], a[40:43], v[60:63]
  v_mfma_f32_16x16x32_bf16 v[68:71], v[164:167], a[72:75], v[68:71]
  v_mfma_f32_16x16x32_bf16 v[76:79], v[164:167], a[104:107], v[76:79]
  v_mfma_f32_16x16x32_bf16 v[84:87], v[164:167], a[136:139], v[84:87]
  v_mfma_f32_16x16x32_bf16 v[92:95], v[164:167], a[168:171], v[92:95]
  s_waitcnt lgkmcnt(4)
  v_mfma_f32_16x16x32_bf16 v[52:55], v[180:183], a[12:15], v[52:55]
  s_add_u32 m0, s27, 21152
  s_nop 0
  buffer_load_dwordx4 v120, s[12:15], s34 offen offset:1024 nt lds
  v_mfma_f32_16x16x32_bf16 v[60:63], v[180:183], a[44:47], v[60:63]
  v_mfma_f32_16x16x32_bf16 v[68:71], v[180:183], a[76:79], v[68:71]
  v_mfma_f32_16x16x32_bf16 v[76:79], v[180:183], a[108:111], v[76:79]
  v_mfma_f32_16x16x32_bf16 v[84:87], v[180:183], a[140:143], v[84:87]
  v_mfma_f32_16x16x32_bf16 v[92:95], v[180:183], a[172:175], v[92:95]
  s_waitcnt lgkmcnt(3)
  v_mfma_f32_16x16x32_bf16 v[52:55], v[196:199], a[16:19], v[52:55]
  s_add_u32 m0, s27, 21184
  s_nop 0
  buffer_load_dwordx4 v120, s[12:15], s34 offen offset:2048 nt lds
  v_mfma_f32_16x16x32_bf16 v[60:63], v[196:199], a[48:51], v[60:63]
  v_mfma_f32_16x16x32_bf16 v[68:71], v[196:199], a[80:83], v[68:71]
  v_mfma_f32_16x16x32_bf16 v[76:79], v[196:199], a[112:115], v[76:79]
  v_mfma_f32_16x16x32_bf16 v[84:87], v[196:199], a[144:147], v[84:87]
  v_mfma_f32_16x16x32_bf16 v[92:95], v[196:199], a[176:179], v[92:95]
  s_waitcnt lgkmcnt(2)
  v_mfma_f32_16x16x32_bf16 v[52:55], v[212:215], a[20:23], v[52:55]
  s_add_u32 m0, s27, 21216
  s_nop 0
  buffer_load_dwordx4 v120, s[12:15], s34 offen offset:3072 nt lds
  v_mfma_f32_16x16x32_bf16 v[60:63], v[212:215], a[52:55], v[60:63]
  v_mfma_f32_16x16x32_bf16 v[68:71], v[212:215], a[84:87], v[68:71]
  v_mfma_f32_16x16x32_bf16 v[76:79], v[212:215], a[116:119], v[76:79]
  v_mfma_f32_16x16x32_bf16 v[84:87], v[212:215], a[148:151], v[84:87]
  v_mfma_f32_16x16x32_bf16 v[92:95], v[212:215], a[180:183], v[92:95]
  s_waitcnt lgkmcnt(1)
  v_mfma_f32_16x16x32_bf16 v[52:55], v[228:231], a[24:27], v[52:55]
  s_mov_b32 s35, 49152
  s_add_u32 m0, s26, 50688
  s_nop 0
  buffer_load_dwordx4 v118, s[8:11], s35 offen offset:0 nt lds
  v_mfma_f32_16x16x32_bf16 v[60:63], v[228:231], a[56:59], v[60:63]
  v_mfma_f32_16x16x32_bf16 v[68:71], v[228:231], a[88:91], v[68:71]
  v_mfma_f32_16x16x32_bf16 v[76:79], v[228:231], a[120:123], v[76:79]
  v_mfma_f32_16x16x32_bf16 v[84:87], v[228:231], a[152:155], v[84:87]
  v_mfma_f32_16x16x32_bf16 v[92:95], v[228:231], a[184:187], v[92:95]
  s_waitcnt lgkmcnt(0)
  v_mfma_f32_16x16x32_bf16 v[52:55], v[244:247], a[28:31], v[52:55]
  s_add_u32 m0, s26, 50720
  s_nop 0
  buffer_load_dwordx4 v118, s[8:11], s35 offen offset:1024 nt lds
  v_mfma_f32_16x16x32_bf16 v[60:63], v[244:247], a[60:63], v[60:63]
  v_mfma_f32_16x16x32_bf16 v[68:71], v[244:247], a[92:95], v[68:71]
  v_mfma_f32_16x16x32_bf16 v[76:79], v[244:247], a[124:127], v[76:79]
  v_mfma_f32_16x16x32_bf16 v[84:87], v[244:247], a[156:159], v[84:87]
  v_mfma_f32_16x16x32_bf16 v[92:95], v[244:247], a[188:191], v[92:95]
  s_waitcnt vmcnt(10)
  ds_read_b128 v[136:139], v121 offset:8448
  ds_read_b128 v[152:155], v121 offset:8512
  ds_read_b128 v[168:171], v121 offset:8576
  ds_read_b128 v[184:187], v121 offset:8640
  ds_read_b128 v[200:203], v121 offset:8704
  ds_read_b128 v[216:219], v121 offset:8768
  ds_read_b128 v[232:235], v121 offset:8832
  ds_read_b128 v[248:251], v121 offset:8896
  s_waitcnt lgkmcnt(7)
  v_mfma_f32_16x16x32_bf16 v[48:51], v[136:139], a[0:3], 0
  s_mov_b32 s36, 57344
  s_add_u32 m0, s26, 0
  s_nop 0
  buffer_load_dwordx4 v118, s[8:11], s36 offen offset:0 nt lds
  v_mul_f32 v4, s25, v4
  v_mul_f32 v5, s25, v5
  v_exp_f32 v4, v4
  v_mfma_f32_16x16x32_bf16 v[56:59], v[136:139], a[32:35], 0
  v_mul_f32 v6, s25, v6
  v_exp_f32 v5, v5
  v_mul_f32 v7, s25, v7
  v_mfma_f32_16x16x32_bf16 v[64:67], v[136:139], a[64:67], 0
  v_exp_f32 v6, v6
  v_cvt_pk_bf16_f32 v4, v4, v5
  v_mul_f32 v52, s25, v52
  v_mfma_f32_16x16x32_bf16 v[72:75], v[136:139], a[96:99], 0
  v_exp_f32 v7, v7
  v_mul_f32 v53, s25, v53
  v_exp_f32 v52, v52
  v_mfma_f32_16x16x32_bf16 v[80:83], v[136:139], a[128:131], 0
  v_cvt_pk_bf16_f32 v5, v6, v7
  v_mul_f32 v54, s25, v54
  v_exp_f32 v53, v53
  v_mfma_f32_16x16x32_bf16 v[88:91], v[136:139], a[160:163], 0
  s_waitcnt lgkmcnt(6)
  v_mul_f32 v55, s25, v55
  v_mfma_f32_16x16x32_bf16 v[48:51], v[152:155], a[4:7], v[48:51]
  s_add_u32 m0, s26, 32
  s_nop 0
  buffer_load_dwordx4 v118, s[8:11], s36 offen offset:1024 nt lds
  v_exp_f32 v54, v54
  v_cvt_pk_bf16_f32 v6, v52, v53
  v_exp_f32 v55, v55
  v_mfma_f32_16x16x32_bf16 v[56:59], v[152:155], a[36:39], v[56:59]
  s_nop 0
  v_cvt_pk_bf16_f32 v7, v54, v55
  v_mul_f32 v12, s25, v12
  v_mfma_f32_16x16x32_bf16 v[64:67], v[152:155], a[68:71], v[64:67]
  v_mul_f32 v13, s25, v13
  v_exp_f32 v12, v12
  v_mul_f32 v14, s25, v14
  v_mfma_f32_16x16x32_bf16 v[72:75], v[152:155], a[100:103], v[72:75]
  v_exp_f32 v13, v13
  v_mul_f32 v15, s25, v15
  v_exp_f32 v14, v14
  v_mfma_f32_16x16x32_bf16 v[80:83], v[152:155], a[132:135], v[80:83]
  v_cvt_pk_bf16_f32 v12, v12, v13
  v_mul_f32 v60, s25, v60
  v_exp_f32 v15, v15
  v_mfma_f32_16x16x32_bf16 v[88:91], v[152:155], a[164:167], v[88:91]
  s_waitcnt lgkmcnt(5)
  v_mul_f32 v61, s25, v61
  v_mfma_f32_16x16x32_bf16 v[48:51], v[168:171], a[8:11], v[48:51]
  v_exp_f32 v60, v60
  v_cvt_pk_bf16_f32 v13, v14, v15
  v_mul_f32 v62, s25, v62
  v_mfma_f32_16x16x32_bf16 v[56:59], v[168:171], a[40:43], v[56:59]
  v_exp_f32 v61, v61
  v_mul_f32 v63, s25, v63
  v_exp_f32 v62, v62
  v_mfma_f32_16x16x32_bf16 v[64:67], v[168:171], a[72:75], v[64:67]
  v_cvt_pk_bf16_f32 v14, v60, v61
  v_exp_f32 v63, v63
  s_nop 0
  v_mfma_f32_16x16x32_bf16 v[72:75], v[168:171], a[104:107], v[72:75]
  v_cvt_pk_bf16_f32 v15, v62, v63
  v_mul_f32 v20, s25, v20
  v_mul_f32 v21, s25, v21
  v_mfma_f32_16x16x32_bf16 v[80:83], v[168:171], a[136:139], v[80:83]
  v_exp_f32 v20, v20
  v_mul_f32 v22, s25, v22
  v_exp_f32 v21, v21
  v_mfma_f32_16x16x32_bf16 v[88:91], v[168:171], a[168:171], v[88:91]
  s_waitcnt lgkmcnt(4)
  v_mul_f32 v23, s25, v23
  v_mfma_f32_16x16x32_bf16 v[48:51], v[184:187], a[12:15], v[48:51]
  v_exp_f32 v22, v22
  v_cvt_pk_bf16_f32 v20, v20, v21
  v_mul_f32 v68, s25, v68
  v_mfma_f32_16x16x32_bf16 v[56:59], v[184:187], a[44:47], v[56:59]
  v_exp_f32 v23, v23
  v_mul_f32 v69, s25, v69
  v_exp_f32 v68, v68
  v_mfma_f32_16x16x32_bf16 v[64:67], v[184:187], a[76:79], v[64:67]
  v_cvt_pk_bf16_f32 v21, v22, v23
  v_mul_f32 v70, s25, v70
  v_exp_f32 v69, v69
  v_mfma_f32_16x16x32_bf16 v[72:75], v[184:187], a[108:111], v[72:75]
  v_mul_f32 v71, s25, v71
  v_exp_f32 v70, v70
  v_cvt_pk_bf16_f32 v22, v68, v69
  v_mfma_f32_16x16x32_bf16 v[80:83], v[184:187], a[140:143], v[80:83]
  v_exp_f32 v71, v71
  s_nop 0
  v_cvt_pk_bf16_f32 v23, v70, v71
  v_mfma_f32_16x16x32_bf16 v[88:91], v[184:187], a[172:175], v[88:91]
  s_waitcnt lgkmcnt(3)
  v_mul_f32 v28, s25, v28
  v_mfma_f32_16x16x32_bf16 v[48:51], v[200:203], a[16:19], v[48:51]
  v_mul_f32 v29, s25, v29
  v_exp_f32 v28, v28
  v_mul_f32 v30, s25, v30
  v_mfma_f32_16x16x32_bf16 v[56:59], v[200:203], a[48:51], v[56:59]
  v_exp_f32 v29, v29
  v_mul_f32 v31, s25, v31
  v_exp_f32 v30, v30
  v_mfma_f32_16x16x32_bf16 v[64:67], v[200:203], a[80:83], v[64:67]
  v_cvt_pk_bf16_f32 v28, v28, v29
  v_mul_f32 v76, s25, v76
  v_exp_f32 v31, v31
  v_mfma_f32_16x16x32_bf16 v[72:75], v[200:203], a[112:115], v[72:75]
  v_mul_f32 v77, s25, v77
  v_exp_f32 v76, v76
  v_cvt_pk_bf16_f32 v29, v30, v31
  v_mfma_f32_16x16x32_bf16 v[80:83], v[200:203], a[144:147], v[80:83]
  v_mul_f32 v78, s25, v78
  v_exp_f32 v77, v77
  v_mul_f32 v79, s25, v79
  v_mfma_f32_16x16x32_bf16 v[88:91], v[200:203], a[176:179], v[88:91]
  s_waitcnt lgkmcnt(2)
  v_exp_f32 v78, v78
  v_mfma_f32_16x16x32_bf16 v[48:51], v[216:219], a[20:23], v[48:51]
  v_cvt_pk_bf16_f32 v30, v76, v77
  v_exp_f32 v79, v79
  s_nop 0
  v_mfma_f32_16x16x32_bf16 v[56:59], v[216:219], a[52:55], v[56:59]
  v_cvt_pk_bf16_f32 v31, v78, v79
  v_mul_f32 v36, s25, v36
  v_mul_f32 v37, s25, v37
  v_mfma_f32_16x16x32_bf16 v[64:67], v[216:219], a[84:87], v[64:67]
  v_exp_f32 v36, v36
  v_mul_f32 v38, s25, v38
  v_exp_f32 v37, v37
  v_mfma_f32_16x16x32_bf16 v[72:75], v[216:219], a[116:119], v[72:75]
  v_mul_f32 v39, s25, v39
  v_exp_f32 v38, v38
  v_cvt_pk_bf16_f32 v36, v36, v37
  v_mfma_f32_16x16x32_bf16 v[80:83], v[216:219], a[148:151], v[80:83]
  v_mul_f32 v84, s25, v84
  v_exp_f32 v39, v39
  v_mul_f32 v85, s25, v85
  v_mfma_f32_16x16x32_bf16 v[88:91], v[216:219], a[180:183], v[88:91]
  s_waitcnt lgkmcnt(1)
  v_exp_f32 v84, v84
  v_mfma_f32_16x16x32_bf16 v[48:51], v[232:235], a[24:27], v[48:51]
  v_cvt_pk_bf16_f32 v37, v38, v39
  v_mul_f32 v86, s25, v86
  v_exp_f32 v85, v85
  v_mfma_f32_16x16x32_bf16 v[56:59], v[232:235], a[56:59], v[56:59]
  v_mul_f32 v87, s25, v87
  v_exp_f32 v86, v86
  v_cvt_pk_bf16_f32 v38, v84, v85
  v_mfma_f32_16x16x32_bf16 v[64:67], v[232:235], a[88:91], v[64:67]
  v_exp_f32 v87, v87
  s_nop 0
  v_cvt_pk_bf16_f32 v39, v86, v87
  v_mfma_f32_16x16x32_bf16 v[72:75], v[232:235], a[120:123], v[72:75]
  v_mul_f32 v44, s25, v44
  v_mul_f32 v45, s25, v45
  v_exp_f32 v44, v44
  v_mfma_f32_16x16x32_bf16 v[80:83], v[232:235], a[152:155], v[80:83]
  v_mul_f32 v46, s25, v46
  v_exp_f32 v45, v45
  v_mul_f32 v47, s25, v47
  v_mfma_f32_16x16x32_bf16 v[88:91], v[232:235], a[184:187], v[88:91]
  s_waitcnt lgkmcnt(0)
  v_mfma_f32_16x16x32_bf16 v[48:51], v[248:251], a[28:31], v[48:51]
  v_exp_f32 v46, v46
  v_cvt_pk_bf16_f32 v44, v44, v45
  v_mul_f32 v92, s25, v92
  v_mfma_f32_16x16x32_bf16 v[56:59], v[248:251], a[60:63], v[56:59]
  v_exp_f32 v47, v47
  v_mul_f32 v93, s25, v93
  v_exp_f32 v92, v92
  v_mfma_f32_16x16x32_bf16 v[64:67], v[248:251], a[92:95], v[64:67]
  v_cvt_pk_bf16_f32 v45, v46, v47
  v_mul_f32 v94, s25, v94
  v_exp_f32 v93, v93
  v_mfma_f32_16x16x32_bf16 v[72:75], v[248:251], a[124:127], v[72:75]
  v_mul_f32 v95, s25, v95
  v_exp_f32 v94, v94
  v_cvt_pk_bf16_f32 v46, v92, v93
  v_mfma_f32_16x16x32_bf16 v[80:83], v[248:251], a[156:159], v[80:83]
  v_exp_f32 v95, v95
  s_nop 0
  v_cvt_pk_bf16_f32 v47, v94, v95
  v_mfma_f32_16x16x32_bf16 v[88:91], v[248:251], a[188:191], v[88:91]
  s_waitcnt vmcnt(4)
  ds_read_b128 v[140:143], v121 offset:16896
  ds_read_b128 v[156:159], v121 offset:16960
  ds_read_b128 v[172:175], v121 offset:17024
  ds_read_b128 v[188:191], v121 offset:17088
  ds_read_b128 v[204:207], v121 offset:17152
  ds_read_b128 v[220:223], v121 offset:17216
  ds_read_b128 v[236:239], v121 offset:17280
  ds_read_b128 v[252:255], v121 offset:17344
  s_waitcnt lgkmcnt(0)
  s_barrier
  v_mfma_f32_16x16x32_bf16 v[52:55], v[140:143], a[0:3], 0
  s_mov_b32 s37, 65536
  v_mul_f32 v48, s25, v48
  v_mul_f32 v49, s25, v49
  v_mfma_f32_16x16x32_bf16 v[60:63], v[140:143], a[32:35], 0
  ds_write_b128 v113, v[0:3] offset:0
  s_add_u32 m0, s26, 8448
  v_exp_f32 v48, v48
  v_mfma_f32_16x16x32_bf16 v[68:71], v[140:143], a[64:67], 0
  buffer_load_dwordx4 v118, s[8:11], s37 offen offset:0 nt lds
  s_mov_b32 s38, 73728
  v_mul_f32 v50, s25, v50
  v_exp_f32 v49, v49
  v_mfma_f32_16x16x32_bf16 v[76:79], v[140:143], a[96:99], 0
  s_mov_b32 s39, 81920
  v_mul_f32 v51, s25, v51
  v_exp_f32 v50, v50
  v_mfma_f32_16x16x32_bf16 v[84:87], v[140:143], a[128:131], 0
  s_mov_b32 s40, 90112
  v_cvt_pk_bf16_f32 v48, v48, v49
  v_exp_f32 v51, v51
  v_mfma_f32_16x16x32_bf16 v[92:95], v[140:143], a[160:163], 0
  s_add_u32 m0, s26, 8480
  v_mul_f32 v56, s25, v56
  v_mul_f32 v57, s25, v57
  v_mfma_f32_16x16x32_bf16 v[52:55], v[156:159], a[4:7], v[52:55]
  s_mov_b32 s41, 98304
  v_cvt_pk_bf16_f32 v49, v50, v51
  v_exp_f32 v56, v56
  v_mfma_f32_16x16x32_bf16 v[60:63], v[156:159], a[36:39], v[60:63]
  buffer_load_dwordx4 v118, s[8:11], s37 offen offset:1024 nt lds
  v_mul_f32 v58, s25, v58
  v_exp_f32 v57, v57
  v_mfma_f32_16x16x32_bf16 v[68:71], v[156:159], a[68:71], v[68:71]
  ds_write_b128 v113, v[4:7] offset:1024
  v_mul_f32 v59, s25, v59
  v_exp_f32 v58, v58
  v_mfma_f32_16x16x32_bf16 v[76:79], v[156:159], a[100:103], v[76:79]
  v_cvt_pk_bf16_f32 v56, v56, v57
  v_exp_f32 v59, v59
  v_mfma_f32_16x16x32_bf16 v[84:87], v[156:159], a[132:135], v[84:87]
  v_mul_f32 v64, s25, v64
  v_mul_f32 v65, s25, v65
  v_mfma_f32_16x16x32_bf16 v[92:95], v[156:159], a[164:167], v[92:95]
  s_add_u32 m0, s26, 16896
  v_cvt_pk_bf16_f32 v57, v58, v59
  v_exp_f32 v64, v64
  v_mfma_f32_16x16x32_bf16 v[52:55], v[172:175], a[8:11], v[52:55]
  v_mul_f32 v66, s25, v66
  v_exp_f32 v65, v65
  v_mfma_f32_16x16x32_bf16 v[60:63], v[172:175], a[40:43], v[60:63]
  buffer_load_dwordx4 v118, s[8:11], s38 offen offset:0 nt lds
  v_mul_f32 v67, s25, v67
  v_exp_f32 v66, v66
  v_mfma_f32_16x16x32_bf16 v[68:71], v[172:175], a[72:75], v[68:71]
  v_cvt_pk_bf16_f32 v64, v64, v65
  v_exp_f32 v67, v67
  v_mfma_f32_16x16x32_bf16 v[76:79], v[172:175], a[104:107], v[76:79]
  ds_write_b128 v113, v[8:11] offset:12288
  v_mul_f32 v72, s25, v72
  v_mul_f32 v73, s25, v73
  v_mfma_f32_16x16x32_bf16 v[84:87], v[172:175], a[136:139], v[84:87]
  v_cvt_pk_bf16_f32 v65, v66, v67
  v_exp_f32 v72, v72
  v_mfma_f32_16x16x32_bf16 v[92:95], v[172:175], a[168:171], v[92:95]
  s_add_u32 m0, s26, 16928
  v_mul_f32 v74, s25, v74
  v_exp_f32 v73, v73
  v_mfma_f32_16x16x32_bf16 v[52:55], v[188:191], a[12:15], v[52:55]
  v_mul_f32 v75, s25, v75
  v_exp_f32 v74, v74
  v_mfma_f32_16x16x32_bf16 v[60:63], v[188:191], a[44:47], v[60:63]
  buffer_load_dwordx4 v118, s[8:11], s38 offen offset:1024 nt lds
  v_cvt_pk_bf16_f32 v72, v72, v73
  v_exp_f32 v75, v75
  v_mfma_f32_16x16x32_bf16 v[68:71], v[188:191], a[76:79], v[68:71]
  v_mul_f32 v80, s25, v80
  v_mul_f32 v81, s25, v81
  v_mfma_f32_16x16x32_bf16 v[76:79], v[188:191], a[108:111], v[76:79]
  v_cvt_pk_bf16_f32 v73, v74, v75
  v_exp_f32 v80, v80
  v_mfma_f32_16x16x32_bf16 v[84:87], v[188:191], a[140:143], v[84:87]
  ds_write_b128 v113, v[12:15] offset:13312
  v_mul_f32 v82, s25, v82
  v_exp_f32 v81, v81
  v_mfma_f32_16x16x32_bf16 v[92:95], v[188:191], a[172:175], v[92:95]
  s_add_u32 m0, s26, 25344
  v_mul_f32 v83, s25, v83
  v_exp_f32 v82, v82
  v_mfma_f32_16x16x32_bf16 v[52:55], v[204:207], a[16:19], v[52:55]
  v_cvt_pk_bf16_f32 v80, v80, v81
  v_exp_f32 v83, v83
  v_mfma_f32_16x16x32_bf16 v[60:63], v[204:207], a[48:51], v[60:63]
  buffer_load_dwordx4 v118, s[8:11], s39 offen offset:0 nt lds
  v_mul_f32 v88, s25, v88
  v_mul_f32 v89, s25, v89
  v_mfma_f32_16x16x32_bf16 v[68:71], v[204:207], a[80:83], v[68:71]
  s_waitcnt vmcnt(7)
  s_barrier
  v_cvt_pk_bf16_f32 v81, v82, v83
  v_exp_f32 v88, v88
  v_mfma_f32_16x16x32_bf16 v[76:79], v[204:207], a[112:115], v[76:79]
  ds_read_b128 v[96:99], v112 offset:50688
  v_mul_f32 v90, s25, v90
  v_exp_f32 v89, v89
  v_mfma_f32_16x16x32_bf16 v[84:87], v[204:207], a[144:147], v[84:87]
  ds_read_b128 v[100:103], v112 offset:50752
  v_mul_f32 v91, s25, v91
  v_exp_f32 v90, v90
  v_mfma_f32_16x16x32_bf16 v[92:95], v[204:207], a[176:179], v[92:95]
  ds_write_b128 v113, v[16:19] offset:24576
  s_add_u32 m0, s26, 25376
  v_cvt_pk_bf16_f32 v88, v88, v89
  v_exp_f32 v91, v91
  v_mfma_f32_16x16x32_bf16 v[52:55], v[220:223], a[20:23], v[52:55]
  ds_read_b128 v[104:107], v112 offset:50816
  v_cvt_pk_bf16_f32 v89, v90, v91
  v_mfma_f32_16x16x32_bf16 v[60:63], v[220:223], a[52:55], v[60:63]
  buffer_load_dwordx4 v118, s[8:11], s39 offen offset:1024 nt lds
  v_mfma_f32_16x16x32_bf16 v[68:71], v[220:223], a[84:87], v[68:71]
  v_mfma_f32_16x16x32_bf16 v[76:79], v[220:223], a[116:119], v[76:79]
  v_mfma_f32_16x16x32_bf16 v[84:87], v[220:223], a[148:151], v[84:87]
  v_mfma_f32_16x16x32_bf16 v[92:95], v[220:223], a[180:183], v[92:95]
  s_add_u32 m0, s26, 33792
  v_mfma_f32_16x16x32_bf16 v[52:55], v[236:239], a[24:27], v[52:55]
  ds_write_b128 v113, v[20:23] offset:25600
  v_mfma_f32_16x16x32_bf16 v[60:63], v[236:239], a[56:59], v[60:63]
  buffer_load_dwordx4 v118, s[8:11], s40 offen offset:0 nt lds
  v_mfma_f32_16x16x32_bf16 v[68:71], v[236:239], a[88:91], v[68:71]
  v_mfma_f32_16x16x32_bf16 v[76:79], v[236:239], a[120:123], v[76:79]
  v_mfma_f32_16x16x32_bf16 v[84:87], v[236:239], a[152:155], v[84:87]
  v_mfma_f32_16x16x32_bf16 v[92:95], v[236:239], a[184:187], v[92:95]
  s_add_u32 m0, s26, 33824
  v_mfma_f32_16x16x32_bf16 v[52:55], v[252:255], a[28:31], v[52:55]
  v_mfma_f32_16x16x32_bf16 v[60:63], v[252:255], a[60:63], v[60:63]
  buffer_load_dwordx4 v118, s[8:11], s40 offen offset:1024 nt lds
  v_mfma_f32_16x16x32_bf16 v[68:71], v[252:255], a[92:95], v[68:71]
  ds_write_b128 v113, v[24:27] offset:36864
  v_mfma_f32_16x16x32_bf16 v[76:79], v[252:255], a[124:127], v[76:79]
  v_mfma_f32_16x16x32_bf16 v[84:87], v[252:255], a[156:159], v[84:87]
  v_mfma_f32_16x16x32_bf16 v[92:95], v[252:255], a[188:191], v[92:95]
  s_waitcnt lgkmcnt(5)
  s_add_u32 m0, s26, 42240
  v_mul_f32 v52, s25, v52
  v_mul_f32 v53, s25, v53
  v_mfma_f32_16x16x32_bf16 v[0:3], a[192:195], v[96:99], 0
  v_exp_f32 v52, v52
  v_mfma_f32_16x16x32_bf16 v[4:7], a[224:227], v[96:99], 0
  buffer_load_dwordx4 v118, s[8:11], s41 offen offset:0 nt lds
  v_mul_f32 v54, s25, v54
  v_exp_f32 v53, v53
  v_mfma_f32_16x16x32_bf16 v[8:11], v[128:131], v[96:99], 0
  ds_write_b128 v113, v[28:31] offset:37888
  v_mul_f32 v55, s25, v55
  v_cvt_pk_bf16_f32 v50, v52, v53
  v_mfma_f32_16x16x32_bf16 v[12:15], v[132:135], v[96:99], 0
  v_exp_f32 v54, v54
  v_mfma_f32_16x16x32_bf16 v[16:19], v[136:139], v[96:99], 0
  v_exp_f32 v55, v55
  v_mfma_f32_16x16x32_bf16 v[20:23], v[140:143], v[96:99], 0
  s_waitcnt lgkmcnt(5)
  ds_read_b128 v[96:99], v112 offset:50880
  s_add_u32 m0, s26, 42272
  v_mul_f32 v60, s25, v60
  v_mfma_f32_16x16x32_bf16 v[0:3], a[196:199], v[100:103], v[0:3]
  v_mul_f32 v61, s25, v61
  v_cvt_pk_bf16_f32 v51, v54, v55
  v_mfma_f32_16x16x32_bf16 v[4:7], a[228:231], v[100:103], v[4:7]
  buffer_load_dwordx4 v118, s[8:11], s41 offen offset:1024 nt lds
  v_exp_f32 v60, v60
  v_mfma_f32_16x16x32_bf16 v[8:11], v[144:147], v[100:103], v[8:11]
  ds_write_b128 v113, v[48:51] offset:2048
  v_mul_f32 v62, s25, v62
  v_mul_f32 v63, s25, v63
  v_mfma_f32_16x16x32_bf16 v[12:15], v[148:151], v[100:103], v[12:15]
  ds_write_b128 v114, v[32:35] offset:0
  v_exp_f32 v61, v61
  v_mfma_f32_16x16x32_bf16 v[16:19], v[152:155], v[100:103], v[16:19]
  v_exp_f32 v62, v62
  v_mfma_f32_16x16x32_bf16 v[20:23], v[156:159], v[100:103], v[20:23]
  s_waitcnt lgkmcnt(6)
  ds_read_b128 v[100:103], v112 offset:50944
  v_cvt_pk_bf16_f32 v58, v60, v61
  v_mfma_f32_16x16x32_bf16 v[0:3], a[200:203], v[104:107], v[0:3]
  v_exp_f32 v63, v63
  v_mfma_f32_16x16x32_bf16 v[4:7], a[232:235], v[104:107], v[4:7]
  v_mul_f32 v68, s25, v68
  v_mul_f32 v69, s25, v69
  v_mfma_f32_16x16x32_bf16 v[8:11], v[160:163], v[104:107], v[8:11]
  v_cvt_pk_bf16_f32 v59, v62, v63
  v_mul_f32 v70, s25, v70
  v_mfma_f32_16x16x32_bf16 v[12:15], v[164:167], v[104:107], v[12:15]
  ds_write_b128 v113, v[56:59] offset:14336
  v_exp_f32 v68, v68
  v_mfma_f32_16x16x32_bf16 v[16:19], v[168:171], v[104:107], v[16:19]
  ds_write_b128 v114, v[36:39] offset:1024
  v_exp_f32 v69, v69
  v_mfma_f32_16x16x32_bf16 v[20:23], v[172:175], v[104:107], v[20:23]
  s_waitcnt lgkmcnt(5)
  ds_read_b128 v[104:107], v112 offset:51008
  v_mul_f32 v71, s25, v71
  v_mfma_f32_16x16x32_bf16 v[0:3], a[204:207], v[96:99], v[0:3]
  v_exp_f32 v70, v70
  v_mfma_f32_16x16x32_bf16 v[4:7], a[236:239], v[96:99], v[4:7]
  v_cvt_pk_bf16_f32 v66, v68, v69
  v_mul_f32 v76, s25, v76
  v_mfma_f32_16x16x32_bf16 v[8:11], v[176:179], v[96:99], v[8:11]
  v_exp_f32 v71, v71
  v_mfma_f32_16x16x32_bf16 v[12:15], v[180:183], v[96:99], v[12:15]
  v_mul_f32 v77, s25, v77
  v_cvt_pk_bf16_f32 v67, v70, v71
  v_mfma_f32_16x16x32_bf16 v[16:19], v[184:187], v[96:99], v[16:19]
  ds_write_b128 v113, v[64:67] offset:26624
  v_exp_f32 v76, v76
  v_mfma_f32_16x16x32_bf16 v[20:23], v[188:191], v[96:99], v[20:23]
  s_waitcnt lgkmcnt(4)
  ds_write_b128 v114, v[40:43] offset:12288
  v_mul_f32 v78, s25, v78
  v_mul_f32 v79, s25, v79
  v_mfma_f32_16x16x32_bf16 v[0:3], a[208:211], v[100:103], v[0:3]
  ds_read_b128 v[96:99], v112 offset:51072
  v_mul_f32 v84, s25, v84
  v_mfma_f32_16x16x32_bf16 v[4:7], a[240:243], v[100:103], v[4:7]
  v_exp_f32 v77, v77
  v_mfma_f32_16x16x32_bf16 v[8:11], v[192:195], v[100:103], v[8:11]
  v_exp_f32 v78, v78
  v_mfma_f32_16x16x32_bf16 v[12:15], v[196:199], v[100:103], v[12:15]
  v_cvt_pk_bf16_f32 v74, v76, v77
  v_mul_f32 v85, s25, v85
  v_mfma_f32_16x16x32_bf16 v[16:19], v[200:203], v[100:103], v[16:19]
  s_waitcnt vmcnt(10)
  s_barrier
  v_exp_f32 v79, v79
  v_mfma_f32_16x16x32_bf16 v[20:23], v[204:207], v[100:103], v[20:23]
  s_waitcnt lgkmcnt(3)
  ds_read_b128 v[100:103], v112 offset:51136
  v_cvt_pk_bf16_f32 v75, v78, v79
  v_mfma_f32_16x16x32_bf16 v[0:3], a[212:215], v[104:107], v[0:3]
  ds_write_b128 v114, v[44:47] offset:13312
  v_exp_f32 v84, v84
  v_mfma_f32_16x16x32_bf16 v[4:7], a[244:247], v[104:107], v[4:7]
  ds_write_b128 v113, v[72:75] offset:38912
  v_mul_f32 v86, s25, v86
  v_mul_f32 v87, s25, v87
  v_mfma_f32_16x16x32_bf16 v[8:11], v[208:211], v[104:107], v[8:11]
  v_exp_f32 v85, v85
  v_mfma_f32_16x16x32_bf16 v[12:15], v[212:215], v[104:107], v[12:15]
  v_exp_f32 v86, v86
  v_mfma_f32_16x16x32_bf16 v[16:19], v[216:219], v[104:107], v[16:19]
  v_cvt_pk_bf16_f32 v82, v84, v85
  v_mul_f32 v92, s25, v92
  v_mfma_f32_16x16x32_bf16 v[20:23], v[220:223], v[104:107], v[20:23]
  s_waitcnt lgkmcnt(3)
  ds_read_b128 v[104:107], v112 offset:0
  v_mul_f32 v93, s25, v93
  v_mfma_f32_16x16x32_bf16 v[0:3], a[216:219], v[96:99], v[0:3]
  v_exp_f32 v87, v87
  v_mfma_f32_16x16x32_bf16 v[4:7], a[248:251], v[96:99], v[4:7]
  v_cvt_pk_bf16_f32 v83, v86, v87
  v_mul_f32 v94, s25, v94
  v_mfma_f32_16x16x32_bf16 v[8:11], v[224:227], v[96:99], v[8:11]
  ds_write_b128 v114, v[80:83] offset:2048
  v_exp_f32 v92, v92
  v_mfma_f32_16x16x32_bf16 v[12:15], v[228:231], v[96:99], v[12:15]
  v_exp_f32 v93, v93
  v_mfma_f32_16x16x32_bf16 v[16:19], v[232:235], v[96:99], v[16:19]
  v_mul_f32 v95, s25, v95
  v_cvt_pk_bf16_f32 v90, v92, v93
  v_mfma_f32_16x16x32_bf16 v[20:23], v[236:239], v[96:99], v[20:23]
  s_waitcnt lgkmcnt(4)
  ds_read_b128 v[96:99], v112 offset:64
  v_mfma_f32_16x16x32_bf16 v[0:3], a[220:223], v[100:103], v[0:3]
  v_exp_f32 v94, v94
  v_mfma_f32_16x16x32_bf16 v[4:7], a[252:255], v[100:103], v[4:7]
  v_exp_f32 v95, v95
  v_mfma_f32_16x16x32_bf16 v[8:11], v[240:243], v[100:103], v[8:11]
  v_cvt_pk_bf16_f32 v91, v94, v95
  v_mfma_f32_16x16x32_bf16 v[12:15], v[244:247], v[100:103], v[12:15]
  ds_write_b128 v114, v[88:91] offset:14336
  v_mfma_f32_16x16x32_bf16 v[16:19], v[248:251], v[100:103], v[16:19]
  v_mul_f32 v0, s25, v0
  v_mul_f32 v1, s25, v1
  v_mfma_f32_16x16x32_bf16 v[20:23], v[252:255], v[100:103], v[20:23]
  s_waitcnt lgkmcnt(3)
  ds_read_b128 v[100:103], v112 offset:128
  v_mul_f32 v2, s25, v2
  v_mfma_f32_16x16x32_bf16 v[24:27], a[192:195], v[104:107], 0
  v_exp_f32 v0, v0
  v_mfma_f32_16x16x32_bf16 v[28:31], a[224:227], v[104:107], 0
  v_exp_f32 v1, v1
  v_mfma_f32_16x16x32_bf16 v[32:35], v[128:131], v[104:107], 0
  v_mul_f32 v3, s25, v3
  v_mul_f32 v4, s25, v4
  v_mfma_f32_16x16x32_bf16 v[36:39], v[132:135], v[104:107], 0
  v_exp_f32 v2, v2
  v_mfma_f32_16x16x32_bf16 v[40:43], v[136:139], v[104:107], 0
  v_cvt_pk_bf16_f32 v0, v0, v1
  v_mul_f32 v5, s25, v5
  v_mfma_f32_16x16x32_bf16 v[44:47], v[140:143], v[104:107], 0
  s_waitcnt lgkmcnt(2)
  ds_read_b128 v[104:107], v112 offset:192
  v_mul_f32 v6, s25, v6
  v_mfma_f32_16x16x32_bf16 v[24:27], a[196:199], v[96:99], v[24:27]
  v_exp_f32 v3, v3
  v_mfma_f32_16x16x32_bf16 v[28:31], a[228:231], v[96:99], v[28:31]
  v_exp_f32 v4, v4
  v_mfma_f32_16x16x32_bf16 v[32:35], v[144:147], v[96:99], v[32:35]
  v_cvt_pk_bf16_f32 v1, v2, v3
  v_mul_f32 v7, s25, v7
  v_mfma_f32_16x16x32_bf16 v[36:39], v[148:151], v[96:99], v[36:39]
  v_exp_f32 v5, v5
  v_mfma_f32_16x16x32_bf16 v[40:43], v[152:155], v[96:99], v[40:43]
  v_exp_f32 v6, v6
  v_mfma_f32_16x16x32_bf16 v[44:47], v[156:159], v[96:99], v[44:47]
  s_waitcnt lgkmcnt(1)
  ds_read_b128 v[96:99], v112 offset:256
  v_cvt_pk_bf16_f32 v2, v4, v5
  v_mfma_f32_16x16x32_bf16 v[24:27], a[200:203], v[100:103], v[24:27]
  v_exp_f32 v7, v7
  v_mfma_f32_16x16x32_bf16 v[28:31], a[232:235], v[100:103], v[28:31]
  v_mul_f32 v8, s25, v8
  v_cvt_pk_bf16_f32 v3, v6, v7
  v_mfma_f32_16x16x32_bf16 v[32:35], v[160:163], v[100:103], v[32:35]
  ds_write_b128 v114, v[0:3] offset:24576
  v_mul_f32 v9, s25, v9
  v_mul_f32 v10, s25, v10
  v_mfma_f32_16x16x32_bf16 v[36:39], v[164:167], v[100:103], v[36:39]
  v_exp_f32 v8, v8
  v_mfma_f32_16x16x32_bf16 v[40:43], v[168:171], v[100:103], v[40:43]
  v_exp_f32 v9, v9
  v_mfma_f32_16x16x32_bf16 v[44:47], v[172:175], v[100:103], v[44:47]
  s_waitcnt lgkmcnt(2)
  ds_read_b128 v[100:103], v112 offset:320
  v_mul_f32 v11, s25, v11
  v_mfma_f32_16x16x32_bf16 v[24:27], a[204:207], v[104:107], v[24:27]
  v_exp_f32 v10, v10
  v_mfma_f32_16x16x32_bf16 v[28:31], a[236:239], v[104:107], v[28:31]
  v_mul_f32 v12, s25, v12
  v_cvt_pk_bf16_f32 v8, v8, v9
  v_mfma_f32_16x16x32_bf16 v[32:35], v[176:179], v[104:107], v[32:35]
  v_exp_f32 v11, v11
  v_mfma_f32_16x16x32_bf16 v[36:39], v[180:183], v[104:107], v[36:39]
  v_mul_f32 v13, s25, v13
  v_mul_f32 v14, s25, v14
  v_mfma_f32_16x16x32_bf16 v[40:43], v[184:187], v[104:107], v[40:43]
  v_exp_f32 v12, v12
  v_mfma_f32_16x16x32_bf16 v[44:47], v[188:191], v[104:107], v[44:47]
  s_waitcnt lgkmcnt(2)
  ds_read_b128 v[104:107], v112 offset:384
  v_cvt_pk_bf16_f32 v9, v10, v11
  v_mfma_f32_16x16x32_bf16 v[24:27], a[208:211], v[96:99], v[24:27]
  v_exp_f32 v13, v13
  v_mfma_f32_16x16x32_bf16 v[28:31], a[240:243], v[96:99], v[28:31]
  v_mul_f32 v15, s25, v15
  v_cvt_pk_bf16_f32 v10, v12, v13
  v_mfma_f32_16x16x32_bf16 v[32:35], v[192:195], v[96:99], v[32:35]
  v_exp_f32 v14, v14
  v_mfma_f32_16x16x32_bf16 v[36:39], v[196:199], v[96:99], v[36:39]
  v_exp_f32 v15, v15
  v_mfma_f32_16x16x32_bf16 v[40:43], v[200:203], v[96:99], v[40:43]
  s_waitcnt vmcnt(8)
  s_barrier
  v_mul_f32 v16, s25, v16
  v_cvt_pk_bf16_f32 v11, v14, v15
  v_mfma_f32_16x16x32_bf16 v[44:47], v[204:207], v[96:99], v[44:47]
  s_waitcnt lgkmcnt(1)
  ds_read_b128 v[96:99], v112 offset:448
  v_mul_f32 v17, s25, v17
  v_mfma_f32_16x16x32_bf16 v[24:27], a[212:215], v[100:103], v[24:27]
  ds_write_b128 v114, v[8:11] offset:25600
  v_exp_f32 v16, v16
  v_mfma_f32_16x16x32_bf16 v[28:31], a[244:247], v[100:103], v[28:31]
  v_mul_f32 v18, s25, v18
  v_mul_f32 v19, s25, v19
  v_mfma_f32_16x16x32_bf16 v[32:35], v[208:211], v[100:103], v[32:35]
  v_exp_f32 v17, v17
  v_mfma_f32_16x16x32_bf16 v[36:39], v[212:215], v[100:103], v[36:39]
  v_exp_f32 v18, v18
  v_mfma_f32_16x16x32_bf16 v[40:43], v[216:219], v[100:103], v[40:43]
  v_mul_f32 v20, s25, v20
  v_cvt_pk_bf16_f32 v16, v16, v17
  v_mfma_f32_16x16x32_bf16 v[44:47], v[220:223], v[100:103], v[44:47]
  s_waitcnt lgkmcnt(2)
  ds_read_b128 v[100:103], v112 offset:8448
  v_mul_f32 v21, s25, v21
  v_mfma_f32_16x16x32_bf16 v[24:27], a[216:219], v[104:107], v[24:27]
  v_exp_f32 v19, v19
  v_mfma_f32_16x16x32_bf16 v[28:31], a[248:251], v[104:107], v[28:31]
  v_exp_f32 v20, v20
  v_mfma_f32_16x16x32_bf16 v[32:35], v[224:227], v[104:107], v[32:35]
  v_mul_f32 v22, s25, v22
  v_cvt_pk_bf16_f32 v17, v18, v19
  v_mfma_f32_16x16x32_bf16 v[36:39], v[228:231], v[104:107], v[36:39]
  v_exp_f32 v21, v21
  v_mfma_f32_16x16x32_bf16 v[40:43], v[232:235], v[104:107], v[40:43]
  v_mul_f32 v23, s25, v23
  v_cvt_pk_bf16_f32 v18, v20, v21
  v_mfma_f32_16x16x32_bf16 v[44:47], v[236:239], v[104:107], v[44:47]
  s_waitcnt lgkmcnt(2)
  ds_read_b128 v[104:107], v112 offset:8512
  v_mfma_f32_16x16x32_bf16 v[24:27], a[220:223], v[96:99], v[24:27]
  v_exp_f32 v22, v22
  v_mfma_f32_16x16x32_bf16 v[28:31], a[252:255], v[96:99], v[28:31]
  v_exp_f32 v23, v23
  v_mfma_f32_16x16x32_bf16 v[32:35], v[240:243], v[96:99], v[32:35]
  v_cvt_pk_bf16_f32 v19, v22, v23
  v_mfma_f32_16x16x32_bf16 v[36:39], v[244:247], v[96:99], v[36:39]
  ds_write_b128 v114, v[16:19] offset:26624
  v_mfma_f32_16x16x32_bf16 v[40:43], v[248:251], v[96:99], v[40:43]
  v_mul_f32 v24, s25, v24
  v_mul_f32 v25, s25, v25
  v_mfma_f32_16x16x32_bf16 v[44:47], v[252:255], v[96:99], v[44:47]
  s_waitcnt lgkmcnt(2)
  ds_read_b128 v[96:99], v112 offset:8576
  v_mul_f32 v26, s25, v26
  v_mfma_f32_16x16x32_bf16 v[48:51], a[192:195], v[100:103], 0
  v_exp_f32 v24, v24
  v_mfma_f32_16x16x32_bf16 v[52:55], a[224:227], v[100:103], 0
  v_exp_f32 v25, v25
  v_mfma_f32_16x16x32_bf16 v[56:59], v[128:131], v[100:103], 0
  v_mul_f32 v27, s25, v27
  v_mul_f32 v28, s25, v28
  v_mfma_f32_16x16x32_bf16 v[60:63], v[132:135], v[100:103], 0
  v_exp_f32 v26, v26
  v_mfma_f32_16x16x32_bf16 v[64:67], v[136:139], v[100:103], 0
  v_cvt_pk_bf16_f32 v24, v24, v25
  v_mul_f32 v29, s25, v29
  v_mfma_f32_16x16x32_bf16 v[68:71], v[140:143], v[100:103], 0
  s_waitcnt lgkmcnt(2)
  ds_read_b128 v[100:103], v112 offset:8640
  v_mul_f32 v30, s25, v30
  v_mfma_f32_16x16x32_bf16 v[48:51], a[196:199], v[104:107], v[48:51]
  v_exp_f32 v27, v27
  v_mfma_f32_16x16x32_bf16 v[52:55], a[228:231], v[104:107], v[52:55]
  v_exp_f32 v28, v28
  v_mfma_f32_16x16x32_bf16 v[56:59], v[144:147], v[104:107], v[56:59]
  s_waitcnt vmcnt(4)
  s_barrier
  v_cvt_pk_bf16_f32 v25, v26, v27
  v_mul_f32 v31, s25, v31
  v_mfma_f32_16x16x32_bf16 v[60:63], v[148:151], v[104:107], v[60:63]
  s_mov_b32 s42, 106496
  v_exp_f32 v29, v29
  v_mfma_f32_16x16x32_bf16 v[64:67], v[152:155], v[104:107], v[64:67]
  s_add_u32 m0, s26, 50688
  v_exp_f32 v30, v30
  v_mfma_f32_16x16x32_bf16 v[68:71], v[156:159], v[104:107], v[68:71]
  s_waitcnt lgkmcnt(1)
  buffer_load_dwordx4 v118, s[8:11], s42 offen offset:0 nt lds
  s_mov_b32 s43, 114688
  v_cvt_pk_bf16_f32 v26, v28, v29
  v_mul_f32 v32, s25, v32
  v_mfma_f32_16x16x32_bf16 v[48:51], a[200:203], v[96:99], v[48:51]
  ds_read_b128 v[104:107], v112 offset:8704
  v_mul_f32 v33, s25, v33
  v_mfma_f32_16x16x32_bf16 v[52:55], a[232:235], v[96:99], v[52:55]
  v_exp_f32 v31, v31
  v_mfma_f32_16x16x32_bf16 v[56:59], v[160:163], v[96:99], v[56:59]
  ds_read_b128 a[0:3], v115 offset:0
  v_cvt_pk_bf16_f32 v27, v30, v31
  v_mfma_f32_16x16x32_bf16 v[60:63], v[164:167], v[96:99], v[60:63]
  ds_write_b128 v114, v[24:27] offset:36864
  v_exp_f32 v32, v32
  v_mfma_f32_16x16x32_bf16 v[64:67], v[168:171], v[96:99], v[64:67]
  v_mul_f32 v34, s25, v34
  v_mul_f32 v35, s25, v35
  v_mfma_f32_16x16x32_bf16 v[68:71], v[172:175], v[96:99], v[68:71]
  s_waitcnt lgkmcnt(3)
  ds_read_b128 v[96:99], v112 offset:8768
  v_mul_f32 v36, s25, v36
  v_mfma_f32_16x16x32_bf16 v[48:51], a[204:207], v[100:103], v[48:51]
  s_add_u32 m0, s26, 50720
  v_exp_f32 v33, v33
  v_mfma_f32_16x16x32_bf16 v[52:55], a[236:239], v[100:103], v[52:55]
  ds_read_b128 a[4:7], v115 offset:1024
  v_cvt_pk_bf16_f32 v32, v32, v33
  v_mfma_f32_16x16x32_bf16 v[56:59], v[176:179], v[100:103], v[56:59]
  buffer_load_dwordx4 v118, s[8:11], s42 offen offset:1024 nt lds
  v_exp_f32 v34, v34
  v_mfma_f32_16x16x32_bf16 v[60:63], v[180:183], v[100:103], v[60:63]
  v_exp_f32 v35, v35
  v_mfma_f32_16x16x32_bf16 v[64:67], v[184:187], v[100:103], v[64:67]
  v_mul_f32 v37, s25, v37
  v_mul_f32 v38, s25, v38
  v_mfma_f32_16x16x32_bf16 v[68:71], v[188:191], v[100:103], v[68:71]
  s_waitcnt lgkmcnt(4)
  ds_read_b128 v[100:103], v112 offset:8832
  v_cvt_pk_bf16_f32 v33, v34, v35
  v_mfma_f32_16x16x32_bf16 v[48:51], a[208:211], v[104:107], v[48:51]
  v_exp_f32 v36, v36
  v_mfma_f32_16x16x32_bf16 v[52:55], a[240:243], v[104:107], v[52:55]
  ds_read_b128 a[8:11], v115 offset:2048
  v_mul_f32 v39, s25, v39
  v_mfma_f32_16x16x32_bf16 v[56:59], v[192:195], v[104:107], v[56:59]
  v_exp_f32 v37, v37
  v_mfma_f32_16x16x32_bf16 v[60:63], v[196:199], v[104:107], v[60:63]
  v_exp_f32 v38, v38
  v_mfma_f32_16x16x32_bf16 v[64:67], v[200:203], v[104:107], v[64:67]
  s_add_u32 m0, s26, 0
  v_cvt_pk_bf16_f32 v34, v36, v37
  v_mul_f32 v40, s25, v40
  v_mfma_f32_16x16x32_bf16 v[68:71], v[204:207], v[104:107], v[68:71]
  s_waitcnt lgkmcnt(3)
  ds_read_b128 v[104:107], v112 offset:8896
  v_mul_f32 v41, s25, v41
  v_mfma_f32_16x16x32_bf16 v[48:51], a[212:215], v[96:99], v[48:51]
  buffer_load_dwordx4 v118, s[8:11], s43 offen offset:0 nt lds
  v_exp_f32 v39, v39
  v_mfma_f32_16x16x32_bf16 v[52:55], a[244:247], v[96:99], v[52:55]
  ds_read_b128 a[12:15], v115 offset:3072
  v_cvt_pk_bf16_f32 v35, v38, v39
  v_mfma_f32_16x16x32_bf16 v[56:59], v[208:211], v[96:99], v[56:59]
  ds_write_b128 v114, v[32:35] offset:37888
  v_exp_f32 v40, v40
  v_mfma_f32_16x16x32_bf16 v[60:63], v[212:215], v[96:99], v[60:63]
  v_mul_f32 v42, s25, v42
  v_mul_f32 v43, s25, v43
  v_mfma_f32_16x16x32_bf16 v[64:67], v[216:219], v[96:99], v[64:67]
  v_exp_f32 v41, v41
  v_mfma_f32_16x16x32_bf16 v[68:71], v[220:223], v[96:99], v[68:71]
  s_waitcnt lgkmcnt(4)
  ds_read_b128 v[96:99], v112 offset:16896
  v_mul_f32 v44, s25, v44
  v_mfma_f32_16x16x32_bf16 v[48:51], a[216:219], v[100:103], v[48:51]
  v_exp_f32 v42, v42
  v_mfma_f32_16x16x32_bf16 v[52:55], a[248:251], v[100:103], v[52:55]
  ds_read_b128 a[16:19], v115 offset:4096
  v_cvt_pk_bf16_f32 v40, v40, v41
  v_mfma_f32_16x16x32_bf16 v[56:59], v[224:227], v[100:103], v[56:59]
  s_add_u32 m0, s26, 32
  v_exp_f32 v43, v43
  v_mfma_f32_16x16x32_bf16 v[60:63], v[228:231], v[100:103], v[60:63]
  v_mul_f32 v45, s25, v45
  v_mul_f32 v46, s25, v46
  v_mfma_f32_16x16x32_bf16 v[64:67], v[232:235], v[100:103], v[64:67]
  buffer_load_dwordx4 v118, s[8:11], s43 offen offset:1024 nt lds
  v_exp_f32 v44, v44
  v_mfma_f32_16x16x32_bf16 v[68:71], v[236:239], v[100:103], v[68:71]
  s_waitcnt lgkmcnt(4)
  ds_read_b128 v[100:103], v112 offset:16960
  v_cvt_pk_bf16_f32 v41, v42, v43
  v_mfma_f32_16x16x32_bf16 v[48:51], a[220:223], v[104:107], v[48:51]
  v_exp_f32 v45, v45
  v_mfma_f32_16x16x32_bf16 v[52:55], a[252:255], v[104:107], v[52:55]
  ds_read_b128 a[20:23], v115 offset:5120
  v_mul_f32 v47, s25, v47
  v_mfma_f32_16x16x32_bf16 v[56:59], v[240:243], v[104:107], v[56:59]
  v_exp_f32 v46, v46
  v_mfma_f32_16x16x32_bf16 v[60:63], v[244:247], v[104:107], v[60:63]
  v_cvt_pk_bf16_f32 v42, v44, v45
  v_mul_f32 v48, s25, v48
  v_mfma_f32_16x16x32_bf16 v[64:67], v[248:251], v[104:107], v[64:67]
  v_exp_f32 v47, v47
  v_mfma_f32_16x16x32_bf16 v[68:71], v[252:255], v[104:107], v[68:71]
  s_waitcnt lgkmcnt(3)
  ds_read_b128 v[104:107], v112 offset:17024
  v_cvt_pk_bf16_f32 v43, v46, v47
  v_mfma_f32_16x16x32_bf16 v[72:75], a[192:195], v[96:99], 0
  ds_write_b128 v114, v[40:43] offset:38912
  v_mul_f32 v49, s25, v49
  v_mul_f32 v50, s25, v50
  v_mfma_f32_16x16x32_bf16 v[76:79], a[224:227], v[96:99], 0
  ds_read_b128 a[24:27], v115 offset:6144
  v_mul_f32 v51, s25, v51
  v_mfma_f32_16x16x32_bf16 v[80:83], v[128:131], v[96:99], 0
  v_exp_f32 v48, v48
  v_mfma_f32_16x16x32_bf16 v[84:87], v[132:135], v[96:99], 0
  v_exp_f32 v49, v49
  v_mfma_f32_16x16x32_bf16 v[88:91], v[136:139], v[96:99], 0
  v_exp_f32 v50, v50
  v_mfma_f32_16x16x32_bf16 v[92:95], v[140:143], v[96:99], 0
  s_waitcnt lgkmcnt(4)
  ds_read_b128 v[96:99], v112 offset:17088
  v_mul_f32 v52, s25, v52
  v_mfma_f32_16x16x32_bf16 v[72:75], a[196:199], v[100:103], v[72:75]
  ds_read_b128 a[28:31], v115 offset:7168
  v_cvt_pk_bf16_f32 v48, v48, v49
  v_mfma_f32_16x16x32_bf16 v[76:79], a[228:231], v[100:103], v[76:79]
  v_exp_f32 v51, v51
  v_mfma_f32_16x16x32_bf16 v[80:83], v[144:147], v[100:103], v[80:83]
  v_mul_f32 v53, s25, v53
  v_mul_f32 v54, s25, v54
  v_mfma_f32_16x16x32_bf16 v[84:87], v[148:151], v[100:103], v[84:87]
  v_exp_f32 v52, v52
  v_mfma_f32_16x16x32_bf16 v[88:91], v[152:155], v[100:103], v[88:91]
  v_cvt_pk_bf16_f32 v49, v50, v51
  v_mul_f32 v55, s25, v55
  v_mfma_f32_16x16x32_bf16 v[92:95], v[156:159], v[100:103], v[92:95]
  s_waitcnt lgkmcnt(4)
  ds_read_b128 v[100:103], v112 offset:17152
  v_mul_f32 v56, s25, v56
  v_mfma_f32_16x16x32_bf16 v[72:75], a[200:203], v[104:107], v[72:75]
  ds_read_b128 a[32:35], v115 offset:8192
  v_mul_f32 v57, s25, v57
  v_mfma_f32_16x16x32_bf16 v[76:79], a[232:235], v[104:107], v[76:79]
  v_exp_f32 v53, v53
  v_mfma_f32_16x16x32_bf16 v[80:83], v[160:163], v[104:107], v[80:83]
  v_exp_f32 v54, v54
  v_mfma_f32_16x16x32_bf16 v[84:87], v[164:167], v[104:107], v[84:87]
  v_cvt_pk_bf16_f32 v50, v52, v53
  v_mul_f32 v58, s25, v58
  v_mfma_f32_16x16x32_bf16 v[88:91], v[168:171], v[104:107], v[88:91]
  v_exp_f32 v55, v55
  v_mfma_f32_16x16x32_bf16 v[92:95], v[172:175], v[104:107], v[92:95]
  s_waitcnt lgkmcnt(3)
  ds_read_b128 v[104:107], v112 offset:17216
  v_cvt_pk_bf16_f32 v51, v54, v55
  v_mfma_f32_16x16x32_bf16 v[72:75], a[204:207], v[96:99], v[72:75]
  ds_read_b128 a[36:39], v115 offset:9216
  v_mul_f32 v59, s25, v59
  v_mfma_f32_16x16x32_bf16 v[76:79], a[236:239], v[96:99], v[76:79]
  v_exp_f32 v56, v56
  v_mfma_f32_16x16x32_bf16 v[80:83], v[176:179], v[96:99], v[80:83]
  v_exp_f32 v57, v57
  v_mfma_f32_16x16x32_bf16 v[84:87], v[180:183], v[96:99], v[84:87]
  v_exp_f32 v58, v58
  v_mfma_f32_16x16x32_bf16 v[88:91], v[184:187], v[96:99], v[88:91]
  v_mul_f32 v60, s25, v60
  v_cvt_pk_bf16_f32 v56, v56, v57
  v_mfma_f32_16x16x32_bf16 v[92:95], v[188:191], v[96:99], v[92:95]
  s_waitcnt lgkmcnt(3)
  ds_read_b128 v[96:99], v112 offset:17280
  v_mul_f32 v61, s25, v61
  v_mfma_f32_16x16x32_bf16 v[72:75], a[208:211], v[100:103], v[72:75]
  ds_read_b128 a[40:43], v115 offset:10240
  v_mul_f32 v62, s25, v62
  v_mfma_f32_16x16x32_bf16 v[76:79], a[240:243], v[100:103], v[76:79]
  v_exp_f32 v59, v59
  v_mfma_f32_16x16x32_bf16 v[80:83], v[192:195], v[100:103], v[80:83]
  v_exp_f32 v60, v60
  v_mfma_f32_16x16x32_bf16 v[84:87], v[196:199], v[100:103], v[84:87]
  v_cvt_pk_bf16_f32 v57, v58, v59
  v_mul_f32 v63, s25, v63
  v_mfma_f32_16x16x32_bf16 v[88:91], v[200:203], v[100:103], v[88:91]
  v_exp_f32 v61, v61
  v_mfma_f32_16x16x32_bf16 v[92:95], v[204:207], v[100:103], v[92:95]
  s_waitcnt lgkmcnt(3)
  ds_read_b128 v[100:103], v112 offset:17344
  v_cvt_pk_bf16_f32 v58, v60, v61
  v_mfma_f32_16x16x32_bf16 v[72:75], a[212:215], v[104:107], v[72:75]
  ds_read_b128 a[44:47], v115 offset:11264
  v_mul_f32 v64, s25, v64
  v_mfma_f32_16x16x32_bf16 v[76:79], a[244:247], v[104:107], v[76:79]
  v_exp_f32 v62, v62
  v_mfma_f32_16x16x32_bf16 v[80:83], v[208:211], v[104:107], v[80:83]
  v_exp_f32 v63, v63
  v_mfma_f32_16x16x32_bf16 v[84:87], v[212:215], v[104:107], v[84:87]
  v_cvt_pk_bf16_f32 v59, v62, v63
  v_mul_f32 v65, s25, v65
  v_mfma_f32_16x16x32_bf16 v[88:91], v[216:219], v[104:107], v[88:91]
  v_exp_f32 v64, v64
  v_mfma_f32_16x16x32_bf16 v[92:95], v[220:223], v[104:107], v[92:95]
  s_waitcnt lgkmcnt(3)
  ds_read_b128 v[104:107], v112 offset:25344
  v_mul_f32 v66, s25, v66
  v_mfma_f32_16x16x32_bf16 v[72:75], a[216:219], v[96:99], v[72:75]
  v_exp_f32 v65, v65
  v_mfma_f32_16x16x32_bf16 v[76:79], a[248:251], v[96:99], v[76:79]
  v_mul_f32 v67, s25, v67
  v_mul_f32 v68, s25, v68
  v_mfma_f32_16x16x32_bf16 v[80:83], v[224:227], v[96:99], v[80:83]
  v_exp_f32 v66, v66
  v_mfma_f32_16x16x32_bf16 v[84:87], v[228:231], v[96:99], v[84:87]
  v_cvt_pk_bf16_f32 v64, v64, v65
  v_mul_f32 v69, s25, v69
  v_mfma_f32_16x16x32_bf16 v[88:91], v[232:235], v[96:99], v[88:91]
  v_exp_f32 v67, v67
  v_mfma_f32_16x16x32_bf16 v[92:95], v[236:239], v[96:99], v[92:95]
  s_waitcnt lgkmcnt(2)
  ds_read_b128 v[96:99], v112 offset:25408
  v_mul_f32 v70, s25, v70
  v_mfma_f32_16x16x32_bf16 v[72:75], a[220:223], v[100:103], v[72:75]
  v_exp_f32 v68, v68
  v_mfma_f32_16x16x32_bf16 v[76:79], a[252:255], v[100:103], v[76:79]
  v_cvt_pk_bf16_f32 v65, v66, v67
  v_mul_f32 v71, s25, v71
  v_mfma_f32_16x16x32_bf16 v[80:83], v[240:243], v[100:103], v[80:83]
  v_exp_f32 v69, v69
  v_mfma_f32_16x16x32_bf16 v[84:87], v[244:247], v[100:103], v[84:87]
  v_exp_f32 v70, v70
  v_mfma_f32_16x16x32_bf16 v[88:91], v[248:251], v[100:103], v[88:91]
  v_cvt_pk_bf16_f32 v66, v68, v69
  v_mul_f32 v72, s25, v72
  v_mfma_f32_16x16x32_bf16 v[92:95], v[252:255], v[100:103], v[92:95]
  s_waitcnt lgkmcnt(1)
  ds_read_b128 v[100:103], v112 offset:25472
  v_mul_f32 v73, s25, v73
  v_mfma_f32_16x16x32_bf16 v[0:3], a[192:195], v[104:107], 0
  v_exp_f32 v71, v71
  v_mfma_f32_16x16x32_bf16 v[4:7], a[224:227], v[104:107], 0
  v_cvt_pk_bf16_f32 v67, v70, v71
  v_mul_f32 v74, s25, v74
  v_mfma_f32_16x16x32_bf16 v[8:11], v[128:131], v[104:107], 0
  v_exp_f32 v72, v72
  v_mfma_f32_16x16x32_bf16 v[12:15], v[132:135], v[104:107], 0
  v_exp_f32 v73, v73
  v_mfma_f32_16x16x32_bf16 v[16:19], v[136:139], v[104:107], 0
  v_mul_f32 v75, s25, v75
  v_mul_f32 v76, s25, v76
  v_mfma_f32_16x16x32_bf16 v[20:23], v[140:143], v[104:107], 0
  s_waitcnt lgkmcnt(1)
  ds_read_b128 v[104:107], v112 offset:25536
  v_cvt_pk_bf16_f32 v72, v72, v73
  v_mfma_f32_16x16x32_bf16 v[0:3], a[196:199], v[96:99], v[0:3]
  v_exp_f32 v74, v74
  v_mfma_f32_16x16x32_bf16 v[4:7], a[228:231], v[96:99], v[4:7]
  v_exp_f32 v75, v75
  v_mfma_f32_16x16x32_bf16 v[8:11], v[144:147], v[96:99], v[8:11]
  s_waitcnt vmcnt(4)
  s_barrier
  v_mul_f32 v77, s25, v77
  v_mul_f32 v78, s25, v78
  v_mfma_f32_16x16x32_bf16 v[12:15], v[148:151], v[96:99], v[12:15]
  ds_write_b128 v113, v[48:51] offset:0
  s_mov_b32 s44, 122880
  v_exp_f32 v76, v76
  v_mfma_f32_16x16x32_bf16 v[16:19], v[152:155], v[96:99], v[16:19]
  ds_write_b128 v113, v[56:59] offset:1024
  s_add_u32 m0, s26, 8448
  v_cvt_pk_bf16_f32 v73, v74, v75
  v_mul_f32 v79, s25, v79
  v_mfma_f32_16x16x32_bf16 v[20:23], v[156:159], v[96:99], v[20:23]
  s_waitcnt lgkmcnt(3)
  ds_write_b128 v113, v[64:67] offset:2048
  s_mov_b32 s45, 131072
  v_exp_f32 v77, v77
  v_mfma_f32_16x16x32_bf16 v[0:3], a[200:203], v[100:103], v[0:3]
  buffer_load_dwordx4 v118, s[8:11], s44 offen offset:0 nt lds
  v_exp_f32 v78, v78
  v_mfma_f32_16x16x32_bf16 v[4:7], a[232:235], v[100:103], v[4:7]
  ds_read_b128 v[96:99], v112 offset:25600
  v_cvt_pk_bf16_f32 v74, v76, v77
  v_mfma_f32_16x16x32_bf16 v[8:11], v[160:163], v[100:103], v[8:11]
  ds_read_b128 a[48:51], v115 offset:49152
  v_mul_f32 v80, s25, v80
  v_mfma_f32_16x16x32_bf16 v[12:15], v[164:167], v[100:103], v[12:15]
  v_exp_f32 v79, v79
  v_mfma_f32_16x16x32_bf16 v[16:19], v[168:171], v[100:103], v[16:19]
  v_cvt_pk_bf16_f32 v75, v78, v79
  v_mul_f32 v81, s25, v81
  v_mfma_f32_16x16x32_bf16 v[20:23], v[172:175], v[100:103], v[20:23]
  s_waitcnt lgkmcnt(5)
  ds_read_b128 v[100:103], v112 offset:25664
  v_mul_f32 v82, s25, v82
  v_mfma_f32_16x16x32_bf16 v[0:3], a[204:207], v[104:107], v[0:3]
  ds_write_b128 v113, v[72:75] offset:12288
  s_add_u32 m0, s26, 8480
  v_exp_f32 v80, v80
  v_mfma_f32_16x16x32_bf16 v[4:7], a[236:239], v[104:107], v[4:7]
  ds_read_b128 a[52:55], v115 offset:50176
  v_mul_f32 v83, s25, v83
  v_mfma_f32_16x16x32_bf16 v[8:11], v[176:179], v[104:107], v[8:11]
  buffer_load_dwordx4 v118, s[8:11], s44 offen offset:1024 nt lds
  v_exp_f32 v81, v81
  v_mfma_f32_16x16x32_bf16 v[12:15], v[180:183], v[104:107], v[12:15]
  v_exp_f32 v82, v82
  v_mfma_f32_16x16x32_bf16 v[16:19], v[184:187], v[104:107], v[16:19]
  v_mul_f32 v84, s25, v84
  v_cvt_pk_bf16_f32 v80, v80, v81
  v_mfma_f32_16x16x32_bf16 v[20:23], v[188:191], v[104:107], v[20:23]
  s_waitcnt lgkmcnt(4)
  ds_read_b128 v[104:107], v112 offset:25728
  v_mul_f32 v85, s25, v85
  v_mfma_f32_16x16x32_bf16 v[0:3], a[208:211], v[96:99], v[0:3]
  v_exp_f32 v83, v83
  v_mfma_f32_16x16x32_bf16 v[4:7], a[240:243], v[96:99], v[4:7]
  ds_read_b128 a[56:59], v115 offset:51200
  v_mul_f32 v86, s25, v86
  v_mfma_f32_16x16x32_bf16 v[8:11], v[192:195], v[96:99], v[8:11]
  v_exp_f32 v84, v84
  v_mfma_f32_16x16x32_bf16 v[12:15], v[196:199], v[96:99], v[12:15]
  v_cvt_pk_bf16_f32 v81, v82, v83
  v_mul_f32 v87, s25, v87
  v_mfma_f32_16x16x32_bf16 v[16:19], v[200:203], v[96:99], v[16:19]
  s_add_u32 m0, s26, 16896
  v_exp_f32 v85, v85
  v_mfma_f32_16x16x32_bf16 v[20:23], v[204:207], v[96:99], v[20:23]
  s_waitcnt lgkmcnt(4)
  ds_read_b128 v[96:99], v112 offset:25792
  v_cvt_pk_bf16_f32 v82, v84, v85
  v_mfma_f32_16x16x32_bf16 v[0:3], a[212:215], v[100:103], v[0:3]
  buffer_load_dwordx4 v118, s[8:11], s45 offen offset:0 nt lds
  v_exp_f32 v86, v86
  v_mfma_f32_16x16x32_bf16 v[4:7], a[244:247], v[100:103], v[4:7]
  ds_read_b128 a[60:63], v115 offset:52224
  v_mul_f32 v88, s25, v88
  v_mfma_f32_16x16x32_bf16 v[8:11], v[208:211], v[100:103], v[8:11]
  v_exp_f32 v87, v87
  v_mfma_f32_16x16x32_bf16 v[12:15], v[212:215], v[100:103], v[12:15]
  v_cvt_pk_bf16_f32 v83, v86, v87
  v_mul_f32 v89, s25, v89
  v_mfma_f32_16x16x32_bf16 v[16:19], v[216:219], v[100:103], v[16:19]
  ds_write_b128 v113, v[80:83] offset:13312
  v_exp_f32 v88, v88
  v_mfma_f32_16x16x32_bf16 v[20:23], v[220:223], v[100:103], v[20:23]
  s_waitcnt lgkmcnt(4)
  ds_read_b128 v[100:103], v112 offset:33792
  v_mul_f32 v90, s25, v90
  v_mfma_f32_16x16x32_bf16 v[0:3], a[216:219], v[104:107], v[0:3]
  v_exp_f32 v89, v89
  v_mfma_f32_16x16x32_bf16 v[4:7], a[248:251], v[104:107], v[4:7]
  ds_read_b128 a[64:67], v115 offset:53248
  v_mul_f32 v91, s25, v91
  v_mfma_f32_16x16x32_bf16 v[8:11], v[224:227], v[104:107], v[8:11]
  s_add_u32 m0, s26, 16928
  v_exp_f32 v90, v90
  v_mfma_f32_16x16x32_bf16 v[12:15], v[228:231], v[104:107], v[12:15]
  v_mul_f32 v92, s25, v92
  v_cvt_pk_bf16_f32 v88, v88, v89
  v_mfma_f32_16x16x32_bf16 v[16:19], v[232:235], v[104:107], v[16:19]
  buffer_load_dwordx4 v118, s[8:11], s45 offen offset:1024 nt lds
  v_exp_f32 v91, v91
  v_mfma_f32_16x16x32_bf16 v[20:23], v[236:239], v[104:107], v[20:23]
  s_waitcnt lgkmcnt(4)
  ds_read_b128 v[104:107], v112 offset:33856
  v_mul_f32 v93, s25, v93
  v_mfma_f32_16x16x32_bf16 v[0:3], a[220:223], v[96:99], v[0:3]
  v_exp_f32 v92, v92
  v_mfma_f32_16x16x32_bf16 v[4:7], a[252:255], v[96:99], v[4:7]
  ds_read_b128 a[68:71], v115 offset:54272
  v_mul_f32 v94, s25, v94
  v_mfma_f32_16x16x32_bf16 v[8:11], v[240:243], v[96:99], v[8:11]
  v_cvt_pk_bf16_f32 v89, v90, v91
  v_mul_f32 v95, s25, v95
  v_mfma_f32_16x16x32_bf16 v[12:15], v[244:247], v[96:99], v[12:15]
  v_exp_f32 v93, v93
  v_mfma_f32_16x16x32_bf16 v[16:19], v[248:251], v[96:99], v[16:19]
  v_exp_f32 v94, v94
  v_mfma_f32_16x16x32_bf16 v[20:23], v[252:255], v[96:99], v[20:23]
  s_waitcnt lgkmcnt(3)
  ds_read_b128 v[96:99], v112 offset:33920
  v_cvt_pk_bf16_f32 v90, v92, v93
  v_mfma_f32_16x16x32_bf16 v[24:27], a[192:195], v[100:103], 0
  v_exp_f32 v95, v95
  v_mfma_f32_16x16x32_bf16 v[28:31], a[224:227], v[100:103], 0
  ds_read_b128 a[72:75], v115 offset:55296
  v_mul_f32 v0, s25, v0
  v_mfma_f32_16x16x32_bf16 v[32:35], v[128:131], v[100:103], 0
  v_cvt_pk_bf16_f32 v91, v94, v95
  v_mul_f32 v1, s25, v1
  v_mfma_f32_16x16x32_bf16 v[36:39], v[132:135], v[100:103], 0
  ds_write_b128 v113, v[88:91] offset:14336
  v_exp_f32 v0, v0
  v_mfma_f32_16x16x32_bf16 v[40:43], v[136:139], v[100:103], 0
  v_mul_f32 v2, s25, v2
  v_mul_f32 v3, s25, v3
  v_mfma_f32_16x16x32_bf16 v[44:47], v[140:143], v[100:103], 0
  s_waitcnt lgkmcnt(4)
  ds_read_b128 v[100:103], v112 offset:33984
  v_mul_f32 v4, s25, v4
  v_mfma_f32_16x16x32_bf16 v[24:27], a[196:199], v[104:107], v[24:27]
  ds_read_b128 a[76:79], v115 offset:56320
  v_mul_f32 v5, s25, v5
  v_mfma_f32_16x16x32_bf16 v[28:31], a[228:231], v[104:107], v[28:31]
  v_exp_f32 v1, v1
  v_mfma_f32_16x16x32_bf16 v[32:35], v[144:147], v[104:107], v[32:35]
  v_exp_f32 v2, v2
  v_mfma_f32_16x16x32_bf16 v[36:39], v[148:151], v[104:107], v[36:39]
  v_cvt_pk_bf16_f32 v0, v0, v1
  v_mul_f32 v6, s25, v6
  v_mfma_f32_16x16x32_bf16 v[40:43], v[152:155], v[104:107], v[40:43]
  v_exp_f32 v3, v3
  v_mfma_f32_16x16x32_bf16 v[44:47], v[156:159], v[104:107], v[44:47]
  s_waitcnt lgkmcnt(4)
  ds_read_b128 v[104:107], v112 offset:34048
  v_cvt_pk_bf16_f32 v1, v2, v3
  v_mfma_f32_16x16x32_bf16 v[24:27], a[200:203], v[96:99], v[24:27]
  ds_read_b128 a[80:83], v115 offset:57344
  v_mul_f32 v7, s25, v7
  v_mfma_f32_16x16x32_bf16 v[28:31], a[232:235], v[96:99], v[28:31]
  v_exp_f32 v4, v4
  v_mfma_f32_16x16x32_bf16 v[32:35], v[160:163], v[96:99], v[32:35]
  v_exp_f32 v5, v5
  v_mfma_f32_16x16x32_bf16 v[36:39], v[164:167], v[96:99], v[36:39]
  v_exp_f32 v6, v6
  v_mfma_f32_16x16x32_bf16 v[40:43], v[168:171], v[96:99], v[40:43]
  v_cvt_pk_bf16_f32 v2, v4, v5
  v_mul_f32 v8, s25, v8
  v_mfma_f32_16x16x32_bf16 v[44:47], v[172:175], v[96:99], v[44:47]
  s_waitcnt lgkmcnt(3)
  ds_read_b128 v[96:99], v112 offset:34112
  v_mul_f32 v9, s25, v9
  v_mfma_f32_16x16x32_bf16 v[24:27], a[204:207], v[100:103], v[24:27]
  ds_read_b128 a[84:87], v115 offset:58368
  v_mul_f32 v10, s25, v10
  v_mfma_f32_16x16x32_bf16 v[28:31], a[236:239], v[100:103], v[28:31]
  v_exp_f32 v7, v7
  v_mfma_f32_16x16x32_bf16 v[32:35], v[176:179], v[100:103], v[32:35]
  v_cvt_pk_bf16_f32 v3, v6, v7
  v_mul_f32 v11, s25, v11
  v_mfma_f32_16x16x32_bf16 v[36:39], v[180:183], v[100:103], v[36:39]
  ds_write_b128 v113, v[0:3] offset:24576
  v_exp_f32 v8, v8
  v_mfma_f32_16x16x32_bf16 v[40:43], v[184:187], v[100:103], v[40:43]
  v_exp_f32 v9, v9
  v_mfma_f32_16x16x32_bf16 v[44:47], v[188:191], v[100:103], v[44:47]
  s_waitcnt lgkmcnt(4)
  ds_read_b128 v[100:103], v112 offset:34176
  v_mul_f32 v12, s25, v12
  v_mfma_f32_16x16x32_bf16 v[24:27], a[208:211], v[104:107], v[24:27]
  ds_read_b128 a[88:91], v115 offset:59392
  v_cvt_pk_bf16_f32 v8, v8, v9
  v_mfma_f32_16x16x32_bf16 v[28:31], a[240:243], v[104:107], v[28:31]
  v_exp_f32 v10, v10
  v_mfma_f32_16x16x32_bf16 v[32:35], v[192:195], v[104:107], v[32:35]
  v_exp_f32 v11, v11
  v_mfma_f32_16x16x32_bf16 v[36:39], v[196:199], v[104:107], v[36:39]
  v_mul_f32 v13, s25, v13
  v_mul_f32 v14, s25, v14
  v_mfma_f32_16x16x32_bf16 v[40:43], v[200:203], v[104:107], v[40:43]
  v_exp_f32 v12, v12
  v_mfma_f32_16x16x32_bf16 v[44:47], v[204:207], v[104:107], v[44:47]
  s_waitcnt lgkmcnt(4)
  ds_read_b128 v[104:107], v112 offset:34240
  v_cvt_pk_bf16_f32 v9, v10, v11
  v_mfma_f32_16x16x32_bf16 v[24:27], a[212:215], v[96:99], v[24:27]
  ds_read_b128 a[92:95], v115 offset:60416
  v_mul_f32 v15, s25, v15
  v_mfma_f32_16x16x32_bf16 v[28:31], a[244:247], v[96:99], v[28:31]
  v_exp_f32 v13, v13
  v_mfma_f32_16x16x32_bf16 v[32:35], v[208:211], v[96:99], v[32:35]
  v_exp_f32 v14, v14
  v_mfma_f32_16x16x32_bf16 v[36:39], v[212:215], v[96:99], v[36:39]
  v_cvt_pk_bf16_f32 v10, v12, v13
  v_mul_f32 v16, s25, v16
  v_mfma_f32_16x16x32_bf16 v[40:43], v[216:219], v[96:99], v[40:43]
  v_exp_f32 v15, v15
  v_mfma_f32_16x16x32_bf16 v[44:47], v[220:223], v[96:99], v[44:47]
  s_waitcnt lgkmcnt(3)
  ds_read_b128 v[96:99], v112 offset:42240
  v_cvt_pk_bf16_f32 v11, v14, v15
  v_mfma_f32_16x16x32_bf16 v[24:27], a[216:219], v[100:103], v[24:27]
  ds_write_b128 v113, v[8:11] offset:25600
  v_mul_f32 v17, s25, v17
  v_mul_f32 v18, s25, v18
  v_mfma_f32_16x16x32_bf16 v[28:31], a[248:251], v[100:103], v[28:31]
  v_exp_f32 v16, v16
  v_mfma_f32_16x16x32_bf16 v[32:35], v[224:227], v[100:103], v[32:35]
  v_exp_f32 v17, v17
  v_mfma_f32_16x16x32_bf16 v[36:39], v[228:231], v[100:103], v[36:39]
  v_mul_f32 v19, s25, v19
  v_mul_f32 v20, s25, v20
  v_mfma_f32_16x16x32_bf16 v[40:43], v[232:235], v[100:103], v[40:43]
  v_exp_f32 v18, v18
  v_mfma_f32_16x16x32_bf16 v[44:47], v[236:239], v[100:103], v[44:47]
  s_waitcnt lgkmcnt(3)
  ds_read_b128 v[100:103], v112 offset:42304
  v_cvt_pk_bf16_f32 v16, v16, v17
  v_mfma_f32_16x16x32_bf16 v[24:27], a[220:223], v[104:107], v[24:27]
  v_exp_f32 v19, v19
  v_mfma_f32_16x16x32_bf16 v[28:31], a[252:255], v[104:107], v[28:31]
  v_mul_f32 v21, s25, v21
  v_mul_f32 v22, s25, v22
  v_mfma_f32_16x16x32_bf16 v[32:35], v[240:243], v[104:107], v[32:35]
  v_exp_f32 v20, v20
  v_mfma_f32_16x16x32_bf16 v[36:39], v[244:247], v[104:107], v[36:39]
  v_cvt_pk_bf16_f32 v17, v18, v19
  v_mul_f32 v23, s25, v23
  v_mfma_f32_16x16x32_bf16 v[40:43], v[248:251], v[104:107], v[40:43]
  v_exp_f32 v21, v21
  v_mfma_f32_16x16x32_bf16 v[44:47], v[252:255], v[104:107], v[44:47]
  s_waitcnt lgkmcnt(2)
  ds_read_b128 v[104:107], v112 offset:42368
  v_cvt_pk_bf16_f32 v18, v20, v21
  v_mfma_f32_16x16x32_bf16 v[48:51], a[192:195], v[96:99], 0
  v_exp_f32 v22, v22
  v_mfma_f32_16x16x32_bf16 v[52:55], a[224:227], v[96:99], 0
  v_exp_f32 v23, v23
  v_mfma_f32_16x16x32_bf16 v[56:59], v[128:131], v[96:99], 0
  v_mul_f32 v24, s25, v24
  v_cvt_pk_bf16_f32 v19, v22, v23
  v_mfma_f32_16x16x32_bf16 v[60:63], v[132:135], v[96:99], 0
  ds_write_b128 v113, v[16:19] offset:26624
  v_mul_f32 v25, s25, v25
  v_mul_f32 v26, s25, v26
  v_mfma_f32_16x16x32_bf16 v[64:67], v[136:139], v[96:99], 0
  v_exp_f32 v24, v24
  v_mfma_f32_16x16x32_bf16 v[68:71], v[140:143], v[96:99], 0
  s_waitcnt lgkmcnt(2)
  ds_read_b128 v[96:99], v112 offset:42432
  v_mul_f32 v27, s25, v27
  v_mfma_f32_16x16x32_bf16 v[48:51], a[196:199], v[100:103], v[48:51]
  v_exp_f32 v25, v25
  v_mfma_f32_16x16x32_bf16 v[52:55], a[228:231], v[100:103], v[52:55]
  v_exp_f32 v26, v26
  v_mfma_f32_16x16x32_bf16 v[56:59], v[144:147], v[100:103], v[56:59]
  s_waitcnt vmcnt(4)
  s_barrier
  v_mul_f32 v28, s25, v28
  v_cvt_pk_bf16_f32 v24, v24, v25
  v_mfma_f32_16x16x32_bf16 v[60:63], v[148:151], v[100:103], v[60:63]
  s_mov_b32 s46, 139264
  v_exp_f32 v27, v27
  v_mfma_f32_16x16x32_bf16 v[64:67], v[152:155], v[100:103], v[64:67]
  s_add_u32 m0, s26, 25344
  v_mul_f32 v29, s25, v29
  v_mul_f32 v30, s25, v30
  v_mfma_f32_16x16x32_bf16 v[68:71], v[156:159], v[100:103], v[68:71]
  s_waitcnt lgkmcnt(2)
  buffer_load_dwordx4 v118, s[8:11], s46 offen offset:0 nt lds
  s_mov_b32 s47, 147456
  v_exp_f32 v28, v28
  v_mfma_f32_16x16x32_bf16 v[48:51], a[200:203], v[104:107], v[48:51]
  ds_read_b128 v[100:103], v112 offset:42496
  v_cvt_pk_bf16_f32 v25, v26, v27
  v_mfma_f32_16x16x32_bf16 v[52:55], a[232:235], v[104:107], v[52:55]
  v_exp_f32 v29, v29
  v_mfma_f32_16x16x32_bf16 v[56:59], v[160:163], v[104:107], v[56:59]
  v_mul_f32 v31, s25, v31
  v_cvt_pk_bf16_f32 v26, v28, v29
  v_mfma_f32_16x16x32_bf16 v[60:63], v[164:167], v[104:107], v[60:63]
  v_exp_f32 v30, v30
  v_mfma_f32_16x16x32_bf16 v[64:67], v[168:171], v[104:107], v[64:67]
  v_exp_f32 v31, v31
  v_mfma_f32_16x16x32_bf16 v[68:71], v[172:175], v[104:107], v[68:71]
  s_waitcnt lgkmcnt(1)
  ds_read_b128 v[104:107], v112 offset:42560
  v_mul_f32 v32, s25, v32
  v_mfma_f32_16x16x32_bf16 v[48:51], a[204:207], v[96:99], v[48:51]
  s_add_u32 m0, s26, 25376
  v_cvt_pk_bf16_f32 v27, v30, v31
  v_mul_f32 v33, s25, v33
  v_mfma_f32_16x16x32_bf16 v[52:55], a[236:239], v[96:99], v[52:55]
  ds_write_b128 v113, v[24:27] offset:36864
  v_exp_f32 v32, v32
  v_mfma_f32_16x16x32_bf16 v[56:59], v[176:179], v[96:99], v[56:59]
  buffer_load_dwordx4 v118, s[8:11], s46 offen offset:1024 nt lds
  v_mul_f32 v34, s25, v34
  v_mul_f32 v35, s25, v35
  v_mfma_f32_16x16x32_bf16 v[60:63], v[180:183], v[96:99], v[60:63]
  v_exp_f32 v33, v33
  v_mfma_f32_16x16x32_bf16 v[64:67], v[184:187], v[96:99], v[64:67]
  v_exp_f32 v34, v34
  v_mfma_f32_16x16x32_bf16 v[68:71], v[188:191], v[96:99], v[68:71]
  s_waitcnt lgkmcnt(2)
  ds_read_b128 v[96:99], v112 offset:42624
  v_mul_f32 v36, s25, v36
  v_mfma_f32_16x16x32_bf16 v[48:51], a[208:211], v[100:103], v[48:51]
  v_cvt_pk_bf16_f32 v32, v32, v33
  v_mul_f32 v37, s25, v37
  v_mfma_f32_16x16x32_bf16 v[52:55], a[240:243], v[100:103], v[52:55]
  v_exp_f32 v35, v35
  v_mfma_f32_16x16x32_bf16 v[56:59], v[192:195], v[100:103], v[56:59]
  v_exp_f32 v36, v36
  v_mfma_f32_16x16x32_bf16 v[60:63], v[196:199], v[100:103], v[60:63]
  v_mul_f32 v38, s25, v38
  v_cvt_pk_bf16_f32 v33, v34, v35
  v_mfma_f32_16x16x32_bf16 v[64:67], v[200:203], v[100:103], v[64:67]
  s_add_u32 m0, s26, 33792
  v_exp_f32 v37, v37
  v_mfma_f32_16x16x32_bf16 v[68:71], v[204:207], v[100:103], v[68:71]
  s_waitcnt lgkmcnt(2)
  ds_read_b128 v[100:103], v112 offset:42688
  v_mul_f32 v39, s25, v39
  v_mfma_f32_16x16x32_bf16 v[48:51], a[212:215], v[104:107], v[48:51]
  buffer_load_dwordx4 v118, s[8:11], s47 offen offset:0 nt lds
  v_exp_f32 v38, v38
  v_mfma_f32_16x16x32_bf16 v[52:55], a[244:247], v[104:107], v[52:55]
  v_cvt_pk_bf16_f32 v34, v36, v37
  v_mul_f32 v40, s25, v40
  v_mfma_f32_16x16x32_bf16 v[56:59], v[208:211], v[104:107], v[56:59]
  v_exp_f32 v39, v39
  v_mfma_f32_16x16x32_bf16 v[60:63], v[212:215], v[104:107], v[60:63]
  v_cvt_pk_bf16_f32 v35, v38, v39
  v_mul_f32 v41, s25, v41
  v_mfma_f32_16x16x32_bf16 v[64:67], v[216:219], v[104:107], v[64:67]
  ds_write_b128 v113, v[32:35] offset:37888
  v_exp_f32 v40, v40
  v_mfma_f32_16x16x32_bf16 v[68:71], v[220:223], v[104:107], v[68:71]
  s_waitcnt lgkmcnt(2)
  ds_read_b128 v[104:107], v112 offset:50688
  v_mul_f32 v42, s25, v42
  v_mfma_f32_16x16x32_bf16 v[48:51], a[216:219], v[96:99], v[48:51]
  v_exp_f32 v41, v41
  v_mfma_f32_16x16x32_bf16 v[52:55], a[248:251], v[96:99], v[52:55]
  v_mul_f32 v43, s25, v43
  v_mul_f32 v44, s25, v44
  v_mfma_f32_16x16x32_bf16 v[56:59], v[224:227], v[96:99], v[56:59]
  s_add_u32 m0, s26, 33824
  v_exp_f32 v42, v42
  v_mfma_f32_16x16x32_bf16 v[60:63], v[228:231], v[96:99], v[60:63]
  v_cvt_pk_bf16_f32 v40, v40, v41
  v_mul_f32 v45, s25, v45
  v_mfma_f32_16x16x32_bf16 v[64:67], v[232:235], v[96:99], v[64:67]
  buffer_load_dwordx4 v118, s[8:11], s47 offen offset:1024 nt lds
  v_exp_f32 v43, v43
  v_mfma_f32_16x16x32_bf16 v[68:71], v[236:239], v[96:99], v[68:71]
  s_waitcnt lgkmcnt(2)
  ds_read_b128 v[96:99], v112 offset:50752
  v_mul_f32 v46, s25, v46
  v_mfma_f32_16x16x32_bf16 v[48:51], a[220:223], v[100:103], v[48:51]
  v_exp_f32 v44, v44
  v_mfma_f32_16x16x32_bf16 v[52:55], a[252:255], v[100:103], v[52:55]
  v_cvt_pk_bf16_f32 v41, v42, v43
  v_mul_f32 v47, s25, v47
  v_mfma_f32_16x16x32_bf16 v[56:59], v[240:243], v[100:103], v[56:59]
  v_exp_f32 v45, v45
  v_mfma_f32_16x16x32_bf16 v[60:63], v[244:247], v[100:103], v[60:63]
  v_exp_f32 v46, v46
  v_mfma_f32_16x16x32_bf16 v[64:67], v[248:251], v[100:103], v[64:67]
  v_cvt_pk_bf16_f32 v42, v44, v45
  v_mul_f32 v48, s25, v48
  v_mfma_f32_16x16x32_bf16 v[68:71], v[252:255], v[100:103], v[68:71]
  s_waitcnt lgkmcnt(1)
  ds_read_b128 v[100:103], v112 offset:50816
  v_mul_f32 v49, s25, v49
  v_mfma_f32_16x16x32_bf16 v[72:75], a[192:195], v[104:107], 0
  v_exp_f32 v47, v47
  v_mfma_f32_16x16x32_bf16 v[76:79], a[224:227], v[104:107], 0
  v_cvt_pk_bf16_f32 v43, v46, v47
  v_mul_f32 v50, s25, v50
  v_mfma_f32_16x16x32_bf16 v[80:83], v[128:131], v[104:107], 0
  ds_write_b128 v113, v[40:43] offset:38912
  v_exp_f32 v48, v48
  v_mfma_f32_16x16x32_bf16 v[84:87], v[132:135], v[104:107], 0
  v_exp_f32 v49, v49
  v_mfma_f32_16x16x32_bf16 v[88:91], v[136:139], v[104:107], 0
  v_mul_f32 v51, s25, v51
  v_mul_f32 v52, s25, v52
  v_mfma_f32_16x16x32_bf16 v[92:95], v[140:143], v[104:107], 0
  s_waitcnt lgkmcnt(2)
  ds_read_b128 v[104:107], v112 offset:50880
  v_cvt_pk_bf16_f32 v48, v48, v49
  v_mfma_f32_16x16x32_bf16 v[72:75], a[196:199], v[96:99], v[72:75]
  v_exp_f32 v50, v50
  v_mfma_f32_16x16x32_bf16 v[76:79], a[228:231], v[96:99], v[76:79]
  v_exp_f32 v51, v51
  v_mfma_f32_16x16x32_bf16 v[80:83], v[144:147], v[96:99], v[80:83]
  v_mul_f32 v53, s25, v53
  v_mul_f32 v54, s25, v54
  v_mfma_f32_16x16x32_bf16 v[84:87], v[148:151], v[96:99], v[84:87]
  v_exp_f32 v52, v52
  v_mfma_f32_16x16x32_bf16 v[88:91], v[152:155], v[96:99], v[88:91]
  v_cvt_pk_bf16_f32 v49, v50, v51
  v_mul_f32 v55, s25, v55
  v_mfma_f32_16x16x32_bf16 v[92:95], v[156:159], v[96:99], v[92:95]
  s_waitcnt lgkmcnt(2)
  ds_read_b128 v[96:99], v112 offset:50944
  v_mul_f32 v56, s25, v56
  v_mfma_f32_16x16x32_bf16 v[72:75], a[200:203], v[100:103], v[72:75]
  v_exp_f32 v53, v53
  v_mfma_f32_16x16x32_bf16 v[76:79], a[232:235], v[100:103], v[76:79]
  v_exp_f32 v54, v54
  v_mfma_f32_16x16x32_bf16 v[80:83], v[160:163], v[100:103], v[80:83]
  v_cvt_pk_bf16_f32 v50, v52, v53
  v_mul_f32 v57, s25, v57
  v_mfma_f32_16x16x32_bf16 v[84:87], v[164:167], v[100:103], v[84:87]
  v_exp_f32 v55, v55
  v_mfma_f32_16x16x32_bf16 v[88:91], v[168:171], v[100:103], v[88:91]
  v_cvt_pk_bf16_f32 v51, v54, v55
  v_mul_f32 v58, s25, v58
  v_mfma_f32_16x16x32_bf16 v[92:95], v[172:175], v[100:103], v[92:95]
  s_waitcnt lgkmcnt(1)
  ds_read_b128 v[100:103], v112 offset:51008
  v_mul_f32 v59, s25, v59
  v_mfma_f32_16x16x32_bf16 v[72:75], a[204:207], v[104:107], v[72:75]
  ds_write_b128 v114, v[48:51] offset:0
  v_exp_f32 v56, v56
  v_mfma_f32_16x16x32_bf16 v[76:79], a[236:239], v[104:107], v[76:79]
  v_exp_f32 v57, v57
  v_mfma_f32_16x16x32_bf16 v[80:83], v[176:179], v[104:107], v[80:83]
  v_exp_f32 v58, v58
  v_mfma_f32_16x16x32_bf16 v[84:87], v[180:183], v[104:107], v[84:87]
  v_mul_f32 v60, s25, v60
  v_cvt_pk_bf16_f32 v56, v56, v57
  v_mfma_f32_16x16x32_bf16 v[88:91], v[184:187], v[104:107], v[88:91]
  v_exp_f32 v59, v59
  v_mfma_f32_16x16x32_bf16 v[92:95], v[188:191], v[104:107], v[92:95]
  s_waitcnt lgkmcnt(2)
  ds_read_b128 v[104:107], v112 offset:51072
  v_mul_f32 v61, s25, v61
  v_mfma_f32_16x16x32_bf16 v[72:75], a[208:211], v[96:99], v[72:75]
  v_exp_f32 v60, v60
  v_mfma_f32_16x16x32_bf16 v[76:79], a[240:243], v[96:99], v[76:79]
  v_mul_f32 v62, s25, v62
  v_cvt_pk_bf16_f32 v57, v58, v59
  v_mfma_f32_16x16x32_bf16 v[80:83], v[192:195], v[96:99], v[80:83]
  v_exp_f32 v61, v61
  v_mfma_f32_16x16x32_bf16 v[84:87], v[196:199], v[96:99], v[84:87]
  v_mul_f32 v63, s25, v63
  v_cvt_pk_bf16_f32 v58, v60, v61
  v_mfma_f32_16x16x32_bf16 v[88:91], v[200:203], v[96:99], v[88:91]
  v_exp_f32 v62, v62
  v_mfma_f32_16x16x32_bf16 v[92:95], v[204:207], v[96:99], v[92:95]
  s_waitcnt lgkmcnt(2)
  ds_read_b128 v[96:99], v112 offset:51136
  v_mul_f32 v64, s25, v64
  v_mfma_f32_16x16x32_bf16 v[72:75], a[212:215], v[100:103], v[72:75]
  v_exp_f32 v63, v63
  v_mfma_f32_16x16x32_bf16 v[76:79], a[244:247], v[100:103], v[76:79]
  v_cvt_pk_bf16_f32 v59, v62, v63
  v_mul_f32 v65, s25, v65
  v_mfma_f32_16x16x32_bf16 v[80:83], v[208:211], v[100:103], v[80:83]
  ds_write_b128 v114, v[56:59] offset:1024
  v_exp_f32 v64, v64
  v_mfma_f32_16x16x32_bf16 v[84:87], v[212:215], v[100:103], v[84:87]
  v_mul_f32 v66, s25, v66
  v_mul_f32 v67, s25, v67
  v_mfma_f32_16x16x32_bf16 v[88:91], v[216:219], v[100:103], v[88:91]
  v_exp_f32 v65, v65
  v_mfma_f32_16x16x32_bf16 v[92:95], v[220:223], v[100:103], v[92:95]
  s_waitcnt lgkmcnt(2)
  ds_read_b128 v[100:103], v112 offset:0
  v_mul_f32 v68, s25, v68
  v_mfma_f32_16x16x32_bf16 v[72:75], a[216:219], v[104:107], v[72:75]
  v_exp_f32 v66, v66
  v_mfma_f32_16x16x32_bf16 v[76:79], a[248:251], v[104:107], v[76:79]
  v_cvt_pk_bf16_f32 v64, v64, v65
  v_mul_f32 v69, s25, v69
  v_mfma_f32_16x16x32_bf16 v[80:83], v[224:227], v[104:107], v[80:83]
  v_exp_f32 v67, v67
  v_mfma_f32_16x16x32_bf16 v[84:87], v[228:231], v[104:107], v[84:87]
  v_exp_f32 v68, v68
  v_mfma_f32_16x16x32_bf16 v[88:91], v[232:235], v[104:107], v[88:91]
  v_mul_f32 v70, s25, v70
  v_cvt_pk_bf16_f32 v65, v66, v67
  v_mfma_f32_16x16x32_bf16 v[92:95], v[236:239], v[104:107], v[92:95]
  s_waitcnt lgkmcnt(2)
  ds_read_b128 v[104:107], v112 offset:64
  v_mul_f32 v71, s25, v71
  v_mfma_f32_16x16x32_bf16 v[72:75], a[220:223], v[96:99], v[72:75]
  v_exp_f32 v69, v69
  v_mfma_f32_16x16x32_bf16 v[76:79], a[252:255], v[96:99], v[76:79]
  v_exp_f32 v70, v70
  v_mfma_f32_16x16x32_bf16 v[80:83], v[240:243], v[96:99], v[80:83]
  v_cvt_pk_bf16_f32 v66, v68, v69
  v_mfma_f32_16x16x32_bf16 v[84:87], v[244:247], v[96:99], v[84:87]
  v_exp_f32 v71, v71
  v_mfma_f32_16x16x32_bf16 v[88:91], v[248:251], v[96:99], v[88:91]
  v_mul_f32 v72, s25, v72
  v_cvt_pk_bf16_f32 v67, v70, v71
  v_mfma_f32_16x16x32_bf16 v[92:95], v[252:255], v[96:99], v[92:95]
  s_waitcnt lgkmcnt(1)
  ds_read_b128 v[96:99], v112 offset:128
  v_mul_f32 v73, s25, v73
  v_mfma_f32_16x16x32_bf16 v[0:3], a[192:195], v[100:103], 0
  ds_write_b128 v114, v[64:67] offset:2048
  v_exp_f32 v72, v72
  v_mfma_f32_16x16x32_bf16 v[4:7], a[224:227], v[100:103], 0
  v_mul_f32 v74, s25, v74
  v_mul_f32 v75, s25, v75
  v_mfma_f32_16x16x32_bf16 v[8:11], v[128:131], v[100:103], 0
  v_exp_f32 v73, v73
  v_mfma_f32_16x16x32_bf16 v[12:15], v[132:135], v[100:103], 0
  v_exp_f32 v74, v74
  v_mfma_f32_16x16x32_bf16 v[16:19], v[136:139], v[100:103], 0
  v_mul_f32 v76, s25, v76
  v_cvt_pk_bf16_f32 v72, v72, v73
  v_mfma_f32_16x16x32_bf16 v[20:23], v[140:143], v[100:103], 0
  s_waitcnt lgkmcnt(2)
  ds_read_b128 v[100:103], v112 offset:192
  v_mul_f32 v77, s25, v77
  v_mfma_f32_16x16x32_bf16 v[0:3], a[196:199], v[104:107], v[0:3]
  v_exp_f32 v75, v75
  v_mfma_f32_16x16x32_bf16 v[4:7], a[228:231], v[104:107], v[4:7]
  v_exp_f32 v76, v76
  v_mfma_f32_16x16x32_bf16 v[8:11], v[144:147], v[104:107], v[8:11]
  s_waitcnt vmcnt(4)
  s_barrier
  v_mul_f32 v78, s25, v78
  v_cvt_pk_bf16_f32 v73, v74, v75
  v_mfma_f32_16x16x32_bf16 v[12:15], v[148:151], v[104:107], v[12:15]
  s_mov_b32 s32, 155648
  v_exp_f32 v77, v77
  v_mfma_f32_16x16x32_bf16 v[16:19], v[152:155], v[104:107], v[16:19]
  s_add_u32 m0, s26, 42240
  v_mul_f32 v79, s25, v79
  v_cvt_pk_bf16_f32 v74, v76, v77
  v_mfma_f32_16x16x32_bf16 v[20:23], v[156:159], v[104:107], v[20:23]
  s_waitcnt lgkmcnt(2)
  buffer_load_dwordx4 v118, s[8:11], s32 offen offset:0 nt lds
  s_mov_b32 s33, 163840
  v_exp_f32 v78, v78
  v_mfma_f32_16x16x32_bf16 v[0:3], a[200:203], v[96:99], v[0:3]
  ds_read_b128 v[104:107], v112 offset:256
  v_mul_f32 v80, s25, v80
  v_mfma_f32_16x16x32_bf16 v[4:7], a[232:235], v[96:99], v[4:7]
  v_exp_f32 v79, v79
  v_mfma_f32_16x16x32_bf16 v[8:11], v[160:163], v[96:99], v[8:11]
  ds_read_b128 a[96:99], v115 offset:0
  v_cvt_pk_bf16_f32 v75, v78, v79
  v_mfma_f32_16x16x32_bf16 v[12:15], v[164:167], v[96:99], v[12:15]
  ds_write_b128 v114, v[72:75] offset:12288
  v_mul_f32 v81, s25, v81
  v_mul_f32 v82, s25, v82
  v_mfma_f32_16x16x32_bf16 v[16:19], v[168:171], v[96:99], v[16:19]
  v_exp_f32 v80, v80
  v_mfma_f32_16x16x32_bf16 v[20:23], v[172:175], v[96:99], v[20:23]
  s_waitcnt lgkmcnt(3)
  ds_read_b128 v[96:99], v112 offset:320
  v_mul_f32 v83, s25, v83
  v_mfma_f32_16x16x32_bf16 v[0:3], a[204:207], v[100:103], v[0:3]
  s_add_u32 m0, s26, 42272
  v_exp_f32 v81, v81
  v_mfma_f32_16x16x32_bf16 v[4:7], a[236:239], v[100:103], v[4:7]
  ds_read_b128 a[100:103], v115 offset:1024
  v_mul_f32 v84, s25, v84
  v_mfma_f32_16x16x32_bf16 v[8:11], v[176:179], v[100:103], v[8:11]
  buffer_load_dwordx4 v118, s[8:11], s32 offen offset:1024 nt lds
  v_exp_f32 v82, v82
  v_mfma_f32_16x16x32_bf16 v[12:15], v[180:183], v[100:103], v[12:15]
  v_cvt_pk_bf16_f32 v80, v80, v81
  v_mul_f32 v85, s25, v85
  v_mfma_f32_16x16x32_bf16 v[16:19], v[184:187], v[100:103], v[16:19]
  v_exp_f32 v83, v83
  v_mfma_f32_16x16x32_bf16 v[20:23], v[188:191], v[100:103], v[20:23]
  s_waitcnt lgkmcnt(4)
  ds_read_b128 v[100:103], v112 offset:384
  v_mul_f32 v86, s25, v86
  v_mfma_f32_16x16x32_bf16 v[0:3], a[208:211], v[104:107], v[0:3]
  v_exp_f32 v84, v84
  v_mfma_f32_16x16x32_bf16 v[4:7], a[240:243], v[104:107], v[4:7]
  ds_read_b128 a[104:107], v115 offset:2048
  v_cvt_pk_bf16_f32 v81, v82, v83
  v_mfma_f32_16x16x32_bf16 v[8:11], v[192:195], v[104:107], v[8:11]
  v_exp_f32 v85, v85
  v_mfma_f32_16x16x32_bf16 v[12:15], v[196:199], v[104:107], v[12:15]
  v_mul_f32 v87, s25, v87
  v_cvt_pk_bf16_f32 v82, v84, v85
  v_mfma_f32_16x16x32_bf16 v[16:19], v[200:203], v[104:107], v[16:19]
  s_add_u32 m0, s26, 50688
  v_exp_f32 v86, v86
  v_mfma_f32_16x16x32_bf16 v[20:23], v[204:207], v[104:107], v[20:23]
  s_waitcnt lgkmcnt(3)
  ds_read_b128 v[104:107], v112 offset:448
  v_mul_f32 v88, s25, v88
  v_mfma_f32_16x16x32_bf16 v[0:3], a[212:215], v[96:99], v[0:3]
  buffer_load_dwordx4 v118, s[8:11], s33 offen offset:0 nt lds
  v_exp_f32 v87, v87
  v_mfma_f32_16x16x32_bf16 v[4:7], a[244:247], v[96:99], v[4:7]
  ds_read_b128 a[108:111], v115 offset:3072
  v_cvt_pk_bf16_f32 v83, v86, v87
  v_mfma_f32_16x16x32_bf16 v[8:11], v[208:211], v[96:99], v[8:11]
  ds_write_b128 v114, v[80:83] offset:13312
  v_mul_f32 v89, s25, v89
  v_mul_f32 v90, s25, v90
  v_mfma_f32_16x16x32_bf16 v[12:15], v[212:215], v[96:99], v[12:15]
  v_exp_f32 v88, v88
  v_mfma_f32_16x16x32_bf16 v[16:19], v[216:219], v[96:99], v[16:19]
  v_exp_f32 v89, v89
  v_mfma_f32_16x16x32_bf16 v[20:23], v[220:223], v[96:99], v[20:23]
  s_waitcnt lgkmcnt(4)
  ds_read_b128 v[96:99], v112 offset:8448
  v_mul_f32 v91, s25, v91
  v_mfma_f32_16x16x32_bf16 v[0:3], a[216:219], v[100:103], v[0:3]
  v_exp_f32 v90, v90
  v_mfma_f32_16x16x32_bf16 v[4:7], a[248:251], v[100:103], v[4:7]
  ds_read_b128 a[112:115], v115 offset:4096
  v_mul_f32 v92, s25, v92
  v_mfma_f32_16x16x32_bf16 v[8:11], v[224:227], v[100:103], v[8:11]
  s_add_u32 m0, s26, 50720
  v_cvt_pk_bf16_f32 v88, v88, v89
  v_mul_f32 v93, s25, v93
  v_mfma_f32_16x16x32_bf16 v[12:15], v[228:231], v[100:103], v[12:15]
  v_exp_f32 v91, v91
  v_mfma_f32_16x16x32_bf16 v[16:19], v[232:235], v[100:103], v[16:19]
  buffer_load_dwordx4 v118, s[8:11], s33 offen offset:1024 nt lds
  v_exp_f32 v92, v92
  v_mfma_f32_16x16x32_bf16 v[20:23], v[236:239], v[100:103], v[20:23]
  s_waitcnt lgkmcnt(4)
  ds_read_b128 v[100:103], v112 offset:8512
  v_mul_f32 v94, s25, v94
  v_mfma_f32_16x16x32_bf16 v[0:3], a[220:223], v[104:107], v[0:3]
  v_cvt_pk_bf16_f32 v89, v90, v91
  v_mul_f32 v95, s25, v95
  v_mfma_f32_16x16x32_bf16 v[4:7], a[252:255], v[104:107], v[4:7]
  ds_read_b128 a[116:119], v115 offset:5120
  v_mfma_f32_16x16x32_bf16 v[8:11], v[240:243], v[104:107], v[8:11]
  v_exp_f32 v93, v93
  v_mfma_f32_16x16x32_bf16 v[12:15], v[244:247], v[104:107], v[12:15]
  v_exp_f32 v94, v94
  v_mfma_f32_16x16x32_bf16 v[16:19], v[248:251], v[104:107], v[16:19]
  v_cvt_pk_bf16_f32 v90, v92, v93
  v_mul_f32 v0, s25, v0
  v_mfma_f32_16x16x32_bf16 v[20:23], v[252:255], v[104:107], v[20:23]
  s_waitcnt lgkmcnt(3)
  ds_read_b128 v[104:107], v112 offset:8576
  v_mul_f32 v1, s25, v1
  v_mfma_f32_16x16x32_bf16 v[24:27], a[192:195], v[96:99], 0
  v_exp_f32 v95, v95
  v_mfma_f32_16x16x32_bf16 v[28:31], a[224:227], v[96:99], 0
  ds_read_b128 a[120:123], v115 offset:6144
  v_cvt_pk_bf16_f32 v91, v94, v95
  v_mfma_f32_16x16x32_bf16 v[32:35], v[128:131], v[96:99], 0
  ds_write_b128 v114, v[88:91] offset:14336
  v_exp_f32 v0, v0
  v_mfma_f32_16x16x32_bf16 v[36:39], v[132:135], v[96:99], 0
  v_mul_f32 v2, s25, v2
  v_mul_f32 v3, s25, v3
  v_mfma_f32_16x16x32_bf16 v[40:43], v[136:139], v[96:99], 0
  v_exp_f32 v1, v1
  v_mfma_f32_16x16x32_bf16 v[44:47], v[140:143], v[96:99], 0
  s_waitcnt lgkmcnt(4)
  ds_read_b128 v[96:99], v112 offset:8640
  v_mul_f32 v4, s25, v4
  v_mfma_f32_16x16x32_bf16 v[24:27], a[196:199], v[100:103], v[24:27]
  ds_read_b128 a[124:127], v115 offset:7168
  v_cvt_pk_bf16_f32 v0, v0, v1
  v_mfma_f32_16x16x32_bf16 v[28:31], a[228:231], v[100:103], v[28:31]
  v_exp_f32 v2, v2
  v_mfma_f32_16x16x32_bf16 v[32:35], v[144:147], v[100:103], v[32:35]
  v_exp_f32 v3, v3
  v_mfma_f32_16x16x32_bf16 v[36:39], v[148:151], v[100:103], v[36:39]
  v_mul_f32 v5, s25, v5
  v_mul_f32 v6, s25, v6
  v_mfma_f32_16x16x32_bf16 v[40:43], v[152:155], v[100:103], v[40:43]
  v_exp_f32 v4, v4
  v_mfma_f32_16x16x32_bf16 v[44:47], v[156:159], v[100:103], v[44:47]
  s_waitcnt lgkmcnt(4)
  ds_read_b128 v[100:103], v112 offset:8704
  v_cvt_pk_bf16_f32 v1, v2, v3
  v_mfma_f32_16x16x32_bf16 v[24:27], a[200:203], v[104:107], v[24:27]
  ds_read_b128 a[128:131], v115 offset:8192
  v_mul_f32 v7, s25, v7
  v_mfma_f32_16x16x32_bf16 v[28:31], a[232:235], v[104:107], v[28:31]
  v_exp_f32 v5, v5
  v_mfma_f32_16x16x32_bf16 v[32:35], v[160:163], v[104:107], v[32:35]
  v_exp_f32 v6, v6
  v_mfma_f32_16x16x32_bf16 v[36:39], v[164:167], v[104:107], v[36:39]
  v_cvt_pk_bf16_f32 v2, v4, v5
  v_mul_f32 v8, s25, v8
  v_mfma_f32_16x16x32_bf16 v[40:43], v[168:171], v[104:107], v[40:43]
  v_exp_f32 v7, v7
  v_mfma_f32_16x16x32_bf16 v[44:47], v[172:175], v[104:107], v[44:47]
  s_waitcnt lgkmcnt(3)
  ds_read_b128 v[104:107], v112 offset:8768
  v_cvt_pk_bf16_f32 v3, v6, v7
  v_mfma_f32_16x16x32_bf16 v[24:27], a[204:207], v[96:99], v[24:27]
  ds_read_b128 a[132:135], v115 offset:9216
  v_mul_f32 v9, s25, v9
  v_mfma_f32_16x16x32_bf16 v[28:31], a[236:239], v[96:99], v[28:31]
  ds_write_b128 v114, v[0:3] offset:24576
  v_exp_f32 v8, v8
  v_mfma_f32_16x16x32_bf16 v[32:35], v[176:179], v[96:99], v[32:35]
  v_mul_f32 v10, s25, v10
  v_mul_f32 v11, s25, v11
  v_mfma_f32_16x16x32_bf16 v[36:39], v[180:183], v[96:99], v[36:39]
  v_exp_f32 v9, v9
  v_mfma_f32_16x16x32_bf16 v[40:43], v[184:187], v[96:99], v[40:43]
  v_exp_f32 v10, v10
  v_mfma_f32_16x16x32_bf16 v[44:47], v[188:191], v[96:99], v[44:47]
  s_waitcnt lgkmcnt(4)
  ds_read_b128 v[96:99], v112 offset:8832
  v_mul_f32 v12, s25, v12
  v_mfma_f32_16x16x32_bf16 v[24:27], a[208:211], v[100:103], v[24:27]
  ds_read_b128 a[136:139], v115 offset:10240
  v_cvt_pk_bf16_f32 v8, v8, v9
  v_mfma_f32_16x16x32_bf16 v[28:31], a[240:243], v[100:103], v[28:31]
  v_exp_f32 v11, v11
  v_mfma_f32_16x16x32_bf16 v[32:35], v[192:195], v[100:103], v[32:35]
  v_mul_f32 v13, s25, v13
  v_mul_f32 v14, s25, v14
  v_mfma_f32_16x16x32_bf16 v[36:39], v[196:199], v[100:103], v[36:39]
  v_exp_f32 v12, v12
  v_mfma_f32_16x16x32_bf16 v[40:43], v[200:203], v[100:103], v[40:43]
  v_cvt_pk_bf16_f32 v9, v10, v11
  v_mul_f32 v15, s25, v15
  v_mfma_f32_16x16x32_bf16 v[44:47], v[204:207], v[100:103], v[44:47]
  s_waitcnt lgkmcnt(4)
  ds_read_b128 v[100:103], v112 offset:8896
  v_mul_f32 v16, s25, v16
  v_mfma_f32_16x16x32_bf16 v[24:27], a[212:215], v[104:107], v[24:27]
  ds_read_b128 a[140:143], v115 offset:11264
  v_mul_f32 v17, s25, v17
  v_mfma_f32_16x16x32_bf16 v[28:31], a[244:247], v[104:107], v[28:31]
  v_exp_f32 v13, v13
  v_mfma_f32_16x16x32_bf16 v[32:35], v[208:211], v[104:107], v[32:35]
  v_exp_f32 v14, v14
  v_mfma_f32_16x16x32_bf16 v[36:39], v[212:215], v[104:107], v[36:39]
  v_cvt_pk_bf16_f32 v10, v12, v13
  v_mul_f32 v18, s25, v18
  v_mfma_f32_16x16x32_bf16 v[40:43], v[216:219], v[104:107], v[40:43]
  v_exp_f32 v15, v15
  v_mfma_f32_16x16x32_bf16 v[44:47], v[220:223], v[104:107], v[44:47]
  s_waitcnt lgkmcnt(3)
  ds_read_b128 v[104:107], v112 offset:16896
  v_cvt_pk_bf16_f32 v11, v14, v15
  v_mfma_f32_16x16x32_bf16 v[24:27], a[216:219], v[96:99], v[24:27]
  ds_write_b128 v114, v[8:11] offset:25600
  v_exp_f32 v16, v16
  v_mfma_f32_16x16x32_bf16 v[28:31], a[248:251], v[96:99], v[28:31]
  v_exp_f32 v17, v17
  v_mfma_f32_16x16x32_bf16 v[32:35], v[224:227], v[96:99], v[32:35]
  v_mul_f32 v19, s25, v19
  v_mul_f32 v20, s25, v20
  v_mfma_f32_16x16x32_bf16 v[36:39], v[228:231], v[96:99], v[36:39]
  v_exp_f32 v18, v18
  v_mfma_f32_16x16x32_bf16 v[40:43], v[232:235], v[96:99], v[40:43]
  v_cvt_pk_bf16_f32 v16, v16, v17
  v_mul_f32 v21, s25, v21
  v_mfma_f32_16x16x32_bf16 v[44:47], v[236:239], v[96:99], v[44:47]
  s_waitcnt lgkmcnt(3)
  ds_read_b128 v[96:99], v112 offset:16960
  v_mul_f32 v22, s25, v22
  v_mfma_f32_16x16x32_bf16 v[24:27], a[220:223], v[100:103], v[24:27]
  v_exp_f32 v19, v19
  v_mfma_f32_16x16x32_bf16 v[28:31], a[252:255], v[100:103], v[28:31]
  v_exp_f32 v20, v20
  v_mfma_f32_16x16x32_bf16 v[32:35], v[240:243], v[100:103], v[32:35]
  v_cvt_pk_bf16_f32 v17, v18, v19
  v_mul_f32 v23, s25, v23
  v_mfma_f32_16x16x32_bf16 v[36:39], v[244:247], v[100:103], v[36:39]
  v_exp_f32 v21, v21
  v_mfma_f32_16x16x32_bf16 v[40:43], v[248:251], v[100:103], v[40:43]
  v_exp_f32 v22, v22
  v_mfma_f32_16x16x32_bf16 v[44:47], v[252:255], v[100:103], v[44:47]
  s_waitcnt lgkmcnt(2)
  ds_read_b128 v[100:103], v112 offset:17024
  v_cvt_pk_bf16_f32 v18, v20, v21
  v_mfma_f32_16x16x32_bf16 v[48:51], a[192:195], v[104:107], 0
  v_exp_f32 v23, v23
  v_mfma_f32_16x16x32_bf16 v[52:55], a[224:227], v[104:107], 0
  v_mul_f32 v24, s25, v24
  v_cvt_pk_bf16_f32 v19, v22, v23
  v_mfma_f32_16x16x32_bf16 v[56:59], v[128:131], v[104:107], 0
  ds_write_b128 v114, v[16:19] offset:26624
  v_mul_f32 v25, s25, v25
  v_mul_f32 v26, s25, v26
  v_mfma_f32_16x16x32_bf16 v[60:63], v[132:135], v[104:107], 0
  v_exp_f32 v24, v24
  v_mfma_f32_16x16x32_bf16 v[64:67], v[136:139], v[104:107], 0
  v_exp_f32 v25, v25
  v_mfma_f32_16x16x32_bf16 v[68:71], v[140:143], v[104:107], 0
  s_waitcnt lgkmcnt(2)
  ds_read_b128 v[104:107], v112 offset:17088
  v_mul_f32 v27, s25, v27
  v_mfma_f32_16x16x32_bf16 v[48:51], a[196:199], v[96:99], v[48:51]
  s_lshl_b32 s58, s24, 13
  v_exp_f32 v26, v26
  v_mfma_f32_16x16x32_bf16 v[52:55], a[228:231], v[96:99], v[52:55]
  v_mul_f32 v28, s25, v28
  v_cvt_pk_bf16_f32 v24, v24, v25
  v_mfma_f32_16x16x32_bf16 v[56:59], v[144:147], v[96:99], v[56:59]
  s_waitcnt vmcnt(4)
  s_barrier
  v_exp_f32 v27, v27
  v_mfma_f32_16x16x32_bf16 v[60:63], v[148:151], v[96:99], v[60:63]
  s_mov_b32 s34, 172032
  v_mul_f32 v29, s25, v29
  v_mul_f32 v30, s25, v30
  v_mfma_f32_16x16x32_bf16 v[64:67], v[152:155], v[96:99], v[64:67]
  s_add_u32 m0, s26, 0
  v_exp_f32 v28, v28
  v_mfma_f32_16x16x32_bf16 v[68:71], v[156:159], v[96:99], v[68:71]
  s_waitcnt lgkmcnt(2)
  buffer_load_dwordx4 v118, s[8:11], s34 offen offset:0 nt lds
  s_mov_b32 s35, 180224
  v_cvt_pk_bf16_f32 v25, v26, v27
  v_mul_f32 v31, s25, v31
  v_mfma_f32_16x16x32_bf16 v[48:51], a[200:203], v[100:103], v[48:51]
  ds_read_b128 v[96:99], v112 offset:17152
  v_mul_f32 v32, s25, v32
  v_mfma_f32_16x16x32_bf16 v[52:55], a[232:235], v[100:103], v[52:55]
  v_exp_f32 v29, v29
  v_mfma_f32_16x16x32_bf16 v[56:59], v[160:163], v[100:103], v[56:59]
  v_exp_f32 v30, v30
  v_mfma_f32_16x16x32_bf16 v[60:63], v[164:167], v[100:103], v[60:63]
  v_cvt_pk_bf16_f32 v26, v28, v29
  v_mul_f32 v33, s25, v33
  v_mfma_f32_16x16x32_bf16 v[64:67], v[168:171], v[100:103], v[64:67]
  v_exp_f32 v31, v31
  v_mfma_f32_16x16x32_bf16 v[68:71], v[172:175], v[100:103], v[68:71]
  s_waitcnt lgkmcnt(1)
  ds_read_b128 v[100:103], v112 offset:17216
  v_cvt_pk_bf16_f32 v27, v30, v31
  v_mfma_f32_16x16x32_bf16 v[48:51], a[204:207], v[104:107], v[48:51]
  ds_write_b128 v114, v[24:27] offset:36864
  s_add_u32 m0, s26, 32
  v_exp_f32 v32, v32
  v_mfma_f32_16x16x32_bf16 v[52:55], a[236:239], v[104:107], v[52:55]
  v_mul_f32 v34, s25, v34
  v_mul_f32 v35, s25, v35
  v_mfma_f32_16x16x32_bf16 v[56:59], v[176:179], v[104:107], v[56:59]
  buffer_load_dwordx4 v118, s[8:11], s34 offen offset:1024 nt lds
  v_exp_f32 v33, v33
  v_mfma_f32_16x16x32_bf16 v[60:63], v[180:183], v[104:107], v[60:63]
  v_exp_f32 v34, v34
  v_mfma_f32_16x16x32_bf16 v[64:67], v[184:187], v[104:107], v[64:67]
  v_mul_f32 v36, s25, v36
  v_cvt_pk_bf16_f32 v32, v32, v33
  v_mfma_f32_16x16x32_bf16 v[68:71], v[188:191], v[104:107], v[68:71]
  s_waitcnt lgkmcnt(2)
  ds_read_b128 v[104:107], v112 offset:17280
  v_mul_f32 v37, s25, v37
  v_mfma_f32_16x16x32_bf16 v[48:51], a[208:211], v[96:99], v[48:51]
  v_exp_f32 v35, v35
  v_mfma_f32_16x16x32_bf16 v[52:55], a[240:243], v[96:99], v[52:55]
  v_exp_f32 v36, v36
  v_mfma_f32_16x16x32_bf16 v[56:59], v[192:195], v[96:99], v[56:59]
  v_mul_f32 v38, s25, v38
  v_cvt_pk_bf16_f32 v33, v34, v35
  v_mfma_f32_16x16x32_bf16 v[60:63], v[196:199], v[96:99], v[60:63]
  v_exp_f32 v37, v37
  v_mfma_f32_16x16x32_bf16 v[64:67], v[200:203], v[96:99], v[64:67]
  s_add_u32 m0, s26, 8448
  v_mul_f32 v39, s25, v39
  v_cvt_pk_bf16_f32 v34, v36, v37
  v_mfma_f32_16x16x32_bf16 v[68:71], v[204:207], v[96:99], v[68:71]
  s_waitcnt lgkmcnt(2)
  ds_read_b128 v[96:99], v112 offset:17344
  s_mov_b32 s36, 0
  v_mul_f32 v40, s25, v40
  v_mfma_f32_16x16x32_bf16 v[48:51], a[212:215], v[100:103], v[48:51]
  buffer_load_dwordx4 v118, s[8:11], s35 offen offset:0 nt lds
  v_exp_f32 v38, v38
  v_mfma_f32_16x16x32_bf16 v[52:55], a[244:247], v[100:103], v[52:55]
  v_exp_f32 v39, v39
  v_mfma_f32_16x16x32_bf16 v[56:59], v[208:211], v[100:103], v[56:59]
  v_cvt_pk_bf16_f32 v35, v38, v39
  v_mul_f32 v41, s25, v41
  v_mfma_f32_16x16x32_bf16 v[60:63], v[212:215], v[100:103], v[60:63]
  ds_write_b128 v114, v[32:35] offset:37888
  v_exp_f32 v40, v40
  v_mfma_f32_16x16x32_bf16 v[64:67], v[216:219], v[100:103], v[64:67]
  v_mul_f32 v42, s25, v42
  v_mul_f32 v43, s25, v43
  v_mfma_f32_16x16x32_bf16 v[68:71], v[220:223], v[100:103], v[68:71]
  s_waitcnt lgkmcnt(2)
  ds_read_b128 v[100:103], v112 offset:25344
  v_mul_f32 v44, s25, v44
  v_mfma_f32_16x16x32_bf16 v[48:51], a[216:219], v[104:107], v[48:51]
  v_exp_f32 v41, v41
  v_mfma_f32_16x16x32_bf16 v[52:55], a[248:251], v[104:107], v[52:55]
  v_exp_f32 v42, v42
  v_mfma_f32_16x16x32_bf16 v[56:59], v[224:227], v[104:107], v[56:59]
  s_add_u32 m0, s26, 8480
  v_cvt_pk_bf16_f32 v40, v40, v41
  v_mul_f32 v45, s25, v45
  v_mfma_f32_16x16x32_bf16 v[60:63], v[228:231], v[104:107], v[60:63]
  v_exp_f32 v43, v43
  v_mfma_f32_16x16x32_bf16 v[64:67], v[232:235], v[104:107], v[64:67]
  buffer_load_dwordx4 v118, s[8:11], s35 offen offset:1024 nt lds
  s_add_u32 m0, s29, 158464
  v_exp_f32 v44, v44
  v_mfma_f32_16x16x32_bf16 v[68:71], v[236:239], v[104:107], v[68:71]
  s_waitcnt lgkmcnt(2)
  buffer_load_dwordx4 v119, s[16:19], s36 offen nt lds
  v_mul_f32 v46, s25, v46
  v_cvt_pk_bf16_f32 v41, v42, v43
  v_mfma_f32_16x16x32_bf16 v[48:51], a[220:223], v[96:99], v[48:51]
  ds_read_b128 v[104:107], v112 offset:25408
  v_mul_f32 v47, s25, v47
  v_mfma_f32_16x16x32_bf16 v[52:55], a[252:255], v[96:99], v[52:55]
  v_exp_f32 v45, v45
  v_mfma_f32_16x16x32_bf16 v[56:59], v[240:243], v[96:99], v[56:59]
  v_exp_f32 v46, v46
  v_mfma_f32_16x16x32_bf16 v[60:63], v[244:247], v[96:99], v[60:63]
  v_cvt_pk_bf16_f32 v42, v44, v45
  v_mul_f32 v48, s25, v48
  v_mfma_f32_16x16x32_bf16 v[64:67], v[248:251], v[96:99], v[64:67]
  v_exp_f32 v47, v47
  v_mfma_f32_16x16x32_bf16 v[68:71], v[252:255], v[96:99], v[68:71]
  s_waitcnt lgkmcnt(1)
  ds_read_b128 v[96:99], v112 offset:25472
  v_cvt_pk_bf16_f32 v43, v46, v47
  v_mfma_f32_16x16x32_bf16 v[72:75], a[192:195], v[100:103], 0
  ds_write_b128 v114, v[40:43] offset:38912
  v_mul_f32 v49, s25, v49
  v_mul_f32 v50, s25, v50
  v_mfma_f32_16x16x32_bf16 v[76:79], a[224:227], v[100:103], 0
  v_exp_f32 v48, v48
  v_mfma_f32_16x16x32_bf16 v[80:83], v[128:131], v[100:103], 0
  v_exp_f32 v49, v49
  v_mfma_f32_16x16x32_bf16 v[84:87], v[132:135], v[100:103], 0
  v_mul_f32 v51, s25, v51
  v_mul_f32 v52, s25, v52
  v_mfma_f32_16x16x32_bf16 v[88:91], v[136:139], v[100:103], 0
  v_exp_f32 v50, v50
  v_mfma_f32_16x16x32_bf16 v[92:95], v[140:143], v[100:103], 0
  s_waitcnt lgkmcnt(2)
  ds_read_b128 v[100:103], v112 offset:25536
  v_cvt_pk_bf16_f32 v48, v48, v49
  v_mfma_f32_16x16x32_bf16 v[72:75], a[196:199], v[104:107], v[72:75]
  v_exp_f32 v51, v51
  v_mfma_f32_16x16x32_bf16 v[76:79], a[228:231], v[104:107], v[76:79]
  v_mul_f32 v53, s25, v53
  v_mul_f32 v54, s25, v54
  v_mfma_f32_16x16x32_bf16 v[80:83], v[144:147], v[104:107], v[80:83]
  v_exp_f32 v52, v52
  v_mfma_f32_16x16x32_bf16 v[84:87], v[148:151], v[104:107], v[84:87]
  v_cvt_pk_bf16_f32 v49, v50, v51
  v_mul_f32 v55, s25, v55
  v_mfma_f32_16x16x32_bf16 v[88:91], v[152:155], v[104:107], v[88:91]
  v_exp_f32 v53, v53
  v_mfma_f32_16x16x32_bf16 v[92:95], v[156:159], v[104:107], v[92:95]
  s_waitcnt lgkmcnt(2)
  ds_read_b128 v[104:107], v112 offset:25600
  v_cvt_pk_bf16_f32 v50, v52, v53
  v_mfma_f32_16x16x32_bf16 v[72:75], a[200:203], v[96:99], v[72:75]
  v_exp_f32 v54, v54
  v_mfma_f32_16x16x32_bf16 v[76:79], a[232:235], v[96:99], v[76:79]
  v_exp_f32 v55, v55
  v_mfma_f32_16x16x32_bf16 v[80:83], v[160:163], v[96:99], v[80:83]
  v_mul_f32 v56, s25, v56
  v_cvt_pk_bf16_f32 v51, v54, v55
  v_mfma_f32_16x16x32_bf16 v[84:87], v[164:167], v[96:99], v[84:87]
  ds_write_b128 v113, v[48:51] offset:0
  v_mul_f32 v57, s25, v57
  v_mul_f32 v58, s25, v58
  v_mfma_f32_16x16x32_bf16 v[88:91], v[168:171], v[96:99], v[88:91]
  v_exp_f32 v56, v56
  v_mfma_f32_16x16x32_bf16 v[92:95], v[172:175], v[96:99], v[92:95]
  s_waitcnt lgkmcnt(2)
  ds_read_b128 v[96:99], v112 offset:25664
  v_mul_f32 v59, s25, v59
  v_mfma_f32_16x16x32_bf16 v[72:75], a[204:207], v[100:103], v[72:75]
  v_exp_f32 v57, v57
  v_mfma_f32_16x16x32_bf16 v[76:79], a[236:239], v[100:103], v[76:79]
  v_exp_f32 v58, v58
  v_mfma_f32_16x16x32_bf16 v[80:83], v[176:179], v[100:103], v[80:83]
  v_mul_f32 v60, s25, v60
  v_cvt_pk_bf16_f32 v56, v56, v57
  v_mfma_f32_16x16x32_bf16 v[84:87], v[180:183], v[100:103], v[84:87]
  v_exp_f32 v59, v59
  v_mfma_f32_16x16x32_bf16 v[88:91], v[184:187], v[100:103], v[88:91]
  v_mul_f32 v61, s25, v61
  v_mul_f32 v62, s25, v62
  v_mfma_f32_16x16x32_bf16 v[92:95], v[188:191], v[100:103], v[92:95]
  s_waitcnt lgkmcnt(2)
  ds_read_b128 v[100:103], v112 offset:25728
  v_cvt_pk_bf16_f32 v57, v58, v59
  v_mfma_f32_16x16x32_bf16 v[72:75], a[208:211], v[104:107], v[72:75]
  v_exp_f32 v60, v60
  v_mfma_f32_16x16x32_bf16 v[76:79], a[240:243], v[104:107], v[76:79]
  v_exp_f32 v61, v61
  v_mfma_f32_16x16x32_bf16 v[80:83], v[192:195], v[104:107], v[80:83]
  v_mul_f32 v63, s25, v63
  v_cvt_pk_bf16_f32 v58, v60, v61
  v_mfma_f32_16x16x32_bf16 v[84:87], v[196:199], v[104:107], v[84:87]
  v_exp_f32 v62, v62
  v_mfma_f32_16x16x32_bf16 v[88:91], v[200:203], v[104:107], v[88:91]
  v_exp_f32 v63, v63
  v_mfma_f32_16x16x32_bf16 v[92:95], v[204:207], v[104:107], v[92:95]
  s_waitcnt lgkmcnt(1)
  ds_read_b128 v[104:107], v112 offset:25792
  v_mul_f32 v64, s25, v64
  v_mfma_f32_16x16x32_bf16 v[72:75], a[212:215], v[96:99], v[72:75]
  v_cvt_pk_bf16_f32 v59, v62, v63
  v_mul_f32 v65, s25, v65
  v_mfma_f32_16x16x32_bf16 v[76:79], a[244:247], v[96:99], v[76:79]
  ds_write_b128 v113, v[56:59] offset:1024
  v_exp_f32 v64, v64
  v_mfma_f32_16x16x32_bf16 v[80:83], v[208:211], v[96:99], v[80:83]
  v_mul_f32 v66, s25, v66
  v_mul_f32 v67, s25, v67
  v_mfma_f32_16x16x32_bf16 v[84:87], v[212:215], v[96:99], v[84:87]
  v_exp_f32 v65, v65
  v_mfma_f32_16x16x32_bf16 v[88:91], v[216:219], v[96:99], v[88:91]
  v_exp_f32 v66, v66
  v_mfma_f32_16x16x32_bf16 v[92:95], v[220:223], v[96:99], v[92:95]
  s_waitcnt lgkmcnt(2)
  ds_read_b128 v[96:99], v112 offset:33792
  v_mul_f32 v68, s25, v68
  v_mfma_f32_16x16x32_bf16 v[72:75], a[216:219], v[100:103], v[72:75]
  v_cvt_pk_bf16_f32 v64, v64, v65
  v_mul_f32 v69, s25, v69
  v_mfma_f32_16x16x32_bf16 v[76:79], a[248:251], v[100:103], v[76:79]
  v_exp_f32 v67, v67
  v_mfma_f32_16x16x32_bf16 v[80:83], v[224:227], v[100:103], v[80:83]
  v_exp_f32 v68, v68
  v_mfma_f32_16x16x32_bf16 v[84:87], v[228:231], v[100:103], v[84:87]
  v_mul_f32 v70, s25, v70
  v_cvt_pk_bf16_f32 v65, v66, v67
  v_mfma_f32_16x16x32_bf16 v[88:91], v[232:235], v[100:103], v[88:91]
  v_exp_f32 v69, v69
  v_mfma_f32_16x16x32_bf16 v[92:95], v[236:239], v[100:103], v[92:95]
  s_waitcnt lgkmcnt(2)
  ds_read_b128 v[100:103], v112 offset:33856
  v_mul_f32 v71, s25, v71
  v_mfma_f32_16x16x32_bf16 v[72:75], a[220:223], v[104:107], v[72:75]
  v_exp_f32 v70, v70
  v_mfma_f32_16x16x32_bf16 v[76:79], a[252:255], v[104:107], v[76:79]
  v_cvt_pk_bf16_f32 v66, v68, v69
  v_mfma_f32_16x16x32_bf16 v[80:83], v[240:243], v[104:107], v[80:83]
  v_exp_f32 v71, v71
  v_mfma_f32_16x16x32_bf16 v[84:87], v[244:247], v[104:107], v[84:87]
  v_cvt_pk_bf16_f32 v67, v70, v71
  v_mfma_f32_16x16x32_bf16 v[88:91], v[248:251], v[104:107], v[88:91]
  ds_write_b128 v113, v[64:67] offset:2048
  v_mul_f32 v72, s25, v72
  v_mul_f32 v73, s25, v73
  v_mfma_f32_16x16x32_bf16 v[92:95], v[252:255], v[104:107], v[92:95]
  s_waitcnt lgkmcnt(2)
  ds_read_b128 v[104:107], v112 offset:33920
  v_mul_f32 v74, s25, v74
  v_mfma_f32_16x16x32_bf16 v[0:3], a[192:195], v[96:99], 0
  v_exp_f32 v72, v72
  v_mfma_f32_16x16x32_bf16 v[4:7], a[224:227], v[96:99], 0
  v_exp_f32 v73, v73
  v_mfma_f32_16x16x32_bf16 v[8:11], v[128:131], v[96:99], 0
  v_mul_f32 v75, s25, v75
  v_mul_f32 v76, s25, v76
  v_mfma_f32_16x16x32_bf16 v[12:15], v[132:135], v[96:99], 0
  v_exp_f32 v74, v74
  v_mfma_f32_16x16x32_bf16 v[16:19], v[136:139], v[96:99], 0
  v_cvt_pk_bf16_f32 v72, v72, v73
  v_mul_f32 v77, s25, v77
  v_mfma_f32_16x16x32_bf16 v[20:23], v[140:143], v[96:99], 0
  s_waitcnt lgkmcnt(2)
  ds_read_b128 v[96:99], v112 offset:33984
  v_mul_f32 v78, s25, v78
  v_mfma_f32_16x16x32_bf16 v[0:3], a[196:199], v[100:103], v[0:3]
  v_exp_f32 v75, v75
  v_mfma_f32_16x16x32_bf16 v[4:7], a[228:231], v[100:103], v[4:7]
  v_exp_f32 v76, v76
  v_mfma_f32_16x16x32_bf16 v[8:11], v[144:147], v[100:103], v[8:11]
  s_waitcnt vmcnt(5)
  s_barrier
  v_cvt_pk_bf16_f32 v73, v74, v75
  v_mul_f32 v79, s25, v79
  v_mfma_f32_16x16x32_bf16 v[12:15], v[148:151], v[100:103], v[12:15]
  s_mov_b32 s37, 188416
  v_exp_f32 v77, v77
  v_mfma_f32_16x16x32_bf16 v[16:19], v[152:155], v[100:103], v[16:19]
  s_add_u32 m0, s26, 16896
  v_exp_f32 v78, v78
  v_mfma_f32_16x16x32_bf16 v[20:23], v[156:159], v[100:103], v[20:23]
  s_waitcnt lgkmcnt(1)
  buffer_load_dwordx4 v118, s[8:11], s37 offen offset:0 nt lds
  v_cvt_pk_bf16_f32 v74, v76, v77
  v_mul_f32 v80, s25, v80
  v_mfma_f32_16x16x32_bf16 v[0:3], a[200:203], v[104:107], v[0:3]
  ds_read_b128 v[100:103], v112 offset:34048
  v_mul_f32 v81, s25, v81
  v_mfma_f32_16x16x32_bf16 v[4:7], a[232:235], v[104:107], v[4:7]
  v_exp_f32 v79, v79
  v_mfma_f32_16x16x32_bf16 v[8:11], v[160:163], v[104:107], v[8:11]
  ds_read_b128 a[144:147], v115 offset:49152
  v_cvt_pk_bf16_f32 v75, v78, v79
  v_mfma_f32_16x16x32_bf16 v[12:15], v[164:167], v[104:107], v[12:15]
  ds_write_b128 v113, v[72:75] offset:12288
  v_exp_f32 v80, v80
  v_mfma_f32_16x16x32_bf16 v[16:19], v[168:171], v[104:107], v[16:19]
  v_mul_f32 v82, s25, v82
  v_mul_f32 v83, s25, v83
  v_mfma_f32_16x16x32_bf16 v[20:23], v[172:175], v[104:107], v[20:23]
  s_waitcnt lgkmcnt(3)
  ds_read_b128 v[104:107], v112 offset:34112
  v_mul_f32 v84, s25, v84
  v_mfma_f32_16x16x32_bf16 v[0:3], a[204:207], v[96:99], v[0:3]
  s_add_u32 m0, s26, 16928
  v_exp_f32 v81, v81
  v_mfma_f32_16x16x32_bf16 v[4:7], a[236:239], v[96:99], v[4:7]
  ds_read_b128 a[148:151], v115 offset:50176
  v_cvt_pk_bf16_f32 v80, v80, v81
  v_mfma_f32_16x16x32_bf16 v[8:11], v[176:179], v[96:99], v[8:11]
  buffer_load_dwordx4 v118, s[8:11], s37 offen offset:1024 nt lds
  v_exp_f32 v82, v82
  v_mfma_f32_16x16x32_bf16 v[12:15], v[180:183], v[96:99], v[12:15]
  v_exp_f32 v83, v83
  v_mfma_f32_16x16x32_bf16 v[16:19], v[184:187], v[96:99], v[16:19]
  v_mul_f32 v85, s25, v85
  v_mul_f32 v86, s25, v86
  v_mfma_f32_16x16x32_bf16 v[20:23], v[188:191], v[96:99], v[20:23]
  s_waitcnt lgkmcnt(4)
  ds_read_b128 v[96:99], v112 offset:34176
  v_cvt_pk_bf16_f32 v81, v82, v83
  v_mfma_f32_16x16x32_bf16 v[0:3], a[208:211], v[100:103], v[0:3]
  v_exp_f32 v84, v84
  v_mfma_f32_16x16x32_bf16 v[4:7], a[240:243], v[100:103], v[4:7]
  ds_read_b128 a[152:155], v115 offset:51200
  v_mul_f32 v87, s25, v87
  v_mfma_f32_16x16x32_bf16 v[8:11], v[192:195], v[100:103], v[8:11]
  v_exp_f32 v85, v85
  v_mfma_f32_16x16x32_bf16 v[12:15], v[196:199], v[100:103], v[12:15]
  v_exp_f32 v86, v86
  v_mfma_f32_16x16x32_bf16 v[16:19], v[200:203], v[100:103], v[16:19]
  v_cvt_pk_bf16_f32 v82, v84, v85
  v_mul_f32 v88, s25, v88
  v_mfma_f32_16x16x32_bf16 v[20:23], v[204:207], v[100:103], v[20:23]
  s_waitcnt lgkmcnt(3)
  ds_read_b128 v[100:103], v112 offset:34240
  s_mov_b32 s38, 16384
  v_mul_f32 v89, s25, v89
  v_mfma_f32_16x16x32_bf16 v[0:3], a[212:215], v[104:107], v[0:3]
  s_add_u32 m0, s29, 25344
  v_exp_f32 v87, v87
  v_mfma_f32_16x16x32_bf16 v[4:7], a[244:247], v[104:107], v[4:7]
  ds_read_b128 a[156:159], v115 offset:52224
  v_cvt_pk_bf16_f32 v83, v86, v87
  v_mfma_f32_16x16x32_bf16 v[8:11], v[208:211], v[104:107], v[8:11]
  buffer_load_dwordx4 v119, s[16:19], s38 offen nt lds
  v_exp_f32 v88, v88
  v_mfma_f32_16x16x32_bf16 v[12:15], v[212:215], v[104:107], v[12:15]
  ds_write_b128 v113, v[80:83] offset:13312
  v_mul_f32 v90, s25, v90
  v_mul_f32 v91, s25, v91
  v_mfma_f32_16x16x32_bf16 v[16:19], v[216:219], v[104:107], v[16:19]
  v_exp_f32 v89, v89
  v_mfma_f32_16x16x32_bf16 v[20:23], v[220:223], v[104:107], v[20:23]
  s_waitcnt lgkmcnt(4)
  ds_read_b128 v[104:107], v112 offset:42240
  v_mul_f32 v92, s25, v92
  v_mfma_f32_16x16x32_bf16 v[0:3], a[216:219], v[96:99], v[0:3]
  v_exp_f32 v90, v90
  v_mfma_f32_16x16x32_bf16 v[4:7], a[248:251], v[96:99], v[4:7]
  ds_read_b128 a[160:163], v115 offset:53248
  v_cvt_pk_bf16_f32 v88, v88, v89
  v_mfma_f32_16x16x32_bf16 v[8:11], v[224:227], v[96:99], v[8:11]
  v_exp_f32 v91, v91
  v_mfma_f32_16x16x32_bf16 v[12:15], v[228:231], v[96:99], v[12:15]
  s_mov_b32 s39, 32768
  v_mul_f32 v93, s25, v93
  v_mul_f32 v94, s25, v94
  v_mfma_f32_16x16x32_bf16 v[16:19], v[232:235], v[96:99], v[16:19]
  s_add_u32 m0, s29, 29440
  v_exp_f32 v92, v92
  v_mfma_f32_16x16x32_bf16 v[20:23], v[236:239], v[96:99], v[20:23]
  s_waitcnt lgkmcnt(4)
  ds_read_b128 v[96:99], v112 offset:42304
  v_cvt_pk_bf16_f32 v89, v90, v91
  v_mfma_f32_16x16x32_bf16 v[0:3], a[220:223], v[100:103], v[0:3]
  buffer_load_dwordx4 v119, s[16:19], s39 offen nt lds
  v_exp_f32 v93, v93
  v_mfma_f32_16x16x32_bf16 v[4:7], a[252:255], v[100:103], v[4:7]
  ds_read_b128 a[164:167], v115 offset:54272
  v_mul_f32 v95, s25, v95
  v_mfma_f32_16x16x32_bf16 v[8:11], v[240:243], v[100:103], v[8:11]
  v_exp_f32 v94, v94
  v_mfma_f32_16x16x32_bf16 v[12:15], v[244:247], v[100:103], v[12:15]
  v_cvt_pk_bf16_f32 v90, v92, v93
  v_mul_f32 v0, s25, v0
  v_mfma_f32_16x16x32_bf16 v[16:19], v[248:251], v[100:103], v[16:19]
  v_exp_f32 v95, v95
  v_mfma_f32_16x16x32_bf16 v[20:23], v[252:255], v[100:103], v[20:23]
  s_waitcnt lgkmcnt(3)
  ds_read_b128 v[100:103], v112 offset:42368
  v_cvt_pk_bf16_f32 v91, v94, v95
  v_mfma_f32_16x16x32_bf16 v[24:27], a[192:195], v[104:107], 0
  ds_write_b128 v113, v[88:91] offset:14336
  v_mul_f32 v1, s25, v1
  v_mul_f32 v2, s25, v2
  v_mfma_f32_16x16x32_bf16 v[28:31], a[224:227], v[104:107], 0
  ds_read_b128 a[168:171], v115 offset:55296
  v_mul_f32 v3, s25, v3
  v_mfma_f32_16x16x32_bf16 v[32:35], v[128:131], v[104:107], 0
  v_exp_f32 v0, v0
  v_mfma_f32_16x16x32_bf16 v[36:39], v[132:135], v[104:107], 0
  v_exp_f32 v1, v1
  v_mfma_f32_16x16x32_bf16 v[40:43], v[136:139], v[104:107], 0
  v_exp_f32 v2, v2
  v_mfma_f32_16x16x32_bf16 v[44:47], v[140:143], v[104:107], 0
  s_waitcnt lgkmcnt(4)
  ds_read_b128 v[104:107], v112 offset:42432
  v_mul_f32 v4, s25, v4
  v_mfma_f32_16x16x32_bf16 v[24:27], a[196:199], v[96:99], v[24:27]
  ds_read_b128 a[172:175], v115 offset:56320
  v_cvt_pk_bf16_f32 v0, v0, v1
  v_mfma_f32_16x16x32_bf16 v[28:31], a[228:231], v[96:99], v[28:31]
  v_exp_f32 v3, v3
  v_mfma_f32_16x16x32_bf16 v[32:35], v[144:147], v[96:99], v[32:35]
  v_mul_f32 v5, s25, v5
  v_mul_f32 v6, s25, v6
  v_mfma_f32_16x16x32_bf16 v[36:39], v[148:151], v[96:99], v[36:39]
  v_exp_f32 v4, v4
  v_mfma_f32_16x16x32_bf16 v[40:43], v[152:155], v[96:99], v[40:43]
  v_cvt_pk_bf16_f32 v1, v2, v3
  v_mul_f32 v7, s25, v7
  v_mfma_f32_16x16x32_bf16 v[44:47], v[156:159], v[96:99], v[44:47]
  s_waitcnt lgkmcnt(4)
  ds_read_b128 v[96:99], v112 offset:42496
  v_mul_f32 v8, s25, v8
  v_mfma_f32_16x16x32_bf16 v[24:27], a[200:203], v[100:103], v[24:27]
  ds_read_b128 a[176:179], v115 offset:57344
  v_mul_f32 v9, s25, v9
  v_mfma_f32_16x16x32_bf16 v[28:31], a[232:235], v[100:103], v[28:31]
  v_exp_f32 v5, v5
  v_mfma_f32_16x16x32_bf16 v[32:35], v[160:163], v[100:103], v[32:35]
  v_exp_f32 v6, v6
  v_mfma_f32_16x16x32_bf16 v[36:39], v[164:167], v[100:103], v[36:39]
  v_cvt_pk_bf16_f32 v2, v4, v5
  v_mul_f32 v10, s25, v10
  v_mfma_f32_16x16x32_bf16 v[40:43], v[168:171], v[100:103], v[40:43]
  v_exp_f32 v7, v7
  v_mfma_f32_16x16x32_bf16 v[44:47], v[172:175], v[100:103], v[44:47]
  s_waitcnt lgkmcnt(3)
  ds_read_b128 v[100:103], v112 offset:42560
  v_cvt_pk_bf16_f32 v3, v6, v7
  v_mfma_f32_16x16x32_bf16 v[24:27], a[204:207], v[104:107], v[24:27]
  ds_read_b128 a[180:183], v115 offset:58368
  v_mul_f32 v11, s25, v11
  v_mfma_f32_16x16x32_bf16 v[28:31], a[236:239], v[104:107], v[28:31]
  ds_write_b128 v113, v[0:3] offset:24576
  v_exp_f32 v8, v8
  v_mfma_f32_16x16x32_bf16 v[32:35], v[176:179], v[104:107], v[32:35]
  v_exp_f32 v9, v9
  v_mfma_f32_16x16x32_bf16 v[36:39], v[180:183], v[104:107], v[36:39]
  v_exp_f32 v10, v10
  v_mfma_f32_16x16x32_bf16 v[40:43], v[184:187], v[104:107], v[40:43]
  v_mul_f32 v12, s25, v12
  v_cvt_pk_bf16_f32 v8, v8, v9
  v_mfma_f32_16x16x32_bf16 v[44:47], v[188:191], v[104:107], v[44:47]
  s_waitcnt lgkmcnt(4)
  ds_read_b128 v[104:107], v112 offset:42624
  v_mul_f32 v13, s25, v13
  v_mfma_f32_16x16x32_bf16 v[24:27], a[208:211], v[96:99], v[24:27]
  ds_read_b128 a[184:187], v115 offset:59392
  v_mul_f32 v14, s25, v14
  v_mfma_f32_16x16x32_bf16 v[28:31], a[240:243], v[96:99], v[28:31]
  v_exp_f32 v11, v11
  v_mfma_f32_16x16x32_bf16 v[32:35], v[192:195], v[96:99], v[32:35]
  v_exp_f32 v12, v12
  v_mfma_f32_16x16x32_bf16 v[36:39], v[196:199], v[96:99], v[36:39]
  v_cvt_pk_bf16_f32 v9, v10, v11
  v_mul_f32 v15, s25, v15
  v_mfma_f32_16x16x32_bf16 v[40:43], v[200:203], v[96:99], v[40:43]
  v_exp_f32 v13, v13
  v_mfma_f32_16x16x32_bf16 v[44:47], v[204:207], v[96:99], v[44:47]
  s_waitcnt lgkmcnt(4)
  ds_read_b128 v[96:99], v112 offset:42688
  v_cvt_pk_bf16_f32 v10, v12, v13
  v_mfma_f32_16x16x32_bf16 v[24:27], a[212:215], v[100:103], v[24:27]
  ds_read_b128 a[188:191], v115 offset:60416
  v_mul_f32 v16, s25, v16
  v_mfma_f32_16x16x32_bf16 v[28:31], a[244:247], v[100:103], v[28:31]
  v_exp_f32 v14, v14
  v_mfma_f32_16x16x32_bf16 v[32:35], v[208:211], v[100:103], v[32:35]
  v_exp_f32 v15, v15
  v_mfma_f32_16x16x32_bf16 v[36:39], v[212:215], v[100:103], v[36:39]
  v_cvt_pk_bf16_f32 v11, v14, v15
  v_mul_f32 v17, s25, v17
  v_mfma_f32_16x16x32_bf16 v[40:43], v[216:219], v[100:103], v[40:43]
  ds_write_b128 v113, v[8:11] offset:25600
  v_exp_f32 v16, v16
  v_mfma_f32_16x16x32_bf16 v[44:47], v[220:223], v[100:103], v[44:47]
  s_waitcnt lgkmcnt(4)
  ds_read_b128 v[100:103], v112 offset:50688
  v_mul_f32 v18, s25, v18
  v_mfma_f32_16x16x32_bf16 v[24:27], a[216:219], v[104:107], v[24:27]
  v_exp_f32 v17, v17
  v_mfma_f32_16x16x32_bf16 v[28:31], a[248:251], v[104:107], v[28:31]
  v_mul_f32 v19, s25, v19
  v_mul_f32 v20, s25, v20
  v_mfma_f32_16x16x32_bf16 v[32:35], v[224:227], v[104:107], v[32:35]
  v_exp_f32 v18, v18
  v_mfma_f32_16x16x32_bf16 v[36:39], v[228:231], v[104:107], v[36:39]
  v_cvt_pk_bf16_f32 v16, v16, v17
  v_mul_f32 v21, s25, v21
  v_mfma_f32_16x16x32_bf16 v[40:43], v[232:235], v[104:107], v[40:43]
  v_exp_f32 v19, v19
  v_mfma_f32_16x16x32_bf16 v[44:47], v[236:239], v[104:107], v[44:47]
  s_waitcnt lgkmcnt(3)
  ds_read_b128 v[104:107], v112 offset:50752
  v_mul_f32 v22, s25, v22
  v_mfma_f32_16x16x32_bf16 v[24:27], a[220:223], v[96:99], v[24:27]
  v_exp_f32 v20, v20
  v_mfma_f32_16x16x32_bf16 v[28:31], a[252:255], v[96:99], v[28:31]
  v_cvt_pk_bf16_f32 v17, v18, v19
  v_mul_f32 v23, s25, v23
  v_mfma_f32_16x16x32_bf16 v[32:35], v[240:243], v[96:99], v[32:35]
  v_exp_f32 v21, v21
  v_mfma_f32_16x16x32_bf16 v[36:39], v[244:247], v[96:99], v[36:39]
  v_exp_f32 v22, v22
  v_mfma_f32_16x16x32_bf16 v[40:43], v[248:251], v[96:99], v[40:43]
  v_cvt_pk_bf16_f32 v18, v20, v21
  v_mul_f32 v24, s25, v24
  v_mfma_f32_16x16x32_bf16 v[44:47], v[252:255], v[96:99], v[44:47]
  s_waitcnt lgkmcnt(1)
  ds_read_b128 v[96:99], v112 offset:50816
  v_mul_f32 v25, s25, v25
  v_mfma_f32_16x16x32_bf16 v[48:51], a[192:195], v[100:103], 0
  v_exp_f32 v23, v23
  v_mfma_f32_16x16x32_bf16 v[52:55], a[224:227], v[100:103], 0
  v_cvt_pk_bf16_f32 v19, v22, v23
  v_mul_f32 v26, s25, v26
  v_mfma_f32_16x16x32_bf16 v[56:59], v[128:131], v[100:103], 0
  ds_write_b128 v113, v[16:19] offset:26624
  v_exp_f32 v24, v24
  v_mfma_f32_16x16x32_bf16 v[60:63], v[132:135], v[100:103], 0
  v_exp_f32 v25, v25
  v_mfma_f32_16x16x32_bf16 v[64:67], v[136:139], v[100:103], 0
  v_mul_f32 v27, s25, v27
  v_mul_f32 v28, s25, v28
  v_mfma_f32_16x16x32_bf16 v[68:71], v[140:143], v[100:103], 0
  s_waitcnt lgkmcnt(2)
  ds_read_b128 v[100:103], v112 offset:50880
  v_cvt_pk_bf16_f32 v24, v24, v25
  v_mfma_f32_16x16x32_bf16 v[48:51], a[196:199], v[104:107], v[48:51]
  v_exp_f32 v26, v26
  v_mfma_f32_16x16x32_bf16 v[52:55], a[228:231], v[104:107], v[52:55]
  v_exp_f32 v27, v27
  v_mfma_f32_16x16x32_bf16 v[56:59], v[144:147], v[104:107], v[56:59]
  s_waitcnt vmcnt(5)
  s_barrier
  v_mul_f32 v29, s25, v29
  v_mul_f32 v30, s25, v30
  v_mfma_f32_16x16x32_bf16 v[60:63], v[148:151], v[104:107], v[60:63]
  s_mov_b32 s40, 49152
  v_exp_f32 v28, v28
  v_mfma_f32_16x16x32_bf16 v[64:67], v[152:155], v[104:107], v[64:67]
  s_add_u32 m0, s29, 33792
  v_cvt_pk_bf16_f32 v25, v26, v27
  v_mul_f32 v31, s25, v31
  v_mfma_f32_16x16x32_bf16 v[68:71], v[156:159], v[104:107], v[68:71]
  s_waitcnt lgkmcnt(2)
  ds_read_b128 v[104:107], v112 offset:50944
  v_mul_f32 v32, s25, v32
  v_mfma_f32_16x16x32_bf16 v[48:51], a[200:203], v[96:99], v[48:51]
  buffer_load_dwordx4 v119, s[16:19], s40 offen nt lds
  v_exp_f32 v29, v29
  v_mfma_f32_16x16x32_bf16 v[52:55], a[232:235], v[96:99], v[52:55]
  v_exp_f32 v30, v30
  v_mfma_f32_16x16x32_bf16 v[56:59], v[160:163], v[96:99], v[56:59]
  v_cvt_pk_bf16_f32 v26, v28, v29
  v_mul_f32 v33, s25, v33
  v_mfma_f32_16x16x32_bf16 v[60:63], v[164:167], v[96:99], v[60:63]
  v_exp_f32 v31, v31
  v_mfma_f32_16x16x32_bf16 v[64:67], v[168:171], v[96:99], v[64:67]
  v_cvt_pk_bf16_f32 v27, v30, v31
  v_mul_f32 v34, s25, v34
  v_mfma_f32_16x16x32_bf16 v[68:71], v[172:175], v[96:99], v[68:71]
  s_waitcnt lgkmcnt(1)
  ds_read_b128 v[96:99], v112 offset:51008
  v_mul_f32 v35, s25, v35
  v_mfma_f32_16x16x32_bf16 v[48:51], a[204:207], v[100:103], v[48:51]
  ds_write_b128 v113, v[24:27] offset:36864
  v_exp_f32 v32, v32
  v_mfma_f32_16x16x32_bf16 v[52:55], a[236:239], v[100:103], v[52:55]
  s_mov_b32 s41, 65536
  v_exp_f32 v33, v33
  v_mfma_f32_16x16x32_bf16 v[56:59], v[176:179], v[100:103], v[56:59]
  s_add_u32 m0, s29, 37888
  v_exp_f32 v34, v34
  v_mfma_f32_16x16x32_bf16 v[60:63], v[180:183], v[100:103], v[60:63]
  v_mul_f32 v36, s25, v36
  v_cvt_pk_bf16_f32 v32, v32, v33
  v_mfma_f32_16x16x32_bf16 v[64:67], v[184:187], v[100:103], v[64:67]
  buffer_load_dwordx4 v119, s[16:19], s41 offen nt lds
  v_exp_f32 v35, v35
  v_mfma_f32_16x16x32_bf16 v[68:71], v[188:191], v[100:103], v[68:71]
  s_waitcnt lgkmcnt(2)
  ds_read_b128 v[100:103], v112 offset:51072
  v_mul_f32 v37, s25, v37
  v_mfma_f32_16x16x32_bf16 v[48:51], a[208:211], v[104:107], v[48:51]
  v_exp_f32 v36, v36
  v_mfma_f32_16x16x32_bf16 v[52:55], a[240:243], v[104:107], v[52:55]
  v_mul_f32 v38, s25, v38
  v_cvt_pk_bf16_f32 v33, v34, v35
  v_mfma_f32_16x16x32_bf16 v[56:59], v[192:195], v[104:107], v[56:59]
  v_exp_f32 v37, v37
  v_mfma_f32_16x16x32_bf16 v[60:63], v[196:199], v[104:107], v[60:63]
  v_mul_f32 v39, s25, v39
  v_cvt_pk_bf16_f32 v34, v36, v37
  v_mfma_f32_16x16x32_bf16 v[64:67], v[200:203], v[104:107], v[64:67]
  v_exp_f32 v38, v38
  v_mfma_f32_16x16x32_bf16 v[68:71], v[204:207], v[104:107], v[68:71]
  s_waitcnt lgkmcnt(2)
  ds_read_b128 v[104:107], v112 offset:51136
  s_mov_b32 s42, 81920
  v_mul_f32 v40, s25, v40
  v_mfma_f32_16x16x32_bf16 v[48:51], a[212:215], v[96:99], v[48:51]
  s_add_u32 m0, s29, 42240
  v_exp_f32 v39, v39
  v_mfma_f32_16x16x32_bf16 v[52:55], a[244:247], v[96:99], v[52:55]
  v_cvt_pk_bf16_f32 v35, v38, v39
  v_mul_f32 v41, s25, v41
  v_mfma_f32_16x16x32_bf16 v[56:59], v[208:211], v[96:99], v[56:59]
  buffer_load_dwordx4 v119, s[16:19], s42 offen nt lds
  v_exp_f32 v40, v40
  v_mfma_f32_16x16x32_bf16 v[60:63], v[212:215], v[96:99], v[60:63]
  ds_write_b128 v113, v[32:35] offset:37888
  v_mul_f32 v42, s25, v42
  v_mul_f32 v43, s25, v43
  v_mfma_f32_16x16x32_bf16 v[64:67], v[216:219], v[96:99], v[64:67]
  v_exp_f32 v41, v41
  v_mfma_f32_16x16x32_bf16 v[68:71], v[220:223], v[96:99], v[68:71]
  s_waitcnt lgkmcnt(2)
  ds_read_b128 v[96:99], v112 offset:0
  v_mul_f32 v44, s25, v44
  v_mfma_f32_16x16x32_bf16 v[48:51], a[216:219], v[100:103], v[48:51]
  v_exp_f32 v42, v42
  v_mfma_f32_16x16x32_bf16 v[52:55], a[248:251], v[100:103], v[52:55]
  v_cvt_pk_bf16_f32 v40, v40, v41
  v_mul_f32 v45, s25, v45
  v_mfma_f32_16x16x32_bf16 v[56:59], v[224:227], v[100:103], v[56:59]
  v_exp_f32 v43, v43
  v_mfma_f32_16x16x32_bf16 v[60:63], v[228:231], v[100:103], v[60:63]
  s_mov_b32 s43, 98304
  v_exp_f32 v44, v44
  v_mfma_f32_16x16x32_bf16 v[64:67], v[232:235], v[100:103], v[64:67]
  s_add_u32 m0, s29, 46336
  v_mul_f32 v46, s25, v46
  v_cvt_pk_bf16_f32 v41, v42, v43
  v_mfma_f32_16x16x32_bf16 v[68:71], v[236:239], v[100:103], v[68:71]
  s_waitcnt lgkmcnt(2)
  ds_read_b128 v[100:103], v112 offset:64
  v_mul_f32 v47, s25, v47
  v_mfma_f32_16x16x32_bf16 v[48:51], a[220:223], v[104:107], v[48:51]
  buffer_load_dwordx4 v119, s[16:19], s43 offen nt lds
  v_exp_f32 v45, v45
  v_mfma_f32_16x16x32_bf16 v[52:55], a[252:255], v[104:107], v[52:55]
  v_exp_f32 v46, v46
  v_mfma_f32_16x16x32_bf16 v[56:59], v[240:243], v[104:107], v[56:59]
  v_cvt_pk_bf16_f32 v42, v44, v45
  v_mfma_f32_16x16x32_bf16 v[60:63], v[244:247], v[104:107], v[60:63]
  v_exp_f32 v47, v47
  v_mfma_f32_16x16x32_bf16 v[64:67], v[248:251], v[104:107], v[64:67]
  v_mul_f32 v48, s25, v48
  v_cvt_pk_bf16_f32 v43, v46, v47
  v_mfma_f32_16x16x32_bf16 v[68:71], v[252:255], v[104:107], v[68:71]
  s_waitcnt lgkmcnt(1)
  ds_read_b128 v[104:107], v112 offset:128
  v_mul_f32 v49, s25, v49
  v_mfma_f32_16x16x32_bf16 v[72:75], a[192:195], v[96:99], 0
  ds_write_b128 v113, v[40:43] offset:38912
  v_exp_f32 v48, v48
  v_mfma_f32_16x16x32_bf16 v[76:79], a[224:227], v[96:99], 0
  v_mul_f32 v50, s25, v50
  v_mul_f32 v51, s25, v51
  v_mfma_f32_16x16x32_bf16 v[80:83], v[128:131], v[96:99], 0
  v_exp_f32 v49, v49
  v_mfma_f32_16x16x32_bf16 v[84:87], v[132:135], v[96:99], 0
  v_exp_f32 v50, v50
  v_mfma_f32_16x16x32_bf16 v[88:91], v[136:139], v[96:99], 0
  v_mul_f32 v52, s25, v52
  v_cvt_pk_bf16_f32 v48, v48, v49
  v_mfma_f32_16x16x32_bf16 v[92:95], v[140:143], v[96:99], 0
  s_waitcnt lgkmcnt(2)
  ds_read_b128 v[96:99], v112 offset:192
  v_mul_f32 v53, s25, v53
  v_mfma_f32_16x16x32_bf16 v[72:75], a[196:199], v[100:103], v[72:75]
  v_exp_f32 v51, v51
  v_mfma_f32_16x16x32_bf16 v[76:79], a[228:231], v[100:103], v[76:79]
  v_exp_f32 v52, v52
  v_mfma_f32_16x16x32_bf16 v[80:83], v[144:147], v[100:103], v[80:83]
  v_mul_f32 v54, s25, v54
  v_cvt_pk_bf16_f32 v49, v50, v51
  v_mfma_f32_16x16x32_bf16 v[84:87], v[148:151], v[100:103], v[84:87]
  v_exp_f32 v53, v53
  v_mfma_f32_16x16x32_bf16 v[88:91], v[152:155], v[100:103], v[88:91]
  v_mul_f32 v55, s25, v55
  v_cvt_pk_bf16_f32 v50, v52, v53
  v_mfma_f32_16x16x32_bf16 v[92:95], v[156:159], v[100:103], v[92:95]
  s_waitcnt lgkmcnt(2)
  ds_read_b128 v[100:103], v112 offset:256
  v_mul_f32 v56, s25, v56
  v_mfma_f32_16x16x32_bf16 v[72:75], a[200:203], v[104:107], v[72:75]
  v_exp_f32 v54, v54
  v_mfma_f32_16x16x32_bf16 v[76:79], a[232:235], v[104:107], v[76:79]
  v_exp_f32 v55, v55
  v_mfma_f32_16x16x32_bf16 v[80:83], v[160:163], v[104:107], v[80:83]
  v_cvt_pk_bf16_f32 v51, v54, v55
  v_mul_f32 v57, s25, v57
  v_mfma_f32_16x16x32_bf16 v[84:87], v[164:167], v[104:107], v[84:87]
  ds_write_b128 v114, v[48:51] offset:0
  v_exp_f32 v56, v56
  v_mfma_f32_16x16x32_bf16 v[88:91], v[168:171], v[104:107], v[88:91]
  v_mul_f32 v58, s25, v58
  v_mul_f32 v59, s25, v59
  v_mfma_f32_16x16x32_bf16 v[92:95], v[172:175], v[104:107], v[92:95]
  s_waitcnt lgkmcnt(2)
  ds_read_b128 v[104:107], v112 offset:320
  v_mul_f32 v60, s25, v60
  v_mfma_f32_16x16x32_bf16 v[72:75], a[204:207], v[96:99], v[72:75]
  v_exp_f32 v57, v57
  v_mfma_f32_16x16x32_bf16 v[76:79], a[236:239], v[96:99], v[76:79]
  v_exp_f32 v58, v58
  v_mfma_f32_16x16x32_bf16 v[80:83], v[176:179], v[96:99], v[80:83]
  v_cvt_pk_bf16_f32 v56, v56, v57
  v_mul_f32 v61, s25, v61
  v_mfma_f32_16x16x32_bf16 v[84:87], v[180:183], v[96:99], v[84:87]
  v_exp_f32 v59, v59
  v_mfma_f32_16x16x32_bf16 v[88:91], v[184:187], v[96:99], v[88:91]
  v_exp_f32 v60, v60
  v_mfma_f32_16x16x32_bf16 v[92:95], v[188:191], v[96:99], v[92:95]
  s_waitcnt lgkmcnt(2)
  ds_read_b128 v[96:99], v112 offset:384
  v_mul_f32 v62, s25, v62
  v_mfma_f32_16x16x32_bf16 v[72:75], a[208:211], v[100:103], v[72:75]
  v_cvt_pk_bf16_f32 v57, v58, v59
  v_mul_f32 v63, s25, v63
  v_mfma_f32_16x16x32_bf16 v[76:79], a[240:243], v[100:103], v[76:79]
  v_exp_f32 v61, v61
  v_mfma_f32_16x16x32_bf16 v[80:83], v[192:195], v[100:103], v[80:83]
  v_exp_f32 v62, v62
  v_mfma_f32_16x16x32_bf16 v[84:87], v[196:199], v[100:103], v[84:87]
  v_cvt_pk_bf16_f32 v58, v60, v61
  v_mul_f32 v64, s25, v64
  v_mfma_f32_16x16x32_bf16 v[88:91], v[200:203], v[100:103], v[88:91]
  v_exp_f32 v63, v63
  v_mfma_f32_16x16x32_bf16 v[92:95], v[204:207], v[100:103], v[92:95]
  s_waitcnt lgkmcnt(1)
  ds_read_b128 v[100:103], v112 offset:448
  v_cvt_pk_bf16_f32 v59, v62, v63
  v_mfma_f32_16x16x32_bf16 v[72:75], a[212:215], v[104:107], v[72:75]
  ds_write_b128 v114, v[56:59] offset:1024
  v_mul_f32 v65, s25, v65
  v_mul_f32 v66, s25, v66
  v_mfma_f32_16x16x32_bf16 v[76:79], a[244:247], v[104:107], v[76:79]
  v_exp_f32 v64, v64
  v_mfma_f32_16x16x32_bf16 v[80:83], v[208:211], v[104:107], v[80:83]
  v_exp_f32 v65, v65
  v_mfma_f32_16x16x32_bf16 v[84:87], v[212:215], v[104:107], v[84:87]
  v_mul_f32 v67, s25, v67
  v_mul_f32 v68, s25, v68
  v_mfma_f32_16x16x32_bf16 v[88:91], v[216:219], v[104:107], v[88:91]
  v_exp_f32 v66, v66
  v_mfma_f32_16x16x32_bf16 v[92:95], v[220:223], v[104:107], v[92:95]
  s_waitcnt lgkmcnt(2)
  ds_read_b128 v[104:107], v112 offset:8448
  v_cvt_pk_bf16_f32 v64, v64, v65
  v_mfma_f32_16x16x32_bf16 v[72:75], a[216:219], v[96:99], v[72:75]
  v_exp_f32 v67, v67
  v_mfma_f32_16x16x32_bf16 v[76:79], a[248:251], v[96:99], v[76:79]
  v_mul_f32 v69, s25, v69
  v_mul_f32 v70, s25, v70
  v_mfma_f32_16x16x32_bf16 v[80:83], v[224:227], v[96:99], v[80:83]
  v_exp_f32 v68, v68
  v_mfma_f32_16x16x32_bf16 v[84:87], v[228:231], v[96:99], v[84:87]
  v_cvt_pk_bf16_f32 v65, v66, v67
  v_mul_f32 v71, s25, v71
  v_mfma_f32_16x16x32_bf16 v[88:91], v[232:235], v[96:99], v[88:91]
  v_exp_f32 v69, v69
  v_mfma_f32_16x16x32_bf16 v[92:95], v[236:239], v[96:99], v[92:95]
  s_waitcnt lgkmcnt(2)
  ds_read_b128 v[96:99], v112 offset:8512
  v_cvt_pk_bf16_f32 v66, v68, v69
  v_mfma_f32_16x16x32_bf16 v[72:75], a[220:223], v[100:103], v[72:75]
  v_exp_f32 v70, v70
  v_mfma_f32_16x16x32_bf16 v[76:79], a[252:255], v[100:103], v[76:79]
  v_exp_f32 v71, v71
  v_mfma_f32_16x16x32_bf16 v[80:83], v[240:243], v[100:103], v[80:83]
  v_cvt_pk_bf16_f32 v67, v70, v71
  v_mfma_f32_16x16x32_bf16 v[84:87], v[244:247], v[100:103], v[84:87]
  ds_write_b128 v114, v[64:67] offset:2048
  v_mfma_f32_16x16x32_bf16 v[88:91], v[248:251], v[100:103], v[88:91]
  v_mul_f32 v72, s25, v72
  v_mul_f32 v73, s25, v73
  v_mfma_f32_16x16x32_bf16 v[92:95], v[252:255], v[100:103], v[92:95]
  s_waitcnt lgkmcnt(2)
  ds_read_b128 v[100:103], v112 offset:8576
  v_mul_f32 v74, s25, v74
  v_mfma_f32_16x16x32_bf16 v[0:3], a[192:195], v[104:107], 0
  v_exp_f32 v72, v72
  v_mfma_f32_16x16x32_bf16 v[4:7], a[224:227], v[104:107], 0
  v_exp_f32 v73, v73
  v_mfma_f32_16x16x32_bf16 v[8:11], v[128:131], v[104:107], 0
  v_mul_f32 v75, s25, v75
  v_mul_f32 v76, s25, v76
  v_mfma_f32_16x16x32_bf16 v[12:15], v[132:135], v[104:107], 0
  v_exp_f32 v74, v74
  v_mfma_f32_16x16x32_bf16 v[16:19], v[136:139], v[104:107], 0
  v_cvt_pk_bf16_f32 v72, v72, v73
  v_mul_f32 v77, s25, v77
  v_mfma_f32_16x16x32_bf16 v[20:23], v[140:143], v[104:107], 0
  s_waitcnt lgkmcnt(2)
  ds_read_b128 v[104:107], v112 offset:8640
  v_mul_f32 v78, s25, v78
  v_mfma_f32_16x16x32_bf16 v[0:3], a[196:199], v[96:99], v[0:3]
  v_exp_f32 v75, v75
  v_mfma_f32_16x16x32_bf16 v[4:7], a[228:231], v[96:99], v[4:7]
  v_exp_f32 v76, v76
  v_mfma_f32_16x16x32_bf16 v[8:11], v[144:147], v[96:99], v[8:11]
  s_waitcnt vmcnt(4)
  s_barrier
  v_cvt_pk_bf16_f32 v73, v74, v75
  v_mul_f32 v79, s25, v79
  v_mfma_f32_16x16x32_bf16 v[12:15], v[148:151], v[96:99], v[12:15]
  s_mov_b32 s44, 114688
  v_exp_f32 v77, v77
  v_mfma_f32_16x16x32_bf16 v[16:19], v[152:155], v[96:99], v[16:19]
  s_add_u32 m0, s29, 50688
  v_exp_f32 v78, v78
  v_mfma_f32_16x16x32_bf16 v[20:23], v[156:159], v[96:99], v[20:23]
  s_waitcnt lgkmcnt(1)
  ds_read_b128 v[96:99], v112 offset:8704
  v_cvt_pk_bf16_f32 v74, v76, v77
  v_mfma_f32_16x16x32_bf16 v[0:3], a[200:203], v[100:103], v[0:3]
  buffer_load_dwordx4 v119, s[16:19], s44 offen nt lds
  v_exp_f32 v79, v79
  v_mfma_f32_16x16x32_bf16 v[4:7], a[232:235], v[100:103], v[4:7]
  v_mul_f32 v80, s25, v80
  v_cvt_pk_bf16_f32 v75, v78, v79
  v_mfma_f32_16x16x32_bf16 v[8:11], v[160:163], v[100:103], v[8:11]
  ds_write_b128 v114, v[72:75] offset:12288
  v_mul_f32 v81, s25, v81
  v_mul_f32 v82, s25, v82
  v_mfma_f32_16x16x32_bf16 v[12:15], v[164:167], v[100:103], v[12:15]
  v_exp_f32 v80, v80
  v_mfma_f32_16x16x32_bf16 v[16:19], v[168:171], v[100:103], v[16:19]
  v_exp_f32 v81, v81
  v_mfma_f32_16x16x32_bf16 v[20:23], v[172:175], v[100:103], v[20:23]
  s_waitcnt lgkmcnt(2)
  ds_read_b128 v[100:103], v112 offset:8768
  v_mul_f32 v83, s25, v83
  v_mfma_f32_16x16x32_bf16 v[0:3], a[204:207], v[104:107], v[0:3]
  v_exp_f32 v82, v82
  v_mfma_f32_16x16x32_bf16 v[4:7], a[236:239], v[104:107], v[4:7]
  s_mov_b32 s45, 131072
  v_mul_f32 v84, s25, v84
  v_cvt_pk_bf16_f32 v80, v80, v81
  v_mfma_f32_16x16x32_bf16 v[8:11], v[176:179], v[104:107], v[8:11]
  s_add_u32 m0, s29, 54784
  v_exp_f32 v83, v83
  v_mfma_f32_16x16x32_bf16 v[12:15], v[180:183], v[104:107], v[12:15]
  v_mul_f32 v85, s25, v85
  v_mul_f32 v86, s25, v86
  v_mfma_f32_16x16x32_bf16 v[16:19], v[184:187], v[104:107], v[16:19]
  buffer_load_dwordx4 v119, s[16:19], s45 offen nt lds
  v_exp_f32 v84, v84
  v_mfma_f32_16x16x32_bf16 v[20:23], v[188:191], v[104:107], v[20:23]
  s_waitcnt lgkmcnt(2)
  ds_read_b128 v[104:107], v112 offset:8832
  v_cvt_pk_bf16_f32 v81, v82, v83
  v_mfma_f32_16x16x32_bf16 v[0:3], a[208:211], v[96:99], v[0:3]
  v_exp_f32 v85, v85
  v_mfma_f32_16x16x32_bf16 v[4:7], a[240:243], v[96:99], v[4:7]
  v_mul_f32 v87, s25, v87
  v_cvt_pk_bf16_f32 v82, v84, v85
  v_mfma_f32_16x16x32_bf16 v[8:11], v[192:195], v[96:99], v[8:11]
  v_exp_f32 v86, v86
  v_mfma_f32_16x16x32_bf16 v[12:15], v[196:199], v[96:99], v[12:15]
  v_exp_f32 v87, v87
  v_mfma_f32_16x16x32_bf16 v[16:19], v[200:203], v[96:99], v[16:19]
  v_mul_f32 v88, s25, v88
  v_cvt_pk_bf16_f32 v83, v86, v87
  v_mfma_f32_16x16x32_bf16 v[20:23], v[204:207], v[96:99], v[20:23]
  s_waitcnt lgkmcnt(1)
  ds_read_b128 v[96:99], v112 offset:8896
  s_mov_b32 s46, 147456
  v_mul_f32 v89, s25, v89
  v_mfma_f32_16x16x32_bf16 v[0:3], a[212:215], v[100:103], v[0:3]
  ds_write_b128 v114, v[80:83] offset:13312
  s_add_u32 m0, s29, 0
  v_exp_f32 v88, v88
  v_mfma_f32_16x16x32_bf16 v[4:7], a[244:247], v[100:103], v[4:7]
  v_mul_f32 v90, s25, v90
  v_mul_f32 v91, s25, v91
  v_mfma_f32_16x16x32_bf16 v[8:11], v[208:211], v[100:103], v[8:11]
  buffer_load_dwordx4 v119, s[16:19], s46 offen nt lds
  v_exp_f32 v89, v89
  v_mfma_f32_16x16x32_bf16 v[12:15], v[212:215], v[100:103], v[12:15]
  v_exp_f32 v90, v90
  v_mfma_f32_16x16x32_bf16 v[16:19], v[216:219], v[100:103], v[16:19]
  v_mul_f32 v92, s25, v92
  v_cvt_pk_bf16_f32 v88, v88, v89
  v_mfma_f32_16x16x32_bf16 v[20:23], v[220:223], v[100:103], v[20:23]
  s_waitcnt lgkmcnt(2)
  ds_read_b128 v[100:103], v112 offset:16896
  v_mul_f32 v93, s25, v93
  v_mfma_f32_16x16x32_bf16 v[0:3], a[216:219], v[104:107], v[0:3]
  v_exp_f32 v91, v91
  v_mfma_f32_16x16x32_bf16 v[4:7], a[248:251], v[104:107], v[4:7]
  v_exp_f32 v92, v92
  v_mfma_f32_16x16x32_bf16 v[8:11], v[224:227], v[104:107], v[8:11]
  v_mul_f32 v94, s25, v94
  v_cvt_pk_bf16_f32 v89, v90, v91
  v_mfma_f32_16x16x32_bf16 v[12:15], v[228:231], v[104:107], v[12:15]
  s_mov_b32 s47, 163840
  v_exp_f32 v93, v93
  v_mfma_f32_16x16x32_bf16 v[16:19], v[232:235], v[104:107], v[16:19]
  s_add_u32 m0, s29, 4096
  v_mul_f32 v95, s25, v95
  v_cvt_pk_bf16_f32 v90, v92, v93
  v_mfma_f32_16x16x32_bf16 v[20:23], v[236:239], v[104:107], v[20:23]
  s_waitcnt lgkmcnt(2)
  ds_read_b128 v[104:107], v112 offset:16960
  v_mfma_f32_16x16x32_bf16 v[0:3], a[220:223], v[96:99], v[0:3]
  buffer_load_dwordx4 v119, s[16:19], s47 offen nt lds
  v_exp_f32 v94, v94
  v_mfma_f32_16x16x32_bf16 v[4:7], a[252:255], v[96:99], v[4:7]
  v_exp_f32 v95, v95
  v_mfma_f32_16x16x32_bf16 v[8:11], v[240:243], v[96:99], v[8:11]
  v_cvt_pk_bf16_f32 v91, v94, v95
  v_mfma_f32_16x16x32_bf16 v[12:15], v[244:247], v[96:99], v[12:15]
  ds_write_b128 v114, v[88:91] offset:14336
  v_mul_f32 v0, s25, v0
  v_mul_f32 v1, s25, v1
  v_mfma_f32_16x16x32_bf16 v[16:19], v[248:251], v[96:99], v[16:19]
  v_exp_f32 v0, v0
  v_mfma_f32_16x16x32_bf16 v[20:23], v[252:255], v[96:99], v[20:23]
  s_waitcnt lgkmcnt(2)
  ds_read_b128 v[96:99], v112 offset:17024
  v_mul_f32 v2, s25, v2
  v_mfma_f32_16x16x32_bf16 v[24:27], a[192:195], v[100:103], 0
  v_exp_f32 v1, v1
  v_mfma_f32_16x16x32_bf16 v[28:31], a[224:227], v[100:103], 0
  v_mul_f32 v3, s25, v3
  v_mul_f32 v4, s25, v4
  v_mfma_f32_16x16x32_bf16 v[32:35], v[128:131], v[100:103], 0
  v_exp_f32 v2, v2
  v_mfma_f32_16x16x32_bf16 v[36:39], v[132:135], v[100:103], 0
  v_cvt_pk_bf16_f32 v0, v0, v1
  v_mul_f32 v5, s25, v5
  v_mfma_f32_16x16x32_bf16 v[40:43], v[136:139], v[100:103], 0
  v_exp_f32 v3, v3
  v_mfma_f32_16x16x32_bf16 v[44:47], v[140:143], v[100:103], 0
  s_waitcnt lgkmcnt(2)
  ds_read_b128 v[100:103], v112 offset:17088
  v_mul_f32 v6, s25, v6
  v_mfma_f32_16x16x32_bf16 v[24:27], a[196:199], v[104:107], v[24:27]
  v_exp_f32 v4, v4
  v_mfma_f32_16x16x32_bf16 v[28:31], a[228:231], v[104:107], v[28:31]
  v_cvt_pk_bf16_f32 v1, v2, v3
  v_mul_f32 v7, s25, v7
  v_mfma_f32_16x16x32_bf16 v[32:35], v[144:147], v[104:107], v[32:35]
  v_exp_f32 v5, v5
  v_mfma_f32_16x16x32_bf16 v[36:39], v[148:151], v[104:107], v[36:39]
  v_exp_f32 v6, v6
  v_mfma_f32_16x16x32_bf16 v[40:43], v[152:155], v[104:107], v[40:43]
  v_cvt_pk_bf16_f32 v2, v4, v5
  v_mul_f32 v8, s25, v8
  v_mfma_f32_16x16x32_bf16 v[44:47], v[156:159], v[104:107], v[44:47]
  s_waitcnt lgkmcnt(1)
  ds_read_b128 v[104:107], v112 offset:17152
  v_mul_f32 v9, s25, v9
  v_mfma_f32_16x16x32_bf16 v[24:27], a[200:203], v[96:99], v[24:27]
  v_exp_f32 v7, v7
  v_mfma_f32_16x16x32_bf16 v[28:31], a[232:235], v[96:99], v[28:31]
  v_cvt_pk_bf16_f32 v3, v6, v7
  v_mul_f32 v10, s25, v10
  v_mfma_f32_16x16x32_bf16 v[32:35], v[160:163], v[96:99], v[32:35]
  ds_write_b128 v114, v[0:3] offset:24576
  v_exp_f32 v8, v8
  v_mfma_f32_16x16x32_bf16 v[36:39], v[164:167], v[96:99], v[36:39]
  v_exp_f32 v9, v9
  v_mfma_f32_16x16x32_bf16 v[40:43], v[168:171], v[96:99], v[40:43]
  v_mul_f32 v11, s25, v11
  v_mul_f32 v12, s25, v12
  v_mfma_f32_16x16x32_bf16 v[44:47], v[172:175], v[96:99], v[44:47]
  s_waitcnt lgkmcnt(2)
  ds_read_b128 v[96:99], v112 offset:17216
  v_cvt_pk_bf16_f32 v8, v8, v9
  v_mfma_f32_16x16x32_bf16 v[24:27], a[204:207], v[100:103], v[24:27]
  v_exp_f32 v10, v10
  v_mfma_f32_16x16x32_bf16 v[28:31], a[236:239], v[100:103], v[28:31]
  v_exp_f32 v11, v11
  v_mfma_f32_16x16x32_bf16 v[32:35], v[176:179], v[100:103], v[32:35]
  v_mbcnt_lo_u32_b32 v168, -1, 0
  v_mbcnt_hi_u32_b32 v168, -1, v168
  v_mfma_f32_16x16x32_bf16 v[36:39], v[180:183], v[100:103], v[36:39]
  v_lshrrev_b32 v169, 2, v168
  v_lshlrev_b32 v169, 7, v169
  v_mfma_f32_16x16x32_bf16 v[40:43], v[184:187], v[100:103], v[40:43]
  v_and_b32 v172, 3, v168
  v_lshl_add_u32 v169, v172, 3, v169
  v_mfma_f32_16x16x32_bf16 v[44:47], v[188:191], v[100:103], v[44:47]
  s_waitcnt lgkmcnt(2)
  ds_read_b128 v[100:103], v112 offset:17280
  v_bfe_u32 v172, v168, 3, 2
  v_mfma_f32_16x16x32_bf16 v[24:27], a[208:211], v[104:107], v[24:27]
  v_lshlrev_b32 v172, 5, v172
  v_xor_b32 v160, 0, v172
  v_mfma_f32_16x16x32_bf16 v[28:31], a[240:243], v[104:107], v[28:31]
  v_add_u32 v160, v160, v169
  v_xor_b32 v161, 32, v172
  v_mfma_f32_16x16x32_bf16 v[32:35], v[192:195], v[104:107], v[32:35]
  v_add_u32 v161, v161, v169
  v_xor_b32 v162, 64, v172
  v_mfma_f32_16x16x32_bf16 v[36:39], v[196:199], v[104:107], v[36:39]
  v_add_u32 v162, v162, v169
  v_xor_b32 v163, 96, v172
  v_add_u32 v163, v163, v169
  v_mfma_f32_16x16x32_bf16 v[40:43], v[200:203], v[104:107], v[40:43]
  v_mov_b32 v172, 0x3f803f80
  v_mov_b32 v173, 0x3f803f80
  v_mfma_f32_16x16x32_bf16 v[44:47], v[204:207], v[104:107], v[44:47]
  s_waitcnt lgkmcnt(1)
  ds_read_b128 v[104:107], v112 offset:17344
  v_mov_b32 v174, 0x3f803f80
  v_mfma_f32_16x16x32_bf16 v[24:27], a[212:215], v[96:99], v[24:27]
  v_mov_b32 v175, 0x3f803f80
  v_mul_f32 v13, s25, v13
  v_mfma_f32_16x16x32_bf16 v[28:31], a[244:247], v[96:99], v[28:31]
  v_exp_f32 v12, v12
  v_mfma_f32_16x16x32_bf16 v[32:35], v[208:211], v[96:99], v[32:35]
  v_mul_f32 v14, s25, v14
  v_cvt_pk_bf16_f32 v9, v10, v11
  v_mfma_f32_16x16x32_bf16 v[36:39], v[212:215], v[96:99], v[36:39]
  v_add_u32 v160, 158464, v160
  v_add_u32 v161, 158464, v161
  v_mfma_f32_16x16x32_bf16 v[40:43], v[216:219], v[96:99], v[40:43]
  ds_read_b64_tr_b16 v[128:129], v160 offset:0
  v_add_u32 v162, 158464, v162
  v_mfma_f32_16x16x32_bf16 v[44:47], v[220:223], v[96:99], v[44:47]
  s_waitcnt lgkmcnt(2)
  ds_read_b64_tr_b16 v[130:131], v160 offset:2048
  v_add_u32 v163, 158464, v163
  v_mfma_f32_16x16x32_bf16 v[24:27], a[216:219], v[100:103], v[24:27]
  ds_read_b64_tr_b16 v[132:133], v161 offset:0
  v_mul_f32 v15, s25, v15
  v_mfma_f32_16x16x32_bf16 v[28:31], a[248:251], v[100:103], v[28:31]
  ds_read_b64_tr_b16 v[134:135], v161 offset:2048
  v_exp_f32 v13, v13
  v_mfma_f32_16x16x32_bf16 v[32:35], v[224:227], v[100:103], v[32:35]
  ds_read_b64_tr_b16 v[136:137], v162 offset:0
  v_cvt_pk_bf16_f32 v10, v12, v13
  v_mfma_f32_16x16x32_bf16 v[36:39], v[228:231], v[100:103], v[36:39]
  ds_read_b64_tr_b16 v[138:139], v162 offset:2048
  v_exp_f32 v14, v14
  v_mfma_f32_16x16x32_bf16 v[40:43], v[232:235], v[100:103], v[40:43]
  ds_read_b64_tr_b16 v[140:141], v163 offset:0
  v_exp_f32 v15, v15
  v_mfma_f32_16x16x32_bf16 v[44:47], v[236:239], v[100:103], v[44:47]
  s_waitcnt lgkmcnt(7)
  ds_read_b64_tr_b16 v[142:143], v163 offset:2048
  v_mul_f32 v16, s25, v16
  v_mfma_f32_16x16x32_bf16 v[24:27], a[220:223], v[104:107], v[24:27]
  v_cvt_pk_bf16_f32 v11, v14, v15
  v_mul_f32 v17, s25, v17
  v_mfma_f32_16x16x32_bf16 v[28:31], a[252:255], v[104:107], v[28:31]
  ds_write_b128 v114, v[8:11] offset:25600
  v_exp_f32 v16, v16
  v_mfma_f32_16x16x32_bf16 v[32:35], v[240:243], v[104:107], v[32:35]
  v_mul_f32 v18, s25, v18
  v_mul_f32 v19, s25, v19
  v_mfma_f32_16x16x32_bf16 v[36:39], v[244:247], v[104:107], v[36:39]
  v_exp_f32 v17, v17
  v_mfma_f32_16x16x32_bf16 v[40:43], v[248:251], v[104:107], v[40:43]
  v_exp_f32 v18, v18
  v_mfma_f32_16x16x32_bf16 v[44:47], v[252:255], v[104:107], v[44:47]
  s_waitcnt lgkmcnt(7)
  v_mul_f32 v20, s25, v20
  v_cvt_pk_bf16_f32 v16, v16, v17
  v_mfma_f32_16x16x32_bf16 v[176:179], v[128:131], a[0:3], 0
  s_waitcnt lgkmcnt(5)
  v_exp_f32 v19, v19
  v_mfma_f32_16x16x32_bf16 v[180:183], v[132:135], a[0:3], 0
  s_waitcnt lgkmcnt(3)
  v_mul_f32 v21, s25, v21
  v_subrev_u32 v160, 133120, v160
  v_mfma_f32_16x16x32_bf16 v[184:187], v[136:139], a[0:3], 0
  s_waitcnt lgkmcnt(1)
  ds_read_b64_tr_b16 v[144:145], v160 offset:0
  v_subrev_u32 v161, 133120, v161
  v_mfma_f32_16x16x32_bf16 v[188:191], v[140:143], a[0:3], 0
  ds_read_b64_tr_b16 v[146:147], v160 offset:2048
  v_subrev_u32 v162, 133120, v162
  v_mfma_f32_16x16x32_bf16 v[192:195], v[172:175], a[0:3], 0
  ds_read_b64_tr_b16 v[148:149], v161 offset:0
  v_subrev_u32 v163, 133120, v163
  v_mul_f32 v22, s25, v22
  v_mfma_f32_16x16x32_bf16 v[196:199], v[128:131], a[48:51], 0
  ds_read_b64_tr_b16 v[150:151], v161 offset:2048
  v_exp_f32 v20, v20
  v_mfma_f32_16x16x32_bf16 v[200:203], v[132:135], a[48:51], 0
  ds_read_b64_tr_b16 v[152:153], v162 offset:0
  v_cvt_pk_bf16_f32 v17, v18, v19
  v_mul_f32 v23, s25, v23
  v_mfma_f32_16x16x32_bf16 v[204:207], v[136:139], a[48:51], 0
  ds_read_b64_tr_b16 v[154:155], v162 offset:2048
  v_exp_f32 v21, v21
  v_mfma_f32_16x16x32_bf16 v[208:211], v[140:143], a[48:51], 0
  ds_read_b64_tr_b16 v[156:157], v163 offset:0
  s_waitcnt vmcnt(0)
  s_barrier
  v_exp_f32 v22, v22
  v_mfma_f32_16x16x32_bf16 v[212:215], v[172:175], a[48:51], 0
  ds_read_b128 a[192:195], v115 offset:0
  ds_read_b128 a[196:199], v115 offset:1024
  s_mov_b32 s32, 180224
  v_cvt_pk_bf16_f32 v18, v20, v21
  v_mfma_f32_16x16x32_bf16 v[216:219], v[128:131], a[96:99], 0
  ds_read_b64_tr_b16 v[158:159], v163 offset:2048
  s_add_u32 m0, s29, 8448
  v_exp_f32 v23, v23
  v_mfma_f32_16x16x32_bf16 v[220:223], v[132:135], a[96:99], 0
  ds_read_b128 a[200:203], v115 offset:2048
  v_mul_f32 v24, s25, v24
  v_cvt_pk_bf16_f32 v19, v22, v23
  v_mfma_f32_16x16x32_bf16 v[224:227], v[136:139], a[96:99], 0
  ds_write_b128 v114, v[16:19] offset:26624
  v_mul_f32 v25, s25, v25
  v_exp_f32 v24, v24
  v_mfma_f32_16x16x32_bf16 v[228:231], v[140:143], a[96:99], 0
  buffer_load_dwordx4 v119, s[16:19], s32 offen nt lds
  v_mul_f32 v26, s25, v26
  v_mul_f32 v27, s25, v27
  v_mfma_f32_16x16x32_bf16 v[232:235], v[172:175], a[96:99], 0
  s_waitcnt lgkmcnt(10)
  ds_read_b128 a[204:207], v115 offset:3072
  v_mul_f32 v28, s25, v28
  v_mfma_f32_16x16x32_bf16 v[176:179], v[144:147], a[4:7], v[176:179]
  s_waitcnt lgkmcnt(9)
  ds_read_b64_tr_b16 v[128:129], v160 offset:4096
  v_exp_f32 v25, v25
  v_mfma_f32_16x16x32_bf16 v[180:183], v[148:151], a[4:7], v[180:183]
  s_waitcnt lgkmcnt(8)
  ds_read_b64_tr_b16 v[130:131], v160 offset:6144
  v_exp_f32 v26, v26
  v_mfma_f32_16x16x32_bf16 v[184:187], v[152:155], a[4:7], v[184:187]
  s_waitcnt lgkmcnt(5)
  ds_read_b128 a[208:211], v115 offset:4096
  v_cvt_pk_bf16_f32 v24, v24, v25
  v_mul_f32 v29, s25, v29
  v_mfma_f32_16x16x32_bf16 v[188:191], v[156:159], a[4:7], v[188:191]
  ds_read_b64_tr_b16 v[132:133], v161 offset:4096
  v_exp_f32 v27, v27
  v_mfma_f32_16x16x32_bf16 v[192:195], v[172:175], a[4:7], v[192:195]
  ds_read_b64_tr_b16 v[134:135], v161 offset:6144
  s_mov_b32 s33, 128
  v_mul_f32 v30, s25, v30
  v_mfma_f32_16x16x32_bf16 v[196:199], v[144:147], a[52:55], v[196:199]
  ds_read_b64_tr_b16 v[136:137], v162 offset:4096
  s_add_u32 m0, s29, 12544
  v_exp_f32 v28, v28
  v_mfma_f32_16x16x32_bf16 v[200:203], v[148:151], a[52:55], v[200:203]
  ds_read_b128 a[212:215], v115 offset:5120
  v_cvt_pk_bf16_f32 v25, v26, v27
  v_mul_f32 v31, s25, v31
  v_mfma_f32_16x16x32_bf16 v[204:207], v[152:155], a[52:55], v[204:207]
  ds_read_b64_tr_b16 v[138:139], v162 offset:6144
  v_exp_f32 v29, v29
  v_mfma_f32_16x16x32_bf16 v[208:211], v[156:159], a[52:55], v[208:211]
  buffer_load_dwordx4 v119, s[16:19], s33 offen nt lds
  v_exp_f32 v30, v30
  v_cvt_pk_bf16_f32 v26, v28, v29
  v_mfma_f32_16x16x32_bf16 v[212:215], v[172:175], a[52:55], v[212:215]
  ds_read_b64_tr_b16 v[140:141], v163 offset:4096
  v_exp_f32 v31, v31
  v_mfma_f32_16x16x32_bf16 v[216:219], v[144:147], a[100:103], v[216:219]
  ds_read_b64_tr_b16 v[142:143], v163 offset:6144
  v_mul_f32 v32, s25, v32
  v_mfma_f32_16x16x32_bf16 v[220:223], v[148:151], a[100:103], v[220:223]
  ds_read_b128 a[216:219], v115 offset:6144
  v_cvt_pk_bf16_f32 v27, v30, v31
  v_mfma_f32_16x16x32_bf16 v[224:227], v[152:155], a[100:103], v[224:227]
  ds_write_b128 v114, v[24:27] offset:36864
  v_mul_f32 v33, s25, v33
  v_mul_f32 v34, s25, v34
  v_mfma_f32_16x16x32_bf16 v[228:231], v[156:159], a[100:103], v[228:231]
  ds_read_b128 a[220:223], v115 offset:7168
  v_mul_f32 v35, s25, v35
  v_mfma_f32_16x16x32_bf16 v[232:235], v[172:175], a[100:103], v[232:235]
  s_waitcnt lgkmcnt(11)
  ds_read_b64_tr_b16 v[144:145], v160 offset:8448
  s_mov_b32 s34, 16512
  v_exp_f32 v32, v32
  v_mfma_f32_16x16x32_bf16 v[176:179], v[128:131], a[8:11], v[176:179]
  s_waitcnt lgkmcnt(9)
  ds_read_b128 a[224:227], v115 offset:8192
  s_add_u32 m0, s29, 16896
  v_mul_f32 v36, s25, v36
  v_mfma_f32_16x16x32_bf16 v[180:183], v[132:135], a[8:11], v[180:183]
  s_waitcnt lgkmcnt(7)
  ds_read_b64_tr_b16 v[146:147], v160 offset:10496
  v_exp_f32 v33, v33
  v_mfma_f32_16x16x32_bf16 v[184:187], v[136:139], a[8:11], v[184:187]
  s_waitcnt lgkmcnt(6)
  buffer_load_dwordx4 v119, s[16:19], s34 offen nt lds
  v_exp_f32 v34, v34
  v_cvt_pk_bf16_f32 v32, v32, v33
  v_mfma_f32_16x16x32_bf16 v[188:191], v[140:143], a[8:11], v[188:191]
  ds_read_b64_tr_b16 v[148:149], v161 offset:8448
  v_mul_f32 v37, s25, v37
  v_mfma_f32_16x16x32_bf16 v[192:195], v[172:175], a[8:11], v[192:195]
  ds_read_b128 a[228:231], v115 offset:9216
  v_exp_f32 v35, v35
  v_mfma_f32_16x16x32_bf16 v[196:199], v[128:131], a[56:59], v[196:199]
  ds_read_b64_tr_b16 v[150:151], v161 offset:10496
  v_mul_f32 v38, s25, v38
  v_mfma_f32_16x16x32_bf16 v[200:203], v[132:135], a[56:59], v[200:203]
  ds_read_b64_tr_b16 v[152:153], v162 offset:8448
  v_exp_f32 v36, v36
  v_mfma_f32_16x16x32_bf16 v[204:207], v[136:139], a[56:59], v[204:207]
  ds_read_b64_tr_b16 v[154:155], v162 offset:10496
  v_cvt_pk_bf16_f32 v33, v34, v35
  v_mul_f32 v39, s25, v39
  v_mfma_f32_16x16x32_bf16 v[208:211], v[140:143], a[56:59], v[208:211]
  ds_read_b64_tr_b16 v[156:157], v163 offset:8448
  v_exp_f32 v37, v37
  v_mfma_f32_16x16x32_bf16 v[212:215], v[172:175], a[56:59], v[212:215]
  ds_read_b128 a[232:235], v115 offset:10240
  s_mov_b32 s35, 32896
  v_exp_f32 v38, v38
  v_mfma_f32_16x16x32_bf16 v[216:219], v[128:131], a[104:107], v[216:219]
  ds_read_b64_tr_b16 v[158:159], v163 offset:10496
  s_add_u32 m0, s29, 20992
  v_cvt_pk_bf16_f32 v34, v36, v37
  v_mul_f32 v40, s25, v40
  v_mfma_f32_16x16x32_bf16 v[220:223], v[132:135], a[104:107], v[220:223]
  ds_read_b128 a[236:239], v115 offset:11264
  v_exp_f32 v39, v39
  v_mfma_f32_16x16x32_bf16 v[224:227], v[136:139], a[104:107], v[224:227]
  buffer_load_dwordx4 v119, s[16:19], s35 offen nt lds
  v_cvt_pk_bf16_f32 v35, v38, v39
  v_mul_f32 v41, s25, v41
  v_mfma_f32_16x16x32_bf16 v[228:231], v[140:143], a[104:107], v[228:231]
  ds_write_b128 v114, v[32:35] offset:37888
  v_exp_f32 v40, v40
  v_mfma_f32_16x16x32_bf16 v[232:235], v[172:175], a[104:107], v[232:235]
  s_waitcnt lgkmcnt(10)
  ds_read_b64_tr_b16 v[128:129], v160 offset:12544
  v_mul_f32 v42, s25, v42
  v_mfma_f32_16x16x32_bf16 v[176:179], v[144:147], a[12:15], v[176:179]
  s_waitcnt lgkmcnt(8)
  ds_read_b64_tr_b16 v[130:131], v160 offset:14592
  v_and_b32 v169, 7, v168
  v_mfma_f32_16x16x32_bf16 v[180:183], v[148:151], a[12:15], v[180:183]
  s_waitcnt lgkmcnt(7)
  ds_read_b64_tr_b16 v[132:133], v161 offset:12544
  v_lshlrev_b32 v169, 9, v169
  v_mfma_f32_16x16x32_bf16 v[184:187], v[152:155], a[12:15], v[184:187]
  s_waitcnt lgkmcnt(5)
  ds_read_b64_tr_b16 v[134:135], v161 offset:14592
  v_bfe_u32 v99, v168, 3, 1
  v_lshl_add_u32 v169, v99, 6, v169
  v_mfma_f32_16x16x32_bf16 v[188:191], v[156:159], a[12:15], v[188:191]
  ds_read_b64_tr_b16 v[136:137], v162 offset:12544
  v_bfe_u32 v99, v168, 4, 1
  v_lshl_add_u32 v169, v99, 5, v169
  v_mfma_f32_16x16x32_bf16 v[192:195], v[172:175], a[12:15], v[192:195]
  ds_read_b64_tr_b16 v[138:139], v162 offset:14592
  v_bfe_u32 v99, v168, 5, 1
  v_lshl_add_u32 v169, v99, 4, v169
  v_mfma_f32_16x16x32_bf16 v[196:199], v[144:147], a[60:63], v[196:199]
  ds_read_b64_tr_b16 v[140:141], v163 offset:12544
  v_add_u32 v169, s58, v169
  v_mul_f32 v43, s25, v43
  v_mfma_f32_16x16x32_bf16 v[200:203], v[148:151], a[60:63], v[200:203]
  ds_read_b64_tr_b16 v[142:143], v163 offset:14592
  v_exp_f32 v41, v41
  v_mfma_f32_16x16x32_bf16 v[204:207], v[152:155], a[60:63], v[204:207]
  v_exp_f32 v42, v42
  v_mul_f32 v44, s25, v44
  v_mfma_f32_16x16x32_bf16 v[208:211], v[156:159], a[60:63], v[208:211]
  v_cvt_pk_bf16_f32 v40, v40, v41
  v_exp_f32 v43, v43
  v_mfma_f32_16x16x32_bf16 v[212:215], v[172:175], a[60:63], v[212:215]
  v_mul_f32 v45, s25, v45
  v_exp_f32 v44, v44
  v_mfma_f32_16x16x32_bf16 v[216:219], v[144:147], a[108:111], v[216:219]
  ds_read_b64_tr_b16 v[144:145], v160 offset:16896
  v_mul_f32 v46, s25, v46
  v_cvt_pk_bf16_f32 v41, v42, v43
  v_mfma_f32_16x16x32_bf16 v[220:223], v[148:151], a[108:111], v[220:223]
  ds_read_b64_tr_b16 v[146:147], v160 offset:18944
  v_exp_f32 v45, v45
  v_mfma_f32_16x16x32_bf16 v[224:227], v[152:155], a[108:111], v[224:227]
  ds_read_b64_tr_b16 v[148:149], v161 offset:16896
  v_mul_f32 v47, s25, v47
  v_cvt_pk_bf16_f32 v42, v44, v45
  v_mfma_f32_16x16x32_bf16 v[228:231], v[156:159], a[108:111], v[228:231]
  ds_read_b64_tr_b16 v[150:151], v161 offset:18944
  v_exp_f32 v46, v46
  v_mfma_f32_16x16x32_bf16 v[232:235], v[172:175], a[108:111], v[232:235]
  s_waitcnt lgkmcnt(10)
  ds_read_b64_tr_b16 v[152:153], v162 offset:16896
  v_exp_f32 v47, v47
  v_mfma_f32_16x16x32_bf16 v[176:179], v[128:131], a[16:19], v[176:179]
  s_waitcnt lgkmcnt(9)
  ds_read_b64_tr_b16 v[154:155], v162 offset:18944
  v_cvt_pk_bf16_f32 v43, v46, v47
  v_mfma_f32_16x16x32_bf16 v[180:183], v[132:135], a[16:19], v[180:183]
  s_waitcnt lgkmcnt(8)
  ds_write_b128 v114, v[40:43] offset:38912
  v_mfma_f32_16x16x32_bf16 v[184:187], v[136:139], a[16:19], v[184:187]
  s_waitcnt lgkmcnt(7)
  ds_read_b64_tr_b16 v[156:157], v163 offset:16896
  v_mfma_f32_16x16x32_bf16 v[188:191], v[140:143], a[16:19], v[188:191]
  ds_read_b64_tr_b16 v[158:159], v163 offset:18944
  v_mfma_f32_16x16x32_bf16 v[192:195], v[172:175], a[16:19], v[192:195]
  s_waitcnt lgkmcnt(2)
  s_barrier
  v_mfma_f32_16x16x32_bf16 v[196:199], v[128:131], a[64:67], v[196:199]
  ds_read_b128 a[240:243], v115 offset:49152
  s_mov_b32 s36, 49280
  v_mfma_f32_16x16x32_bf16 v[200:203], v[132:135], a[64:67], v[200:203]
  s_add_u32 m0, s29, 59136
  v_mfma_f32_16x16x32_bf16 v[204:207], v[136:139], a[64:67], v[204:207]
  buffer_load_dwordx4 v119, s[16:19], s36 offen nt lds
  v_mfma_f32_16x16x32_bf16 v[208:211], v[140:143], a[64:67], v[208:211]
  ds_read_b128 a[244:247], v115 offset:50176
  v_mfma_f32_16x16x32_bf16 v[212:215], v[172:175], a[64:67], v[212:215]
  v_mfma_f32_16x16x32_bf16 v[216:219], v[128:131], a[112:115], v[216:219]
  ds_read_b128 a[248:251], v115 offset:51200
  v_mfma_f32_16x16x32_bf16 v[220:223], v[132:135], a[112:115], v[220:223]
  ds_read_b64_tr_b16 v[128:129], v160 offset:20992
  v_mfma_f32_16x16x32_bf16 v[224:227], v[136:139], a[112:115], v[224:227]
  ds_read_b64_tr_b16 v[130:131], v160 offset:23040
  s_mov_b32 s37, 65664
  v_mfma_f32_16x16x32_bf16 v[228:231], v[140:143], a[112:115], v[228:231]
  ds_read_b64_tr_b16 v[132:133], v161 offset:20992
  s_add_u32 m0, s29, 63232
  v_mfma_f32_16x16x32_bf16 v[232:235], v[172:175], a[112:115], v[232:235]
  ds_read_b128 a[252:255], v115 offset:52224
  v_mfma_f32_16x16x32_bf16 v[176:179], v[144:147], a[20:23], v[176:179]
  buffer_load_dwordx4 v119, s[16:19], s37 offen nt lds
  v_mfma_f32_16x16x32_bf16 v[180:183], v[148:151], a[20:23], v[180:183]
  ds_read_b64_tr_b16 v[134:135], v161 offset:23040
  v_mfma_f32_16x16x32_bf16 v[184:187], v[152:155], a[20:23], v[184:187]
  s_waitcnt lgkmcnt(8)
  ds_read_b128 v[0:3], v115 offset:53248
  v_mfma_f32_16x16x32_bf16 v[188:191], v[156:159], a[20:23], v[188:191]
  ds_read_b64_tr_b16 v[136:137], v162 offset:20992
  v_mfma_f32_16x16x32_bf16 v[192:195], v[172:175], a[20:23], v[192:195]
  ds_read_b64_tr_b16 v[138:139], v162 offset:23040
  v_mfma_f32_16x16x32_bf16 v[196:199], v[144:147], a[68:71], v[196:199]
  ds_read_b128 v[4:7], v115 offset:54272
  v_mfma_f32_16x16x32_bf16 v[200:203], v[148:151], a[68:71], v[200:203]
  ds_read_b64_tr_b16 v[140:141], v163 offset:20992
  s_mov_b32 s38, 82048
  v_mfma_f32_16x16x32_bf16 v[204:207], v[152:155], a[68:71], v[204:207]
  ds_read_b64_tr_b16 v[142:143], v163 offset:23040
  s_add_u32 m0, s29, 67328
  v_mfma_f32_16x16x32_bf16 v[208:211], v[156:159], a[68:71], v[208:211]
  v_mfma_f32_16x16x32_bf16 v[212:215], v[172:175], a[68:71], v[212:215]
  ds_read_b128 v[8:11], v115 offset:55296
  v_mfma_f32_16x16x32_bf16 v[216:219], v[144:147], a[116:119], v[216:219]
  buffer_load_dwordx4 v119, s[16:19], s38 offen nt lds
  v_mfma_f32_16x16x32_bf16 v[220:223], v[148:151], a[116:119], v[220:223]
  ds_read_b64_tr_b16 v[144:145], v160 offset:25344
  v_mfma_f32_16x16x32_bf16 v[224:227], v[152:155], a[116:119], v[224:227]
  ds_read_b128 v[12:15], v115 offset:56320
  v_mfma_f32_16x16x32_bf16 v[228:231], v[156:159], a[116:119], v[228:231]
  ds_read_b64_tr_b16 v[146:147], v160 offset:27392
  v_mfma_f32_16x16x32_bf16 v[232:235], v[172:175], a[116:119], v[232:235]
  s_waitcnt lgkmcnt(13)
  ds_read_b64_tr_b16 v[148:149], v161 offset:25344
  v_mfma_f32_16x16x32_bf16 v[176:179], v[128:131], a[24:27], v[176:179]
  s_waitcnt lgkmcnt(11)
  ds_read_b128 v[16:19], v115 offset:57344
  s_mov_b32 s39, 98432
  v_mfma_f32_16x16x32_bf16 v[180:183], v[132:135], a[24:27], v[180:183]
  s_waitcnt lgkmcnt(9)
  ds_read_b64_tr_b16 v[150:151], v161 offset:27392
  s_add_u32 m0, s29, 71424
  v_mfma_f32_16x16x32_bf16 v[184:187], v[136:139], a[24:27], v[184:187]
  s_waitcnt lgkmcnt(7)
  ds_read_b64_tr_b16 v[152:153], v162 offset:25344
  v_mfma_f32_16x16x32_bf16 v[188:191], v[140:143], a[24:27], v[188:191]
  buffer_load_dwordx4 v119, s[16:19], s39 offen nt lds
  v_mfma_f32_16x16x32_bf16 v[192:195], v[172:175], a[24:27], v[192:195]
  ds_read_b128 v[20:23], v115 offset:58368
  v_mfma_f32_16x16x32_bf16 v[196:199], v[128:131], a[72:75], v[196:199]
  ds_read_b64_tr_b16 v[154:155], v162 offset:27392
  v_mfma_f32_16x16x32_bf16 v[200:203], v[132:135], a[72:75], v[200:203]
  ds_read_b64_tr_b16 v[156:157], v163 offset:25344
  v_mfma_f32_16x16x32_bf16 v[204:207], v[136:139], a[72:75], v[204:207]
  ds_read_b128 v[24:27], v115 offset:59392
  v_mfma_f32_16x16x32_bf16 v[208:211], v[140:143], a[72:75], v[208:211]
  ds_read_b64_tr_b16 v[158:159], v163 offset:27392
  v_mfma_f32_16x16x32_bf16 v[212:215], v[172:175], a[72:75], v[212:215]
  s_mov_b32 s40, 114816
  v_mfma_f32_16x16x32_bf16 v[216:219], v[128:131], a[120:123], v[216:219]
  ds_read_b128 v[28:31], v115 offset:60416
  s_add_u32 m0, s29, 75520
  v_mfma_f32_16x16x32_bf16 v[220:223], v[132:135], a[120:123], v[220:223]
  ds_read_b64_tr_b16 v[128:129], v160 offset:29440
  v_mfma_f32_16x16x32_bf16 v[224:227], v[136:139], a[120:123], v[224:227]
  buffer_load_dwordx4 v119, s[16:19], s40 offen nt lds
  v_mfma_f32_16x16x32_bf16 v[228:231], v[140:143], a[120:123], v[228:231]
  ds_read_b64_tr_b16 v[130:131], v160 offset:31488
  v_subrev_u32 v160, 25344, v160
  v_mfma_f32_16x16x32_bf16 v[232:235], v[172:175], a[120:123], v[232:235]
  s_waitcnt lgkmcnt(12)
  ds_read_b64_tr_b16 v[132:133], v161 offset:29440
  v_mfma_f32_16x16x32_bf16 v[176:179], v[144:147], a[28:31], v[176:179]
  s_waitcnt lgkmcnt(10)
  ds_read_b64_tr_b16 v[134:135], v161 offset:31488
  v_subrev_u32 v161, 25344, v161
  v_mfma_f32_16x16x32_bf16 v[180:183], v[148:151], a[28:31], v[180:183]
  s_waitcnt lgkmcnt(8)
  ds_read_b64_tr_b16 v[136:137], v162 offset:29440
  v_mfma_f32_16x16x32_bf16 v[184:187], v[152:155], a[28:31], v[184:187]
  s_waitcnt lgkmcnt(6)
  ds_read_b64_tr_b16 v[138:139], v162 offset:31488
  v_subrev_u32 v162, 25344, v162
  v_mfma_f32_16x16x32_bf16 v[188:191], v[156:159], a[28:31], v[188:191]
  ds_read_b64_tr_b16 v[140:141], v163 offset:29440
  s_mov_b32 s41, 131200
  v_mfma_f32_16x16x32_bf16 v[192:195], v[172:175], a[28:31], v[192:195]
  ds_read_b64_tr_b16 v[142:143], v163 offset:31488
  s_add_u32 m0, s29, 79616
  v_subrev_u32 v163, 25344, v163
  v_mfma_f32_16x16x32_bf16 v[196:199], v[144:147], a[76:79], v[196:199]
  v_mfma_f32_16x16x32_bf16 v[200:203], v[148:151], a[76:79], v[200:203]
  buffer_load_dwordx4 v119, s[16:19], s41 offen nt lds
  v_mfma_f32_16x16x32_bf16 v[204:207], v[152:155], a[76:79], v[204:207]
  v_mfma_f32_16x16x32_bf16 v[208:211], v[156:159], a[76:79], v[208:211]
  v_mfma_f32_16x16x32_bf16 v[212:215], v[172:175], a[76:79], v[212:215]
  v_mfma_f32_16x16x32_bf16 v[216:219], v[144:147], a[124:127], v[216:219]
  ds_read_b64_tr_b16 v[144:145], v160 offset:0
  v_mfma_f32_16x16x32_bf16 v[220:223], v[148:151], a[124:127], v[220:223]
  ds_read_b64_tr_b16 v[146:147], v160 offset:2048
  v_mfma_f32_16x16x32_bf16 v[224:227], v[152:155], a[124:127], v[224:227]
  ds_read_b64_tr_b16 v[148:149], v161 offset:0
  s_mov_b32 s42, 147584
  v_mfma_f32_16x16x32_bf16 v[228:231], v[156:159], a[124:127], v[228:231]
  ds_read_b64_tr_b16 v[150:151], v161 offset:2048
  s_add_u32 m0, s29, 83712
  v_mfma_f32_16x16x32_bf16 v[232:235], v[172:175], a[124:127], v[232:235]
  s_waitcnt lgkmcnt(10)
  ds_read_b64_tr_b16 v[152:153], v162 offset:0
  v_mfma_f32_16x16x32_bf16 v[176:179], v[128:131], a[32:35], v[176:179]
  s_waitcnt lgkmcnt(9)
  buffer_load_dwordx4 v119, s[16:19], s42 offen nt lds
  v_mfma_f32_16x16x32_bf16 v[180:183], v[132:135], a[32:35], v[180:183]
  s_waitcnt lgkmcnt(7)
  ds_read_b64_tr_b16 v[154:155], v162 offset:2048
  v_mfma_f32_16x16x32_bf16 v[184:187], v[136:139], a[32:35], v[184:187]
  s_waitcnt lgkmcnt(6)
  ds_read_b64_tr_b16 v[156:157], v163 offset:0
  v_mfma_f32_16x16x32_bf16 v[188:191], v[140:143], a[32:35], v[188:191]
  ds_read_b64_tr_b16 v[158:159], v163 offset:2048
  v_mfma_f32_16x16x32_bf16 v[192:195], v[172:175], a[32:35], v[192:195]
  v_mfma_f32_16x16x32_bf16 v[196:199], v[128:131], a[80:83], v[196:199]
  s_waitcnt vmcnt(7)
  s_barrier
  v_mfma_f32_16x16x32_bf16 v[200:203], v[132:135], a[80:83], v[200:203]
  s_mov_b32 s43, 163968
  v_mfma_f32_16x16x32_bf16 v[204:207], v[136:139], a[80:83], v[204:207]
  s_add_u32 m0, s29, 87808
  v_mfma_f32_16x16x32_bf16 v[208:211], v[140:143], a[80:83], v[208:211]
  v_mfma_f32_16x16x32_bf16 v[212:215], v[172:175], a[80:83], v[212:215]
  buffer_load_dwordx4 v119, s[16:19], s43 offen nt lds
  v_mfma_f32_16x16x32_bf16 v[216:219], v[128:131], a[128:131], v[216:219]
  ds_read_b64_tr_b16 v[128:129], v160 offset:4096
  v_mfma_f32_16x16x32_bf16 v[220:223], v[132:135], a[128:131], v[220:223]
  ds_read_b64_tr_b16 v[130:131], v160 offset:6144
  v_mfma_f32_16x16x32_bf16 v[224:227], v[136:139], a[128:131], v[224:227]
  ds_read_b64_tr_b16 v[132:133], v161 offset:4096
  v_mfma_f32_16x16x32_bf16 v[228:231], v[140:143], a[128:131], v[228:231]
  ds_read_b64_tr_b16 v[134:135], v161 offset:6144
  v_mfma_f32_16x16x32_bf16 v[232:235], v[172:175], a[128:131], v[232:235]
  s_waitcnt lgkmcnt(10)
  ds_read_b64_tr_b16 v[136:137], v162 offset:4096
  v_mfma_f32_16x16x32_bf16 v[176:179], v[144:147], a[36:39], v[176:179]
  s_waitcnt lgkmcnt(9)
  ds_read_b64_tr_b16 v[138:139], v162 offset:6144
  s_mov_b32 s44, 180352
  v_mfma_f32_16x16x32_bf16 v[180:183], v[148:151], a[36:39], v[180:183]
  s_waitcnt lgkmcnt(8)
  ds_read_b64_tr_b16 v[140:141], v163 offset:4096
  s_add_u32 m0, s29, 91904
  v_mfma_f32_16x16x32_bf16 v[184:187], v[152:155], a[36:39], v[184:187]
  s_waitcnt lgkmcnt(7)
  ds_read_b64_tr_b16 v[142:143], v163 offset:6144
  v_mfma_f32_16x16x32_bf16 v[188:191], v[156:159], a[36:39], v[188:191]
  buffer_load_dwordx4 v119, s[16:19], s44 offen nt lds
  v_mfma_f32_16x16x32_bf16 v[192:195], v[172:175], a[36:39], v[192:195]
  v_mfma_f32_16x16x32_bf16 v[196:199], v[144:147], a[84:87], v[196:199]
  v_mfma_f32_16x16x32_bf16 v[200:203], v[148:151], a[84:87], v[200:203]
  v_mfma_f32_16x16x32_bf16 v[204:207], v[152:155], a[84:87], v[204:207]
  v_mfma_f32_16x16x32_bf16 v[208:211], v[156:159], a[84:87], v[208:211]
  v_mfma_f32_16x16x32_bf16 v[212:215], v[172:175], a[84:87], v[212:215]
  s_mov_b32 s45, 256
  v_mfma_f32_16x16x32_bf16 v[216:219], v[144:147], a[132:135], v[216:219]
  ds_read_b64_tr_b16 v[144:145], v160 offset:8448
  s_add_u32 m0, s29, 96000
  v_mfma_f32_16x16x32_bf16 v[220:223], v[148:151], a[132:135], v[220:223]
  ds_read_b64_tr_b16 v[146:147], v160 offset:10496
  v_add_u32 v160, 158464, v160
  v_mfma_f32_16x16x32_bf16 v[224:227], v[152:155], a[132:135], v[224:227]
  buffer_load_dwordx4 v119, s[16:19], s45 offen nt lds
  v_mfma_f32_16x16x32_bf16 v[228:231], v[156:159], a[132:135], v[228:231]
  ds_read_b64_tr_b16 v[148:149], v161 offset:8448
  v_mfma_f32_16x16x32_bf16 v[232:235], v[172:175], a[132:135], v[232:235]
  s_waitcnt lgkmcnt(9)
  ds_read_b64_tr_b16 v[150:151], v161 offset:10496
  v_add_u32 v161, 158464, v161
  v_mfma_f32_16x16x32_bf16 v[176:179], v[128:131], a[40:43], v[176:179]
  s_waitcnt lgkmcnt(8)
  ds_read_b64_tr_b16 v[152:153], v162 offset:8448
  v_mfma_f32_16x16x32_bf16 v[180:183], v[132:135], a[40:43], v[180:183]
  s_waitcnt lgkmcnt(7)
  ds_read_b64_tr_b16 v[154:155], v162 offset:10496
  v_add_u32 v162, 158464, v162
  v_mfma_f32_16x16x32_bf16 v[184:187], v[136:139], a[40:43], v[184:187]
  s_waitcnt lgkmcnt(6)
  ds_read_b64_tr_b16 v[156:157], v163 offset:8448
  v_mfma_f32_16x16x32_bf16 v[188:191], v[140:143], a[40:43], v[188:191]
  ds_read_b64_tr_b16 v[158:159], v163 offset:10496
  s_mov_b32 s46, 16640
  v_add_u32 v163, 158464, v163
  v_mfma_f32_16x16x32_bf16 v[192:195], v[172:175], a[40:43], v[192:195]
  s_add_u32 m0, s29, 100096
  v_mfma_f32_16x16x32_bf16 v[196:199], v[128:131], a[88:91], v[196:199]
  v_mfma_f32_16x16x32_bf16 v[200:203], v[132:135], a[88:91], v[200:203]
  buffer_load_dwordx4 v119, s[16:19], s46 offen nt lds
  v_mfma_f32_16x16x32_bf16 v[204:207], v[136:139], a[88:91], v[204:207]
  v_mfma_f32_16x16x32_bf16 v[208:211], v[140:143], a[88:91], v[208:211]
  v_mfma_f32_16x16x32_bf16 v[212:215], v[172:175], a[88:91], v[212:215]
  v_mfma_f32_16x16x32_bf16 v[216:219], v[128:131], a[136:139], v[216:219]
  ds_read_b64_tr_b16 v[128:129], v160 offset:0
  v_mfma_f32_16x16x32_bf16 v[220:223], v[132:135], a[136:139], v[220:223]
  ds_read_b64_tr_b16 v[130:131], v160 offset:2048
  v_subrev_u32 v160, 133120, v160
  v_mfma_f32_16x16x32_bf16 v[224:227], v[136:139], a[136:139], v[224:227]
  ds_read_b64_tr_b16 v[132:133], v161 offset:0
  s_mov_b32 s47, 33024
  v_mfma_f32_16x16x32_bf16 v[228:231], v[140:143], a[136:139], v[228:231]
  ds_read_b64_tr_b16 v[134:135], v161 offset:2048
  s_add_u32 m0, s29, 104192
  v_subrev_u32 v161, 133120, v161
  v_mfma_f32_16x16x32_bf16 v[232:235], v[172:175], a[136:139], v[232:235]
  s_waitcnt lgkmcnt(10)
  ds_read_b64_tr_b16 v[136:137], v162 offset:0
  v_mfma_f32_16x16x32_bf16 v[176:179], v[144:147], a[44:47], v[176:179]
  s_waitcnt lgkmcnt(9)
  buffer_load_dwordx4 v119, s[16:19], s47 offen nt lds
  v_mfma_f32_16x16x32_bf16 v[180:183], v[148:151], a[44:47], v[180:183]
  s_waitcnt lgkmcnt(7)
  ds_read_b64_tr_b16 v[138:139], v162 offset:2048
  v_subrev_u32 v162, 133120, v162
  v_mfma_f32_16x16x32_bf16 v[184:187], v[152:155], a[44:47], v[184:187]
  s_waitcnt lgkmcnt(6)
  ds_read_b64_tr_b16 v[140:141], v163 offset:0
  v_mfma_f32_16x16x32_bf16 v[188:191], v[156:159], a[44:47], v[188:191]
  ds_read_b64_tr_b16 v[142:143], v163 offset:2048
  v_subrev_u32 v163, 133120, v163
  v_mfma_f32_16x16x32_bf16 v[192:195], v[172:175], a[44:47], v[192:195]
  v_mfma_f32_16x16x32_bf16 v[196:199], v[144:147], a[92:95], v[196:199]
  v_mfma_f32_16x16x32_bf16 v[200:203], v[148:151], a[92:95], v[200:203]
  v_mfma_f32_16x16x32_bf16 v[204:207], v[152:155], a[92:95], v[204:207]
  v_mfma_f32_16x16x32_bf16 v[208:211], v[156:159], a[92:95], v[208:211]
  v_mfma_f32_16x16x32_bf16 v[212:215], v[172:175], a[92:95], v[212:215]
  v_mfma_f32_16x16x32_bf16 v[216:219], v[144:147], a[140:143], v[216:219]
  ds_read_b64_tr_b16 v[144:145], v160 offset:0
  v_mfma_f32_16x16x32_bf16 v[220:223], v[148:151], a[140:143], v[220:223]
  ds_read_b64_tr_b16 v[146:147], v160 offset:2048
  v_mfma_f32_16x16x32_bf16 v[224:227], v[152:155], a[140:143], v[224:227]
  ds_read_b64_tr_b16 v[148:149], v161 offset:0
  v_mfma_f32_16x16x32_bf16 v[228:231], v[156:159], a[140:143], v[228:231]
  ds_read_b64_tr_b16 v[150:151], v161 offset:2048
  v_mfma_f32_16x16x32_bf16 v[232:235], v[172:175], a[140:143], v[232:235]
  s_waitcnt lgkmcnt(10)
  ds_read_b64_tr_b16 v[152:153], v162 offset:0
  v_mfma_f32_16x16x32_bf16 v[236:239], v[128:131], a[144:147], 0
  s_waitcnt lgkmcnt(9)
  ds_read_b64_tr_b16 v[154:155], v162 offset:2048
  s_mov_b32 s44, 0
  v_mfma_f32_16x16x32_bf16 v[240:243], v[132:135], a[144:147], 0
  s_waitcnt lgkmcnt(8)
  ds_read_b64_tr_b16 v[156:157], v163 offset:0
  v_mfma_f32_16x16x32_bf16 v[244:247], v[136:139], a[144:147], 0
  s_waitcnt lgkmcnt(7)
  ds_read_b64_tr_b16 v[158:159], v163 offset:2048
  s_mov_b32 s32, 49408
  v_mfma_f32_16x16x32_bf16 v[248:251], v[140:143], a[144:147], 0
  s_add_u32 m0, s29, 108288
  v_rcp_f32 v96, v192
  v_mfma_f32_16x16x32_bf16 v[252:255], v[172:175], a[144:147], 0
  v_mul_f32 v176, v176, v96
  v_mul_f32 v177, v177, v96
  v_mfma_f32_16x16x32_bf16 v[164:167], v[128:131], a[192:195], 0
  buffer_load_dwordx4 v119, s[16:19], s32 offen nt lds
  v_mul_f32 v178, v178, v96
  v_mul_f32 v179, v179, v96
  v_mfma_f32_16x16x32_bf16 v[32:35], v[132:135], a[192:195], 0
  v_cvt_pk_bf16_f32 v176, v176, v177
  v_cvt_pk_bf16_f32 v177, v178, v179
  v_mfma_f32_16x16x32_bf16 v[36:39], v[136:139], a[192:195], 0
  v_mul_f32 v180, v180, v96
  v_mul_f32 v181, v181, v96
  v_mfma_f32_16x16x32_bf16 v[40:43], v[140:143], a[192:195], 0
  v_mul_f32 v182, v182, v96
  v_mul_f32 v183, v183, v96
  v_mfma_f32_16x16x32_bf16 v[44:47], v[172:175], a[192:195], 0
  v_cvt_pk_bf16_f32 v178, v180, v181
  v_cvt_pk_bf16_f32 v179, v182, v183
  v_mfma_f32_16x16x32_bf16 v[48:51], v[128:131], a[240:243], 0
  ds_read_b64_tr_b16 v[128:129], v160 offset:4096
  v_mul_f32 v184, v184, v96
  v_mfma_f32_16x16x32_bf16 v[52:55], v[132:135], a[240:243], 0
  ds_read_b64_tr_b16 v[130:131], v160 offset:6144
  v_mul_f32 v185, v185, v96
  v_mfma_f32_16x16x32_bf16 v[56:59], v[136:139], a[240:243], 0
  ds_read_b64_tr_b16 v[132:133], v161 offset:4096
  v_mul_f32 v186, v186, v96
  v_mfma_f32_16x16x32_bf16 v[60:63], v[140:143], a[240:243], 0
  ds_read_b64_tr_b16 v[134:135], v161 offset:6144
  v_mul_f32 v187, v187, v96
  v_mfma_f32_16x16x32_bf16 v[64:67], v[172:175], a[240:243], 0
  s_waitcnt lgkmcnt(10)
  ds_read_b64_tr_b16 v[136:137], v162 offset:4096
  v_cvt_pk_bf16_f32 v184, v184, v185
  v_mfma_f32_16x16x32_bf16 v[236:239], v[144:147], a[148:151], v[236:239]
  s_waitcnt lgkmcnt(9)
  ds_read_b64_tr_b16 v[138:139], v162 offset:6144
  s_mov_b32 s33, 65792
  v_cvt_pk_bf16_f32 v185, v186, v187
  v_mfma_f32_16x16x32_bf16 v[240:243], v[148:151], a[148:151], v[240:243]
  s_waitcnt lgkmcnt(8)
  ds_read_b64_tr_b16 v[140:141], v163 offset:4096
  s_add_u32 m0, s29, 112384
  v_mul_f32 v188, v188, v96
  v_mfma_f32_16x16x32_bf16 v[244:247], v[152:155], a[148:151], v[244:247]
  s_waitcnt lgkmcnt(7)
  ds_read_b64_tr_b16 v[142:143], v163 offset:6144
  v_mul_f32 v189, v189, v96
  v_mfma_f32_16x16x32_bf16 v[248:251], v[156:159], a[148:151], v[248:251]
  buffer_load_dwordx4 v119, s[16:19], s33 offen nt lds
  v_permlane16_swap_b32 v176, v178
  v_mfma_f32_16x16x32_bf16 v[252:255], v[172:175], a[148:151], v[252:255]
  v_permlane16_swap_b32 v177, v179
  v_mfma_f32_16x16x32_bf16 v[164:167], v[144:147], a[196:199], v[164:167]
  v_mul_f32 v190, v190, v96
  v_mul_f32 v191, v191, v96
  v_mfma_f32_16x16x32_bf16 v[32:35], v[148:151], a[196:199], v[32:35]
  v_cvt_pk_bf16_f32 v186, v188, v189
  v_cvt_pk_bf16_f32 v187, v190, v191
  v_mfma_f32_16x16x32_bf16 v[36:39], v[152:155], a[196:199], v[36:39]
  v_permlane16_swap_b32 v184, v186
  v_mfma_f32_16x16x32_bf16 v[40:43], v[156:159], a[196:199], v[40:43]
  v_permlane16_swap_b32 v185, v187
  v_mfma_f32_16x16x32_bf16 v[44:47], v[172:175], a[196:199], v[44:47]
  v_mov_b32 v180, v184
  v_mov_b32_dpp v184, v176 row_ror:8 row_mask:0xf bank_mask:0x3
  v_mfma_f32_16x16x32_bf16 v[48:51], v[144:147], a[244:247], v[48:51]
  ds_read_b64_tr_b16 v[144:145], v160 offset:8448
  v_mov_b32_dpp v176, v180 row_ror:8 row_mask:0xf bank_mask:0xc
  v_mfma_f32_16x16x32_bf16 v[52:55], v[148:151], a[244:247], v[52:55]
  ds_read_b64_tr_b16 v[146:147], v160 offset:10496
  v_mov_b32 v181, v185
  v_mfma_f32_16x16x32_bf16 v[56:59], v[152:155], a[244:247], v[56:59]
  ds_read_b64_tr_b16 v[148:149], v161 offset:8448
  v_mov_b32_dpp v185, v177 row_ror:8 row_mask:0xf bank_mask:0x3
  v_mfma_f32_16x16x32_bf16 v[60:63], v[156:159], a[244:247], v[60:63]
  ds_read_b64_tr_b16 v[150:151], v161 offset:10496
  s_mov_b32 s45, 4096
  v_mov_b32_dpp v177, v181 row_ror:8 row_mask:0xf bank_mask:0xc
  v_mfma_f32_16x16x32_bf16 v[64:67], v[172:175], a[244:247], v[64:67]
  s_waitcnt lgkmcnt(10)
  ds_read_b64_tr_b16 v[152:153], v162 offset:8448
  s_mov_b32 s34, 82176
  v_mov_b32 v182, v186
  v_mfma_f32_16x16x32_bf16 v[236:239], v[128:131], a[152:155], v[236:239]
  s_waitcnt lgkmcnt(9)
  ds_read_b64_tr_b16 v[154:155], v162 offset:10496
  s_add_u32 m0, s29, 116480
  v_mov_b32_dpp v186, v178 row_ror:8 row_mask:0xf bank_mask:0x3
  v_mfma_f32_16x16x32_bf16 v[240:243], v[132:135], a[152:155], v[240:243]
  s_waitcnt lgkmcnt(8)
  ds_read_b64_tr_b16 v[156:157], v163 offset:8448
  v_mov_b32_dpp v178, v182 row_ror:8 row_mask:0xf bank_mask:0xc
  v_mfma_f32_16x16x32_bf16 v[244:247], v[136:139], a[152:155], v[244:247]
  s_waitcnt lgkmcnt(7)
  buffer_load_dwordx4 v119, s[16:19], s34 offen nt lds
  v_mov_b32 v183, v187
  v_mov_b32_dpp v187, v179 row_ror:8 row_mask:0xf bank_mask:0x3
  v_mfma_f32_16x16x32_bf16 v[248:251], v[140:143], a[152:155], v[248:251]
  buffer_store_dwordx4 v[184:187], v169, s[20:23], s45 offen nt
  v_mov_b32_dpp v179, v183 row_ror:8 row_mask:0xf bank_mask:0xc
  v_mfma_f32_16x16x32_bf16 v[252:255], v[172:175], a[152:155], v[252:255]
  buffer_store_dwordx4 v[176:179], v169, s[20:23], s44 offen nt
  v_rcp_f32 v97, v212
  v_mfma_f32_16x16x32_bf16 v[164:167], v[128:131], a[200:203], v[164:167]
  ds_read_b64_tr_b16 v[158:159], v163 offset:10496
  v_mul_f32 v196, v196, v97
  v_mfma_f32_16x16x32_bf16 v[32:35], v[132:135], a[200:203], v[32:35]
  v_mul_f32 v197, v197, v97
  v_mul_f32 v198, v198, v97
  v_mfma_f32_16x16x32_bf16 v[36:39], v[136:139], a[200:203], v[36:39]
  v_mul_f32 v199, v199, v97
  v_cvt_pk_bf16_f32 v196, v196, v197
  v_mfma_f32_16x16x32_bf16 v[40:43], v[140:143], a[200:203], v[40:43]
  v_cvt_pk_bf16_f32 v197, v198, v199
  v_mul_f32 v200, v200, v97
  v_mfma_f32_16x16x32_bf16 v[44:47], v[172:175], a[200:203], v[44:47]
  v_mul_f32 v201, v201, v97
  v_mul_f32 v202, v202, v97
  v_mfma_f32_16x16x32_bf16 v[48:51], v[128:131], a[248:251], v[48:51]
  ds_read_b64_tr_b16 v[128:129], v160 offset:12544
  v_mul_f32 v203, v203, v97
  v_mfma_f32_16x16x32_bf16 v[52:55], v[132:135], a[248:251], v[52:55]
  ds_read_b64_tr_b16 v[130:131], v160 offset:14592
  v_cvt_pk_bf16_f32 v198, v200, v201
  v_mfma_f32_16x16x32_bf16 v[56:59], v[136:139], a[248:251], v[56:59]
  ds_read_b64_tr_b16 v[132:133], v161 offset:12544
  s_mov_b32 s35, 98560
  v_cvt_pk_bf16_f32 v199, v202, v203
  v_mfma_f32_16x16x32_bf16 v[60:63], v[140:143], a[248:251], v[60:63]
  ds_read_b64_tr_b16 v[134:135], v161 offset:14592
  s_add_u32 m0, s29, 120576
  v_mul_f32 v204, v204, v97
  v_mfma_f32_16x16x32_bf16 v[64:67], v[172:175], a[248:251], v[64:67]
  s_waitcnt lgkmcnt(10)
  ds_read_b64_tr_b16 v[136:137], v162 offset:12544
  v_mul_f32 v205, v205, v97
  v_mfma_f32_16x16x32_bf16 v[236:239], v[144:147], a[156:159], v[236:239]
  s_waitcnt lgkmcnt(9)
  buffer_load_dwordx4 v119, s[16:19], s35 offen nt lds
  v_mul_f32 v206, v206, v97
  v_mul_f32 v207, v207, v97
  v_mfma_f32_16x16x32_bf16 v[240:243], v[148:151], a[156:159], v[240:243]
  s_waitcnt lgkmcnt(7)
  ds_read_b64_tr_b16 v[138:139], v162 offset:14592
  v_cvt_pk_bf16_f32 v204, v204, v205
  v_mfma_f32_16x16x32_bf16 v[244:247], v[152:155], a[156:159], v[244:247]
  s_waitcnt lgkmcnt(6)
  ds_read_b64_tr_b16 v[140:141], v163 offset:12544
  v_cvt_pk_bf16_f32 v205, v206, v207
  v_mfma_f32_16x16x32_bf16 v[248:251], v[156:159], a[156:159], v[248:251]
  ds_read_b64_tr_b16 v[142:143], v163 offset:14592
  v_mul_f32 v208, v208, v97
  v_mfma_f32_16x16x32_bf16 v[252:255], v[172:175], a[156:159], v[252:255]
  v_permlane16_swap_b32 v196, v198
  v_mfma_f32_16x16x32_bf16 v[164:167], v[144:147], a[204:207], v[164:167]
  v_permlane16_swap_b32 v197, v199
  v_mfma_f32_16x16x32_bf16 v[32:35], v[148:151], a[204:207], v[32:35]
  v_mul_f32 v209, v209, v97
  v_mul_f32 v210, v210, v97
  v_mfma_f32_16x16x32_bf16 v[36:39], v[152:155], a[204:207], v[36:39]
  v_mul_f32 v211, v211, v97
  v_cvt_pk_bf16_f32 v206, v208, v209
  v_mfma_f32_16x16x32_bf16 v[40:43], v[156:159], a[204:207], v[40:43]
  v_cvt_pk_bf16_f32 v207, v210, v211
  v_mfma_f32_16x16x32_bf16 v[44:47], v[172:175], a[204:207], v[44:47]
  v_permlane16_swap_b32 v204, v206
  v_mfma_f32_16x16x32_bf16 v[48:51], v[144:147], a[252:255], v[48:51]
  ds_read_b64_tr_b16 v[144:145], v160 offset:16896
  v_mov_b32 v200, v204
  v_mfma_f32_16x16x32_bf16 v[52:55], v[148:151], a[252:255], v[52:55]
  ds_read_b64_tr_b16 v[146:147], v160 offset:18944
  s_mov_b32 s36, 114944
  v_mov_b32_dpp v204, v196 row_ror:8 row_mask:0xf bank_mask:0x3
  v_mfma_f32_16x16x32_bf16 v[56:59], v[152:155], a[252:255], v[56:59]
  ds_read_b64_tr_b16 v[148:149], v161 offset:16896
  s_add_u32 m0, s29, 124672
  v_mov_b32_dpp v196, v200 row_ror:8 row_mask:0xf bank_mask:0xc
  v_mfma_f32_16x16x32_bf16 v[60:63], v[156:159], a[252:255], v[60:63]
  ds_read_b64_tr_b16 v[150:151], v161 offset:18944
  s_mov_b32 s46, 32768
  v_mov_b32 v202, v206
  v_mfma_f32_16x16x32_bf16 v[64:67], v[172:175], a[252:255], v[64:67]
  s_waitcnt lgkmcnt(10)
  buffer_load_dwordx4 v119, s[16:19], s36 offen nt lds
  v_permlane16_swap_b32 v205, v207
  v_mfma_f32_16x16x32_bf16 v[236:239], v[128:131], a[160:163], v[236:239]
  s_waitcnt lgkmcnt(8)
  ds_read_b64_tr_b16 v[152:153], v162 offset:16896
  v_mov_b32 v201, v205
  v_mfma_f32_16x16x32_bf16 v[240:243], v[132:135], a[160:163], v[240:243]
  s_waitcnt lgkmcnt(7)
  ds_read_b64_tr_b16 v[154:155], v162 offset:18944
  v_mov_b32_dpp v205, v197 row_ror:8 row_mask:0xf bank_mask:0x3
  v_mfma_f32_16x16x32_bf16 v[244:247], v[136:139], a[160:163], v[244:247]
  s_waitcnt lgkmcnt(6)
  ds_read_b64_tr_b16 v[156:157], v163 offset:16896
  v_mov_b32_dpp v197, v201 row_ror:8 row_mask:0xf bank_mask:0xc
  v_mfma_f32_16x16x32_bf16 v[248:251], v[140:143], a[160:163], v[248:251]
  ds_read_b64_tr_b16 v[158:159], v163 offset:18944
  v_mov_b32_dpp v206, v198 row_ror:8 row_mask:0xf bank_mask:0x3
  v_mfma_f32_16x16x32_bf16 v[252:255], v[172:175], a[160:163], v[252:255]
  v_mov_b32_dpp v198, v202 row_ror:8 row_mask:0xf bank_mask:0xc
  v_mov_b32 v203, v207
  v_mfma_f32_16x16x32_bf16 v[164:167], v[128:131], a[208:211], v[164:167]
  v_mov_b32_dpp v207, v199 row_ror:8 row_mask:0xf bank_mask:0x3
  v_mov_b32_dpp v199, v203 row_ror:8 row_mask:0xf bank_mask:0xc
  v_mfma_f32_16x16x32_bf16 v[32:35], v[132:135], a[208:211], v[32:35]
  buffer_store_dwordx4 v[196:199], v169, s[20:23], s46 offen nt
  v_rcp_f32 v98, v232
  v_mfma_f32_16x16x32_bf16 v[36:39], v[136:139], a[208:211], v[36:39]
  v_mul_f32 v216, v216, v98
  v_mul_f32 v217, v217, v98
  v_mfma_f32_16x16x32_bf16 v[40:43], v[140:143], a[208:211], v[40:43]
  v_mul_f32 v218, v218, v98
  v_mul_f32 v219, v219, v98
  v_mfma_f32_16x16x32_bf16 v[44:47], v[172:175], a[208:211], v[44:47]
  s_mov_b32 s37, 131328
  v_cvt_pk_bf16_f32 v216, v216, v217
  v_cvt_pk_bf16_f32 v217, v218, v219
  v_mfma_f32_16x16x32_bf16 v[48:51], v[128:131], v[0:3], v[48:51]
  ds_read_b64_tr_b16 v[128:129], v160 offset:20992
  s_add_u32 m0, s29, 128768
  v_mul_f32 v220, v220, v98
  v_mfma_f32_16x16x32_bf16 v[52:55], v[132:135], v[0:3], v[52:55]
  ds_read_b64_tr_b16 v[130:131], v160 offset:23040
  v_mul_f32 v221, v221, v98
  v_mfma_f32_16x16x32_bf16 v[56:59], v[136:139], v[0:3], v[56:59]
  buffer_load_dwordx4 v119, s[16:19], s37 offen nt lds
  v_mul_f32 v222, v222, v98
  v_mul_f32 v223, v223, v98
  v_mfma_f32_16x16x32_bf16 v[60:63], v[140:143], v[0:3], v[60:63]
  ds_read_b64_tr_b16 v[132:133], v161 offset:20992
  v_cvt_pk_bf16_f32 v218, v220, v221
  v_mfma_f32_16x16x32_bf16 v[64:67], v[172:175], v[0:3], v[64:67]
  s_waitcnt lgkmcnt(9)
  ds_read_b64_tr_b16 v[134:135], v161 offset:23040
  v_cvt_pk_bf16_f32 v219, v222, v223
  v_mfma_f32_16x16x32_bf16 v[236:239], v[144:147], a[164:167], v[236:239]
  s_waitcnt lgkmcnt(8)
  ds_read_b64_tr_b16 v[136:137], v162 offset:20992
  v_mul_f32 v224, v224, v98
  v_mfma_f32_16x16x32_bf16 v[240:243], v[148:151], a[164:167], v[240:243]
  s_waitcnt lgkmcnt(7)
  ds_read_b64_tr_b16 v[138:139], v162 offset:23040
  v_mul_f32 v225, v225, v98
  v_mfma_f32_16x16x32_bf16 v[244:247], v[152:155], a[164:167], v[244:247]
  s_waitcnt lgkmcnt(6)
  ds_read_b64_tr_b16 v[140:141], v163 offset:20992
  v_mul_f32 v226, v226, v98
  v_mfma_f32_16x16x32_bf16 v[248:251], v[156:159], a[164:167], v[248:251]
  ds_read_b64_tr_b16 v[142:143], v163 offset:23040
  v_mul_f32 v227, v227, v98
  v_mfma_f32_16x16x32_bf16 v[252:255], v[172:175], a[164:167], v[252:255]
  v_permlane16_swap_b32 v216, v218
  v_mfma_f32_16x16x32_bf16 v[164:167], v[144:147], a[212:215], v[164:167]
  v_cvt_pk_bf16_f32 v224, v224, v225
  v_cvt_pk_bf16_f32 v225, v226, v227
  v_mfma_f32_16x16x32_bf16 v[32:35], v[148:151], a[212:215], v[32:35]
  v_permlane16_swap_b32 v217, v219
  v_mfma_f32_16x16x32_bf16 v[36:39], v[152:155], a[212:215], v[36:39]
  v_mul_f32 v228, v228, v98
  v_mul_f32 v229, v229, v98
  v_mfma_f32_16x16x32_bf16 v[40:43], v[156:159], a[212:215], v[40:43]
  s_mov_b32 s38, 147712
  v_mul_f32 v230, v230, v98
  v_mul_f32 v231, v231, v98
  v_mfma_f32_16x16x32_bf16 v[44:47], v[172:175], a[212:215], v[44:47]
  s_add_u32 m0, s29, 132864
  v_cvt_pk_bf16_f32 v226, v228, v229
  v_cvt_pk_bf16_f32 v227, v230, v231
  v_mfma_f32_16x16x32_bf16 v[48:51], v[144:147], v[4:7], v[48:51]
  ds_read_b64_tr_b16 v[144:145], v160 offset:25344
  s_mov_b32 s47, 36864
  v_min3_f32 v102, v96, v97, v98
  v_mfma_f32_16x16x32_bf16 v[52:55], v[148:151], v[4:7], v[52:55]
  buffer_load_dwordx4 v119, s[16:19], s38 offen nt lds
  v_permlane16_swap_b32 v224, v226
  v_mfma_f32_16x16x32_bf16 v[56:59], v[152:155], v[4:7], v[56:59]
  ds_read_b64_tr_b16 v[146:147], v160 offset:27392
  v_mov_b32 v220, v224
  v_mfma_f32_16x16x32_bf16 v[60:63], v[156:159], v[4:7], v[60:63]
  ds_read_b64_tr_b16 v[148:149], v161 offset:25344
  v_mov_b32_dpp v224, v216 row_ror:8 row_mask:0xf bank_mask:0x3
  v_mfma_f32_16x16x32_bf16 v[64:67], v[172:175], v[4:7], v[64:67]
  s_waitcnt lgkmcnt(9)
  buffer_store_dwordx4 v[204:207], v169, s[20:23], s47 offen nt
  v_permlane16_swap_b32 v225, v227
  v_mfma_f32_16x16x32_bf16 v[236:239], v[128:131], a[168:171], v[236:239]
  s_waitcnt lgkmcnt(7)
  ds_read_b64_tr_b16 v[150:151], v161 offset:27392
  v_mov_b32_dpp v216, v220 row_ror:8 row_mask:0xf bank_mask:0xc
  v_mfma_f32_16x16x32_bf16 v[240:243], v[132:135], a[168:171], v[240:243]
  s_waitcnt lgkmcnt(6)
  ds_read_b64_tr_b16 v[152:153], v162 offset:25344
  v_mov_b32 v221, v225
  v_mfma_f32_16x16x32_bf16 v[244:247], v[136:139], a[168:171], v[244:247]
  s_waitcnt lgkmcnt(5)
  ds_read_b64_tr_b16 v[154:155], v162 offset:27392
  v_mov_b32_dpp v225, v217 row_ror:8 row_mask:0xf bank_mask:0x3
  v_mfma_f32_16x16x32_bf16 v[248:251], v[140:143], a[168:171], v[248:251]
  ds_read_b64_tr_b16 v[156:157], v163 offset:25344
  v_mov_b32_dpp v217, v221 row_ror:8 row_mask:0xf bank_mask:0xc
  v_mfma_f32_16x16x32_bf16 v[252:255], v[172:175], a[168:171], v[252:255]
  ds_read_b64_tr_b16 v[158:159], v163 offset:27392
  v_mov_b32 v222, v226
  v_mfma_f32_16x16x32_bf16 v[164:167], v[128:131], a[216:219], v[164:167]
  v_mov_b32_dpp v226, v218 row_ror:8 row_mask:0xf bank_mask:0x3
  v_mov_b32_dpp v218, v222 row_ror:8 row_mask:0xf bank_mask:0xc
  v_mfma_f32_16x16x32_bf16 v[32:35], v[132:135], a[216:219], v[32:35]
  s_mov_b32 s39, 164096
  v_mov_b32 v223, v227
  v_mov_b32_dpp v227, v219 row_ror:8 row_mask:0xf bank_mask:0x3
  v_mfma_f32_16x16x32_bf16 v[36:39], v[136:139], a[216:219], v[36:39]
  s_add_u32 m0, s29, 136960
  v_mov_b32_dpp v219, v223 row_ror:8 row_mask:0xf bank_mask:0xc
  v_max3_f32 v103, v96, v97, v98
  v_mfma_f32_16x16x32_bf16 v[40:43], v[140:143], a[216:219], v[40:43]
  v_mfma_f32_16x16x32_bf16 v[44:47], v[172:175], a[216:219], v[44:47]
  buffer_load_dwordx4 v119, s[16:19], s39 offen nt lds
  v_mfma_f32_16x16x32_bf16 v[48:51], v[128:131], v[8:11], v[48:51]
  ds_read_b64_tr_b16 v[128:129], v160 offset:29440
  v_mfma_f32_16x16x32_bf16 v[52:55], v[132:135], v[8:11], v[52:55]
  ds_read_b64_tr_b16 v[130:131], v160 offset:31488
  v_subrev_u32 v160, 25344, v160
  v_mfma_f32_16x16x32_bf16 v[56:59], v[136:139], v[8:11], v[56:59]
  ds_read_b64_tr_b16 v[132:133], v161 offset:29440
  v_mfma_f32_16x16x32_bf16 v[60:63], v[140:143], v[8:11], v[60:63]
  ds_read_b64_tr_b16 v[134:135], v161 offset:31488
  v_subrev_u32 v161, 25344, v161
  v_mfma_f32_16x16x32_bf16 v[64:67], v[172:175], v[8:11], v[64:67]
  s_waitcnt lgkmcnt(10)
  ds_read_b64_tr_b16 v[136:137], v162 offset:29440
  v_mfma_f32_16x16x32_bf16 v[236:239], v[144:147], a[172:175], v[236:239]
  s_waitcnt lgkmcnt(9)
  ds_read_b64_tr_b16 v[138:139], v162 offset:31488
  v_subrev_u32 v162, 25344, v162
  v_mfma_f32_16x16x32_bf16 v[240:243], v[148:151], a[172:175], v[240:243]
  s_waitcnt lgkmcnt(8)
  ds_read_b64_tr_b16 v[140:141], v163 offset:29440
  v_mfma_f32_16x16x32_bf16 v[244:247], v[152:155], a[172:175], v[244:247]
  s_waitcnt lgkmcnt(7)
  ds_read_b64_tr_b16 v[142:143], v163 offset:31488
  v_subrev_u32 v163, 25344, v163
  v_mfma_f32_16x16x32_bf16 v[248:251], v[156:159], a[172:175], v[248:251]
  v_mfma_f32_16x16x32_bf16 v[252:255], v[172:175], a[172:175], v[252:255]
  v_mfma_f32_16x16x32_bf16 v[164:167], v[144:147], a[220:223], v[164:167]
  s_mov_b32 s40, 180480
  v_mfma_f32_16x16x32_bf16 v[32:35], v[148:151], a[220:223], v[32:35]
  s_add_u32 m0, s29, 141056
  v_mfma_f32_16x16x32_bf16 v[36:39], v[152:155], a[220:223], v[36:39]
  v_mfma_f32_16x16x32_bf16 v[40:43], v[156:159], a[220:223], v[40:43]
  buffer_load_dwordx4 v119, s[16:19], s40 offen nt lds
  v_mfma_f32_16x16x32_bf16 v[44:47], v[172:175], a[220:223], v[44:47]
  s_mov_b32 s32, 65536
  v_mfma_f32_16x16x32_bf16 v[48:51], v[144:147], v[12:15], v[48:51]
  ds_read_b64_tr_b16 v[144:145], v160 offset:0
  v_mfma_f32_16x16x32_bf16 v[52:55], v[148:151], v[12:15], v[52:55]
  ds_read_b64_tr_b16 v[146:147], v160 offset:2048
  v_mfma_f32_16x16x32_bf16 v[56:59], v[152:155], v[12:15], v[56:59]
  ds_read_b64_tr_b16 v[148:149], v161 offset:0
  v_mfma_f32_16x16x32_bf16 v[60:63], v[156:159], v[12:15], v[60:63]
  buffer_store_dwordx4 v[216:219], v169, s[20:23], s32 offen nt
  v_mfma_f32_16x16x32_bf16 v[64:67], v[172:175], v[12:15], v[64:67]
  s_waitcnt lgkmcnt(9)
  ds_read_b64_tr_b16 v[150:151], v161 offset:2048
  v_mfma_f32_16x16x32_bf16 v[236:239], v[128:131], a[176:179], v[236:239]
  s_waitcnt lgkmcnt(8)
  ds_read_b64_tr_b16 v[152:153], v162 offset:0
  v_mfma_f32_16x16x32_bf16 v[240:243], v[132:135], a[176:179], v[240:243]
  s_waitcnt lgkmcnt(7)
  ds_read_b64_tr_b16 v[154:155], v162 offset:2048
  v_mfma_f32_16x16x32_bf16 v[244:247], v[136:139], a[176:179], v[244:247]
  s_waitcnt lgkmcnt(6)
  ds_read_b64_tr_b16 v[156:157], v163 offset:0
  v_mfma_f32_16x16x32_bf16 v[248:251], v[140:143], a[176:179], v[248:251]
  ds_read_b64_tr_b16 v[158:159], v163 offset:2048
  s_mov_b32 s41, 384
  v_mfma_f32_16x16x32_bf16 v[252:255], v[172:175], a[176:179], v[252:255]
  s_add_u32 m0, s29, 145152
  v_mfma_f32_16x16x32_bf16 v[164:167], v[128:131], a[224:227], v[164:167]
  v_mfma_f32_16x16x32_bf16 v[32:35], v[132:135], a[224:227], v[32:35]
  buffer_load_dwordx4 v119, s[16:19], s41 offen nt lds
  v_mfma_f32_16x16x32_bf16 v[36:39], v[136:139], a[224:227], v[36:39]
  v_mfma_f32_16x16x32_bf16 v[40:43], v[140:143], a[224:227], v[40:43]
  v_mfma_f32_16x16x32_bf16 v[44:47], v[172:175], a[224:227], v[44:47]
  v_mfma_f32_16x16x32_bf16 v[48:51], v[128:131], v[16:19], v[48:51]
  ds_read_b64_tr_b16 v[128:129], v160 offset:4096
  v_mfma_f32_16x16x32_bf16 v[52:55], v[132:135], v[16:19], v[52:55]
  ds_read_b64_tr_b16 v[130:131], v160 offset:6144
  v_mfma_f32_16x16x32_bf16 v[56:59], v[136:139], v[16:19], v[56:59]
  ds_read_b64_tr_b16 v[132:133], v161 offset:4096
  v_mfma_f32_16x16x32_bf16 v[60:63], v[140:143], v[16:19], v[60:63]
  ds_read_b64_tr_b16 v[134:135], v161 offset:6144
  v_mfma_f32_16x16x32_bf16 v[64:67], v[172:175], v[16:19], v[64:67]
  s_waitcnt lgkmcnt(10)
  ds_read_b64_tr_b16 v[136:137], v162 offset:4096
  v_mfma_f32_16x16x32_bf16 v[236:239], v[144:147], a[180:183], v[236:239]
  s_waitcnt lgkmcnt(9)
  ds_read_b64_tr_b16 v[138:139], v162 offset:6144
  v_mfma_f32_16x16x32_bf16 v[240:243], v[148:151], a[180:183], v[240:243]
  s_waitcnt lgkmcnt(8)
  ds_read_b64_tr_b16 v[140:141], v163 offset:4096
  v_mfma_f32_16x16x32_bf16 v[244:247], v[152:155], a[180:183], v[244:247]
  s_waitcnt lgkmcnt(7)
  ds_read_b64_tr_b16 v[142:143], v163 offset:6144
  s_mov_b32 s42, 16768
  v_mfma_f32_16x16x32_bf16 v[248:251], v[156:159], a[180:183], v[248:251]
  s_add_u32 m0, s29, 149248
  v_mfma_f32_16x16x32_bf16 v[252:255], v[172:175], a[180:183], v[252:255]
  v_mfma_f32_16x16x32_bf16 v[164:167], v[144:147], a[228:231], v[164:167]
  buffer_load_dwordx4 v119, s[16:19], s42 offen nt lds
  v_mfma_f32_16x16x32_bf16 v[32:35], v[148:151], a[228:231], v[32:35]
  v_mfma_f32_16x16x32_bf16 v[36:39], v[152:155], a[228:231], v[36:39]
  s_mov_b32 s33, 69632
  v_mfma_f32_16x16x32_bf16 v[40:43], v[156:159], a[228:231], v[40:43]
  v_mfma_f32_16x16x32_bf16 v[44:47], v[172:175], a[228:231], v[44:47]
  v_mfma_f32_16x16x32_bf16 v[48:51], v[144:147], v[20:23], v[48:51]
  ds_read_b64_tr_b16 v[144:145], v160 offset:8448
  v_mfma_f32_16x16x32_bf16 v[52:55], v[148:151], v[20:23], v[52:55]
  buffer_store_dwordx4 v[224:227], v169, s[20:23], s33 offen nt
  v_mfma_f32_16x16x32_bf16 v[56:59], v[152:155], v[20:23], v[56:59]
  ds_read_b64_tr_b16 v[146:147], v160 offset:10496
  v_mfma_f32_16x16x32_bf16 v[60:63], v[156:159], v[20:23], v[60:63]
  ds_read_b64_tr_b16 v[148:149], v161 offset:8448
  v_mfma_f32_16x16x32_bf16 v[64:67], v[172:175], v[20:23], v[64:67]
  s_waitcnt lgkmcnt(9)
  ds_read_b64_tr_b16 v[150:151], v161 offset:10496
  v_mfma_f32_16x16x32_bf16 v[236:239], v[128:131], a[184:187], v[236:239]
  s_waitcnt lgkmcnt(8)
  ds_read_b64_tr_b16 v[152:153], v162 offset:8448
  s_mov_b32 s43, 33152
  v_mfma_f32_16x16x32_bf16 v[240:243], v[132:135], a[184:187], v[240:243]
  s_waitcnt lgkmcnt(7)
  ds_read_b64_tr_b16 v[154:155], v162 offset:10496
  s_add_u32 m0, s29, 153344
  v_mfma_f32_16x16x32_bf16 v[244:247], v[136:139], a[184:187], v[244:247]
  s_waitcnt lgkmcnt(6)
  ds_read_b64_tr_b16 v[156:157], v163 offset:8448
  v_mfma_f32_16x16x32_bf16 v[248:251], v[140:143], a[184:187], v[248:251]
  buffer_load_dwordx4 v119, s[16:19], s43 offen nt lds
  v_mfma_f32_16x16x32_bf16 v[252:255], v[172:175], a[184:187], v[252:255]
  ds_read_b64_tr_b16 v[158:159], v163 offset:10496
  v_mfma_f32_16x16x32_bf16 v[164:167], v[128:131], a[232:235], v[164:167]
  v_mfma_f32_16x16x32_bf16 v[32:35], v[132:135], a[232:235], v[32:35]
  v_mfma_f32_16x16x32_bf16 v[36:39], v[136:139], a[232:235], v[36:39]
  v_mfma_f32_16x16x32_bf16 v[40:43], v[140:143], a[232:235], v[40:43]
  v_mfma_f32_16x16x32_bf16 v[44:47], v[172:175], a[232:235], v[44:47]
  v_mfma_f32_16x16x32_bf16 v[48:51], v[128:131], v[24:27], v[48:51]
  ds_read_b64_tr_b16 v[128:129], v160 offset:12544
  ds_read_b64_tr_b16 v[130:131], v160 offset:14592
  v_mfma_f32_16x16x32_bf16 v[52:55], v[132:135], v[24:27], v[52:55]
  ds_read_b64_tr_b16 v[132:133], v161 offset:12544
  v_mfma_f32_16x16x32_bf16 v[56:59], v[136:139], v[24:27], v[56:59]
  ds_read_b64_tr_b16 v[134:135], v161 offset:14592
  v_mfma_f32_16x16x32_bf16 v[60:63], v[140:143], v[24:27], v[60:63]
  ds_read_b64_tr_b16 v[136:137], v162 offset:12544
  v_mfma_f32_16x16x32_bf16 v[64:67], v[172:175], v[24:27], v[64:67]
  s_waitcnt lgkmcnt(11)
  ds_read_b64_tr_b16 v[138:139], v162 offset:14592
  v_mfma_f32_16x16x32_bf16 v[236:239], v[144:147], a[188:191], v[236:239]
  s_waitcnt lgkmcnt(10)
  ds_read_b64_tr_b16 v[140:141], v163 offset:12544
  v_mfma_f32_16x16x32_bf16 v[240:243], v[148:151], a[188:191], v[240:243]
  s_waitcnt lgkmcnt(9)
  ds_read_b64_tr_b16 v[142:143], v163 offset:14592
  v_mfma_f32_16x16x32_bf16 v[244:247], v[152:155], a[188:191], v[244:247]
  s_waitcnt lgkmcnt(8)
  v_mfma_f32_16x16x32_bf16 v[248:251], v[156:159], a[188:191], v[248:251]
  v_mfma_f32_16x16x32_bf16 v[252:255], v[172:175], a[188:191], v[252:255]
  v_mfma_f32_16x16x32_bf16 v[164:167], v[144:147], a[236:239], v[164:167]
  v_mfma_f32_16x16x32_bf16 v[32:35], v[148:151], a[236:239], v[32:35]
  v_mfma_f32_16x16x32_bf16 v[36:39], v[152:155], a[236:239], v[36:39]
  v_mfma_f32_16x16x32_bf16 v[40:43], v[156:159], a[236:239], v[40:43]
  v_mfma_f32_16x16x32_bf16 v[44:47], v[172:175], a[236:239], v[44:47]
  v_mfma_f32_16x16x32_bf16 v[48:51], v[144:147], v[28:31], v[48:51]
  ds_read_b64_tr_b16 v[144:145], v160 offset:16896
  v_mfma_f32_16x16x32_bf16 v[52:55], v[148:151], v[28:31], v[52:55]
  ds_read_b64_tr_b16 v[146:147], v160 offset:18944
  v_mfma_f32_16x16x32_bf16 v[56:59], v[152:155], v[28:31], v[56:59]
  ds_read_b64_tr_b16 v[148:149], v161 offset:16896
  v_mfma_f32_16x16x32_bf16 v[60:63], v[156:159], v[28:31], v[60:63]
  ds_read_b64_tr_b16 v[150:151], v161 offset:18944
  v_mfma_f32_16x16x32_bf16 v[64:67], v[172:175], v[28:31], v[64:67]
  s_waitcnt lgkmcnt(10)
  ds_read_b64_tr_b16 v[152:153], v162 offset:16896
  v_mfma_f32_16x16x32_bf16 v[68:71], v[128:131], a[0:3], 0
  s_waitcnt lgkmcnt(9)
  ds_read_b64_tr_b16 v[154:155], v162 offset:18944
  s_mov_b32 s34, 98304
  v_mfma_f32_16x16x32_bf16 v[72:75], v[132:135], a[0:3], 0
  s_waitcnt lgkmcnt(8)
  ds_read_b64_tr_b16 v[156:157], v163 offset:16896
  v_mfma_f32_16x16x32_bf16 v[76:79], v[136:139], a[0:3], 0
  s_waitcnt lgkmcnt(7)
  ds_read_b64_tr_b16 v[158:159], v163 offset:18944
  v_mfma_f32_16x16x32_bf16 v[80:83], v[140:143], a[0:3], 0
  v_rcp_f32 v99, v252
  v_mfma_f32_16x16x32_bf16 v[84:87], v[128:131], a[48:51], 0
  v_mul_f32 v236, v236, v99
  v_mul_f32 v237, v237, v99
  v_mfma_f32_16x16x32_bf16 v[88:91], v[132:135], a[48:51], 0
  v_mul_f32 v238, v238, v99
  v_mul_f32 v239, v239, v99
  v_mfma_f32_16x16x32_bf16 v[92:95], v[136:139], a[48:51], 0
  v_cvt_pk_bf16_f32 v236, v236, v237
  v_cvt_pk_bf16_f32 v237, v238, v239
  v_mfma_f32_16x16x32_bf16 v[104:107], v[140:143], a[48:51], 0
  v_mul_f32 v240, v240, v99
  v_mul_f32 v241, v241, v99
  v_mfma_f32_16x16x32_bf16 v[108:111], v[128:131], a[96:99], 0
  v_mul_f32 v242, v242, v99
  v_mul_f32 v243, v243, v99
  v_mfma_f32_16x16x32_bf16 v[120:123], v[132:135], a[96:99], 0
  v_cvt_pk_bf16_f32 v238, v240, v241
  v_cvt_pk_bf16_f32 v239, v242, v243
  v_mfma_f32_16x16x32_bf16 v[124:127], v[136:139], a[96:99], 0
  v_mul_f32 v244, v244, v99
  v_mul_f32 v245, v245, v99
  v_mfma_f32_16x16x32_bf16 v[112:115], v[140:143], a[96:99], 0
  v_mul_f32 v246, v246, v99
  v_mul_f32 v247, v247, v99
  v_mfma_f32_16x16x32_bf16 v[192:195], v[128:131], a[144:147], 0
  v_permlane16_swap_b32 v236, v238
  v_mfma_f32_16x16x32_bf16 v[188:191], v[132:135], a[144:147], 0
  v_cvt_pk_bf16_f32 v244, v244, v245
  v_cvt_pk_bf16_f32 v245, v246, v247
  v_mfma_f32_16x16x32_bf16 v[180:183], v[136:139], a[144:147], 0
  v_permlane16_swap_b32 v237, v239
  v_mfma_f32_16x16x32_bf16 v[212:215], v[140:143], a[144:147], 0
  v_mul_f32 v248, v248, v99
  v_mul_f32 v249, v249, v99
  v_mfma_f32_16x16x32_bf16 v[208:211], v[128:131], a[192:195], 0
  v_mul_f32 v250, v250, v99
  v_mul_f32 v251, v251, v99
  v_mfma_f32_16x16x32_bf16 v[200:203], v[132:135], a[192:195], 0
  v_cvt_pk_bf16_f32 v246, v248, v249
  v_cvt_pk_bf16_f32 v247, v250, v251
  v_mfma_f32_16x16x32_bf16 v[232:235], v[136:139], a[192:195], 0
  v_permlane16_swap_b32 v244, v246
  v_mfma_f32_16x16x32_bf16 v[228:231], v[140:143], a[192:195], 0
  v_permlane16_swap_b32 v245, v247
  v_mfma_f32_16x16x32_bf16 v[220:223], v[128:131], a[240:243], 0
  ds_read_b64_tr_b16 v[128:129], v160 offset:20992
  v_mov_b32 v240, v244
  v_mfma_f32_16x16x32_bf16 v[176:179], v[132:135], a[240:243], 0
  ds_read_b64_tr_b16 v[130:131], v160 offset:23040
  v_mov_b32_dpp v244, v236 row_ror:8 row_mask:0xf bank_mask:0x3
  v_mfma_f32_16x16x32_bf16 v[184:187], v[136:139], a[240:243], 0
  ds_read_b64_tr_b16 v[132:133], v161 offset:20992
  v_mov_b32_dpp v236, v240 row_ror:8 row_mask:0xf bank_mask:0xc
  v_mfma_f32_16x16x32_bf16 v[196:199], v[140:143], a[240:243], 0
  s_waitcnt lgkmcnt(9)
  ds_read_b64_tr_b16 v[134:135], v161 offset:23040
  v_mov_b32 v241, v245
  v_mfma_f32_16x16x32_bf16 v[68:71], v[144:147], a[4:7], v[68:71]
  s_waitcnt lgkmcnt(8)
  ds_read_b64_tr_b16 v[136:137], v162 offset:20992
  v_mov_b32_dpp v245, v237 row_ror:8 row_mask:0xf bank_mask:0x3
  v_mfma_f32_16x16x32_bf16 v[72:75], v[148:151], a[4:7], v[72:75]
  s_waitcnt lgkmcnt(7)
  ds_read_b64_tr_b16 v[138:139], v162 offset:23040
  v_mov_b32_dpp v237, v241 row_ror:8 row_mask:0xf bank_mask:0xc
  v_mfma_f32_16x16x32_bf16 v[76:79], v[152:155], a[4:7], v[76:79]
  s_waitcnt lgkmcnt(6)
  ds_read_b64_tr_b16 v[140:141], v163 offset:20992
  v_mov_b32 v242, v246
  v_mfma_f32_16x16x32_bf16 v[80:83], v[156:159], a[4:7], v[80:83]
  ds_read_b64_tr_b16 v[142:143], v163 offset:23040
  v_mov_b32_dpp v246, v238 row_ror:8 row_mask:0xf bank_mask:0x3
  v_mfma_f32_16x16x32_bf16 v[84:87], v[144:147], a[52:55], v[84:87]
  v_mov_b32_dpp v238, v242 row_ror:8 row_mask:0xf bank_mask:0xc
  v_mov_b32 v243, v247
  v_mfma_f32_16x16x32_bf16 v[88:91], v[148:151], a[52:55], v[88:91]
  v_mov_b32_dpp v247, v239 row_ror:8 row_mask:0xf bank_mask:0x3
  v_mov_b32_dpp v239, v243 row_ror:8 row_mask:0xf bank_mask:0xc
  v_mfma_f32_16x16x32_bf16 v[92:95], v[152:155], a[52:55], v[92:95]
  buffer_store_dwordx4 v[236:239], v169, s[20:23], s34 offen nt
  v_rcp_f32 v100, v44
  v_mfma_f32_16x16x32_bf16 v[104:107], v[156:159], a[52:55], v[104:107]
  v_min3_f32 v102, v99, v100, v102
  v_max3_f32 v103, v99, v100, v103
  v_mfma_f32_16x16x32_bf16 v[108:111], v[144:147], a[100:103], v[108:111]
  v_mul_f32 v164, v164, v100
  v_mul_f32 v165, v165, v100
  v_mfma_f32_16x16x32_bf16 v[120:123], v[148:151], a[100:103], v[120:123]
  v_mul_f32 v166, v166, v100
  v_mul_f32 v167, v167, v100
  v_mfma_f32_16x16x32_bf16 v[124:127], v[152:155], a[100:103], v[124:127]
  v_cvt_pk_bf16_f32 v164, v164, v165
  v_cvt_pk_bf16_f32 v165, v166, v167
  v_mfma_f32_16x16x32_bf16 v[112:115], v[156:159], a[100:103], v[112:115]
  v_mul_f32 v32, v32, v100
  v_mul_f32 v33, v33, v100
  v_mfma_f32_16x16x32_bf16 v[192:195], v[144:147], a[148:151], v[192:195]
  v_mul_f32 v34, v34, v100
  v_mul_f32 v35, v35, v100
  v_mfma_f32_16x16x32_bf16 v[188:191], v[148:151], a[148:151], v[188:191]
  v_cvt_pk_bf16_f32 v166, v32, v33
  v_cvt_pk_bf16_f32 v167, v34, v35
  v_mfma_f32_16x16x32_bf16 v[180:183], v[152:155], a[148:151], v[180:183]
  v_mul_f32 v36, v36, v100
  v_mul_f32 v37, v37, v100
  v_mfma_f32_16x16x32_bf16 v[212:215], v[156:159], a[148:151], v[212:215]
  v_mul_f32 v38, v38, v100
  v_mul_f32 v39, v39, v100
  v_mfma_f32_16x16x32_bf16 v[208:211], v[144:147], a[196:199], v[208:211]
  v_permlane16_swap_b32 v164, v166
  v_mfma_f32_16x16x32_bf16 v[200:203], v[148:151], a[196:199], v[200:203]
  v_cvt_pk_bf16_f32 v36, v36, v37
  v_cvt_pk_bf16_f32 v37, v38, v39
  v_mfma_f32_16x16x32_bf16 v[232:235], v[152:155], a[196:199], v[232:235]
  v_permlane16_swap_b32 v165, v167
  v_mfma_f32_16x16x32_bf16 v[228:231], v[156:159], a[196:199], v[228:231]
  v_mul_f32 v40, v40, v100
  v_mul_f32 v41, v41, v100
  v_mfma_f32_16x16x32_bf16 v[220:223], v[144:147], a[244:247], v[220:223]
  v_mul_f32 v42, v42, v100
  v_mul_f32 v43, v43, v100
  v_mfma_f32_16x16x32_bf16 v[176:179], v[148:151], a[244:247], v[176:179]
  s_mov_b32 s35, 102400
  v_cvt_pk_bf16_f32 v38, v40, v41
  v_cvt_pk_bf16_f32 v39, v42, v43
  v_mfma_f32_16x16x32_bf16 v[184:187], v[152:155], a[244:247], v[184:187]
  v_permlane16_swap_b32 v36, v38
  v_mfma_f32_16x16x32_bf16 v[196:199], v[156:159], a[244:247], v[196:199]
  s_waitcnt lgkmcnt(6)
  v_permlane16_swap_b32 v37, v39
  v_mfma_f32_16x16x32_bf16 v[68:71], v[128:131], a[8:11], v[68:71]
  s_waitcnt lgkmcnt(4)
  v_mov_b32 v32, v36
  v_mov_b32_dpp v36, v164 row_ror:8 row_mask:0xf bank_mask:0x3
  v_mfma_f32_16x16x32_bf16 v[72:75], v[132:135], a[8:11], v[72:75]
  s_waitcnt lgkmcnt(2)
  buffer_store_dwordx4 v[244:247], v169, s[20:23], s35 offen nt
  v_mov_b32_dpp v164, v32 row_ror:8 row_mask:0xf bank_mask:0xc
  v_mov_b32 v33, v37
  v_mfma_f32_16x16x32_bf16 v[76:79], v[136:139], a[8:11], v[76:79]
  s_waitcnt lgkmcnt(0)
  v_mov_b32_dpp v37, v165 row_ror:8 row_mask:0xf bank_mask:0x3
  v_mov_b32_dpp v165, v33 row_ror:8 row_mask:0xf bank_mask:0xc
  v_mfma_f32_16x16x32_bf16 v[80:83], v[140:143], a[8:11], v[80:83]
  v_mov_b32 v34, v38
  v_mov_b32_dpp v38, v166 row_ror:8 row_mask:0xf bank_mask:0x3
  v_mfma_f32_16x16x32_bf16 v[84:87], v[128:131], a[56:59], v[84:87]
  v_mov_b32_dpp v166, v34 row_ror:8 row_mask:0xf bank_mask:0xc
  v_mov_b32 v35, v39
  v_mfma_f32_16x16x32_bf16 v[88:91], v[132:135], a[56:59], v[88:91]
  v_mov_b32_dpp v39, v167 row_ror:8 row_mask:0xf bank_mask:0x3
  v_mov_b32_dpp v167, v35 row_ror:8 row_mask:0xf bank_mask:0xc
  v_mfma_f32_16x16x32_bf16 v[92:95], v[136:139], a[56:59], v[92:95]
  v_rcp_f32 v101, v64
  v_mfma_f32_16x16x32_bf16 v[104:107], v[140:143], a[56:59], v[104:107]
  v_min_f32 v102, v101, v102
  v_max_f32 v103, v101, v103
  v_mfma_f32_16x16x32_bf16 v[108:111], v[128:131], a[104:107], v[108:111]
  v_cmp_nle_f32 vcc, 0x30800000, v102
  v_mul_f32 v48, v48, v101
  v_mfma_f32_16x16x32_bf16 v[120:123], v[132:135], a[104:107], v[120:123]
  v_mul_f32 v49, v49, v101
  v_mul_f32 v50, v50, v101
  v_mfma_f32_16x16x32_bf16 v[124:127], v[136:139], a[104:107], v[124:127]
  s_mov_b64 s[60:61], vcc
  v_cmp_nge_f32 vcc, 0x4e800000, v103
  v_mul_f32 v51, v51, v101
  v_mfma_f32_16x16x32_bf16 v[112:115], v[140:143], a[104:107], v[112:115]
  v_cvt_pk_bf16_f32 v48, v48, v49
  v_cvt_pk_bf16_f32 v49, v50, v51
  v_mfma_f32_16x16x32_bf16 v[192:195], v[128:131], a[152:155], v[192:195]
  s_or_b64 s[60:61], s[60:61], vcc
  s_cselect_b32 s59, 1, 0
  v_mov_b32 v102, s59
  v_mul_f32 v52, v52, v101
  v_mfma_f32_16x16x32_bf16 v[188:191], v[132:135], a[152:155], v[188:191]
  ds_write_b32 v116, v102
  v_mul_f32 v53, v53, v101
  v_mul_f32 v54, v54, v101
  v_mfma_f32_16x16x32_bf16 v[180:183], v[136:139], a[152:155], v[180:183]
  v_mul_f32 v55, v55, v101
  v_cvt_pk_bf16_f32 v50, v52, v53
  v_mfma_f32_16x16x32_bf16 v[212:215], v[140:143], a[152:155], v[212:215]
  v_cvt_pk_bf16_f32 v51, v54, v55
  v_mul_f32 v56, v56, v101
  v_mfma_f32_16x16x32_bf16 v[208:211], v[128:131], a[200:203], v[208:211]
  s_waitcnt vmcnt(20) lgkmcnt(0)
  s_barrier
  v_mul_f32 v57, v57, v101
  v_mul_f32 v58, v58, v101
  v_mfma_f32_16x16x32_bf16 v[200:203], v[132:135], a[200:203], v[200:203]
  ds_read_b128 v[204:207], v117
  ds_read_b64_tr_b16 v[144:145], v160 offset:59136
  v_mfma_f32_16x16x32_bf16 v[232:235], v[136:139], a[200:203], v[232:235]
  ds_read_b64_tr_b16 v[146:147], v160 offset:61184
  ds_read_b64_tr_b16 v[148:149], v161 offset:59136
  v_mfma_f32_16x16x32_bf16 v[228:231], v[140:143], a[200:203], v[228:231]
  ds_read_b64_tr_b16 v[150:151], v161 offset:61184
  ds_read_b64_tr_b16 v[152:153], v162 offset:59136
  v_mfma_f32_16x16x32_bf16 v[220:223], v[128:131], a[248:251], v[220:223]
  ds_read_b64_tr_b16 v[154:155], v162 offset:61184
  ds_read_b64_tr_b16 v[156:157], v163 offset:59136
  v_mfma_f32_16x16x32_bf16 v[176:179], v[132:135], a[248:251], v[176:179]
  ds_read_b64_tr_b16 v[158:159], v163 offset:61184
  v_mul_f32 v59, v59, v101
  v_mfma_f32_16x16x32_bf16 v[184:187], v[136:139], a[248:251], v[184:187]
  ds_read_b64_tr_b16 v[128:129], v160 offset:63232
  v_cvt_pk_bf16_f32 v56, v56, v57
  v_mfma_f32_16x16x32_bf16 v[196:199], v[140:143], a[248:251], v[196:199]
  s_waitcnt lgkmcnt(7)
  ds_read_b64_tr_b16 v[130:131], v160 offset:65280
  v_cvt_pk_bf16_f32 v57, v58, v59
  v_mfma_f32_16x16x32_bf16 v[68:71], v[144:147], a[12:15], v[68:71]
  s_waitcnt lgkmcnt(6)
  ds_read_b64_tr_b16 v[132:133], v161 offset:63232
  v_or3_b32 v204, v204, v205, v206
  v_mfma_f32_16x16x32_bf16 v[72:75], v[148:151], a[12:15], v[72:75]
  s_waitcnt lgkmcnt(5)
  ds_read_b64_tr_b16 v[134:135], v161 offset:65280
  v_or_b32 v204, v204, v207
  v_mfma_f32_16x16x32_bf16 v[76:79], v[152:155], a[12:15], v[76:79]
  s_waitcnt lgkmcnt(4)
  ds_read_b64_tr_b16 v[136:137], v162 offset:63232
  v_readfirstlane_b32 s59, v204
  v_mfma_f32_16x16x32_bf16 v[80:83], v[156:159], a[12:15], v[80:83]
  ds_read_b64_tr_b16 v[138:139], v162 offset:65280
  v_mul_f32 v60, v60, v101
  v_mfma_f32_16x16x32_bf16 v[84:87], v[144:147], a[60:63], v[84:87]
  ds_read_b64_tr_b16 v[140:141], v163 offset:63232
  s_cmp_lg_u32 s59, 0
  s_cbranch_scc1 L_slow
  v_mul_f32 v61, v61, v101
  v_mfma_f32_16x16x32_bf16 v[88:91], v[148:151], a[60:63], v[88:91]
  ds_read_b64_tr_b16 v[142:143], v163 offset:65280
  v_mul_f32 v62, v62, v101
  v_mfma_f32_16x16x32_bf16 v[92:95], v[152:155], a[60:63], v[92:95]
  v_permlane16_swap_b32 v48, v50
  v_mfma_f32_16x16x32_bf16 v[104:107], v[156:159], a[60:63], v[104:107]
  v_permlane16_swap_b32 v49, v51
  v_mfma_f32_16x16x32_bf16 v[108:111], v[144:147], a[108:111], v[108:111]
  v_mul_f32 v63, v63, v101
  v_cvt_pk_bf16_f32 v58, v60, v61
  v_mfma_f32_16x16x32_bf16 v[120:123], v[148:151], a[108:111], v[120:123]
  v_cvt_pk_bf16_f32 v59, v62, v63
  v_add_u32 v160, 67328, v160
  v_mfma_f32_16x16x32_bf16 v[124:127], v[152:155], a[108:111], v[124:127]
  v_permlane16_swap_b32 v56, v58
  v_mfma_f32_16x16x32_bf16 v[112:115], v[156:159], a[108:111], v[112:115]
  v_permlane16_swap_b32 v57, v59
  v_mfma_f32_16x16x32_bf16 v[192:195], v[144:147], a[156:159], v[192:195]
  v_mov_b32 v52, v56
  v_mov_b32_dpp v56, v48 row_ror:8 row_mask:0xf bank_mask:0x3
  v_mfma_f32_16x16x32_bf16 v[188:191], v[148:151], a[156:159], v[188:191]
  v_mov_b32_dpp v48, v52 row_ror:8 row_mask:0xf bank_mask:0xc
  v_mov_b32 v53, v57
  v_mfma_f32_16x16x32_bf16 v[180:183], v[152:155], a[156:159], v[180:183]
  v_mov_b32_dpp v57, v49 row_ror:8 row_mask:0xf bank_mask:0x3
  v_mov_b32_dpp v49, v53 row_ror:8 row_mask:0xf bank_mask:0xc
  v_mfma_f32_16x16x32_bf16 v[212:215], v[156:159], a[156:159], v[212:215]
  v_mov_b32 v54, v58
  v_mov_b32_dpp v58, v50 row_ror:8 row_mask:0xf bank_mask:0x3
  v_mfma_f32_16x16x32_bf16 v[208:211], v[144:147], a[204:207], v[208:211]
  v_mov_b32_dpp v50, v54 row_ror:8 row_mask:0xf bank_mask:0xc
  v_mov_b32 v55, v59
  v_mfma_f32_16x16x32_bf16 v[200:203], v[148:151], a[204:207], v[200:203]
  v_mov_b32_dpp v59, v51 row_ror:8 row_mask:0xf bank_mask:0x3
  v_mov_b32_dpp v51, v55 row_ror:8 row_mask:0xf bank_mask:0xc
  v_mfma_f32_16x16x32_bf16 v[232:235], v[152:155], a[204:207], v[232:235]
  v_add_u32 v161, 67328, v161
  v_add_u32 v162, 67328, v162
  v_mfma_f32_16x16x32_bf16 v[228:231], v[156:159], a[204:207], v[228:231]
  s_mov_b32 s36, 131072
  v_add_u32 v163, 67328, v163
  v_mfma_f32_16x16x32_bf16 v[220:223], v[144:147], a[252:255], v[220:223]
  ds_read_b64_tr_b16 v[144:145], v160 offset:0
  v_mfma_f32_16x16x32_bf16 v[176:179], v[148:151], a[252:255], v[176:179]
  ds_read_b64_tr_b16 v[146:147], v160 offset:2048
  v_mfma_f32_16x16x32_bf16 v[184:187], v[152:155], a[252:255], v[184:187]
  ds_read_b64_tr_b16 v[148:149], v161 offset:0
  v_mfma_f32_16x16x32_bf16 v[196:199], v[156:159], a[252:255], v[196:199]
  s_waitcnt lgkmcnt(9)
  buffer_store_dwordx4 v[164:167], v169, s[20:23], s36 offen nt
  v_mfma_f32_16x16x32_bf16 v[68:71], v[128:131], a[16:19], v[68:71]
  s_waitcnt lgkmcnt(7)
  ds_read_b64_tr_b16 v[150:151], v161 offset:2048
  v_mfma_f32_16x16x32_bf16 v[72:75], v[132:135], a[16:19], v[72:75]
  s_waitcnt lgkmcnt(6)
  ds_read_b64_tr_b16 v[152:153], v162 offset:0
  v_mfma_f32_16x16x32_bf16 v[76:79], v[136:139], a[16:19], v[76:79]
  s_waitcnt lgkmcnt(5)
  ds_read_b64_tr_b16 v[154:155], v162 offset:2048
  v_mfma_f32_16x16x32_bf16 v[80:83], v[140:143], a[16:19], v[80:83]
  ds_read_b64_tr_b16 v[156:157], v163 offset:0
  v_mfma_f32_16x16x32_bf16 v[84:87], v[128:131], a[64:67], v[84:87]
  ds_read_b64_tr_b16 v[158:159], v163 offset:2048
  v_mfma_f32_16x16x32_bf16 v[88:91], v[132:135], a[64:67], v[88:91]
  v_mfma_f32_16x16x32_bf16 v[92:95], v[136:139], a[64:67], v[92:95]
  v_mfma_f32_16x16x32_bf16 v[104:107], v[140:143], a[64:67], v[104:107]
  v_mfma_f32_16x16x32_bf16 v[108:111], v[128:131], a[112:115], v[108:111]
  v_mfma_f32_16x16x32_bf16 v[120:123], v[132:135], a[112:115], v[120:123]
  s_mov_b32 s40, 49536
  v_mfma_f32_16x16x32_bf16 v[124:127], v[136:139], a[112:115], v[124:127]
  s_add_u32 m0, s29, 158464
  v_mfma_f32_16x16x32_bf16 v[112:115], v[140:143], a[112:115], v[112:115]
  v_mfma_f32_16x16x32_bf16 v[192:195], v[128:131], a[160:163], v[192:195]
  buffer_load_dwordx4 v119, s[16:19], s40 offen nt lds
  v_mfma_f32_16x16x32_bf16 v[188:191], v[132:135], a[160:163], v[188:191]
  v_mfma_f32_16x16x32_bf16 v[180:183], v[136:139], a[160:163], v[180:183]
  v_mfma_f32_16x16x32_bf16 v[212:215], v[140:143], a[160:163], v[212:215]
  v_mfma_f32_16x16x32_bf16 v[208:211], v[128:131], a[208:211], v[208:211]
  v_mfma_f32_16x16x32_bf16 v[200:203], v[132:135], a[208:211], v[200:203]
  v_mfma_f32_16x16x32_bf16 v[232:235], v[136:139], a[208:211], v[232:235]
  v_mfma_f32_16x16x32_bf16 v[228:231], v[140:143], a[208:211], v[228:231]
  v_mfma_f32_16x16x32_bf16 v[220:223], v[128:131], v[0:3], v[220:223]
  ds_read_b64_tr_b16 v[128:129], v160 offset:4096
  v_mfma_f32_16x16x32_bf16 v[176:179], v[132:135], v[0:3], v[176:179]
  ds_read_b64_tr_b16 v[130:131], v160 offset:6144
  v_mfma_f32_16x16x32_bf16 v[184:187], v[136:139], v[0:3], v[184:187]
  ds_read_b64_tr_b16 v[132:133], v161 offset:4096
  s_mov_b32 s41, 65920
  v_mfma_f32_16x16x32_bf16 v[196:199], v[140:143], v[0:3], v[196:199]
  s_waitcnt lgkmcnt(9)
  ds_read_b64_tr_b16 v[134:135], v161 offset:6144
  s_add_u32 m0, s29, 25344
  v_mfma_f32_16x16x32_bf16 v[68:71], v[144:147], a[20:23], v[68:71]
  s_waitcnt lgkmcnt(8)
  ds_read_b64_tr_b16 v[136:137], v162 offset:4096
  v_mfma_f32_16x16x32_bf16 v[72:75], v[148:151], a[20:23], v[72:75]
  s_waitcnt lgkmcnt(7)
  buffer_load_dwordx4 v119, s[16:19], s41 offen nt lds
  v_mfma_f32_16x16x32_bf16 v[76:79], v[152:155], a[20:23], v[76:79]
  s_waitcnt lgkmcnt(5)
  ds_read_b64_tr_b16 v[138:139], v162 offset:6144
  v_mfma_f32_16x16x32_bf16 v[80:83], v[156:159], a[20:23], v[80:83]
  ds_read_b64_tr_b16 v[140:141], v163 offset:4096
  v_mfma_f32_16x16x32_bf16 v[84:87], v[144:147], a[68:71], v[84:87]
  ds_read_b64_tr_b16 v[142:143], v163 offset:6144
  v_mfma_f32_16x16x32_bf16 v[88:91], v[148:151], a[68:71], v[88:91]
  v_mfma_f32_16x16x32_bf16 v[92:95], v[152:155], a[68:71], v[92:95]
  v_mfma_f32_16x16x32_bf16 v[104:107], v[156:159], a[68:71], v[104:107]
  v_mfma_f32_16x16x32_bf16 v[108:111], v[144:147], a[116:119], v[108:111]
  v_mfma_f32_16x16x32_bf16 v[120:123], v[148:151], a[116:119], v[120:123]
  v_mfma_f32_16x16x32_bf16 v[124:127], v[152:155], a[116:119], v[124:127]
  v_mfma_f32_16x16x32_bf16 v[112:115], v[156:159], a[116:119], v[112:115]
  v_mfma_f32_16x16x32_bf16 v[192:195], v[144:147], a[164:167], v[192:195]
  s_mov_b32 s42, 82304
  v_mfma_f32_16x16x32_bf16 v[188:191], v[148:151], a[164:167], v[188:191]
  s_add_u32 m0, s29, 29440
  v_mfma_f32_16x16x32_bf16 v[180:183], v[152:155], a[164:167], v[180:183]
  v_mfma_f32_16x16x32_bf16 v[212:215], v[156:159], a[164:167], v[212:215]
  buffer_load_dwordx4 v119, s[16:19], s42 offen nt lds
  v_mfma_f32_16x16x32_bf16 v[208:211], v[144:147], a[212:215], v[208:211]
  s_mov_b32 s37, 135168
  v_mfma_f32_16x16x32_bf16 v[200:203], v[148:151], a[212:215], v[200:203]
  v_mfma_f32_16x16x32_bf16 v[232:235], v[152:155], a[212:215], v[232:235]
  v_mfma_f32_16x16x32_bf16 v[228:231], v[156:159], a[212:215], v[228:231]
  v_mfma_f32_16x16x32_bf16 v[220:223], v[144:147], v[4:7], v[220:223]
  buffer_store_dwordx4 v[36:39], v169, s[20:23], s37 offen nt
  v_mfma_f32_16x16x32_bf16 v[176:179], v[148:151], v[4:7], v[176:179]
  ds_read_b64_tr_b16 v[144:145], v160 offset:8192
  v_mfma_f32_16x16x32_bf16 v[184:187], v[152:155], v[4:7], v[184:187]
  ds_read_b64_tr_b16 v[146:147], v160 offset:10240
  v_mfma_f32_16x16x32_bf16 v[196:199], v[156:159], v[4:7], v[196:199]
  s_waitcnt lgkmcnt(8)
  ds_read_b64_tr_b16 v[148:149], v161 offset:8192
  v_mfma_f32_16x16x32_bf16 v[68:71], v[128:131], a[24:27], v[68:71]
  s_waitcnt lgkmcnt(7)
  ds_read_b64_tr_b16 v[150:151], v161 offset:10240
  v_mfma_f32_16x16x32_bf16 v[72:75], v[132:135], a[24:27], v[72:75]
  s_waitcnt lgkmcnt(6)
  ds_read_b64_tr_b16 v[152:153], v162 offset:8192
  s_mov_b32 s43, 98688
  v_mfma_f32_16x16x32_bf16 v[76:79], v[136:139], a[24:27], v[76:79]
  s_waitcnt lgkmcnt(5)
  ds_read_b64_tr_b16 v[154:155], v162 offset:10240
  s_add_u32 m0, s29, 33792
  v_mfma_f32_16x16x32_bf16 v[80:83], v[140:143], a[24:27], v[80:83]
  ds_read_b64_tr_b16 v[156:157], v163 offset:8192
  v_mfma_f32_16x16x32_bf16 v[84:87], v[128:131], a[72:75], v[84:87]
  buffer_load_dwordx4 v119, s[16:19], s43 offen nt lds
  v_mfma_f32_16x16x32_bf16 v[88:91], v[132:135], a[72:75], v[88:91]
  ds_read_b64_tr_b16 v[158:159], v163 offset:10240
  v_mfma_f32_16x16x32_bf16 v[92:95], v[136:139], a[72:75], v[92:95]
  v_mfma_f32_16x16x32_bf16 v[104:107], v[140:143], a[72:75], v[104:107]
  v_mfma_f32_16x16x32_bf16 v[108:111], v[128:131], a[120:123], v[108:111]
  v_mfma_f32_16x16x32_bf16 v[120:123], v[132:135], a[120:123], v[120:123]
  v_mfma_f32_16x16x32_bf16 v[124:127], v[136:139], a[120:123], v[124:127]
  v_mfma_f32_16x16x32_bf16 v[112:115], v[140:143], a[120:123], v[112:115]
  v_mfma_f32_16x16x32_bf16 v[192:195], v[128:131], a[168:171], v[192:195]
  v_mfma_f32_16x16x32_bf16 v[188:191], v[132:135], a[168:171], v[188:191]
  v_mfma_f32_16x16x32_bf16 v[180:183], v[136:139], a[168:171], v[180:183]
  v_mfma_f32_16x16x32_bf16 v[212:215], v[140:143], a[168:171], v[212:215]
  s_mov_b32 s44, 115072
  v_mfma_f32_16x16x32_bf16 v[208:211], v[128:131], a[216:219], v[208:211]
  s_add_u32 m0, s29, 37888
  v_mfma_f32_16x16x32_bf16 v[200:203], v[132:135], a[216:219], v[200:203]
  v_mfma_f32_16x16x32_bf16 v[232:235], v[136:139], a[216:219], v[232:235]
  buffer_load_dwordx4 v119, s[16:19], s44 offen nt lds
  v_mfma_f32_16x16x32_bf16 v[228:231], v[140:143], a[216:219], v[228:231]
  v_mfma_f32_16x16x32_bf16 v[220:223], v[128:131], v[8:11], v[220:223]
  ds_read_b64_tr_b16 v[128:129], v160 offset:12288
  v_mfma_f32_16x16x32_bf16 v[176:179], v[132:135], v[8:11], v[176:179]
  ds_read_b64_tr_b16 v[130:131], v160 offset:14336
  v_mfma_f32_16x16x32_bf16 v[184:187], v[136:139], v[8:11], v[184:187]
  ds_read_b64_tr_b16 v[132:133], v161 offset:12288
  v_mfma_f32_16x16x32_bf16 v[196:199], v[140:143], v[8:11], v[196:199]
  s_waitcnt lgkmcnt(9)
  ds_read_b64_tr_b16 v[134:135], v161 offset:14336
  v_mfma_f32_16x16x32_bf16 v[68:71], v[144:147], a[28:31], v[68:71]
  s_waitcnt lgkmcnt(8)
  ds_read_b64_tr_b16 v[136:137], v162 offset:12288
  v_mfma_f32_16x16x32_bf16 v[72:75], v[148:151], a[28:31], v[72:75]
  s_waitcnt lgkmcnt(7)
  ds_read_b64_tr_b16 v[138:139], v162 offset:14336
  v_mfma_f32_16x16x32_bf16 v[76:79], v[152:155], a[28:31], v[76:79]
  s_waitcnt lgkmcnt(6)
  ds_read_b64_tr_b16 v[140:141], v163 offset:12288
  v_mfma_f32_16x16x32_bf16 v[80:83], v[156:159], a[28:31], v[80:83]
  ds_read_b64_tr_b16 v[142:143], v163 offset:14336
  v_mfma_f32_16x16x32_bf16 v[84:87], v[144:147], a[76:79], v[84:87]
  s_mov_b32 s45, 131456
  v_mfma_f32_16x16x32_bf16 v[88:91], v[148:151], a[76:79], v[88:91]
  s_add_u32 m0, s29, 42240
  v_mfma_f32_16x16x32_bf16 v[92:95], v[152:155], a[76:79], v[92:95]
  v_mfma_f32_16x16x32_bf16 v[104:107], v[156:159], a[76:79], v[104:107]
  buffer_load_dwordx4 v119, s[16:19], s45 offen nt lds
  v_mfma_f32_16x16x32_bf16 v[108:111], v[144:147], a[124:127], v[108:111]
  v_mfma_f32_16x16x32_bf16 v[120:123], v[148:151], a[124:127], v[120:123]
  v_mfma_f32_16x16x32_bf16 v[124:127], v[152:155], a[124:127], v[124:127]
  v_mfma_f32_16x16x32_bf16 v[112:115], v[156:159], a[124:127], v[112:115]
  v_mfma_f32_16x16x32_bf16 v[192:195], v[144:147], a[172:175], v[192:195]
  v_mfma_f32_16x16x32_bf16 v[188:191], v[148:151], a[172:175], v[188:191]
  v_mfma_f32_16x16x32_bf16 v[180:183], v[152:155], a[172:175], v[180:183]
  s_mov_b32 s38, 163840
  v_mfma_f32_16x16x32_bf16 v[212:215], v[156:159], a[172:175], v[212:215]
  v_mfma_f32_16x16x32_bf16 v[208:211], v[144:147], a[220:223], v[208:211]
  v_mfma_f32_16x16x32_bf16 v[200:203], v[148:151], a[220:223], v[200:203]
  v_mfma_f32_16x16x32_bf16 v[232:235], v[152:155], a[220:223], v[232:235]
  buffer_store_dwordx4 v[48:51], v169, s[20:23], s38 offen nt
  s_mov_b32 s46, 147840
  v_mfma_f32_16x16x32_bf16 v[228:231], v[156:159], a[220:223], v[228:231]
  s_add_u32 m0, s29, 46336
  v_mfma_f32_16x16x32_bf16 v[220:223], v[144:147], v[12:15], v[220:223]
  ds_read_b64_tr_b16 v[144:145], v160 offset:16384
  v_mfma_f32_16x16x32_bf16 v[176:179], v[148:151], v[12:15], v[176:179]
  buffer_load_dwordx4 v119, s[16:19], s46 offen nt lds
  v_mfma_f32_16x16x32_bf16 v[184:187], v[152:155], v[12:15], v[184:187]
  ds_read_b64_tr_b16 v[146:147], v160 offset:18432
  v_mfma_f32_16x16x32_bf16 v[196:199], v[156:159], v[12:15], v[196:199]
  s_waitcnt lgkmcnt(8)
  ds_read_b64_tr_b16 v[148:149], v161 offset:16384
  v_mfma_f32_16x16x32_bf16 v[68:71], v[128:131], a[32:35], v[68:71]
  s_waitcnt lgkmcnt(7)
  ds_read_b64_tr_b16 v[150:151], v161 offset:18432
  v_mfma_f32_16x16x32_bf16 v[72:75], v[132:135], a[32:35], v[72:75]
  s_waitcnt lgkmcnt(6)
  ds_read_b64_tr_b16 v[152:153], v162 offset:16384
  v_mfma_f32_16x16x32_bf16 v[76:79], v[136:139], a[32:35], v[76:79]
  s_waitcnt lgkmcnt(5)
  ds_read_b64_tr_b16 v[154:155], v162 offset:18432
  v_mfma_f32_16x16x32_bf16 v[80:83], v[140:143], a[32:35], v[80:83]
  ds_read_b64_tr_b16 v[156:157], v163 offset:16384
  v_mfma_f32_16x16x32_bf16 v[84:87], v[128:131], a[80:83], v[84:87]
  ds_read_b64_tr_b16 v[158:159], v163 offset:18432
  v_mfma_f32_16x16x32_bf16 v[88:91], v[132:135], a[80:83], v[88:91]
  v_mfma_f32_16x16x32_bf16 v[92:95], v[136:139], a[80:83], v[92:95]
  v_mfma_f32_16x16x32_bf16 v[104:107], v[140:143], a[80:83], v[104:107]
  s_mov_b32 s47, 164224
  v_mfma_f32_16x16x32_bf16 v[108:111], v[128:131], a[128:131], v[108:111]
  s_add_u32 m0, s29, 50688
  v_mfma_f32_16x16x32_bf16 v[120:123], v[132:135], a[128:131], v[120:123]
  v_mfma_f32_16x16x32_bf16 v[124:127], v[136:139], a[128:131], v[124:127]
  buffer_load_dwordx4 v119, s[16:19], s47 offen nt lds
  v_mfma_f32_16x16x32_bf16 v[112:115], v[140:143], a[128:131], v[112:115]
  v_mfma_f32_16x16x32_bf16 v[192:195], v[128:131], a[176:179], v[192:195]
  v_mfma_f32_16x16x32_bf16 v[188:191], v[132:135], a[176:179], v[188:191]
  v_mfma_f32_16x16x32_bf16 v[180:183], v[136:139], a[176:179], v[180:183]
  v_mfma_f32_16x16x32_bf16 v[212:215], v[140:143], a[176:179], v[212:215]
  v_mfma_f32_16x16x32_bf16 v[208:211], v[128:131], a[224:227], v[208:211]
  v_mfma_f32_16x16x32_bf16 v[200:203], v[132:135], a[224:227], v[200:203]
  v_mfma_f32_16x16x32_bf16 v[232:235], v[136:139], a[224:227], v[232:235]
  v_mfma_f32_16x16x32_bf16 v[228:231], v[140:143], a[224:227], v[228:231]
  v_mfma_f32_16x16x32_bf16 v[220:223], v[128:131], v[16:19], v[220:223]
  ds_read_b64_tr_b16 v[128:129], v160 offset:20480
  v_mfma_f32_16x16x32_bf16 v[176:179], v[132:135], v[16:19], v[176:179]
  ds_read_b64_tr_b16 v[130:131], v160 offset:22528
  s_mov_b32 s32, 180608
  v_mfma_f32_16x16x32_bf16 v[184:187], v[136:139], v[16:19], v[184:187]
  ds_read_b64_tr_b16 v[132:133], v161 offset:20480
  s_add_u32 m0, s29, 54784
  v_mfma_f32_16x16x32_bf16 v[196:199], v[140:143], v[16:19], v[196:199]
  s_waitcnt lgkmcnt(9)
  ds_read_b64_tr_b16 v[134:135], v161 offset:22528
  v_mfma_f32_16x16x32_bf16 v[68:71], v[144:147], a[36:39], v[68:71]
  s_waitcnt lgkmcnt(8)
  buffer_load_dwordx4 v119, s[16:19], s32 offen nt lds
  v_mfma_f32_16x16x32_bf16 v[72:75], v[148:151], a[36:39], v[72:75]
  s_waitcnt lgkmcnt(6)
  ds_read_b64_tr_b16 v[136:137], v162 offset:20480
  v_mfma_f32_16x16x32_bf16 v[76:79], v[152:155], a[36:39], v[76:79]
  s_waitcnt lgkmcnt(5)
  ds_read_b64_tr_b16 v[138:139], v162 offset:22528
  v_mfma_f32_16x16x32_bf16 v[80:83], v[156:159], a[36:39], v[80:83]
  ds_read_b64_tr_b16 v[140:141], v163 offset:20480
  v_mfma_f32_16x16x32_bf16 v[84:87], v[144:147], a[84:87], v[84:87]
  ds_read_b64_tr_b16 v[142:143], v163 offset:22528
  v_mfma_f32_16x16x32_bf16 v[88:91], v[148:151], a[84:87], v[88:91]
  v_mfma_f32_16x16x32_bf16 v[92:95], v[152:155], a[84:87], v[92:95]
  v_mfma_f32_16x16x32_bf16 v[104:107], v[156:159], a[84:87], v[104:107]
  v_mfma_f32_16x16x32_bf16 v[108:111], v[144:147], a[132:135], v[108:111]
  v_mfma_f32_16x16x32_bf16 v[120:123], v[148:151], a[132:135], v[120:123]
  v_mfma_f32_16x16x32_bf16 v[124:127], v[152:155], a[132:135], v[124:127]
  v_mfma_f32_16x16x32_bf16 v[112:115], v[156:159], a[132:135], v[112:115]
  v_mfma_f32_16x16x32_bf16 v[192:195], v[144:147], a[180:183], v[192:195]
  s_mov_b32 s39, 167936
  v_mfma_f32_16x16x32_bf16 v[188:191], v[148:151], a[180:183], v[188:191]
  v_mfma_f32_16x16x32_bf16 v[180:183], v[152:155], a[180:183], v[180:183]
  v_mfma_f32_16x16x32_bf16 v[212:215], v[156:159], a[180:183], v[212:215]
  v_mfma_f32_16x16x32_bf16 v[208:211], v[144:147], a[228:231], v[208:211]
  buffer_store_dwordx4 v[56:59], v169, s[20:23], s39 offen nt
  v_mfma_f32_16x16x32_bf16 v[200:203], v[148:151], a[228:231], v[200:203]
  v_mfma_f32_16x16x32_bf16 v[232:235], v[152:155], a[228:231], v[232:235]
  v_mfma_f32_16x16x32_bf16 v[228:231], v[156:159], a[228:231], v[228:231]
  v_mfma_f32_16x16x32_bf16 v[220:223], v[144:147], v[20:23], v[220:223]
  ds_read_b64_tr_b16 v[144:145], v160 offset:24576
  v_mfma_f32_16x16x32_bf16 v[176:179], v[148:151], v[20:23], v[176:179]
  ds_read_b64_tr_b16 v[146:147], v160 offset:26624
  v_mfma_f32_16x16x32_bf16 v[184:187], v[152:155], v[20:23], v[184:187]
  ds_read_b64_tr_b16 v[148:149], v161 offset:24576
  v_mfma_f32_16x16x32_bf16 v[196:199], v[156:159], v[20:23], v[196:199]
  s_waitcnt lgkmcnt(9)
  ds_read_b64_tr_b16 v[150:151], v161 offset:26624
  v_mfma_f32_16x16x32_bf16 v[68:71], v[128:131], a[40:43], v[68:71]
  s_waitcnt lgkmcnt(8)
  ds_read_b64_tr_b16 v[152:153], v162 offset:24576
  v_mfma_f32_16x16x32_bf16 v[72:75], v[132:135], a[40:43], v[72:75]
  s_waitcnt lgkmcnt(7)
  ds_read_b64_tr_b16 v[154:155], v162 offset:26624
  v_mfma_f32_16x16x32_bf16 v[76:79], v[136:139], a[40:43], v[76:79]
  s_waitcnt lgkmcnt(6)
  ds_read_b64_tr_b16 v[156:157], v163 offset:24576
  v_mfma_f32_16x16x32_bf16 v[80:83], v[140:143], a[40:43], v[80:83]
  ds_read_b64_tr_b16 v[158:159], v163 offset:26624
  v_mfma_f32_16x16x32_bf16 v[84:87], v[128:131], a[88:91], v[84:87]
  v_mfma_f32_16x16x32_bf16 v[88:91], v[132:135], a[88:91], v[88:91]
  v_mfma_f32_16x16x32_bf16 v[92:95], v[136:139], a[88:91], v[92:95]
  v_mfma_f32_16x16x32_bf16 v[104:107], v[140:143], a[88:91], v[104:107]
  v_mfma_f32_16x16x32_bf16 v[108:111], v[128:131], a[136:139], v[108:111]
  v_mfma_f32_16x16x32_bf16 v[120:123], v[132:135], a[136:139], v[120:123]
  v_mfma_f32_16x16x32_bf16 v[124:127], v[136:139], a[136:139], v[124:127]
  v_mfma_f32_16x16x32_bf16 v[112:115], v[140:143], a[136:139], v[112:115]
  v_mfma_f32_16x16x32_bf16 v[192:195], v[128:131], a[184:187], v[192:195]
  v_mfma_f32_16x16x32_bf16 v[188:191], v[132:135], a[184:187], v[188:191]
  v_mfma_f32_16x16x32_bf16 v[180:183], v[136:139], a[184:187], v[180:183]
  v_mfma_f32_16x16x32_bf16 v[212:215], v[140:143], a[184:187], v[212:215]
  v_mfma_f32_16x16x32_bf16 v[208:211], v[128:131], a[232:235], v[208:211]
  v_mfma_f32_16x16x32_bf16 v[200:203], v[132:135], a[232:235], v[200:203]
  v_mfma_f32_16x16x32_bf16 v[232:235], v[136:139], a[232:235], v[232:235]
  v_mfma_f32_16x16x32_bf16 v[228:231], v[140:143], a[232:235], v[228:231]
  v_mfma_f32_16x16x32_bf16 v[220:223], v[128:131], v[24:27], v[220:223]
  ds_read_b64_tr_b16 v[128:129], v160 offset:28672
  v_mfma_f32_16x16x32_bf16 v[176:179], v[132:135], v[24:27], v[176:179]
  ds_read_b64_tr_b16 v[130:131], v160 offset:30720
  v_mfma_f32_16x16x32_bf16 v[184:187], v[136:139], v[24:27], v[184:187]
  ds_read_b64_tr_b16 v[132:133], v161 offset:28672
  v_mfma_f32_16x16x32_bf16 v[196:199], v[140:143], v[24:27], v[196:199]
  s_waitcnt lgkmcnt(9)
  ds_read_b64_tr_b16 v[134:135], v161 offset:30720
  v_mfma_f32_16x16x32_bf16 v[68:71], v[144:147], a[44:47], v[68:71]
  s_waitcnt lgkmcnt(8)
  ds_read_b64_tr_b16 v[136:137], v162 offset:28672
  v_mfma_f32_16x16x32_bf16 v[72:75], v[148:151], a[44:47], v[72:75]
  s_waitcnt lgkmcnt(7)
  ds_read_b64_tr_b16 v[138:139], v162 offset:30720
  v_mfma_f32_16x16x32_bf16 v[76:79], v[152:155], a[44:47], v[76:79]
  s_waitcnt lgkmcnt(6)
  ds_read_b64_tr_b16 v[140:141], v163 offset:28672
  v_mfma_f32_16x16x32_bf16 v[80:83], v[156:159], a[44:47], v[80:83]
  ds_read_b64_tr_b16 v[142:143], v163 offset:30720
  v_mfma_f32_16x16x32_bf16 v[84:87], v[144:147], a[92:95], v[84:87]
  v_mul_f32 v68, v68, v96
  v_mul_f32 v69, v69, v96
  v_mfma_f32_16x16x32_bf16 v[88:91], v[148:151], a[92:95], v[88:91]
  v_mul_f32 v70, v70, v96
  v_mul_f32 v71, v71, v96
  v_mfma_f32_16x16x32_bf16 v[92:95], v[152:155], a[92:95], v[92:95]
  v_cvt_pk_bf16_f32 v68, v68, v69
  v_cvt_pk_bf16_f32 v69, v70, v71
  v_mfma_f32_16x16x32_bf16 v[104:107], v[156:159], a[92:95], v[104:107]
  v_mul_f32 v72, v72, v96
  v_mul_f32 v73, v73, v96
  v_mfma_f32_16x16x32_bf16 v[108:111], v[144:147], a[140:143], v[108:111]
  v_mul_f32 v74, v74, v96
  v_mul_f32 v75, v75, v96
  v_mfma_f32_16x16x32_bf16 v[120:123], v[148:151], a[140:143], v[120:123]
  v_cvt_pk_bf16_f32 v70, v72, v73
  v_cvt_pk_bf16_f32 v71, v74, v75
  v_mfma_f32_16x16x32_bf16 v[124:127], v[152:155], a[140:143], v[124:127]
  v_mul_f32 v76, v76, v96
  v_mul_f32 v77, v77, v96
  v_mfma_f32_16x16x32_bf16 v[112:115], v[156:159], a[140:143], v[112:115]
  v_mul_f32 v78, v78, v96
  v_mul_f32 v79, v79, v96
  v_mfma_f32_16x16x32_bf16 v[192:195], v[144:147], a[188:191], v[192:195]
  v_permlane16_swap_b32 v68, v70
  v_mfma_f32_16x16x32_bf16 v[188:191], v[148:151], a[188:191], v[188:191]
  v_cvt_pk_bf16_f32 v76, v76, v77
  v_cvt_pk_bf16_f32 v77, v78, v79
  v_mfma_f32_16x16x32_bf16 v[180:183], v[152:155], a[188:191], v[180:183]
  v_permlane16_swap_b32 v69, v71
  v_mfma_f32_16x16x32_bf16 v[212:215], v[156:159], a[188:191], v[212:215]
  v_mul_f32 v80, v80, v96
  v_mul_f32 v81, v81, v96
  v_mfma_f32_16x16x32_bf16 v[208:211], v[144:147], a[236:239], v[208:211]
  v_mul_f32 v82, v82, v96
  v_mul_f32 v83, v83, v96
  v_mfma_f32_16x16x32_bf16 v[200:203], v[148:151], a[236:239], v[200:203]
  v_cvt_pk_bf16_f32 v78, v80, v81
  v_cvt_pk_bf16_f32 v79, v82, v83
  v_mfma_f32_16x16x32_bf16 v[232:235], v[152:155], a[236:239], v[232:235]
  v_permlane16_swap_b32 v76, v78
  v_mfma_f32_16x16x32_bf16 v[228:231], v[156:159], a[236:239], v[228:231]
  v_permlane16_swap_b32 v77, v79
  v_mfma_f32_16x16x32_bf16 v[220:223], v[144:147], v[28:31], v[220:223]
  ds_read_b64_tr_b16 v[144:145], v160 offset:32768
  v_mov_b32 v72, v76
  v_mfma_f32_16x16x32_bf16 v[176:179], v[148:151], v[28:31], v[176:179]
  ds_read_b64_tr_b16 v[146:147], v160 offset:34816
  v_mov_b32_dpp v76, v68 row_ror:8 row_mask:0xf bank_mask:0x3
  v_mfma_f32_16x16x32_bf16 v[184:187], v[152:155], v[28:31], v[184:187]
  ds_read_b64_tr_b16 v[148:149], v161 offset:32768
  v_mov_b32_dpp v68, v72 row_ror:8 row_mask:0xf bank_mask:0xc
  v_mfma_f32_16x16x32_bf16 v[196:199], v[156:159], v[28:31], v[196:199]
  s_waitcnt lgkmcnt(9)
  ds_read_b64_tr_b16 v[150:151], v161 offset:34816
  v_mov_b32 v73, v77
  v_mfma_f32_16x16x32_bf16 v[216:219], v[128:131], a[0:3], 0
  s_waitcnt lgkmcnt(8)
  ds_read_b64_tr_b16 v[152:153], v162 offset:32768
  s_mov_b32 s33, 128
  v_mov_b32_dpp v77, v69 row_ror:8 row_mask:0xf bank_mask:0x3
  v_mfma_f32_16x16x32_bf16 v[224:227], v[132:135], a[0:3], 0
  s_waitcnt lgkmcnt(7)
  ds_read_b64_tr_b16 v[154:155], v162 offset:34816
  v_mov_b32_dpp v69, v73 row_ror:8 row_mask:0xf bank_mask:0xc
  v_mfma_f32_16x16x32_bf16 v[172:175], v[136:139], a[0:3], 0
  s_waitcnt lgkmcnt(6)
  ds_read_b64_tr_b16 v[156:157], v163 offset:32768
  v_mov_b32 v74, v78
  v_mfma_f32_16x16x32_bf16 v[252:255], v[140:143], a[0:3], 0
  ds_read_b64_tr_b16 v[158:159], v163 offset:34816
  v_mov_b32_dpp v78, v70 row_ror:8 row_mask:0xf bank_mask:0x3
  v_mfma_f32_16x16x32_bf16 v[248:251], v[128:131], a[48:51], 0
  v_mov_b32_dpp v70, v74 row_ror:8 row_mask:0xf bank_mask:0xc
  v_mov_b32 v75, v79
  v_mfma_f32_16x16x32_bf16 v[240:243], v[132:135], a[48:51], 0
  v_mov_b32_dpp v79, v71 row_ror:8 row_mask:0xf bank_mask:0x3
  v_mov_b32_dpp v71, v75 row_ror:8 row_mask:0xf bank_mask:0xc
  v_mfma_f32_16x16x32_bf16 v[44:47], v[136:139], a[48:51], 0
  buffer_store_dwordx4 v[68:71], v169, s[20:23], s33 offen nt
  v_mul_f32 v84, v84, v97
  v_mul_f32 v85, v85, v97
  v_mfma_f32_16x16x32_bf16 v[40:43], v[140:143], a[48:51], 0
  v_mul_f32 v86, v86, v97
  v_mul_f32 v87, v87, v97
  v_mfma_f32_16x16x32_bf16 v[32:35], v[128:131], a[96:99], 0
  v_cvt_pk_bf16_f32 v84, v84, v85
  v_cvt_pk_bf16_f32 v85, v86, v87
  v_mfma_f32_16x16x32_bf16 v[64:67], v[132:135], a[96:99], 0
  v_mul_f32 v88, v88, v97
  v_mul_f32 v89, v89, v97
  v_mfma_f32_16x16x32_bf16 v[60:63], v[136:139], a[96:99], 0
  v_mul_f32 v90, v90, v97
  v_mul_f32 v91, v91, v97
  v_mfma_f32_16x16x32_bf16 v[52:55], v[140:143], a[96:99], 0
  v_cvt_pk_bf16_f32 v86, v88, v89
  v_cvt_pk_bf16_f32 v87, v90, v91
  v_mfma_f32_16x16x32_bf16 v[236:239], v[128:131], a[144:147], 0
  v_mul_f32 v92, v92, v97
  v_mul_f32 v93, v93, v97
  v_mfma_f32_16x16x32_bf16 v[244:247], v[132:135], a[144:147], 0
  v_mul_f32 v94, v94, v97
  v_mul_f32 v95, v95, v97
  v_mfma_f32_16x16x32_bf16 v[164:167], v[136:139], a[144:147], 0
  v_permlane16_swap_b32 v84, v86
  v_mfma_f32_16x16x32_bf16 v[36:39], v[140:143], a[144:147], 0
  v_cvt_pk_bf16_f32 v92, v92, v93
  v_cvt_pk_bf16_f32 v93, v94, v95
  v_mfma_f32_16x16x32_bf16 v[48:51], v[128:131], a[192:195], 0
  v_permlane16_swap_b32 v85, v87
  v_mfma_f32_16x16x32_bf16 v[56:59], v[132:135], a[192:195], 0
  v_mul_f32 v104, v104, v97
  v_mul_f32 v105, v105, v97
  v_mfma_f32_16x16x32_bf16 v[204:207], v[136:139], a[192:195], 0
  v_mul_f32 v106, v106, v97
  v_mul_f32 v107, v107, v97
  v_mfma_f32_16x16x32_bf16 v[80:83], v[140:143], a[192:195], 0
  v_cvt_pk_bf16_f32 v94, v104, v105
  v_cvt_pk_bf16_f32 v95, v106, v107
  v_mfma_f32_16x16x32_bf16 v[72:75], v[128:131], a[240:243], 0
  ds_read_b64_tr_b16 v[128:129], v160 offset:36864
  v_mul_f32 v108, v108, v98
  v_mfma_f32_16x16x32_bf16 v[104:107], v[132:135], a[240:243], 0
  ds_read_b64_tr_b16 v[130:131], v160 offset:38912
  v_mul_f32 v109, v109, v98
  v_permlane16_swap_b32 v92, v94
  v_mov_b32 v88, v92
  s_nop 0
  v_mov_b32_dpp v92, v84 row_ror:8 row_mask:0xf bank_mask:0x3
  v_mov_b32_dpp v84, v88 row_ror:8 row_mask:0xf bank_mask:0xc
  v_permlane16_swap_b32 v93, v95
  v_mov_b32 v89, v93
  s_nop 0
  v_mov_b32_dpp v93, v85 row_ror:8 row_mask:0xf bank_mask:0x3
  v_mov_b32_dpp v85, v89 row_ror:8 row_mask:0xf bank_mask:0xc
  v_mov_b32 v90, v94
  v_mov_b32_dpp v94, v86 row_ror:8 row_mask:0xf bank_mask:0x3
  s_nop 0
  v_mov_b32_dpp v86, v90 row_ror:8 row_mask:0xf bank_mask:0xc
  v_mov_b32 v91, v95
  v_mov_b32_dpp v95, v87 row_ror:8 row_mask:0xf bank_mask:0x3
  s_nop 0
  v_mov_b32_dpp v87, v91 row_ror:8 row_mask:0xf bank_mask:0xc
  v_mfma_f32_16x16x32_bf16 v[88:91], v[136:139], a[240:243], 0
  ds_read_b64_tr_b16 v[132:133], v161 offset:36864
  s_mov_b32 s34, 4224
  v_mul_f32 v110, v110, v98
  v_mul_f32 v112, v112, v98
  v_mul_f32 v113, v113, v98
  v_mul_f32 v114, v114, v98
  v_mul_f32 v115, v115, v98
  v_mul_f32 v126, v126, v98
  v_mul_f32 v125, v125, v98
  v_mul_f32 v127, v127, v98
  v_mul_f32 v124, v124, v98
  v_cvt_pk_bf16_f32 v124, v124, v125
  v_cvt_pk_bf16_f32 v125, v126, v127
  v_cvt_pk_bf16_f32 v126, v112, v113
  v_cvt_pk_bf16_f32 v127, v114, v115
  v_mfma_f32_16x16x32_bf16 v[112:115], v[140:143], a[240:243], 0
  s_waitcnt lgkmcnt(9)
  ds_read_b64_tr_b16 v[134:135], v161 offset:38912
  v_mul_f32 v111, v111, v98
  v_mfma_f32_16x16x32_bf16 v[216:219], v[144:147], a[4:7], v[216:219]
  s_waitcnt lgkmcnt(8)
  ds_read_b64_tr_b16 v[136:137], v162 offset:36864
  s_waitcnt vmcnt(16)
  s_barrier
  v_cvt_pk_bf16_f32 v108, v108, v109
  v_mfma_f32_16x16x32_bf16 v[224:227], v[148:151], a[4:7], v[224:227]
  s_waitcnt lgkmcnt(7)
  ds_read_b64_tr_b16 v[138:139], v162 offset:38912
  v_cvt_pk_bf16_f32 v109, v110, v111
  v_mfma_f32_16x16x32_bf16 v[172:175], v[152:155], a[4:7], v[172:175]
  s_waitcnt lgkmcnt(6)
  buffer_store_dwordx4 v[76:79], v169, s[20:23], s34 offen nt
  v_mul_f32 v120, v120, v98
  v_mul_f32 v121, v121, v98
  v_mfma_f32_16x16x32_bf16 v[252:255], v[156:159], a[4:7], v[252:255]
  ds_read_b64_tr_b16 v[140:141], v163 offset:36864
  v_mul_f32 v122, v122, v98
  v_mfma_f32_16x16x32_bf16 v[248:251], v[144:147], a[52:55], v[248:251]
  ds_read_b64_tr_b16 v[142:143], v163 offset:38912
  v_mul_f32 v123, v123, v98
  v_mfma_f32_16x16x32_bf16 v[240:243], v[148:151], a[52:55], v[240:243]
  v_cvt_pk_bf16_f32 v110, v120, v121
  v_cvt_pk_bf16_f32 v111, v122, v123
  v_mfma_f32_16x16x32_bf16 v[44:47], v[152:155], a[52:55], v[44:47]
  v_permlane16_swap_b32 v108, v110
  v_mfma_f32_16x16x32_bf16 v[40:43], v[156:159], a[52:55], v[40:43]
  v_permlane16_swap_b32 v109, v111
  v_mfma_f32_16x16x32_bf16 v[32:35], v[144:147], a[100:103], v[32:35]
  v_permlane16_swap_b32 v124, v126
  v_mfma_f32_16x16x32_bf16 v[64:67], v[148:151], a[100:103], v[64:67]
  v_permlane16_swap_b32 v125, v127
  v_mfma_f32_16x16x32_bf16 v[60:63], v[152:155], a[100:103], v[60:63]
  v_mov_b32 v120, v124
  v_mov_b32_dpp v124, v108 row_ror:8 row_mask:0xf bank_mask:0x3
  v_mfma_f32_16x16x32_bf16 v[52:55], v[156:159], a[100:103], v[52:55]
  v_mov_b32_dpp v108, v120 row_ror:8 row_mask:0xf bank_mask:0xc
  v_mov_b32 v121, v125
  v_mfma_f32_16x16x32_bf16 v[236:239], v[144:147], a[148:151], v[236:239]
  v_mov_b32_dpp v125, v109 row_ror:8 row_mask:0xf bank_mask:0x3
  v_mov_b32_dpp v109, v121 row_ror:8 row_mask:0xf bank_mask:0xc
  v_mfma_f32_16x16x32_bf16 v[244:247], v[148:151], a[148:151], v[244:247]
  v_mov_b32 v122, v126
  v_mov_b32_dpp v126, v110 row_ror:8 row_mask:0xf bank_mask:0x3
  v_mfma_f32_16x16x32_bf16 v[164:167], v[152:155], a[148:151], v[164:167]
  v_mov_b32_dpp v110, v122 row_ror:8 row_mask:0xf bank_mask:0xc
  v_mov_b32 v123, v127
  v_mfma_f32_16x16x32_bf16 v[36:39], v[156:159], a[148:151], v[36:39]
  v_mov_b32_dpp v127, v111 row_ror:8 row_mask:0xf bank_mask:0x3
  v_mov_b32_dpp v111, v123 row_ror:8 row_mask:0xf bank_mask:0xc
  v_mfma_f32_16x16x32_bf16 v[48:51], v[144:147], a[196:199], v[48:51]
  v_mul_f32 v192, v192, v99
  v_mul_f32 v193, v193, v99
  v_mfma_f32_16x16x32_bf16 v[56:59], v[148:151], a[196:199], v[56:59]
  v_mul_f32 v194, v194, v99
  v_mul_f32 v195, v195, v99
  v_mfma_f32_16x16x32_bf16 v[204:207], v[152:155], a[196:199], v[204:207]
  v_cvt_pk_bf16_f32 v192, v192, v193
  v_cvt_pk_bf16_f32 v193, v194, v195
  v_mfma_f32_16x16x32_bf16 v[80:83], v[156:159], a[196:199], v[80:83]
  v_mul_f32 v188, v188, v99
  v_mul_f32 v189, v189, v99
  v_mfma_f32_16x16x32_bf16 v[72:75], v[144:147], a[244:247], v[72:75]
  ds_read_b64_tr_b16 v[144:145], v160 offset:40960
  v_mul_f32 v190, v190, v99
  v_mfma_f32_16x16x32_bf16 v[104:107], v[148:151], a[244:247], v[104:107]
  ds_read_b64_tr_b16 v[146:147], v160 offset:43008
  s_mov_b32 s35, 32896
  v_mul_f32 v191, v191, v99
  v_mfma_f32_16x16x32_bf16 v[88:91], v[152:155], a[244:247], v[88:91]
  ds_read_b64_tr_b16 v[148:149], v161 offset:40960
  v_cvt_pk_bf16_f32 v194, v188, v189
  v_mfma_f32_16x16x32_bf16 v[112:115], v[156:159], a[244:247], v[112:115]
  s_waitcnt lgkmcnt(9)
  ds_read_b64_tr_b16 v[150:151], v161 offset:43008
  v_cvt_pk_bf16_f32 v195, v190, v191
  v_mfma_f32_16x16x32_bf16 v[216:219], v[128:131], a[8:11], v[216:219]
  s_waitcnt lgkmcnt(8)
  ds_read_b64_tr_b16 v[152:153], v162 offset:40960
  v_mul_f32 v180, v180, v99
  v_mfma_f32_16x16x32_bf16 v[224:227], v[132:135], a[8:11], v[224:227]
  s_waitcnt lgkmcnt(7)
  buffer_store_dwordx4 v[84:87], v169, s[20:23], s35 offen nt
  v_mul_f32 v181, v181, v99
  v_mul_f32 v182, v182, v99
  v_mfma_f32_16x16x32_bf16 v[172:175], v[136:139], a[8:11], v[172:175]
  s_waitcnt lgkmcnt(5)
  ds_read_b64_tr_b16 v[154:155], v162 offset:43008
  v_mul_f32 v183, v183, v99
  v_mfma_f32_16x16x32_bf16 v[252:255], v[140:143], a[8:11], v[252:255]
  ds_read_b64_tr_b16 v[156:157], v163 offset:40960
  v_cvt_pk_bf16_f32 v180, v180, v181
  v_mfma_f32_16x16x32_bf16 v[248:251], v[128:131], a[56:59], v[248:251]
  ds_read_b64_tr_b16 v[158:159], v163 offset:43008
  v_cvt_pk_bf16_f32 v181, v182, v183
  v_mfma_f32_16x16x32_bf16 v[240:243], v[132:135], a[56:59], v[240:243]
  v_permlane16_swap_b32 v192, v194
  v_mfma_f32_16x16x32_bf16 v[44:47], v[136:139], a[56:59], v[44:47]
  v_permlane16_swap_b32 v193, v195
  v_mfma_f32_16x16x32_bf16 v[40:43], v[140:143], a[56:59], v[40:43]
  v_mul_f32 v212, v212, v99
  v_mul_f32 v213, v213, v99
  v_mfma_f32_16x16x32_bf16 v[32:35], v[128:131], a[104:107], v[32:35]
  v_mul_f32 v214, v214, v99
  v_mul_f32 v215, v215, v99
  v_mfma_f32_16x16x32_bf16 v[64:67], v[132:135], a[104:107], v[64:67]
  v_cvt_pk_bf16_f32 v182, v212, v213
  v_cvt_pk_bf16_f32 v183, v214, v215
  v_mfma_f32_16x16x32_bf16 v[60:63], v[136:139], a[104:107], v[60:63]
  v_permlane16_swap_b32 v180, v182
  v_mfma_f32_16x16x32_bf16 v[52:55], v[140:143], a[104:107], v[52:55]
  v_permlane16_swap_b32 v181, v183
  v_mfma_f32_16x16x32_bf16 v[236:239], v[128:131], a[152:155], v[236:239]
  v_mov_b32 v188, v180
  v_mov_b32_dpp v180, v192 row_ror:8 row_mask:0xf bank_mask:0x3
  v_mfma_f32_16x16x32_bf16 v[244:247], v[132:135], a[152:155], v[244:247]
  v_mov_b32_dpp v192, v188 row_ror:8 row_mask:0xf bank_mask:0xc
  v_mov_b32 v189, v181
  v_mfma_f32_16x16x32_bf16 v[164:167], v[136:139], a[152:155], v[164:167]
  v_mov_b32_dpp v181, v193 row_ror:8 row_mask:0xf bank_mask:0x3
  v_mov_b32_dpp v193, v189 row_ror:8 row_mask:0xf bank_mask:0xc
  v_mfma_f32_16x16x32_bf16 v[36:39], v[140:143], a[152:155], v[36:39]
  v_mov_b32 v190, v182
  v_mov_b32_dpp v182, v194 row_ror:8 row_mask:0xf bank_mask:0x3
  v_mfma_f32_16x16x32_bf16 v[48:51], v[128:131], a[200:203], v[48:51]
  v_mov_b32_dpp v194, v190 row_ror:8 row_mask:0xf bank_mask:0xc
  v_mov_b32 v191, v183
  v_mfma_f32_16x16x32_bf16 v[56:59], v[132:135], a[200:203], v[56:59]
  v_mov_b32_dpp v183, v195 row_ror:8 row_mask:0xf bank_mask:0x3
  v_mov_b32_dpp v195, v191 row_ror:8 row_mask:0xf bank_mask:0xc
  v_mfma_f32_16x16x32_bf16 v[204:207], v[136:139], a[200:203], v[204:207]
  v_mul_f32 v208, v208, v100
  v_mul_f32 v209, v209, v100
  v_mfma_f32_16x16x32_bf16 v[80:83], v[140:143], a[200:203], v[80:83]
  v_mul_f32 v210, v210, v100
  v_mul_f32 v211, v211, v100
  v_mfma_f32_16x16x32_bf16 v[72:75], v[128:131], a[248:251], v[72:75]
  ds_read_b64_tr_b16 v[128:129], v160 offset:45056
  s_mov_b32 s36, 36992
  v_cvt_pk_bf16_f32 v208, v208, v209
  v_mfma_f32_16x16x32_bf16 v[104:107], v[132:135], a[248:251], v[104:107]
  ds_read_b64_tr_b16 v[130:131], v160 offset:47104
  v_cvt_pk_bf16_f32 v209, v210, v211
  v_mfma_f32_16x16x32_bf16 v[88:91], v[136:139], a[248:251], v[88:91]
  ds_read_b64_tr_b16 v[132:133], v161 offset:45056
  v_mul_f32 v200, v200, v100
  v_mfma_f32_16x16x32_bf16 v[112:115], v[140:143], a[248:251], v[112:115]
  s_waitcnt lgkmcnt(9)
  ds_read_b64_tr_b16 v[134:135], v161 offset:47104
  v_mul_f32 v201, v201, v100
  v_mfma_f32_16x16x32_bf16 v[216:219], v[144:147], a[12:15], v[216:219]
  s_waitcnt lgkmcnt(8)
  buffer_store_dwordx4 v[92:95], v169, s[20:23], s36 offen nt
  v_mul_f32 v202, v202, v100
  v_mul_f32 v203, v203, v100
  v_mfma_f32_16x16x32_bf16 v[224:227], v[148:151], a[12:15], v[224:227]
  s_waitcnt lgkmcnt(6)
  ds_read_b64_tr_b16 v[136:137], v162 offset:45056
  v_cvt_pk_bf16_f32 v210, v200, v201
  v_mfma_f32_16x16x32_bf16 v[172:175], v[152:155], a[12:15], v[172:175]
  s_waitcnt lgkmcnt(5)
  ds_read_b64_tr_b16 v[138:139], v162 offset:47104
  v_cvt_pk_bf16_f32 v211, v202, v203
  v_mfma_f32_16x16x32_bf16 v[252:255], v[156:159], a[12:15], v[252:255]
  ds_read_b64_tr_b16 v[140:141], v163 offset:45056
  v_mul_f32 v232, v232, v100
  v_mfma_f32_16x16x32_bf16 v[248:251], v[144:147], a[60:63], v[248:251]
  ds_read_b64_tr_b16 v[142:143], v163 offset:47104
  v_mul_f32 v233, v233, v100
  v_mfma_f32_16x16x32_bf16 v[240:243], v[148:151], a[60:63], v[240:243]
  v_mul_f32 v234, v234, v100
  v_mul_f32 v235, v235, v100
  v_mfma_f32_16x16x32_bf16 v[44:47], v[152:155], a[60:63], v[44:47]
  v_permlane16_swap_b32 v208, v210
  v_mfma_f32_16x16x32_bf16 v[40:43], v[156:159], a[60:63], v[40:43]
  v_cvt_pk_bf16_f32 v232, v232, v233
  v_cvt_pk_bf16_f32 v233, v234, v235
  v_mfma_f32_16x16x32_bf16 v[32:35], v[144:147], a[108:111], v[32:35]
  v_permlane16_swap_b32 v209, v211
  v_mfma_f32_16x16x32_bf16 v[64:67], v[148:151], a[108:111], v[64:67]
  v_mul_f32 v228, v228, v100
  v_mul_f32 v229, v229, v100
  v_mfma_f32_16x16x32_bf16 v[60:63], v[152:155], a[108:111], v[60:63]
  v_mul_f32 v230, v230, v100
  v_mul_f32 v231, v231, v100
  v_mfma_f32_16x16x32_bf16 v[52:55], v[156:159], a[108:111], v[52:55]
  v_cvt_pk_bf16_f32 v234, v228, v229
  v_cvt_pk_bf16_f32 v235, v230, v231
  v_mfma_f32_16x16x32_bf16 v[236:239], v[144:147], a[156:159], v[236:239]
  v_permlane16_swap_b32 v232, v234
  v_mfma_f32_16x16x32_bf16 v[244:247], v[148:151], a[156:159], v[244:247]
  v_permlane16_swap_b32 v233, v235
  v_mfma_f32_16x16x32_bf16 v[164:167], v[152:155], a[156:159], v[164:167]
  v_mov_b32 v200, v232
  v_mov_b32_dpp v232, v208 row_ror:8 row_mask:0xf bank_mask:0x3
  v_mfma_f32_16x16x32_bf16 v[36:39], v[156:159], a[156:159], v[36:39]
  v_mov_b32_dpp v208, v200 row_ror:8 row_mask:0xf bank_mask:0xc
  v_mov_b32 v201, v233
  v_mfma_f32_16x16x32_bf16 v[48:51], v[144:147], a[204:207], v[48:51]
  v_mov_b32_dpp v233, v209 row_ror:8 row_mask:0xf bank_mask:0x3
  v_mov_b32_dpp v209, v201 row_ror:8 row_mask:0xf bank_mask:0xc
  v_mfma_f32_16x16x32_bf16 v[56:59], v[148:151], a[204:207], v[56:59]
  v_mov_b32 v202, v234
  v_mov_b32_dpp v234, v210 row_ror:8 row_mask:0xf bank_mask:0x3
  v_mfma_f32_16x16x32_bf16 v[204:207], v[152:155], a[204:207], v[204:207]
  v_mov_b32_dpp v210, v202 row_ror:8 row_mask:0xf bank_mask:0xc
  v_mov_b32 v203, v235
  v_mfma_f32_16x16x32_bf16 v[80:83], v[156:159], a[204:207], v[80:83]
  s_mov_b32 s37, 65664
  v_mov_b32_dpp v235, v211 row_ror:8 row_mask:0xf bank_mask:0x3
  v_mov_b32_dpp v211, v203 row_ror:8 row_mask:0xf bank_mask:0xc
  v_mfma_f32_16x16x32_bf16 v[72:75], v[144:147], a[252:255], v[72:75]
  ds_read_b64_tr_b16 v[144:145], v160 offset:49152
  v_mul_f32 v220, v220, v101
  v_mfma_f32_16x16x32_bf16 v[104:107], v[148:151], a[252:255], v[104:107]
  ds_read_b64_tr_b16 v[146:147], v160 offset:51200
  v_mul_f32 v221, v221, v101
  v_mfma_f32_16x16x32_bf16 v[88:91], v[152:155], a[252:255], v[88:91]
  ds_read_b64_tr_b16 v[148:149], v161 offset:49152
  v_mul_f32 v222, v222, v101
  v_mfma_f32_16x16x32_bf16 v[112:115], v[156:159], a[252:255], v[112:115]
  s_waitcnt lgkmcnt(9)
  buffer_store_dwordx4 v[108:111], v169, s[20:23], s37 offen nt
  v_mul_f32 v223, v223, v101
  v_cvt_pk_bf16_f32 v220, v220, v221
  v_mfma_f32_16x16x32_bf16 v[216:219], v[128:131], a[16:19], v[216:219]
  s_waitcnt lgkmcnt(7)
  ds_read_b64_tr_b16 v[150:151], v161 offset:51200
  v_cvt_pk_bf16_f32 v221, v222, v223
  v_mfma_f32_16x16x32_bf16 v[224:227], v[132:135], a[16:19], v[224:227]
  s_waitcnt lgkmcnt(6)
  ds_read_b64_tr_b16 v[152:153], v162 offset:49152
  v_mul_f32 v176, v176, v101
  v_mfma_f32_16x16x32_bf16 v[172:175], v[136:139], a[16:19], v[172:175]
  s_waitcnt lgkmcnt(5)
  ds_read_b64_tr_b16 v[154:155], v162 offset:51200
  v_mul_f32 v177, v177, v101
  v_mfma_f32_16x16x32_bf16 v[252:255], v[140:143], a[16:19], v[252:255]
  ds_read_b64_tr_b16 v[156:157], v163 offset:49152
  v_mul_f32 v178, v178, v101
  v_mfma_f32_16x16x32_bf16 v[248:251], v[128:131], a[64:67], v[248:251]
  ds_read_b64_tr_b16 v[158:159], v163 offset:51200
  v_mul_f32 v179, v179, v101
  v_mfma_f32_16x16x32_bf16 v[240:243], v[132:135], a[64:67], v[240:243]
  v_cvt_pk_bf16_f32 v222, v176, v177
  v_cvt_pk_bf16_f32 v223, v178, v179
  v_mfma_f32_16x16x32_bf16 v[44:47], v[136:139], a[64:67], v[44:47]
  v_mul_f32 v184, v184, v101
  v_mul_f32 v185, v185, v101
  v_mfma_f32_16x16x32_bf16 v[40:43], v[140:143], a[64:67], v[40:43]
  v_mul_f32 v186, v186, v101
  v_mul_f32 v187, v187, v101
  v_mfma_f32_16x16x32_bf16 v[32:35], v[128:131], a[112:115], v[32:35]
  v_permlane16_swap_b32 v220, v222
  v_mfma_f32_16x16x32_bf16 v[64:67], v[132:135], a[112:115], v[64:67]
  v_cvt_pk_bf16_f32 v184, v184, v185
  v_cvt_pk_bf16_f32 v185, v186, v187
  v_mfma_f32_16x16x32_bf16 v[60:63], v[136:139], a[112:115], v[60:63]
  v_permlane16_swap_b32 v221, v223
  v_mfma_f32_16x16x32_bf16 v[52:55], v[140:143], a[112:115], v[52:55]
  v_mul_f32 v196, v196, v101
  v_mul_f32 v197, v197, v101
  v_mfma_f32_16x16x32_bf16 v[236:239], v[128:131], a[160:163], v[236:239]
  v_mul_f32 v198, v198, v101
  v_mul_f32 v199, v199, v101
  v_mfma_f32_16x16x32_bf16 v[244:247], v[132:135], a[160:163], v[244:247]
  v_cvt_pk_bf16_f32 v186, v196, v197
  v_cvt_pk_bf16_f32 v187, v198, v199
  v_mfma_f32_16x16x32_bf16 v[164:167], v[136:139], a[160:163], v[164:167]
  v_permlane16_swap_b32 v184, v186
  v_mfma_f32_16x16x32_bf16 v[36:39], v[140:143], a[160:163], v[36:39]
  v_permlane16_swap_b32 v185, v187
  v_mfma_f32_16x16x32_bf16 v[48:51], v[128:131], a[208:211], v[48:51]
  v_mov_b32 v176, v184
  v_mov_b32_dpp v184, v220 row_ror:8 row_mask:0xf bank_mask:0x3
  v_mfma_f32_16x16x32_bf16 v[56:59], v[132:135], a[208:211], v[56:59]
  v_mov_b32_dpp v220, v176 row_ror:8 row_mask:0xf bank_mask:0xc
  v_mov_b32 v177, v185
  v_mfma_f32_16x16x32_bf16 v[204:207], v[136:139], a[208:211], v[204:207]
  s_mov_b32 s38, 69760
  v_mov_b32_dpp v185, v221 row_ror:8 row_mask:0xf bank_mask:0x3
  v_mov_b32_dpp v221, v177 row_ror:8 row_mask:0xf bank_mask:0xc
  v_mfma_f32_16x16x32_bf16 v[80:83], v[140:143], a[208:211], v[80:83]
  v_mov_b32 v178, v186
  v_mov_b32_dpp v186, v222 row_ror:8 row_mask:0xf bank_mask:0x3
  v_mfma_f32_16x16x32_bf16 v[72:75], v[128:131], v[0:3], v[72:75]
  ds_read_b64_tr_b16 v[128:129], v160 offset:53248
  v_mov_b32_dpp v222, v178 row_ror:8 row_mask:0xf bank_mask:0xc
  v_mfma_f32_16x16x32_bf16 v[104:107], v[132:135], v[0:3], v[104:107]
  ds_read_b64_tr_b16 v[130:131], v160 offset:55296
  v_mov_b32 v179, v187
  v_mfma_f32_16x16x32_bf16 v[88:91], v[136:139], v[0:3], v[88:91]
  buffer_store_dwordx4 v[124:127], v169, s[20:23], s38 offen nt
  v_mov_b32_dpp v187, v223 row_ror:8 row_mask:0xf bank_mask:0x3
  v_mov_b32_dpp v223, v179 row_ror:8 row_mask:0xf bank_mask:0xc
  v_mfma_f32_16x16x32_bf16 v[112:115], v[140:143], v[0:3], v[112:115]
  s_waitcnt lgkmcnt(8)
  ds_read_b64_tr_b16 v[132:133], v161 offset:53248
  v_mfma_f32_16x16x32_bf16 v[216:219], v[144:147], a[20:23], v[216:219]
  s_waitcnt lgkmcnt(7)
  ds_read_b64_tr_b16 v[134:135], v161 offset:55296
  v_mfma_f32_16x16x32_bf16 v[224:227], v[148:151], a[20:23], v[224:227]
  s_waitcnt lgkmcnt(6)
  ds_read_b64_tr_b16 v[136:137], v162 offset:53248
  v_mfma_f32_16x16x32_bf16 v[172:175], v[152:155], a[20:23], v[172:175]
  s_waitcnt lgkmcnt(5)
  ds_read_b64_tr_b16 v[138:139], v162 offset:55296
  v_mfma_f32_16x16x32_bf16 v[252:255], v[156:159], a[20:23], v[252:255]
  ds_read_b64_tr_b16 v[140:141], v163 offset:53248
  v_mfma_f32_16x16x32_bf16 v[248:251], v[144:147], a[68:71], v[248:251]
  ds_read_b64_tr_b16 v[142:143], v163 offset:55296
  v_mfma_f32_16x16x32_bf16 v[240:243], v[148:151], a[68:71], v[240:243]
  v_mfma_f32_16x16x32_bf16 v[44:47], v[152:155], a[68:71], v[44:47]
  v_mfma_f32_16x16x32_bf16 v[40:43], v[156:159], a[68:71], v[40:43]
  v_mfma_f32_16x16x32_bf16 v[32:35], v[144:147], a[116:119], v[32:35]
  v_mfma_f32_16x16x32_bf16 v[64:67], v[148:151], a[116:119], v[64:67]
  v_mfma_f32_16x16x32_bf16 v[60:63], v[152:155], a[116:119], v[60:63]
  v_mfma_f32_16x16x32_bf16 v[52:55], v[156:159], a[116:119], v[52:55]
  v_mfma_f32_16x16x32_bf16 v[236:239], v[144:147], a[164:167], v[236:239]
  v_mfma_f32_16x16x32_bf16 v[244:247], v[148:151], a[164:167], v[244:247]
  v_mfma_f32_16x16x32_bf16 v[164:167], v[152:155], a[164:167], v[164:167]
  v_mfma_f32_16x16x32_bf16 v[36:39], v[156:159], a[164:167], v[36:39]
  v_mfma_f32_16x16x32_bf16 v[48:51], v[144:147], a[212:215], v[48:51]
  s_mov_b32 s39, 98432
  v_mfma_f32_16x16x32_bf16 v[56:59], v[148:151], a[212:215], v[56:59]
  v_mfma_f32_16x16x32_bf16 v[204:207], v[152:155], a[212:215], v[204:207]
  v_mfma_f32_16x16x32_bf16 v[80:83], v[156:159], a[212:215], v[80:83]
  v_mfma_f32_16x16x32_bf16 v[72:75], v[144:147], v[4:7], v[72:75]
  buffer_store_dwordx4 v[192:195], v169, s[20:23], s39 offen nt
  v_mfma_f32_16x16x32_bf16 v[104:107], v[148:151], v[4:7], v[104:107]
  ds_read_b64_tr_b16 v[144:145], v160 offset:57344
  v_mfma_f32_16x16x32_bf16 v[88:91], v[152:155], v[4:7], v[88:91]
  ds_read_b64_tr_b16 v[146:147], v160 offset:59392
  v_mfma_f32_16x16x32_bf16 v[112:115], v[156:159], v[4:7], v[112:115]
  s_waitcnt lgkmcnt(8)
  ds_read_b64_tr_b16 v[148:149], v161 offset:57344
  v_mfma_f32_16x16x32_bf16 v[216:219], v[128:131], a[24:27], v[216:219]
  s_waitcnt lgkmcnt(7)
  ds_read_b64_tr_b16 v[150:151], v161 offset:59392
  v_mfma_f32_16x16x32_bf16 v[224:227], v[132:135], a[24:27], v[224:227]
  s_waitcnt lgkmcnt(6)
  ds_read_b64_tr_b16 v[152:153], v162 offset:57344
  v_mfma_f32_16x16x32_bf16 v[172:175], v[136:139], a[24:27], v[172:175]
  s_waitcnt lgkmcnt(5)
  ds_read_b64_tr_b16 v[154:155], v162 offset:59392
  v_mfma_f32_16x16x32_bf16 v[252:255], v[140:143], a[24:27], v[252:255]
  ds_read_b64_tr_b16 v[156:157], v163 offset:57344
  v_mfma_f32_16x16x32_bf16 v[248:251], v[128:131], a[72:75], v[248:251]
  ds_read_b64_tr_b16 v[158:159], v163 offset:59392
  v_mfma_f32_16x16x32_bf16 v[240:243], v[132:135], a[72:75], v[240:243]
  v_mfma_f32_16x16x32_bf16 v[44:47], v[136:139], a[72:75], v[44:47]
  v_mfma_f32_16x16x32_bf16 v[40:43], v[140:143], a[72:75], v[40:43]
  v_mfma_f32_16x16x32_bf16 v[32:35], v[128:131], a[120:123], v[32:35]
  v_mfma_f32_16x16x32_bf16 v[64:67], v[132:135], a[120:123], v[64:67]
  v_mfma_f32_16x16x32_bf16 v[60:63], v[136:139], a[120:123], v[60:63]
  v_mfma_f32_16x16x32_bf16 v[52:55], v[140:143], a[120:123], v[52:55]
  v_mfma_f32_16x16x32_bf16 v[236:239], v[128:131], a[168:171], v[236:239]
  v_mfma_f32_16x16x32_bf16 v[244:247], v[132:135], a[168:171], v[244:247]
  v_mfma_f32_16x16x32_bf16 v[164:167], v[136:139], a[168:171], v[164:167]
  v_mfma_f32_16x16x32_bf16 v[36:39], v[140:143], a[168:171], v[36:39]
  s_mov_b32 s40, 102528
  v_mfma_f32_16x16x32_bf16 v[48:51], v[128:131], a[216:219], v[48:51]
  v_mfma_f32_16x16x32_bf16 v[56:59], v[132:135], a[216:219], v[56:59]
  v_mfma_f32_16x16x32_bf16 v[204:207], v[136:139], a[216:219], v[204:207]
  v_mfma_f32_16x16x32_bf16 v[80:83], v[140:143], a[216:219], v[80:83]
  buffer_store_dwordx4 v[180:183], v169, s[20:23], s40 offen nt
  v_mfma_f32_16x16x32_bf16 v[72:75], v[128:131], v[8:11], v[72:75]
  ds_read_b64_tr_b16 v[128:129], v160 offset:61440
  v_mfma_f32_16x16x32_bf16 v[104:107], v[132:135], v[8:11], v[104:107]
  ds_read_b64_tr_b16 v[130:131], v160 offset:63488
  v_add_u32 v160, 65536, v160
  v_mfma_f32_16x16x32_bf16 v[88:91], v[136:139], v[8:11], v[88:91]
  ds_read_b64_tr_b16 v[132:133], v161 offset:61440
  v_mfma_f32_16x16x32_bf16 v[112:115], v[140:143], v[8:11], v[112:115]
  s_waitcnt lgkmcnt(9)
  ds_read_b64_tr_b16 v[134:135], v161 offset:63488
  v_add_u32 v161, 65536, v161
  v_mfma_f32_16x16x32_bf16 v[216:219], v[144:147], a[28:31], v[216:219]
  s_waitcnt lgkmcnt(8)
  ds_read_b64_tr_b16 v[136:137], v162 offset:61440
  v_mfma_f32_16x16x32_bf16 v[224:227], v[148:151], a[28:31], v[224:227]
  s_waitcnt lgkmcnt(7)
  ds_read_b64_tr_b16 v[138:139], v162 offset:63488
  v_add_u32 v162, 65536, v162
  v_mfma_f32_16x16x32_bf16 v[172:175], v[152:155], a[28:31], v[172:175]
  s_waitcnt lgkmcnt(6)
  ds_read_b64_tr_b16 v[140:141], v163 offset:61440
  v_mfma_f32_16x16x32_bf16 v[252:255], v[156:159], a[28:31], v[252:255]
  ds_read_b64_tr_b16 v[142:143], v163 offset:63488
  v_add_u32 v163, 65536, v163
  v_mfma_f32_16x16x32_bf16 v[248:251], v[144:147], a[76:79], v[248:251]
  v_mfma_f32_16x16x32_bf16 v[240:243], v[148:151], a[76:79], v[240:243]
  v_mfma_f32_16x16x32_bf16 v[44:47], v[152:155], a[76:79], v[44:47]
  v_mfma_f32_16x16x32_bf16 v[40:43], v[156:159], a[76:79], v[40:43]
  v_mfma_f32_16x16x32_bf16 v[32:35], v[144:147], a[124:127], v[32:35]
  v_mfma_f32_16x16x32_bf16 v[64:67], v[148:151], a[124:127], v[64:67]
  v_mfma_f32_16x16x32_bf16 v[60:63], v[152:155], a[124:127], v[60:63]
  v_mfma_f32_16x16x32_bf16 v[52:55], v[156:159], a[124:127], v[52:55]
  v_mfma_f32_16x16x32_bf16 v[236:239], v[144:147], a[172:175], v[236:239]
  v_mfma_f32_16x16x32_bf16 v[244:247], v[148:151], a[172:175], v[244:247]
  v_mfma_f32_16x16x32_bf16 v[164:167], v[152:155], a[172:175], v[164:167]
  s_mov_b32 s41, 131200
  v_mfma_f32_16x16x32_bf16 v[36:39], v[156:159], a[172:175], v[36:39]
  v_mfma_f32_16x16x32_bf16 v[48:51], v[144:147], a[220:223], v[48:51]
  v_mfma_f32_16x16x32_bf16 v[56:59], v[148:151], a[220:223], v[56:59]
  v_mfma_f32_16x16x32_bf16 v[204:207], v[152:155], a[220:223], v[204:207]
  buffer_store_dwordx4 v[208:211], v169, s[20:23], s41 offen nt
  v_mfma_f32_16x16x32_bf16 v[80:83], v[156:159], a[220:223], v[80:83]
  v_mfma_f32_16x16x32_bf16 v[72:75], v[144:147], v[12:15], v[72:75]
  ds_read_b64_tr_b16 v[144:145], v160 offset:0
  v_mfma_f32_16x16x32_bf16 v[104:107], v[148:151], v[12:15], v[104:107]
  ds_read_b64_tr_b16 v[146:147], v160 offset:2048
  v_mfma_f32_16x16x32_bf16 v[88:91], v[152:155], v[12:15], v[88:91]
  ds_read_b64_tr_b16 v[148:149], v161 offset:0
  v_mfma_f32_16x16x32_bf16 v[112:115], v[156:159], v[12:15], v[112:115]
  s_waitcnt lgkmcnt(9)
  ds_read_b64_tr_b16 v[150:151], v161 offset:2048
  v_mfma_f32_16x16x32_bf16 v[216:219], v[128:131], a[32:35], v[216:219]
  s_waitcnt lgkmcnt(8)
  ds_read_b64_tr_b16 v[152:153], v162 offset:0
  v_mfma_f32_16x16x32_bf16 v[224:227], v[132:135], a[32:35], v[224:227]
  s_waitcnt lgkmcnt(7)
  ds_read_b64_tr_b16 v[154:155], v162 offset:2048
  v_mfma_f32_16x16x32_bf16 v[172:175], v[136:139], a[32:35], v[172:175]
  s_waitcnt lgkmcnt(6)
  ds_read_b64_tr_b16 v[156:157], v163 offset:0
  v_mfma_f32_16x16x32_bf16 v[252:255], v[140:143], a[32:35], v[252:255]
  ds_read_b64_tr_b16 v[158:159], v163 offset:2048
  v_mfma_f32_16x16x32_bf16 v[248:251], v[128:131], a[80:83], v[248:251]
  v_mfma_f32_16x16x32_bf16 v[240:243], v[132:135], a[80:83], v[240:243]
  v_mfma_f32_16x16x32_bf16 v[44:47], v[136:139], a[80:83], v[44:47]
  v_mfma_f32_16x16x32_bf16 v[40:43], v[140:143], a[80:83], v[40:43]
  v_mfma_f32_16x16x32_bf16 v[32:35], v[128:131], a[128:131], v[32:35]
  v_mfma_f32_16x16x32_bf16 v[64:67], v[132:135], a[128:131], v[64:67]
  v_mfma_f32_16x16x32_bf16 v[60:63], v[136:139], a[128:131], v[60:63]
  v_mfma_f32_16x16x32_bf16 v[52:55], v[140:143], a[128:131], v[52:55]
  v_mfma_f32_16x16x32_bf16 v[236:239], v[128:131], a[176:179], v[236:239]
  v_mfma_f32_16x16x32_bf16 v[244:247], v[132:135], a[176:179], v[244:247]
  s_mov_b32 s42, 135296
  v_mfma_f32_16x16x32_bf16 v[164:167], v[136:139], a[176:179], v[164:167]
  v_mfma_f32_16x16x32_bf16 v[36:39], v[140:143], a[176:179], v[36:39]
  v_mfma_f32_16x16x32_bf16 v[48:51], v[128:131], a[224:227], v[48:51]
  v_mfma_f32_16x16x32_bf16 v[56:59], v[132:135], a[224:227], v[56:59]
  buffer_store_dwordx4 v[232:235], v169, s[20:23], s42 offen nt
  v_mfma_f32_16x16x32_bf16 v[204:207], v[136:139], a[224:227], v[204:207]
  v_mfma_f32_16x16x32_bf16 v[80:83], v[140:143], a[224:227], v[80:83]
  v_mfma_f32_16x16x32_bf16 v[72:75], v[128:131], v[16:19], v[72:75]
  ds_read_b64_tr_b16 v[128:129], v160 offset:4096
  v_mfma_f32_16x16x32_bf16 v[104:107], v[132:135], v[16:19], v[104:107]
  ds_read_b64_tr_b16 v[130:131], v160 offset:6144
  v_mfma_f32_16x16x32_bf16 v[88:91], v[136:139], v[16:19], v[88:91]
  ds_read_b64_tr_b16 v[132:133], v161 offset:4096
  v_mfma_f32_16x16x32_bf16 v[112:115], v[140:143], v[16:19], v[112:115]
  s_waitcnt lgkmcnt(9)
  ds_read_b64_tr_b16 v[134:135], v161 offset:6144
  v_mfma_f32_16x16x32_bf16 v[216:219], v[144:147], a[36:39], v[216:219]
  s_waitcnt lgkmcnt(8)
  ds_read_b64_tr_b16 v[136:137], v162 offset:4096
  v_mfma_f32_16x16x32_bf16 v[224:227], v[148:151], a[36:39], v[224:227]
  s_waitcnt lgkmcnt(7)
  ds_read_b64_tr_b16 v[138:139], v162 offset:6144
  v_mfma_f32_16x16x32_bf16 v[172:175], v[152:155], a[36:39], v[172:175]
  s_waitcnt lgkmcnt(6)
  ds_read_b64_tr_b16 v[140:141], v163 offset:4096
  v_mfma_f32_16x16x32_bf16 v[252:255], v[156:159], a[36:39], v[252:255]
  ds_read_b64_tr_b16 v[142:143], v163 offset:6144
  v_mfma_f32_16x16x32_bf16 v[248:251], v[144:147], a[84:87], v[248:251]
  v_mfma_f32_16x16x32_bf16 v[240:243], v[148:151], a[84:87], v[240:243]
  v_mfma_f32_16x16x32_bf16 v[44:47], v[152:155], a[84:87], v[44:47]
  v_mfma_f32_16x16x32_bf16 v[40:43], v[156:159], a[84:87], v[40:43]
  v_mfma_f32_16x16x32_bf16 v[32:35], v[144:147], a[132:135], v[32:35]
  v_mfma_f32_16x16x32_bf16 v[64:67], v[148:151], a[132:135], v[64:67]
  v_mfma_f32_16x16x32_bf16 v[60:63], v[152:155], a[132:135], v[60:63]
  v_mfma_f32_16x16x32_bf16 v[52:55], v[156:159], a[132:135], v[52:55]
  v_mfma_f32_16x16x32_bf16 v[236:239], v[144:147], a[180:183], v[236:239]
  s_mov_b32 s43, 163968
  v_mfma_f32_16x16x32_bf16 v[244:247], v[148:151], a[180:183], v[244:247]
  v_mfma_f32_16x16x32_bf16 v[164:167], v[152:155], a[180:183], v[164:167]
  v_mfma_f32_16x16x32_bf16 v[36:39], v[156:159], a[180:183], v[36:39]
  v_mfma_f32_16x16x32_bf16 v[48:51], v[144:147], a[228:231], v[48:51]
  buffer_store_dwordx4 v[220:223], v169, s[20:23], s43 offen nt
  v_mfma_f32_16x16x32_bf16 v[56:59], v[148:151], a[228:231], v[56:59]
  v_mfma_f32_16x16x32_bf16 v[204:207], v[152:155], a[228:231], v[204:207]
  v_mfma_f32_16x16x32_bf16 v[80:83], v[156:159], a[228:231], v[80:83]
  v_mfma_f32_16x16x32_bf16 v[72:75], v[144:147], v[20:23], v[72:75]
  ds_read_b64_tr_b16 v[144:145], v160 offset:8192
  v_mfma_f32_16x16x32_bf16 v[104:107], v[148:151], v[20:23], v[104:107]
  ds_read_b64_tr_b16 v[146:147], v160 offset:10240
  v_mfma_f32_16x16x32_bf16 v[88:91], v[152:155], v[20:23], v[88:91]
  ds_read_b64_tr_b16 v[148:149], v161 offset:8192
  v_mfma_f32_16x16x32_bf16 v[112:115], v[156:159], v[20:23], v[112:115]
  s_waitcnt lgkmcnt(9)
  ds_read_b64_tr_b16 v[150:151], v161 offset:10240
  v_mfma_f32_16x16x32_bf16 v[216:219], v[128:131], a[40:43], v[216:219]
  s_waitcnt lgkmcnt(8)
  ds_read_b64_tr_b16 v[152:153], v162 offset:8192
  v_mfma_f32_16x16x32_bf16 v[224:227], v[132:135], a[40:43], v[224:227]
  s_waitcnt lgkmcnt(7)
  ds_read_b64_tr_b16 v[154:155], v162 offset:10240
  v_mfma_f32_16x16x32_bf16 v[172:175], v[136:139], a[40:43], v[172:175]
  s_waitcnt lgkmcnt(6)
  ds_read_b64_tr_b16 v[156:157], v163 offset:8192
  v_mfma_f32_16x16x32_bf16 v[252:255], v[140:143], a[40:43], v[252:255]
  ds_read_b64_tr_b16 v[158:159], v163 offset:10240
  v_mfma_f32_16x16x32_bf16 v[248:251], v[128:131], a[88:91], v[248:251]
  v_mfma_f32_16x16x32_bf16 v[240:243], v[132:135], a[88:91], v[240:243]
  v_mfma_f32_16x16x32_bf16 v[44:47], v[136:139], a[88:91], v[44:47]
  v_mfma_f32_16x16x32_bf16 v[40:43], v[140:143], a[88:91], v[40:43]
  v_mfma_f32_16x16x32_bf16 v[32:35], v[128:131], a[136:139], v[32:35]
  v_mfma_f32_16x16x32_bf16 v[64:67], v[132:135], a[136:139], v[64:67]
  v_mfma_f32_16x16x32_bf16 v[60:63], v[136:139], a[136:139], v[60:63]
  s_mov_b32 s44, 168064
  v_mfma_f32_16x16x32_bf16 v[52:55], v[140:143], a[136:139], v[52:55]
  v_mfma_f32_16x16x32_bf16 v[236:239], v[128:131], a[184:187], v[236:239]
  v_mfma_f32_16x16x32_bf16 v[244:247], v[132:135], a[184:187], v[244:247]
  v_mfma_f32_16x16x32_bf16 v[164:167], v[136:139], a[184:187], v[164:167]
  buffer_store_dwordx4 v[184:187], v169, s[20:23], s44 offen nt
  v_mfma_f32_16x16x32_bf16 v[36:39], v[140:143], a[184:187], v[36:39]
  v_mfma_f32_16x16x32_bf16 v[48:51], v[128:131], a[232:235], v[48:51]
  v_mfma_f32_16x16x32_bf16 v[56:59], v[132:135], a[232:235], v[56:59]
  v_mfma_f32_16x16x32_bf16 v[204:207], v[136:139], a[232:235], v[204:207]
  v_mfma_f32_16x16x32_bf16 v[80:83], v[140:143], a[232:235], v[80:83]
  v_mfma_f32_16x16x32_bf16 v[72:75], v[128:131], v[24:27], v[72:75]
  ds_read_b64_tr_b16 v[128:129], v160 offset:12288
  v_mfma_f32_16x16x32_bf16 v[104:107], v[132:135], v[24:27], v[104:107]
  ds_read_b64_tr_b16 v[130:131], v160 offset:14336
  v_mfma_f32_16x16x32_bf16 v[88:91], v[136:139], v[24:27], v[88:91]
  ds_read_b64_tr_b16 v[132:133], v161 offset:12288
  v_mfma_f32_16x16x32_bf16 v[112:115], v[140:143], v[24:27], v[112:115]
  s_waitcnt lgkmcnt(9)
  ds_read_b64_tr_b16 v[134:135], v161 offset:14336
  v_mfma_f32_16x16x32_bf16 v[216:219], v[144:147], a[44:47], v[216:219]
  s_waitcnt lgkmcnt(8)
  ds_read_b64_tr_b16 v[136:137], v162 offset:12288
  s_waitcnt vmcnt(13)
  s_barrier
  v_mfma_f32_16x16x32_bf16 v[224:227], v[148:151], a[44:47], v[224:227]
  s_waitcnt lgkmcnt(7)
  ds_read_b64_tr_b16 v[138:139], v162 offset:14336
  v_mfma_f32_16x16x32_bf16 v[172:175], v[152:155], a[44:47], v[172:175]
  s_waitcnt lgkmcnt(6)
  ds_read_b64_tr_b16 v[140:141], v163 offset:12288
  v_mfma_f32_16x16x32_bf16 v[252:255], v[156:159], a[44:47], v[252:255]
  ds_read_b64_tr_b16 v[142:143], v163 offset:14336
  v_mul_f32 v216, v216, v96
  v_mfma_f32_16x16x32_bf16 v[248:251], v[144:147], a[92:95], v[248:251]
  v_mul_f32 v217, v217, v96
  v_mul_f32 v218, v218, v96
  v_mfma_f32_16x16x32_bf16 v[240:243], v[148:151], a[92:95], v[240:243]
  v_mul_f32 v219, v219, v96
  v_cvt_pk_bf16_f32 v216, v216, v217
  v_mfma_f32_16x16x32_bf16 v[44:47], v[152:155], a[92:95], v[44:47]
  v_cvt_pk_bf16_f32 v217, v218, v219
  v_mul_f32 v224, v224, v96
  v_mfma_f32_16x16x32_bf16 v[40:43], v[156:159], a[92:95], v[40:43]
  v_mul_f32 v225, v225, v96
  v_mul_f32 v226, v226, v96
  v_mfma_f32_16x16x32_bf16 v[32:35], v[144:147], a[140:143], v[32:35]
  v_mul_f32 v227, v227, v96
  v_cvt_pk_bf16_f32 v218, v224, v225
  v_mfma_f32_16x16x32_bf16 v[64:67], v[148:151], a[140:143], v[64:67]
  v_cvt_pk_bf16_f32 v219, v226, v227
  v_mul_f32 v172, v172, v96
  v_mfma_f32_16x16x32_bf16 v[60:63], v[152:155], a[140:143], v[60:63]
  v_mul_f32 v173, v173, v96
  v_mul_f32 v174, v174, v96
  v_mfma_f32_16x16x32_bf16 v[52:55], v[156:159], a[140:143], v[52:55]
  v_mul_f32 v175, v175, v96
  v_cvt_pk_bf16_f32 v172, v172, v173
  v_mfma_f32_16x16x32_bf16 v[236:239], v[144:147], a[188:191], v[236:239]
  v_permlane16_swap_b32 v216, v218
  v_mfma_f32_16x16x32_bf16 v[244:247], v[148:151], a[188:191], v[244:247]
  v_permlane16_swap_b32 v217, v219
  v_mfma_f32_16x16x32_bf16 v[164:167], v[152:155], a[188:191], v[164:167]
  v_cvt_pk_bf16_f32 v173, v174, v175
  v_mul_f32 v252, v252, v96
  v_mfma_f32_16x16x32_bf16 v[36:39], v[156:159], a[188:191], v[36:39]
  v_mul_f32 v253, v253, v96
  v_mul_f32 v254, v254, v96
  v_mfma_f32_16x16x32_bf16 v[48:51], v[144:147], a[236:239], v[48:51]
  v_mul_f32 v255, v255, v96
  v_cvt_pk_bf16_f32 v174, v252, v253
  v_mfma_f32_16x16x32_bf16 v[56:59], v[148:151], a[236:239], v[56:59]
  v_cvt_pk_bf16_f32 v175, v254, v255
  v_mul_f32 v248, v248, v97
  v_mfma_f32_16x16x32_bf16 v[204:207], v[152:155], a[236:239], v[204:207]
  v_permlane16_swap_b32 v172, v174
  v_mfma_f32_16x16x32_bf16 v[80:83], v[156:159], a[236:239], v[80:83]
  v_permlane16_swap_b32 v173, v175
  v_mfma_f32_16x16x32_bf16 v[72:75], v[144:147], v[28:31], v[72:75]
  ds_read_b64_tr_b16 v[144:145], v160 offset:16384
  v_mov_b32 v224, v172
  v_mfma_f32_16x16x32_bf16 v[104:107], v[148:151], v[28:31], v[104:107]
  ds_read_b64_tr_b16 v[146:147], v160 offset:18432
  v_mov_b32_dpp v172, v216 row_ror:8 row_mask:0xf bank_mask:0x3
  v_mfma_f32_16x16x32_bf16 v[88:91], v[152:155], v[28:31], v[88:91]
  ds_read_b64_tr_b16 v[148:149], v161 offset:16384
  v_mov_b32_dpp v216, v224 row_ror:8 row_mask:0xf bank_mask:0xc
  v_mfma_f32_16x16x32_bf16 v[112:115], v[156:159], v[28:31], v[112:115]
  s_waitcnt lgkmcnt(9)
  ds_read_b64_tr_b16 v[150:151], v161 offset:18432
  v_mov_b32 v225, v173
  v_mfma_f32_16x16x32_bf16 v[120:123], v[128:131], a[0:3], 0
  s_waitcnt lgkmcnt(8)
  ds_read_b64_tr_b16 v[152:153], v162 offset:16384
  s_mov_b32 s45, 256
  v_mov_b32_dpp v173, v217 row_ror:8 row_mask:0xf bank_mask:0x3
  v_mfma_f32_16x16x32_bf16 v[212:215], v[132:135], a[0:3], 0
  s_waitcnt lgkmcnt(7)
  ds_read_b64_tr_b16 v[154:155], v162 offset:18432
  v_mov_b32_dpp v217, v225 row_ror:8 row_mask:0xf bank_mask:0xc
  v_mfma_f32_16x16x32_bf16 v[188:191], v[136:139], a[0:3], 0
  s_waitcnt lgkmcnt(6)
  ds_read_b64_tr_b16 v[156:157], v163 offset:16384
  v_mov_b32 v226, v174
  v_mfma_f32_16x16x32_bf16 v[228:231], v[140:143], a[0:3], 0
  ds_read_b64_tr_b16 v[158:159], v163 offset:18432
  v_mov_b32_dpp v174, v218 row_ror:8 row_mask:0xf bank_mask:0x3
  v_mfma_f32_16x16x32_bf16 v[200:203], v[128:131], a[48:51], 0
  v_mov_b32_dpp v218, v226 row_ror:8 row_mask:0xf bank_mask:0xc
  v_mov_b32 v227, v175
  v_mfma_f32_16x16x32_bf16 v[196:199], v[132:135], a[48:51], 0
  v_mov_b32_dpp v175, v219 row_ror:8 row_mask:0xf bank_mask:0x3
  v_mov_b32_dpp v219, v227 row_ror:8 row_mask:0xf bank_mask:0xc
  v_mfma_f32_16x16x32_bf16 v[176:179], v[136:139], a[48:51], 0
  buffer_store_dwordx4 v[216:219], v169, s[20:23], s45 offen nt
  v_mul_f32 v249, v249, v97
  v_mul_f32 v250, v250, v97
  v_mfma_f32_16x16x32_bf16 v[68:71], v[140:143], a[48:51], 0
  v_mul_f32 v251, v251, v97
  v_cvt_pk_bf16_f32 v248, v248, v249
  v_mfma_f32_16x16x32_bf16 v[76:79], v[128:131], a[96:99], 0
  v_cvt_pk_bf16_f32 v249, v250, v251
  v_mul_f32 v240, v240, v97
  v_mfma_f32_16x16x32_bf16 v[84:87], v[132:135], a[96:99], 0
  v_mul_f32 v241, v241, v97
  v_mul_f32 v242, v242, v97
  v_mfma_f32_16x16x32_bf16 v[92:95], v[136:139], a[96:99], 0
  v_mul_f32 v243, v243, v97
  v_cvt_pk_bf16_f32 v250, v240, v241
  v_mfma_f32_16x16x32_bf16 v[108:111], v[140:143], a[96:99], 0
  v_cvt_pk_bf16_f32 v251, v242, v243
  v_mul_f32 v44, v44, v97
  v_mfma_f32_16x16x32_bf16 v[124:127], v[128:131], a[144:147], 0
  ds_read_b64_tr_b16 v[128:129], v160 offset:20480
  v_mul_f32 v45, v45, v97
  v_mfma_f32_16x16x32_bf16 v[192:195], v[132:135], a[144:147], 0
  ds_read_b64_tr_b16 v[130:131], v160 offset:22528
  v_mul_f32 v46, v46, v97
  v_mfma_f32_16x16x32_bf16 v[180:183], v[136:139], a[144:147], 0
  ds_read_b64_tr_b16 v[132:133], v161 offset:20480
  v_mul_f32 v47, v47, v97
  v_mfma_f32_16x16x32_bf16 v[208:211], v[140:143], a[144:147], 0
  s_waitcnt lgkmcnt(9)
  ds_read_b64_tr_b16 v[134:135], v161 offset:22528
  s_mov_b32 s46, 4352
  v_cvt_pk_bf16_f32 v44, v44, v45
  v_mfma_f32_16x16x32_bf16 v[120:123], v[144:147], a[4:7], v[120:123]
  s_waitcnt lgkmcnt(8)
  ds_read_b64_tr_b16 v[136:137], v162 offset:20480
  v_cvt_pk_bf16_f32 v45, v46, v47
  v_mfma_f32_16x16x32_bf16 v[212:215], v[148:151], a[4:7], v[212:215]
  s_waitcnt lgkmcnt(7)
  ds_read_b64_tr_b16 v[138:139], v162 offset:22528
  v_mul_f32 v40, v40, v97
  v_mfma_f32_16x16x32_bf16 v[188:191], v[152:155], a[4:7], v[188:191]
  s_waitcnt lgkmcnt(6)
  ds_read_b64_tr_b16 v[140:141], v163 offset:20480
  v_mul_f32 v41, v41, v97
  v_mfma_f32_16x16x32_bf16 v[228:231], v[156:159], a[4:7], v[228:231]
  buffer_store_dwordx4 v[172:175], v169, s[20:23], s46 offen nt
  v_permlane16_swap_b32 v248, v250
  v_mfma_f32_16x16x32_bf16 v[200:203], v[144:147], a[52:55], v[200:203]
  ds_read_b64_tr_b16 v[142:143], v163 offset:22528
  v_mul_f32 v42, v42, v97
  v_mfma_f32_16x16x32_bf16 v[196:199], v[148:151], a[52:55], v[196:199]
  v_permlane16_swap_b32 v249, v251
  v_mfma_f32_16x16x32_bf16 v[176:179], v[152:155], a[52:55], v[176:179]
  v_mul_f32 v43, v43, v97
  v_cvt_pk_bf16_f32 v46, v40, v41
  v_mfma_f32_16x16x32_bf16 v[68:71], v[156:159], a[52:55], v[68:71]
  v_cvt_pk_bf16_f32 v47, v42, v43
  v_mul_f32 v32, v32, v98
  v_mfma_f32_16x16x32_bf16 v[76:79], v[144:147], a[100:103], v[76:79]
  v_permlane16_swap_b32 v44, v46
  v_mfma_f32_16x16x32_bf16 v[84:87], v[148:151], a[100:103], v[84:87]
  v_permlane16_swap_b32 v45, v47
  v_mfma_f32_16x16x32_bf16 v[92:95], v[152:155], a[100:103], v[92:95]
  v_mov_b32 v240, v44
  v_mov_b32_dpp v44, v248 row_ror:8 row_mask:0xf bank_mask:0x3
  v_mfma_f32_16x16x32_bf16 v[108:111], v[156:159], a[100:103], v[108:111]
  v_mov_b32_dpp v248, v240 row_ror:8 row_mask:0xf bank_mask:0xc
  v_mov_b32 v241, v45
  v_mfma_f32_16x16x32_bf16 v[124:127], v[144:147], a[148:151], v[124:127]
  ds_read_b64_tr_b16 v[144:145], v160 offset:25600
  v_mov_b32_dpp v45, v249 row_ror:8 row_mask:0xf bank_mask:0x3
  v_mfma_f32_16x16x32_bf16 v[192:195], v[148:151], a[148:151], v[192:195]
  ds_read_b64_tr_b16 v[146:147], v160 offset:27648
  v_mov_b32_dpp v249, v241 row_ror:8 row_mask:0xf bank_mask:0xc
  v_mfma_f32_16x16x32_bf16 v[180:183], v[152:155], a[148:151], v[180:183]
  ds_read_b64_tr_b16 v[148:149], v161 offset:25600
  s_mov_b32 s47, 33024
  v_mov_b32 v242, v46
  v_mfma_f32_16x16x32_bf16 v[208:211], v[156:159], a[148:151], v[208:211]
  s_waitcnt lgkmcnt(9)
  ds_read_b64_tr_b16 v[150:151], v161 offset:27648
  v_mov_b32_dpp v46, v250 row_ror:8 row_mask:0xf bank_mask:0x3
  v_mfma_f32_16x16x32_bf16 v[120:123], v[128:131], a[8:11], v[120:123]
  s_waitcnt lgkmcnt(8)
  ds_read_b64_tr_b16 v[152:153], v162 offset:25600
  v_mov_b32_dpp v250, v242 row_ror:8 row_mask:0xf bank_mask:0xc
  v_mfma_f32_16x16x32_bf16 v[212:215], v[132:135], a[8:11], v[212:215]
  s_waitcnt lgkmcnt(7)
  ds_read_b64_tr_b16 v[154:155], v162 offset:27648
  v_mov_b32 v243, v47
  v_mfma_f32_16x16x32_bf16 v[188:191], v[136:139], a[8:11], v[188:191]
  s_waitcnt lgkmcnt(6)
  ds_read_b64_tr_b16 v[156:157], v163 offset:25600
  v_mov_b32_dpp v47, v251 row_ror:8 row_mask:0xf bank_mask:0x3
  v_mfma_f32_16x16x32_bf16 v[228:231], v[140:143], a[8:11], v[228:231]
  ds_read_b64_tr_b16 v[158:159], v163 offset:27648
  v_mov_b32_dpp v251, v243 row_ror:8 row_mask:0xf bank_mask:0xc
  v_mfma_f32_16x16x32_bf16 v[200:203], v[128:131], a[56:59], v[200:203]
  buffer_store_dwordx4 v[248:251], v169, s[20:23], s47 offen nt
  v_mul_f32 v33, v33, v98
  v_mul_f32 v34, v34, v98
  v_mfma_f32_16x16x32_bf16 v[196:199], v[132:135], a[56:59], v[196:199]
  v_mul_f32 v35, v35, v98
  v_cvt_pk_bf16_f32 v32, v32, v33
  v_mfma_f32_16x16x32_bf16 v[176:179], v[136:139], a[56:59], v[176:179]
  v_cvt_pk_bf16_f32 v33, v34, v35
  v_mul_f32 v64, v64, v98
  v_mfma_f32_16x16x32_bf16 v[68:71], v[140:143], a[56:59], v[68:71]
  v_mul_f32 v65, v65, v98
  v_subrev_u32 v160, 107520, v160
  v_mfma_f32_16x16x32_bf16 v[76:79], v[128:131], a[104:107], v[76:79]
  v_subrev_u32 v161, 107520, v161
  v_subrev_u32 v162, 107520, v162
  v_mfma_f32_16x16x32_bf16 v[84:87], v[132:135], a[104:107], v[84:87]
  v_subrev_u32 v163, 107520, v163
  v_mul_f32 v66, v66, v98
  v_mfma_f32_16x16x32_bf16 v[92:95], v[136:139], a[104:107], v[92:95]
  v_mul_f32 v67, v67, v98
  v_cvt_pk_bf16_f32 v34, v64, v65
  v_mfma_f32_16x16x32_bf16 v[108:111], v[140:143], a[104:107], v[108:111]
  v_cvt_pk_bf16_f32 v35, v66, v67
  v_mul_f32 v60, v60, v98
  v_mfma_f32_16x16x32_bf16 v[124:127], v[128:131], a[152:155], v[124:127]
  ds_read_b64_tr_b16 v[128:129], v160 offset:0
  v_mul_f32 v61, v61, v98
  v_mfma_f32_16x16x32_bf16 v[192:195], v[132:135], a[152:155], v[192:195]
  ds_read_b64_tr_b16 v[130:131], v160 offset:2048
  s_mov_b32 s32, 37120
  v_mul_f32 v62, v62, v98
  v_mfma_f32_16x16x32_bf16 v[180:183], v[136:139], a[152:155], v[180:183]
  ds_read_b64_tr_b16 v[132:133], v161 offset:0
  v_mul_f32 v63, v63, v98
  v_mfma_f32_16x16x32_bf16 v[208:211], v[140:143], a[152:155], v[208:211]
  s_waitcnt lgkmcnt(9)
  ds_read_b64_tr_b16 v[134:135], v161 offset:2048
  v_cvt_pk_bf16_f32 v60, v60, v61
  v_mfma_f32_16x16x32_bf16 v[120:123], v[144:147], a[12:15], v[120:123]
  s_waitcnt lgkmcnt(8)
  ds_read_b64_tr_b16 v[136:137], v162 offset:0
  v_cvt_pk_bf16_f32 v61, v62, v63
  v_mfma_f32_16x16x32_bf16 v[212:215], v[148:151], a[12:15], v[212:215]
  s_waitcnt lgkmcnt(7)
  buffer_store_dwordx4 v[44:47], v169, s[20:23], s32 offen nt
  v_permlane16_swap_b32 v32, v34
  v_mfma_f32_16x16x32_bf16 v[188:191], v[152:155], a[12:15], v[188:191]
  s_waitcnt lgkmcnt(5)
  ds_read_b64_tr_b16 v[138:139], v162 offset:2048
  v_mul_f32 v52, v52, v98
  v_mfma_f32_16x16x32_bf16 v[228:231], v[156:159], a[12:15], v[228:231]
  ds_read_b64_tr_b16 v[140:141], v163 offset:0
  v_mul_f32 v53, v53, v98
  v_mfma_f32_16x16x32_bf16 v[200:203], v[144:147], a[60:63], v[200:203]
  ds_read_b64_tr_b16 v[142:143], v163 offset:2048
  v_mul_f32 v54, v54, v98
  v_mfma_f32_16x16x32_bf16 v[196:199], v[148:151], a[60:63], v[196:199]
  v_permlane16_swap_b32 v33, v35
  v_mfma_f32_16x16x32_bf16 v[176:179], v[152:155], a[60:63], v[176:179]
  v_mul_f32 v55, v55, v98
  v_cvt_pk_bf16_f32 v62, v52, v53
  v_mfma_f32_16x16x32_bf16 v[68:71], v[156:159], a[60:63], v[68:71]
  v_cvt_pk_bf16_f32 v63, v54, v55
  v_mul_f32 v236, v236, v99
  v_mfma_f32_16x16x32_bf16 v[76:79], v[144:147], a[108:111], v[76:79]
  v_permlane16_swap_b32 v60, v62
  v_mfma_f32_16x16x32_bf16 v[84:87], v[148:151], a[108:111], v[84:87]
  v_permlane16_swap_b32 v61, v63
  v_mfma_f32_16x16x32_bf16 v[92:95], v[152:155], a[108:111], v[92:95]
  v_mov_b32 v64, v60
  v_mov_b32_dpp v60, v32 row_ror:8 row_mask:0xf bank_mask:0x3
  v_mfma_f32_16x16x32_bf16 v[108:111], v[156:159], a[108:111], v[108:111]
  v_mov_b32_dpp v32, v64 row_ror:8 row_mask:0xf bank_mask:0xc
  v_mov_b32 v65, v61
  v_mfma_f32_16x16x32_bf16 v[124:127], v[144:147], a[156:159], v[124:127]
  ds_read_b64_tr_b16 v[144:145], v160 offset:4096
  s_mov_b32 s33, 65792
  v_mov_b32_dpp v61, v33 row_ror:8 row_mask:0xf bank_mask:0x3
  v_mfma_f32_16x16x32_bf16 v[192:195], v[148:151], a[156:159], v[192:195]
  ds_read_b64_tr_b16 v[146:147], v160 offset:6144
  v_mov_b32_dpp v33, v65 row_ror:8 row_mask:0xf bank_mask:0xc
  v_mfma_f32_16x16x32_bf16 v[180:183], v[152:155], a[156:159], v[180:183]
  ds_read_b64_tr_b16 v[148:149], v161 offset:4096
  v_mov_b32 v66, v62
  v_mfma_f32_16x16x32_bf16 v[208:211], v[156:159], a[156:159], v[208:211]
  s_waitcnt lgkmcnt(9)
  ds_read_b64_tr_b16 v[150:151], v161 offset:6144
  v_mov_b32_dpp v62, v34 row_ror:8 row_mask:0xf bank_mask:0x3
  v_mfma_f32_16x16x32_bf16 v[120:123], v[128:131], a[16:19], v[120:123]
  s_waitcnt lgkmcnt(8)
  ds_read_b64_tr_b16 v[152:153], v162 offset:4096
  v_mov_b32_dpp v34, v66 row_ror:8 row_mask:0xf bank_mask:0xc
  v_mfma_f32_16x16x32_bf16 v[212:215], v[132:135], a[16:19], v[212:215]
  s_waitcnt lgkmcnt(7)
  ds_read_b64_tr_b16 v[154:155], v162 offset:6144
  v_mov_b32 v67, v63
  v_mfma_f32_16x16x32_bf16 v[188:191], v[136:139], a[16:19], v[188:191]
  s_waitcnt lgkmcnt(6)
  ds_read_b64_tr_b16 v[156:157], v163 offset:4096
  v_mov_b32_dpp v63, v35 row_ror:8 row_mask:0xf bank_mask:0x3
  v_mfma_f32_16x16x32_bf16 v[228:231], v[140:143], a[16:19], v[228:231]
  ds_read_b64_tr_b16 v[158:159], v163 offset:6144
  v_mov_b32_dpp v35, v67 row_ror:8 row_mask:0xf bank_mask:0xc
  v_mfma_f32_16x16x32_bf16 v[200:203], v[128:131], a[64:67], v[200:203]
  buffer_store_dwordx4 v[32:35], v169, s[20:23], s33 offen nt
  v_mul_f32 v237, v237, v99
  v_mul_f32 v238, v238, v99
  v_mfma_f32_16x16x32_bf16 v[196:199], v[132:135], a[64:67], v[196:199]
  v_mul_f32 v239, v239, v99
  v_cvt_pk_bf16_f32 v236, v236, v237
  v_mfma_f32_16x16x32_bf16 v[176:179], v[136:139], a[64:67], v[176:179]
  v_cvt_pk_bf16_f32 v237, v238, v239
  v_mul_f32 v244, v244, v99
  v_mfma_f32_16x16x32_bf16 v[68:71], v[140:143], a[64:67], v[68:71]
  v_mul_f32 v245, v245, v99
  v_mul_f32 v246, v246, v99
  v_mfma_f32_16x16x32_bf16 v[76:79], v[128:131], a[112:115], v[76:79]
  v_mul_f32 v247, v247, v99
  v_cvt_pk_bf16_f32 v238, v244, v245
  v_mfma_f32_16x16x32_bf16 v[84:87], v[132:135], a[112:115], v[84:87]
  v_cvt_pk_bf16_f32 v239, v246, v247
  v_mul_f32 v164, v164, v99
  v_mfma_f32_16x16x32_bf16 v[92:95], v[136:139], a[112:115], v[92:95]
  v_mul_f32 v165, v165, v99
  v_mul_f32 v166, v166, v99
  v_mfma_f32_16x16x32_bf16 v[108:111], v[140:143], a[112:115], v[108:111]
  v_mul_f32 v167, v167, v99
  v_cvt_pk_bf16_f32 v164, v164, v165
  v_mfma_f32_16x16x32_bf16 v[124:127], v[128:131], a[160:163], v[124:127]
  ds_read_b64_tr_b16 v[128:129], v160 offset:8448
  s_mov_b32 s34, 69888
  v_cvt_pk_bf16_f32 v165, v166, v167
  v_mfma_f32_16x16x32_bf16 v[192:195], v[132:135], a[160:163], v[192:195]
  ds_read_b64_tr_b16 v[130:131], v160 offset:10496
  v_mul_f32 v36, v36, v99
  v_mfma_f32_16x16x32_bf16 v[180:183], v[136:139], a[160:163], v[180:183]
  ds_read_b64_tr_b16 v[132:133], v161 offset:8448
  v_mul_f32 v37, v37, v99
  v_mfma_f32_16x16x32_bf16 v[208:211], v[140:143], a[160:163], v[208:211]
  s_waitcnt lgkmcnt(9)
  ds_read_b64_tr_b16 v[134:135], v161 offset:10496
  v_mul_f32 v38, v38, v99
  v_mfma_f32_16x16x32_bf16 v[120:123], v[144:147], a[20:23], v[120:123]
  s_waitcnt lgkmcnt(8)
  buffer_store_dwordx4 v[60:63], v169, s[20:23], s34 offen nt
  v_permlane16_swap_b32 v236, v238
  v_mfma_f32_16x16x32_bf16 v[212:215], v[148:151], a[20:23], v[212:215]
  s_waitcnt lgkmcnt(6)
  ds_read_b64_tr_b16 v[136:137], v162 offset:8448
  v_mul_f32 v39, v39, v99
  v_mfma_f32_16x16x32_bf16 v[188:191], v[152:155], a[20:23], v[188:191]
  s_waitcnt lgkmcnt(5)
  ds_read_b64_tr_b16 v[138:139], v162 offset:10496
  v_cvt_pk_bf16_f32 v166, v36, v37
  v_mfma_f32_16x16x32_bf16 v[228:231], v[156:159], a[20:23], v[228:231]
  ds_read_b64_tr_b16 v[140:141], v163 offset:8448
  v_cvt_pk_bf16_f32 v167, v38, v39
  v_mfma_f32_16x16x32_bf16 v[200:203], v[144:147], a[68:71], v[200:203]
  ds_read_b64_tr_b16 v[142:143], v163 offset:10496
  v_mul_f32 v48, v48, v100
  v_mfma_f32_16x16x32_bf16 v[196:199], v[148:151], a[68:71], v[196:199]
  v_permlane16_swap_b32 v237, v239
  v_mfma_f32_16x16x32_bf16 v[176:179], v[152:155], a[68:71], v[176:179]
  v_permlane16_swap_b32 v164, v166
  v_mfma_f32_16x16x32_bf16 v[68:71], v[156:159], a[68:71], v[68:71]
  v_permlane16_swap_b32 v165, v167
  v_mfma_f32_16x16x32_bf16 v[76:79], v[144:147], a[116:119], v[76:79]
  v_mov_b32 v244, v164
  v_mov_b32_dpp v164, v236 row_ror:8 row_mask:0xf bank_mask:0x3
  v_mfma_f32_16x16x32_bf16 v[84:87], v[148:151], a[116:119], v[84:87]
  v_mov_b32_dpp v236, v244 row_ror:8 row_mask:0xf bank_mask:0xc
  v_mov_b32 v245, v165
  v_mfma_f32_16x16x32_bf16 v[92:95], v[152:155], a[116:119], v[92:95]
  v_mov_b32_dpp v165, v237 row_ror:8 row_mask:0xf bank_mask:0x3
  v_mov_b32_dpp v237, v245 row_ror:8 row_mask:0xf bank_mask:0xc
  v_mfma_f32_16x16x32_bf16 v[108:111], v[156:159], a[116:119], v[108:111]
  s_mov_b32 s35, 98560
  v_mov_b32 v246, v166
  v_mov_b32_dpp v166, v238 row_ror:8 row_mask:0xf bank_mask:0x3
  v_mfma_f32_16x16x32_bf16 v[124:127], v[144:147], a[164:167], v[124:127]
  ds_read_b64_tr_b16 v[144:145], v160 offset:12544
  v_mov_b32_dpp v238, v246 row_ror:8 row_mask:0xf bank_mask:0xc
  v_mfma_f32_16x16x32_bf16 v[192:195], v[148:151], a[164:167], v[192:195]
  ds_read_b64_tr_b16 v[146:147], v160 offset:14592
  v_mov_b32 v247, v167
  v_mfma_f32_16x16x32_bf16 v[180:183], v[152:155], a[164:167], v[180:183]
  ds_read_b64_tr_b16 v[148:149], v161 offset:12544
  v_mov_b32_dpp v167, v239 row_ror:8 row_mask:0xf bank_mask:0x3
  v_mfma_f32_16x16x32_bf16 v[208:211], v[156:159], a[164:167], v[208:211]
  s_waitcnt lgkmcnt(9)
  ds_read_b64_tr_b16 v[150:151], v161 offset:14592
  v_mov_b32_dpp v239, v247 row_ror:8 row_mask:0xf bank_mask:0xc
  v_mfma_f32_16x16x32_bf16 v[120:123], v[128:131], a[24:27], v[120:123]
  s_waitcnt lgkmcnt(8)
  buffer_store_dwordx4 v[236:239], v169, s[20:23], s35 offen nt
  v_mul_f32 v49, v49, v100
  v_mul_f32 v50, v50, v100
  v_mfma_f32_16x16x32_bf16 v[212:215], v[132:135], a[24:27], v[212:215]
  s_waitcnt lgkmcnt(6)
  ds_read_b64_tr_b16 v[152:153], v162 offset:12544
  v_mul_f32 v51, v51, v100
  v_mfma_f32_16x16x32_bf16 v[188:191], v[136:139], a[24:27], v[188:191]
  s_waitcnt lgkmcnt(5)
  ds_read_b64_tr_b16 v[154:155], v162 offset:14592
  v_cvt_pk_bf16_f32 v48, v48, v49
  v_mfma_f32_16x16x32_bf16 v[228:231], v[140:143], a[24:27], v[228:231]
  ds_read_b64_tr_b16 v[156:157], v163 offset:12544
  v_cvt_pk_bf16_f32 v49, v50, v51
  v_mfma_f32_16x16x32_bf16 v[200:203], v[128:131], a[72:75], v[200:203]
  ds_read_b64_tr_b16 v[158:159], v163 offset:14592
  v_mul_f32 v56, v56, v100
  v_mfma_f32_16x16x32_bf16 v[196:199], v[132:135], a[72:75], v[196:199]
  v_mul_f32 v57, v57, v100
  v_mul_f32 v58, v58, v100
  v_mfma_f32_16x16x32_bf16 v[176:179], v[136:139], a[72:75], v[176:179]
  v_mul_f32 v59, v59, v100
  v_cvt_pk_bf16_f32 v50, v56, v57
  v_mfma_f32_16x16x32_bf16 v[68:71], v[140:143], a[72:75], v[68:71]
  v_cvt_pk_bf16_f32 v51, v58, v59
  v_mul_f32 v204, v204, v100
  v_mfma_f32_16x16x32_bf16 v[76:79], v[128:131], a[120:123], v[76:79]
  v_mul_f32 v205, v205, v100
  v_mul_f32 v206, v206, v100
  v_mfma_f32_16x16x32_bf16 v[84:87], v[132:135], a[120:123], v[84:87]
  v_mul_f32 v207, v207, v100
  v_cvt_pk_bf16_f32 v204, v204, v205
  v_mfma_f32_16x16x32_bf16 v[92:95], v[136:139], a[120:123], v[92:95]
  s_mov_b32 s36, 102656
  v_permlane16_swap_b32 v48, v50
  v_mfma_f32_16x16x32_bf16 v[108:111], v[140:143], a[120:123], v[108:111]
  v_permlane16_swap_b32 v49, v51
  v_mfma_f32_16x16x32_bf16 v[124:127], v[128:131], a[168:171], v[124:127]
  ds_read_b64_tr_b16 v[128:129], v160 offset:16896
  v_cvt_pk_bf16_f32 v205, v206, v207
  v_mfma_f32_16x16x32_bf16 v[192:195], v[132:135], a[168:171], v[192:195]
  ds_read_b64_tr_b16 v[130:131], v160 offset:18944
  v_mul_f32 v80, v80, v100
  v_mfma_f32_16x16x32_bf16 v[180:183], v[136:139], a[168:171], v[180:183]
  buffer_store_dwordx4 v[164:167], v169, s[20:23], s36 offen nt
  v_mul_f32 v81, v81, v100
  v_mul_f32 v82, v82, v100
  v_mfma_f32_16x16x32_bf16 v[208:211], v[140:143], a[168:171], v[208:211]
  s_waitcnt lgkmcnt(8)
  ds_read_b64_tr_b16 v[132:133], v161 offset:16896
  v_mul_f32 v83, v83, v100
  v_mfma_f32_16x16x32_bf16 v[120:123], v[144:147], a[28:31], v[120:123]
  s_waitcnt lgkmcnt(7)
  ds_read_b64_tr_b16 v[134:135], v161 offset:18944
  v_cvt_pk_bf16_f32 v206, v80, v81
  v_mfma_f32_16x16x32_bf16 v[212:215], v[148:151], a[28:31], v[212:215]
  s_waitcnt lgkmcnt(6)
  ds_read_b64_tr_b16 v[136:137], v162 offset:16896
  v_cvt_pk_bf16_f32 v207, v82, v83
  v_mfma_f32_16x16x32_bf16 v[188:191], v[152:155], a[28:31], v[188:191]
  s_waitcnt lgkmcnt(5)
  ds_read_b64_tr_b16 v[138:139], v162 offset:18944
  v_mul_f32 v72, v72, v101
  v_mfma_f32_16x16x32_bf16 v[228:231], v[156:159], a[28:31], v[228:231]
  ds_read_b64_tr_b16 v[140:141], v163 offset:16896
  v_mul_f32 v73, v73, v101
  v_mfma_f32_16x16x32_bf16 v[200:203], v[144:147], a[76:79], v[200:203]
  ds_read_b64_tr_b16 v[142:143], v163 offset:18944
  v_mul_f32 v74, v74, v101
  v_mfma_f32_16x16x32_bf16 v[196:199], v[148:151], a[76:79], v[196:199]
  v_permlane16_swap_b32 v204, v206
  v_mfma_f32_16x16x32_bf16 v[176:179], v[152:155], a[76:79], v[176:179]
  v_permlane16_swap_b32 v205, v207
  v_mfma_f32_16x16x32_bf16 v[68:71], v[156:159], a[76:79], v[68:71]
  v_mov_b32 v56, v204
  v_mov_b32_dpp v204, v48 row_ror:8 row_mask:0xf bank_mask:0x3
  v_mfma_f32_16x16x32_bf16 v[76:79], v[144:147], a[124:127], v[76:79]
  v_mov_b32_dpp v48, v56 row_ror:8 row_mask:0xf bank_mask:0xc
  v_mov_b32 v57, v205
  v_mfma_f32_16x16x32_bf16 v[84:87], v[148:151], a[124:127], v[84:87]
  s_mov_b32 s37, 131328
  v_mov_b32_dpp v205, v49 row_ror:8 row_mask:0xf bank_mask:0x3
  v_mov_b32_dpp v49, v57 row_ror:8 row_mask:0xf bank_mask:0xc
  v_mfma_f32_16x16x32_bf16 v[92:95], v[152:155], a[124:127], v[92:95]
  v_mov_b32 v58, v206
  v_mov_b32_dpp v206, v50 row_ror:8 row_mask:0xf bank_mask:0x3
  v_mfma_f32_16x16x32_bf16 v[108:111], v[156:159], a[124:127], v[108:111]
  v_mov_b32_dpp v50, v58 row_ror:8 row_mask:0xf bank_mask:0xc
  v_mov_b32 v59, v207
  v_mfma_f32_16x16x32_bf16 v[124:127], v[144:147], a[172:175], v[124:127]
  ds_read_b64_tr_b16 v[144:145], v160 offset:20992
  v_mov_b32_dpp v207, v51 row_ror:8 row_mask:0xf bank_mask:0x3
  v_mfma_f32_16x16x32_bf16 v[192:195], v[148:151], a[172:175], v[192:195]
  ds_read_b64_tr_b16 v[146:147], v160 offset:23040
  v_mov_b32_dpp v51, v59 row_ror:8 row_mask:0xf bank_mask:0xc
  v_mfma_f32_16x16x32_bf16 v[180:183], v[152:155], a[172:175], v[180:183]
  buffer_store_dwordx4 v[48:51], v169, s[20:23], s37 offen nt
  v_mul_f32 v75, v75, v101
  v_cvt_pk_bf16_f32 v72, v72, v73
  v_mfma_f32_16x16x32_bf16 v[208:211], v[156:159], a[172:175], v[208:211]
  s_waitcnt lgkmcnt(8)
  ds_read_b64_tr_b16 v[148:149], v161 offset:20992
  v_cvt_pk_bf16_f32 v73, v74, v75
  v_mfma_f32_16x16x32_bf16 v[120:123], v[128:131], a[32:35], v[120:123]
  s_waitcnt lgkmcnt(7)
  ds_read_b64_tr_b16 v[150:151], v161 offset:23040
  v_mul_f32 v104, v104, v101
  v_mfma_f32_16x16x32_bf16 v[212:215], v[132:135], a[32:35], v[212:215]
  s_waitcnt lgkmcnt(6)
  ds_read_b64_tr_b16 v[152:153], v162 offset:20992
  v_mul_f32 v105, v105, v101
  v_mfma_f32_16x16x32_bf16 v[188:191], v[136:139], a[32:35], v[188:191]
  s_waitcnt lgkmcnt(5)
  ds_read_b64_tr_b16 v[154:155], v162 offset:23040
  v_mul_f32 v106, v106, v101
  v_mfma_f32_16x16x32_bf16 v[228:231], v[140:143], a[32:35], v[228:231]
  ds_read_b64_tr_b16 v[156:157], v163 offset:20992
  v_mul_f32 v107, v107, v101
  v_mfma_f32_16x16x32_bf16 v[200:203], v[128:131], a[80:83], v[200:203]
  ds_read_b64_tr_b16 v[158:159], v163 offset:23040
  v_cvt_pk_bf16_f32 v74, v104, v105
  v_mfma_f32_16x16x32_bf16 v[196:199], v[132:135], a[80:83], v[196:199]
  v_cvt_pk_bf16_f32 v75, v106, v107
  v_mul_f32 v88, v88, v101
  v_mfma_f32_16x16x32_bf16 v[176:179], v[136:139], a[80:83], v[176:179]
  v_mul_f32 v89, v89, v101
  v_mul_f32 v90, v90, v101
  v_mfma_f32_16x16x32_bf16 v[68:71], v[140:143], a[80:83], v[68:71]
  v_mul_f32 v91, v91, v101
  v_cvt_pk_bf16_f32 v88, v88, v89
  v_mfma_f32_16x16x32_bf16 v[76:79], v[128:131], a[128:131], v[76:79]
  s_mov_b32 s38, 135424
  v_permlane16_swap_b32 v72, v74
  v_mfma_f32_16x16x32_bf16 v[84:87], v[132:135], a[128:131], v[84:87]
  v_permlane16_swap_b32 v73, v75
  v_mfma_f32_16x16x32_bf16 v[92:95], v[136:139], a[128:131], v[92:95]
  v_cvt_pk_bf16_f32 v89, v90, v91
  v_mul_f32 v112, v112, v101
  v_mfma_f32_16x16x32_bf16 v[108:111], v[140:143], a[128:131], v[108:111]
  v_mul_f32 v113, v113, v101
  v_mul_f32 v114, v114, v101
  v_mfma_f32_16x16x32_bf16 v[124:127], v[128:131], a[176:179], v[124:127]
  buffer_store_dwordx4 v[204:207], v169, s[20:23], s38 offen nt
  v_mul_f32 v115, v115, v101
  v_cvt_pk_bf16_f32 v90, v112, v113
  v_mfma_f32_16x16x32_bf16 v[192:195], v[132:135], a[176:179], v[192:195]
  ds_read_b64_tr_b16 v[128:129], v160 offset:25344
  v_cvt_pk_bf16_f32 v91, v114, v115
  v_mfma_f32_16x16x32_bf16 v[180:183], v[136:139], a[176:179], v[180:183]
  ds_read_b64_tr_b16 v[130:131], v160 offset:27392
  v_mfma_f32_16x16x32_bf16 v[208:211], v[140:143], a[176:179], v[208:211]
  s_waitcnt lgkmcnt(8)
  ds_read_b64_tr_b16 v[132:133], v161 offset:25344
  v_mfma_f32_16x16x32_bf16 v[120:123], v[144:147], a[36:39], v[120:123]
  s_waitcnt lgkmcnt(7)
  ds_read_b64_tr_b16 v[134:135], v161 offset:27392
  v_mfma_f32_16x16x32_bf16 v[212:215], v[148:151], a[36:39], v[212:215]
  s_waitcnt lgkmcnt(6)
  ds_read_b64_tr_b16 v[136:137], v162 offset:25344
  v_mfma_f32_16x16x32_bf16 v[188:191], v[152:155], a[36:39], v[188:191]
  s_waitcnt lgkmcnt(5)
  ds_read_b64_tr_b16 v[138:139], v162 offset:27392
  v_mfma_f32_16x16x32_bf16 v[228:231], v[156:159], a[36:39], v[228:231]
  ds_read_b64_tr_b16 v[140:141], v163 offset:25344
  v_mfma_f32_16x16x32_bf16 v[200:203], v[144:147], a[84:87], v[200:203]
  ds_read_b64_tr_b16 v[142:143], v163 offset:27392
  v_mfma_f32_16x16x32_bf16 v[196:199], v[148:151], a[84:87], v[196:199]
  v_permlane16_swap_b32 v88, v90
  v_mfma_f32_16x16x32_bf16 v[176:179], v[152:155], a[84:87], v[176:179]
  v_permlane16_swap_b32 v89, v91
  v_mfma_f32_16x16x32_bf16 v[68:71], v[156:159], a[84:87], v[68:71]
  v_mov_b32 v104, v88
  v_mov_b32_dpp v88, v72 row_ror:8 row_mask:0xf bank_mask:0x3
  v_mfma_f32_16x16x32_bf16 v[76:79], v[144:147], a[132:135], v[76:79]
  s_mov_b32 s39, 164096
  v_mov_b32_dpp v72, v104 row_ror:8 row_mask:0xf bank_mask:0xc
  v_mov_b32 v105, v89
  v_mfma_f32_16x16x32_bf16 v[84:87], v[148:151], a[132:135], v[84:87]
  v_mov_b32_dpp v89, v73 row_ror:8 row_mask:0xf bank_mask:0x3
  v_mov_b32_dpp v73, v105 row_ror:8 row_mask:0xf bank_mask:0xc
  v_mfma_f32_16x16x32_bf16 v[92:95], v[152:155], a[132:135], v[92:95]
  v_mov_b32 v106, v90
  v_mov_b32_dpp v90, v74 row_ror:8 row_mask:0xf bank_mask:0x3
  v_mfma_f32_16x16x32_bf16 v[108:111], v[156:159], a[132:135], v[108:111]
  v_mov_b32_dpp v74, v106 row_ror:8 row_mask:0xf bank_mask:0xc
  v_mov_b32 v107, v91
  v_mfma_f32_16x16x32_bf16 v[124:127], v[144:147], a[180:183], v[124:127]
  ds_read_b64_tr_b16 v[144:145], v160 offset:29440
  v_mov_b32_dpp v91, v75 row_ror:8 row_mask:0xf bank_mask:0x3
  v_mfma_f32_16x16x32_bf16 v[192:195], v[148:151], a[180:183], v[192:195]
  ds_read_b64_tr_b16 v[146:147], v160 offset:31488
  v_mov_b32_dpp v75, v107 row_ror:8 row_mask:0xf bank_mask:0xc
  v_mfma_f32_16x16x32_bf16 v[180:183], v[152:155], a[180:183], v[180:183]
  buffer_store_dwordx4 v[72:75], v169, s[20:23], s39 offen nt
  v_add_u32 v160, 119808, v160
  v_mfma_f32_16x16x32_bf16 v[208:211], v[156:159], a[180:183], v[208:211]
  s_waitcnt lgkmcnt(8)
  ds_read_b64_tr_b16 v[148:149], v161 offset:29440
  v_mfma_f32_16x16x32_bf16 v[120:123], v[128:131], a[40:43], v[120:123]
  s_waitcnt lgkmcnt(7)
  ds_read_b64_tr_b16 v[150:151], v161 offset:31488
  v_add_u32 v161, 119808, v161
  v_mfma_f32_16x16x32_bf16 v[212:215], v[132:135], a[40:43], v[212:215]
  s_waitcnt lgkmcnt(6)
  ds_read_b64_tr_b16 v[152:153], v162 offset:29440
  v_mfma_f32_16x16x32_bf16 v[188:191], v[136:139], a[40:43], v[188:191]
  s_waitcnt lgkmcnt(5)
  ds_read_b64_tr_b16 v[154:155], v162 offset:31488
  v_add_u32 v162, 119808, v162
  v_mfma_f32_16x16x32_bf16 v[228:231], v[140:143], a[40:43], v[228:231]
  ds_read_b64_tr_b16 v[156:157], v163 offset:29440
  v_mfma_f32_16x16x32_bf16 v[200:203], v[128:131], a[88:91], v[200:203]
  ds_read_b64_tr_b16 v[158:159], v163 offset:31488
  v_add_u32 v163, 119808, v163
  v_mfma_f32_16x16x32_bf16 v[196:199], v[132:135], a[88:91], v[196:199]
  v_mfma_f32_16x16x32_bf16 v[176:179], v[136:139], a[88:91], v[176:179]
  v_mfma_f32_16x16x32_bf16 v[68:71], v[140:143], a[88:91], v[68:71]
  s_mov_b32 s40, 168192
  v_mfma_f32_16x16x32_bf16 v[76:79], v[128:131], a[136:139], v[76:79]
  v_mfma_f32_16x16x32_bf16 v[84:87], v[132:135], a[136:139], v[84:87]
  v_mfma_f32_16x16x32_bf16 v[92:95], v[136:139], a[136:139], v[92:95]
  v_mfma_f32_16x16x32_bf16 v[108:111], v[140:143], a[136:139], v[108:111]
  buffer_store_dwordx4 v[88:91], v169, s[20:23], s40 offen nt
  v_mfma_f32_16x16x32_bf16 v[124:127], v[128:131], a[184:187], v[124:127]
  ds_read_b64_tr_b16 v[128:129], v160 offset:0
  v_mfma_f32_16x16x32_bf16 v[192:195], v[132:135], a[184:187], v[192:195]
  ds_read_b64_tr_b16 v[130:131], v160 offset:2048
  v_mfma_f32_16x16x32_bf16 v[180:183], v[136:139], a[184:187], v[180:183]
  ds_read_b64_tr_b16 v[132:133], v161 offset:0
  v_mfma_f32_16x16x32_bf16 v[208:211], v[140:143], a[184:187], v[208:211]
  s_waitcnt lgkmcnt(9)
  ds_read_b64_tr_b16 v[134:135], v161 offset:2048
  v_mfma_f32_16x16x32_bf16 v[120:123], v[144:147], a[44:47], v[120:123]
  s_waitcnt lgkmcnt(8)
  ds_read_b64_tr_b16 v[136:137], v162 offset:0
  v_mfma_f32_16x16x32_bf16 v[212:215], v[148:151], a[44:47], v[212:215]
  s_waitcnt lgkmcnt(7)
  ds_read_b64_tr_b16 v[138:139], v162 offset:2048
  v_mfma_f32_16x16x32_bf16 v[188:191], v[152:155], a[44:47], v[188:191]
  s_waitcnt lgkmcnt(6)
  ds_read_b64_tr_b16 v[140:141], v163 offset:0
  v_mfma_f32_16x16x32_bf16 v[228:231], v[156:159], a[44:47], v[228:231]
  ds_read_b64_tr_b16 v[142:143], v163 offset:2048
  v_mfma_f32_16x16x32_bf16 v[200:203], v[144:147], a[92:95], v[200:203]
  v_mul_f32 v120, v120, v96
  v_mul_f32 v121, v121, v96
  v_mfma_f32_16x16x32_bf16 v[196:199], v[148:151], a[92:95], v[196:199]
  v_mul_f32 v122, v122, v96
  v_mul_f32 v123, v123, v96
  v_mfma_f32_16x16x32_bf16 v[176:179], v[152:155], a[92:95], v[176:179]
  v_cvt_pk_bf16_f32 v120, v120, v121
  v_cvt_pk_bf16_f32 v121, v122, v123
  v_mfma_f32_16x16x32_bf16 v[68:71], v[156:159], a[92:95], v[68:71]
  v_mul_f32 v212, v212, v96
  v_mul_f32 v213, v213, v96
  v_mfma_f32_16x16x32_bf16 v[76:79], v[144:147], a[140:143], v[76:79]
  v_mul_f32 v214, v214, v96
  v_mul_f32 v215, v215, v96
  v_cvt_pk_bf16_f32 v122, v212, v213
  v_cvt_pk_bf16_f32 v123, v214, v215
  v_mfma_f32_16x16x32_bf16 v[84:87], v[148:151], a[140:143], v[84:87]
  v_mul_f32 v188, v188, v96
  v_mul_f32 v189, v189, v96
  v_mul_f32 v190, v190, v96
  v_mul_f32 v191, v191, v96
  v_mfma_f32_16x16x32_bf16 v[92:95], v[152:155], a[140:143], v[92:95]
  v_permlane16_swap_b32 v120, v122
  v_cvt_pk_bf16_f32 v188, v188, v189
  v_cvt_pk_bf16_f32 v189, v190, v191
  v_mfma_f32_16x16x32_bf16 v[108:111], v[156:159], a[140:143], v[108:111]
  v_permlane16_swap_b32 v121, v123
  v_mul_f32 v228, v228, v96
  v_mul_f32 v229, v229, v96
  v_mfma_f32_16x16x32_bf16 v[124:127], v[144:147], a[188:191], v[124:127]
  ds_read_b64_tr_b16 v[144:145], v160 offset:4096
  v_mul_f32 v230, v230, v96
  v_mul_f32 v231, v231, v96
  v_cvt_pk_bf16_f32 v190, v228, v229
  v_mfma_f32_16x16x32_bf16 v[192:195], v[148:151], a[188:191], v[192:195]
  ds_read_b64_tr_b16 v[146:147], v160 offset:6144
  v_cvt_pk_bf16_f32 v191, v230, v231
  v_permlane16_swap_b32 v188, v190
  v_mfma_f32_16x16x32_bf16 v[180:183], v[152:155], a[188:191], v[180:183]
  ds_read_b64_tr_b16 v[148:149], v161 offset:4096
  v_permlane16_swap_b32 v189, v191
  v_mov_b32 v212, v188
  v_mfma_f32_16x16x32_bf16 v[208:211], v[156:159], a[188:191], v[208:211]
  s_waitcnt lgkmcnt(9)
  ds_read_b64_tr_b16 v[150:151], v161 offset:6144
  v_mov_b32_dpp v188, v120 row_ror:8 row_mask:0xf bank_mask:0x3
  v_mov_b32_dpp v120, v212 row_ror:8 row_mask:0xf bank_mask:0xc
  v_mov_b32 v213, v189
  v_mfma_f32_16x16x32_bf16 v[232:235], v[128:131], a[192:195], 0
  s_waitcnt lgkmcnt(8)
  ds_read_b64_tr_b16 v[152:153], v162 offset:4096
  s_mov_b32 s41, 384
  v_mov_b32_dpp v189, v121 row_ror:8 row_mask:0xf bank_mask:0x3
  v_mov_b32_dpp v121, v213 row_ror:8 row_mask:0xf bank_mask:0xc
  v_mov_b32 v214, v190
  v_mfma_f32_16x16x32_bf16 v[220:223], v[132:135], a[192:195], 0
  s_waitcnt lgkmcnt(7)
  ds_read_b64_tr_b16 v[154:155], v162 offset:6144
  v_mov_b32_dpp v190, v122 row_ror:8 row_mask:0xf bank_mask:0x3
  v_mov_b32_dpp v122, v214 row_ror:8 row_mask:0xf bank_mask:0xc
  v_mov_b32 v215, v191
  v_mfma_f32_16x16x32_bf16 v[184:187], v[136:139], a[192:195], 0
  s_waitcnt lgkmcnt(6)
  ds_read_b64_tr_b16 v[156:157], v163 offset:4096
  v_mov_b32_dpp v191, v123 row_ror:8 row_mask:0xf bank_mask:0x3
  v_mov_b32_dpp v123, v215 row_ror:8 row_mask:0xf bank_mask:0xc
  v_mul_f32 v200, v200, v97
  v_mfma_f32_16x16x32_bf16 v[252:255], v[140:143], a[192:195], 0
  ds_read_b64_tr_b16 v[158:159], v163 offset:6144
  v_mul_f32 v201, v201, v97
  v_mul_f32 v202, v202, v97
  v_mul_f32 v203, v203, v97
  v_mfma_f32_16x16x32_bf16 v[224:227], v[128:131], a[240:243], 0
  buffer_store_dwordx4 v[120:123], v169, s[20:23], s41 offen nt
  v_cvt_pk_bf16_f32 v200, v200, v201
  v_cvt_pk_bf16_f32 v201, v202, v203
  v_mul_f32 v196, v196, v97
  v_mul_f32 v197, v197, v97
  v_mfma_f32_16x16x32_bf16 v[40:43], v[132:135], a[240:243], 0
  ds_read_b64_tr_b16 v[128:129], v160 offset:8192
  v_mul_f32 v198, v198, v97
  v_mul_f32 v199, v199, v97
  v_cvt_pk_bf16_f32 v202, v196, v197
  v_mfma_f32_16x16x32_bf16 v[240:243], v[136:139], a[240:243], 0
  ds_read_b64_tr_b16 v[130:131], v160 offset:10240
  v_cvt_pk_bf16_f32 v203, v198, v199
  v_mul_f32 v176, v176, v97
  v_mul_f32 v177, v177, v97
  v_mfma_f32_16x16x32_bf16 v[52:55], v[140:143], a[240:243], 0
  s_waitcnt lgkmcnt(8)
  ds_read_b64_tr_b16 v[132:133], v161 offset:8192
  v_mul_f32 v178, v178, v97
  v_mul_f32 v179, v179, v97
  v_cvt_pk_bf16_f32 v176, v176, v177
  v_mfma_f32_16x16x32_bf16 v[232:235], v[144:147], a[196:199], v[232:235]
  s_waitcnt lgkmcnt(7)
  ds_read_b64_tr_b16 v[134:135], v161 offset:10240
  v_permlane16_swap_b32 v200, v202
  v_cvt_pk_bf16_f32 v177, v178, v179
  v_mfma_f32_16x16x32_bf16 v[220:223], v[148:151], a[196:199], v[220:223]
  s_waitcnt lgkmcnt(6)
  ds_read_b64_tr_b16 v[136:137], v162 offset:8192
  v_permlane16_swap_b32 v201, v203
  v_mul_f32 v68, v68, v97
  v_mfma_f32_16x16x32_bf16 v[184:187], v[152:155], a[196:199], v[184:187]
  s_waitcnt lgkmcnt(5)
  ds_read_b64_tr_b16 v[138:139], v162 offset:10240
  s_mov_b32 s42, 4480
  v_mul_f32 v69, v69, v97
  v_mul_f32 v70, v70, v97
  v_mul_f32 v71, v71, v97
  v_mfma_f32_16x16x32_bf16 v[252:255], v[156:159], a[196:199], v[252:255]
  ds_read_b64_tr_b16 v[140:141], v163 offset:8192
  v_cvt_pk_bf16_f32 v178, v68, v69
  v_cvt_pk_bf16_f32 v179, v70, v71
  v_mul_f32 v76, v76, v98
  v_mfma_f32_16x16x32_bf16 v[224:227], v[144:147], a[244:247], v[224:227]
  ds_read_b64_tr_b16 v[142:143], v163 offset:10240
  v_permlane16_swap_b32 v176, v178
  v_mov_b32 v196, v176
  v_mfma_f32_16x16x32_bf16 v[40:43], v[148:151], a[244:247], v[40:43]
  ds_read_b64_tr_b16 v[144:145], v160 offset:13312
  v_permlane16_swap_b32 v177, v179
  v_mov_b32_dpp v176, v200 row_ror:8 row_mask:0xf bank_mask:0x3
  v_mfma_f32_16x16x32_bf16 v[240:243], v[152:155], a[244:247], v[240:243]
  buffer_store_dwordx4 v[188:191], v169, s[20:23], s42 offen nt
  v_mov_b32_dpp v200, v196 row_ror:8 row_mask:0xf bank_mask:0xc
  v_mov_b32 v197, v177
  v_mov_b32_dpp v177, v201 row_ror:8 row_mask:0xf bank_mask:0x3
  v_mov_b32 v198, v178
  v_mfma_f32_16x16x32_bf16 v[52:55], v[156:159], a[244:247], v[52:55]
  s_waitcnt lgkmcnt(7)
  ds_read_b64_tr_b16 v[146:147], v160 offset:15360
  v_subrev_u32 v160, 119808, v160
  v_mov_b32_dpp v201, v197 row_ror:8 row_mask:0xf bank_mask:0xc
  v_mov_b32_dpp v178, v202 row_ror:8 row_mask:0xf bank_mask:0x3
  v_mfma_f32_16x16x32_bf16 v[232:235], v[128:131], a[200:203], v[232:235]
  s_waitcnt lgkmcnt(6)
  ds_read_b64_tr_b16 v[148:149], v161 offset:13312
  v_mov_b32_dpp v202, v198 row_ror:8 row_mask:0xf bank_mask:0xc
  v_mov_b32 v199, v179
  v_mov_b32_dpp v179, v203 row_ror:8 row_mask:0xf bank_mask:0x3
  v_mfma_f32_16x16x32_bf16 v[220:223], v[132:135], a[200:203], v[220:223]
  s_waitcnt lgkmcnt(5)
  ds_read_b64_tr_b16 v[150:151], v161 offset:15360
  v_subrev_u32 v161, 119808, v161
  v_mov_b32_dpp v203, v199 row_ror:8 row_mask:0xf bank_mask:0xc
  v_mul_f32 v77, v77, v98
  v_mfma_f32_16x16x32_bf16 v[184:187], v[136:139], a[200:203], v[184:187]
  s_waitcnt lgkmcnt(4)
  ds_read_b64_tr_b16 v[152:153], v162 offset:13312
  v_mul_f32 v78, v78, v98
  v_mul_f32 v79, v79, v98
  v_cvt_pk_bf16_f32 v76, v76, v77
  v_mfma_f32_16x16x32_bf16 v[252:255], v[140:143], a[200:203], v[252:255]
  ds_read_b64_tr_b16 v[154:155], v162 offset:15360
  v_subrev_u32 v162, 119808, v162
  v_cvt_pk_bf16_f32 v77, v78, v79
  v_mul_f32 v84, v84, v98
  v_mfma_f32_16x16x32_bf16 v[224:227], v[128:131], a[248:251], v[224:227]
  ds_read_b64_tr_b16 v[156:157], v163 offset:13312
  s_mov_b32 s43, 33152
  v_mul_f32 v85, v85, v98
  v_mul_f32 v86, v86, v98
  v_mul_f32 v87, v87, v98
  v_mfma_f32_16x16x32_bf16 v[40:43], v[132:135], a[248:251], v[40:43]
  ds_read_b64_tr_b16 v[158:159], v163 offset:15360
  v_subrev_u32 v163, 119808, v163
  v_cvt_pk_bf16_f32 v78, v84, v85
  v_cvt_pk_bf16_f32 v79, v86, v87
  v_mfma_f32_16x16x32_bf16 v[240:243], v[136:139], a[248:251], v[240:243]
  ds_read_b64_tr_b16 v[128:129], v160 offset:0
  v_mul_f32 v92, v92, v98
  v_mul_f32 v93, v93, v98
  v_mul_f32 v94, v94, v98
  v_mfma_f32_16x16x32_bf16 v[52:55], v[140:143], a[248:251], v[52:55]
  s_waitcnt lgkmcnt(7)
  ds_read_b64_tr_b16 v[130:131], v160 offset:2048
  v_mul_f32 v95, v95, v98
  v_permlane16_swap_b32 v76, v78
  v_mfma_f32_16x16x32_bf16 v[232:235], v[144:147], a[204:207], v[232:235]
  s_waitcnt lgkmcnt(6)
  buffer_store_dwordx4 v[200:203], v169, s[20:23], s43 offen nt
  v_cvt_pk_bf16_f32 v92, v92, v93
  v_permlane16_swap_b32 v77, v79
  v_cvt_pk_bf16_f32 v93, v94, v95
  v_mfma_f32_16x16x32_bf16 v[220:223], v[148:151], a[204:207], v[220:223]
  s_waitcnt lgkmcnt(4)
  ds_read_b64_tr_b16 v[132:133], v161 offset:0
  v_mul_f32 v108, v108, v98
  v_mul_f32 v109, v109, v98
  v_mul_f32 v110, v110, v98
  v_mfma_f32_16x16x32_bf16 v[184:187], v[152:155], a[204:207], v[184:187]
  s_waitcnt lgkmcnt(3)
  ds_read_b64_tr_b16 v[134:135], v161 offset:2048
  v_mul_f32 v111, v111, v98
  v_cvt_pk_bf16_f32 v94, v108, v109
  v_cvt_pk_bf16_f32 v95, v110, v111
  v_mfma_f32_16x16x32_bf16 v[252:255], v[156:159], a[204:207], v[252:255]
  ds_read_b64_tr_b16 v[136:137], v162 offset:0
  v_permlane16_swap_b32 v92, v94
  v_mov_b32 v84, v92
  v_mfma_f32_16x16x32_bf16 v[224:227], v[144:147], a[252:255], v[224:227]
  ds_read_b64_tr_b16 v[138:139], v162 offset:2048
  v_permlane16_swap_b32 v93, v95
  v_mov_b32_dpp v92, v76 row_ror:8 row_mask:0xf bank_mask:0x3
  v_mfma_f32_16x16x32_bf16 v[40:43], v[148:151], a[252:255], v[40:43]
  ds_read_b64_tr_b16 v[140:141], v163 offset:0
  v_mov_b32_dpp v76, v84 row_ror:8 row_mask:0xf bank_mask:0xc
  v_mov_b32 v85, v93
  v_mov_b32_dpp v93, v77 row_ror:8 row_mask:0xf bank_mask:0x3
  v_mfma_f32_16x16x32_bf16 v[240:243], v[152:155], a[252:255], v[240:243]
  ds_read_b64_tr_b16 v[142:143], v163 offset:2048
  s_mov_b32 s44, 37248
  v_mov_b32_dpp v77, v85 row_ror:8 row_mask:0xf bank_mask:0xc
  v_mov_b32 v86, v94
  v_mov_b32_dpp v94, v78 row_ror:8 row_mask:0xf bank_mask:0x3
  v_mfma_f32_16x16x32_bf16 v[52:55], v[156:159], a[252:255], v[52:55]
  s_waitcnt lgkmcnt(6)
  ds_read_b64_tr_b16 v[144:145], v160 offset:4096
  v_mov_b32_dpp v78, v86 row_ror:8 row_mask:0xf bank_mask:0xc
  v_mov_b32 v87, v95
  v_mov_b32_dpp v95, v79 row_ror:8 row_mask:0xf bank_mask:0x3
  v_mfma_f32_16x16x32_bf16 v[232:235], v[128:131], a[208:211], v[232:235]
  s_waitcnt lgkmcnt(5)
  ds_read_b64_tr_b16 v[146:147], v160 offset:6144
  v_mov_b32_dpp v79, v87 row_ror:8 row_mask:0xf bank_mask:0xc
  v_mul_f32 v124, v124, v99
  v_mul_f32 v125, v125, v99
  v_mfma_f32_16x16x32_bf16 v[220:223], v[132:135], a[208:211], v[220:223]
  s_waitcnt lgkmcnt(4)
  ds_read_b64_tr_b16 v[148:149], v161 offset:4096
  v_mul_f32 v126, v126, v99
  v_mul_f32 v127, v127, v99
  v_cvt_pk_bf16_f32 v124, v124, v125
  v_mfma_f32_16x16x32_bf16 v[184:187], v[136:139], a[208:211], v[184:187]
  s_waitcnt lgkmcnt(3)
  ds_read_b64_tr_b16 v[150:151], v161 offset:6144
  v_cvt_pk_bf16_f32 v125, v126, v127
  v_mul_f32 v192, v192, v99
  v_mul_f32 v193, v193, v99
  v_mfma_f32_16x16x32_bf16 v[252:255], v[140:143], a[208:211], v[252:255]
  buffer_store_dwordx4 v[176:179], v169, s[20:23], s44 offen nt
  v_mul_f32 v194, v194, v99
  v_mul_f32 v195, v195, v99
  v_cvt_pk_bf16_f32 v126, v192, v193
  v_cvt_pk_bf16_f32 v127, v194, v195
  v_mfma_f32_16x16x32_bf16 v[224:227], v[128:131], v[0:3], v[224:227]
  ds_read_b64_tr_b16 v[152:153], v162 offset:4096
  v_mul_f32 v180, v180, v99
  v_mul_f32 v181, v181, v99
  v_mul_f32 v182, v182, v99
  v_mfma_f32_16x16x32_bf16 v[40:43], v[132:135], v[0:3], v[40:43]
  ds_read_b64_tr_b16 v[154:155], v162 offset:6144
  v_mul_f32 v183, v183, v99
  v_permlane16_swap_b32 v124, v126
  v_mfma_f32_16x16x32_bf16 v[240:243], v[136:139], v[0:3], v[240:243]
  ds_read_b64_tr_b16 v[156:157], v163 offset:4096
  v_cvt_pk_bf16_f32 v180, v180, v181
  v_permlane16_swap_b32 v125, v127
  v_mfma_f32_16x16x32_bf16 v[52:55], v[140:143], v[0:3], v[52:55]
  s_waitcnt lgkmcnt(5)
  ds_read_b64_tr_b16 v[158:159], v163 offset:6144
  v_cvt_pk_bf16_f32 v181, v182, v183
  v_mul_f32 v208, v208, v99
  v_mul_f32 v209, v209, v99
  v_mfma_f32_16x16x32_bf16 v[232:235], v[144:147], a[212:215], v[232:235]
  s_waitcnt lgkmcnt(4)
  ds_read_b64_tr_b16 v[128:129], v160 offset:8448
  s_mov_b32 s45, 65920
  v_mul_f32 v210, v210, v99
  v_mul_f32 v211, v211, v99
  v_cvt_pk_bf16_f32 v182, v208, v209
  v_mfma_f32_16x16x32_bf16 v[220:223], v[148:151], a[212:215], v[220:223]
  s_waitcnt lgkmcnt(3)
  ds_read_b64_tr_b16 v[130:131], v160 offset:10496
  v_cvt_pk_bf16_f32 v183, v210, v211
  v_permlane16_swap_b32 v180, v182
  v_mfma_f32_16x16x32_bf16 v[184:187], v[152:155], a[212:215], v[184:187]
  s_waitcnt lgkmcnt(2)
  ds_read_b64_tr_b16 v[132:133], v161 offset:8448
  v_permlane16_swap_b32 v181, v183
  v_mov_b32 v192, v180
  v_mfma_f32_16x16x32_bf16 v[252:255], v[156:159], a[212:215], v[252:255]
  ds_read_b64_tr_b16 v[134:135], v161 offset:10496
  v_mov_b32_dpp v180, v124 row_ror:8 row_mask:0xf bank_mask:0x3
  v_mov_b32_dpp v124, v192 row_ror:8 row_mask:0xf bank_mask:0xc
  v_mov_b32 v193, v181
  v_mfma_f32_16x16x32_bf16 v[224:227], v[144:147], v[4:7], v[224:227]
  ds_read_b64_tr_b16 v[136:137], v162 offset:8448
  v_mov_b32_dpp v181, v125 row_ror:8 row_mask:0xf bank_mask:0x3
  v_mov_b32_dpp v125, v193 row_ror:8 row_mask:0xf bank_mask:0xc
  v_mov_b32 v194, v182
  v_mfma_f32_16x16x32_bf16 v[40:43], v[148:151], v[4:7], v[40:43]
  ds_read_b64_tr_b16 v[138:139], v162 offset:10496
  v_mov_b32_dpp v182, v126 row_ror:8 row_mask:0xf bank_mask:0x3
  v_mov_b32_dpp v126, v194 row_ror:8 row_mask:0xf bank_mask:0xc
  v_mov_b32 v195, v183
  v_mfma_f32_16x16x32_bf16 v[240:243], v[152:155], v[4:7], v[240:243]
  buffer_store_dwordx4 v[76:79], v169, s[20:23], s45 offen nt
  v_mov_b32_dpp v183, v127 row_ror:8 row_mask:0xf bank_mask:0x3
  v_mov_b32_dpp v127, v195 row_ror:8 row_mask:0xf bank_mask:0xc
  v_mfma_f32_16x16x32_bf16 v[52:55], v[156:159], v[4:7], v[52:55]
  s_waitcnt lgkmcnt(4)
  ds_read_b64_tr_b16 v[140:141], v163 offset:8448
  ds_read_b64_tr_b16 v[142:143], v163 offset:10496
  v_mfma_f32_16x16x32_bf16 v[232:235], v[128:131], a[216:219], v[232:235]
  s_waitcnt lgkmcnt(4)
  ds_read_b64_tr_b16 v[144:145], v160 offset:12544
  v_mfma_f32_16x16x32_bf16 v[220:223], v[132:135], a[216:219], v[220:223]
  s_waitcnt lgkmcnt(3)
  ds_read_b64_tr_b16 v[146:147], v160 offset:14592
  v_mfma_f32_16x16x32_bf16 v[184:187], v[136:139], a[216:219], v[184:187]
  s_waitcnt lgkmcnt(2)
  ds_read_b64_tr_b16 v[148:149], v161 offset:12544
  s_mov_b32 s46, 70016
  v_mfma_f32_16x16x32_bf16 v[252:255], v[140:143], a[216:219], v[252:255]
  ds_read_b64_tr_b16 v[150:151], v161 offset:14592
  v_mfma_f32_16x16x32_bf16 v[224:227], v[128:131], v[8:11], v[224:227]
  ds_read_b64_tr_b16 v[152:153], v162 offset:12544
  s_mov_b32 s33, 131456
  v_mfma_f32_16x16x32_bf16 v[40:43], v[132:135], v[8:11], v[40:43]
  ds_read_b64_tr_b16 v[154:155], v162 offset:14592
  s_mov_b32 s34, 135552
  v_mfma_f32_16x16x32_bf16 v[240:243], v[136:139], v[8:11], v[240:243]
  ds_read_b64_tr_b16 v[156:157], v163 offset:12544
  s_mov_b32 s35, 164224
  v_mfma_f32_16x16x32_bf16 v[52:55], v[140:143], v[8:11], v[52:55]
  s_waitcnt lgkmcnt(5)
  ds_read_b64_tr_b16 v[158:159], v163 offset:14592
  s_mov_b32 s36, 168320
  v_mfma_f32_16x16x32_bf16 v[232:235], v[144:147], a[220:223], v[232:235]
  s_waitcnt lgkmcnt(4)
  buffer_store_dwordx4 v[92:95], v169, s[20:23], s46 offen nt
  v_mfma_f32_16x16x32_bf16 v[220:223], v[148:151], a[220:223], v[220:223]
  s_waitcnt lgkmcnt(2)
  ds_read_b64_tr_b16 v[128:129], v160 offset:16896
  ds_read_b64_tr_b16 v[130:131], v160 offset:18944
  v_mfma_f32_16x16x32_bf16 v[184:187], v[152:155], a[220:223], v[184:187]
  s_waitcnt lgkmcnt(2)
  ds_read_b64_tr_b16 v[132:133], v161 offset:16896
  v_mfma_f32_16x16x32_bf16 v[252:255], v[156:159], a[220:223], v[252:255]
  ds_read_b64_tr_b16 v[134:135], v161 offset:18944
  v_mfma_f32_16x16x32_bf16 v[224:227], v[144:147], v[12:15], v[224:227]
  ds_read_b64_tr_b16 v[136:137], v162 offset:16896
  s_mov_b32 s47, 98688
  v_mfma_f32_16x16x32_bf16 v[40:43], v[148:151], v[12:15], v[40:43]
  ds_read_b64_tr_b16 v[138:139], v162 offset:18944
  v_mfma_f32_16x16x32_bf16 v[240:243], v[152:155], v[12:15], v[240:243]
  ds_read_b64_tr_b16 v[140:141], v163 offset:16896
  v_mfma_f32_16x16x32_bf16 v[52:55], v[156:159], v[12:15], v[52:55]
  s_waitcnt lgkmcnt(5)
  ds_read_b64_tr_b16 v[142:143], v163 offset:18944
  v_mfma_f32_16x16x32_bf16 v[232:235], v[128:131], a[224:227], v[232:235]
  s_waitcnt lgkmcnt(4)
  ds_read_b64_tr_b16 v[144:145], v160 offset:20992
  v_mfma_f32_16x16x32_bf16 v[220:223], v[132:135], a[224:227], v[220:223]
  s_waitcnt lgkmcnt(3)
  ds_read_b64_tr_b16 v[146:147], v160 offset:23040
  v_mfma_f32_16x16x32_bf16 v[184:187], v[136:139], a[224:227], v[184:187]
  s_waitcnt lgkmcnt(2)
  buffer_store_dwordx4 v[124:127], v169, s[20:23], s47 offen nt
  v_mfma_f32_16x16x32_bf16 v[252:255], v[140:143], a[224:227], v[252:255]
  ds_read_b64_tr_b16 v[148:149], v161 offset:20992
  ds_read_b64_tr_b16 v[150:151], v161 offset:23040
  v_mfma_f32_16x16x32_bf16 v[224:227], v[128:131], v[16:19], v[224:227]
  ds_read_b64_tr_b16 v[152:153], v162 offset:20992
  v_mfma_f32_16x16x32_bf16 v[40:43], v[132:135], v[16:19], v[40:43]
  ds_read_b64_tr_b16 v[154:155], v162 offset:23040
  v_mfma_f32_16x16x32_bf16 v[240:243], v[136:139], v[16:19], v[240:243]
  ds_read_b64_tr_b16 v[156:157], v163 offset:20992
  s_mov_b32 s32, 102784
  v_mfma_f32_16x16x32_bf16 v[52:55], v[140:143], v[16:19], v[52:55]
  s_waitcnt lgkmcnt(5)
  ds_read_b64_tr_b16 v[158:159], v163 offset:23040
  v_mfma_f32_16x16x32_bf16 v[232:235], v[144:147], a[228:231], v[232:235]
  s_waitcnt lgkmcnt(4)
  ds_read_b64_tr_b16 v[128:129], v160 offset:25344
  v_mfma_f32_16x16x32_bf16 v[220:223], v[148:151], a[228:231], v[220:223]
  s_waitcnt lgkmcnt(3)
  ds_read_b64_tr_b16 v[130:131], v160 offset:27392
  v_mfma_f32_16x16x32_bf16 v[184:187], v[152:155], a[228:231], v[184:187]
  s_waitcnt lgkmcnt(2)
  ds_read_b64_tr_b16 v[132:133], v161 offset:25344
  v_mfma_f32_16x16x32_bf16 v[252:255], v[156:159], a[228:231], v[252:255]
  ds_read_b64_tr_b16 v[134:135], v161 offset:27392
  v_mfma_f32_16x16x32_bf16 v[224:227], v[144:147], v[20:23], v[224:227]
  buffer_store_dwordx4 v[180:183], v169, s[20:23], s32 offen nt
  v_mfma_f32_16x16x32_bf16 v[40:43], v[148:151], v[20:23], v[40:43]
  ds_read_b64_tr_b16 v[136:137], v162 offset:25344
  ds_read_b64_tr_b16 v[138:139], v162 offset:27392
  v_mfma_f32_16x16x32_bf16 v[240:243], v[152:155], v[20:23], v[240:243]
  ds_read_b64_tr_b16 v[140:141], v163 offset:25344
  v_mfma_f32_16x16x32_bf16 v[52:55], v[156:159], v[20:23], v[52:55]
  s_waitcnt lgkmcnt(5)
  ds_read_b64_tr_b16 v[142:143], v163 offset:27392
  v_mfma_f32_16x16x32_bf16 v[232:235], v[128:131], a[232:235], v[232:235]
  s_waitcnt lgkmcnt(4)
  ds_read_b64_tr_b16 v[144:145], v160 offset:29440
  v_mfma_f32_16x16x32_bf16 v[220:223], v[132:135], a[232:235], v[220:223]
  s_waitcnt lgkmcnt(3)
  ds_read_b64_tr_b16 v[146:147], v160 offset:31488
  v_mfma_f32_16x16x32_bf16 v[184:187], v[136:139], a[232:235], v[184:187]
  s_waitcnt lgkmcnt(2)
  ds_read_b64_tr_b16 v[148:149], v161 offset:29440
  v_mfma_f32_16x16x32_bf16 v[252:255], v[140:143], a[232:235], v[252:255]
  ds_read_b64_tr_b16 v[150:151], v161 offset:31488
  v_mfma_f32_16x16x32_bf16 v[224:227], v[128:131], v[24:27], v[224:227]
  ds_read_b64_tr_b16 v[152:153], v162 offset:29440
  v_mfma_f32_16x16x32_bf16 v[40:43], v[132:135], v[24:27], v[40:43]
  ds_read_b64_tr_b16 v[154:155], v162 offset:31488
  v_mfma_f32_16x16x32_bf16 v[240:243], v[136:139], v[24:27], v[240:243]
  ds_read_b64_tr_b16 v[156:157], v163 offset:29440
  v_mfma_f32_16x16x32_bf16 v[52:55], v[140:143], v[24:27], v[52:55]
  s_waitcnt lgkmcnt(5)
  ds_read_b64_tr_b16 v[158:159], v163 offset:31488
  v_mfma_f32_16x16x32_bf16 v[232:235], v[144:147], a[236:239], v[232:235]
  s_waitcnt lgkmcnt(4)
  v_mfma_f32_16x16x32_bf16 v[220:223], v[148:151], a[236:239], v[220:223]
  s_waitcnt lgkmcnt(2)
  v_mfma_f32_16x16x32_bf16 v[184:187], v[152:155], a[236:239], v[184:187]
  s_waitcnt lgkmcnt(0)
  v_mfma_f32_16x16x32_bf16 v[252:255], v[156:159], a[236:239], v[252:255]
  v_mfma_f32_16x16x32_bf16 v[224:227], v[144:147], v[28:31], v[224:227]
  v_mfma_f32_16x16x32_bf16 v[40:43], v[148:151], v[28:31], v[40:43]
  v_mfma_f32_16x16x32_bf16 v[240:243], v[152:155], v[28:31], v[240:243]
  v_mfma_f32_16x16x32_bf16 v[52:55], v[156:159], v[28:31], v[52:55]
  v_mul_f32 v232, v232, v100
  v_mul_f32 v233, v233, v100
  v_cvt_pk_bf16_f32 v232, v232, v233
  v_mul_f32 v234, v234, v100
  v_mul_f32 v235, v235, v100
  v_cvt_pk_bf16_f32 v233, v234, v235
  v_mul_f32 v220, v220, v100
  v_mul_f32 v221, v221, v100
  v_cvt_pk_bf16_f32 v234, v220, v221
  s_nop 1
  v_permlane16_swap_b32 v232, v234
  v_mul_f32 v184, v184, v100
  v_mul_f32 v185, v185, v100
  v_cvt_pk_bf16_f32 v184, v184, v185
  v_mul_f32 v186, v186, v100
  v_mul_f32 v187, v187, v100
  v_cvt_pk_bf16_f32 v185, v186, v187
  v_mul_f32 v252, v252, v100
  v_mul_f32 v253, v253, v100
  v_cvt_pk_bf16_f32 v186, v252, v253
  s_nop 1
  v_permlane16_swap_b32 v184, v186
  v_mov_b32 v220, v184
  s_nop 0
  v_mov_b32_dpp v184, v232 row_ror:8 row_mask:0xf bank_mask:0x3
  v_mov_b32_dpp v232, v220 row_ror:8 row_mask:0xf bank_mask:0xc
  v_mul_f32 v222, v222, v100
  v_mul_f32 v223, v223, v100
  v_cvt_pk_bf16_f32 v235, v222, v223
  s_nop 1
  v_permlane16_swap_b32 v233, v235
  v_mul_f32 v254, v254, v100
  v_mul_f32 v255, v255, v100
  v_cvt_pk_bf16_f32 v187, v254, v255
  s_nop 1
  v_permlane16_swap_b32 v185, v187
  v_mov_b32 v221, v185
  s_nop 0
  v_mov_b32_dpp v185, v233 row_ror:8 row_mask:0xf bank_mask:0x3
  v_mov_b32_dpp v233, v221 row_ror:8 row_mask:0xf bank_mask:0xc
  v_mov_b32 v222, v186
  v_mov_b32_dpp v186, v234 row_ror:8 row_mask:0xf bank_mask:0x3
  s_nop 0
  v_mov_b32_dpp v234, v222 row_ror:8 row_mask:0xf bank_mask:0xc
  v_mov_b32 v223, v187
  v_mov_b32_dpp v187, v235 row_ror:8 row_mask:0xf bank_mask:0x3
  s_nop 0
  v_mov_b32_dpp v235, v223 row_ror:8 row_mask:0xf bank_mask:0xc
  buffer_store_dwordx4 v[232:235], v169, s[20:23], s33 offen nt
  buffer_store_dwordx4 v[184:187], v169, s[20:23], s34 offen nt
  v_mul_f32 v224, v224, v101
  v_mul_f32 v225, v225, v101
  v_mul_f32 v226, v226, v101
  v_mul_f32 v227, v227, v101
  v_cvt_pk_bf16_f32 v224, v224, v225
  v_cvt_pk_bf16_f32 v225, v226, v227
  v_mul_f32 v40, v40, v101
  v_mul_f32 v41, v41, v101
  v_mul_f32 v42, v42, v101
  v_mul_f32 v43, v43, v101
  v_cvt_pk_bf16_f32 v226, v40, v41
  v_cvt_pk_bf16_f32 v227, v42, v43
  v_mul_f32 v240, v240, v101
  v_mul_f32 v241, v241, v101
  v_mul_f32 v242, v242, v101
  v_mul_f32 v243, v243, v101
  v_permlane16_swap_b32 v224, v226
  v_cvt_pk_bf16_f32 v240, v240, v241
  v_permlane16_swap_b32 v225, v227
  v_cvt_pk_bf16_f32 v241, v242, v243
  v_mul_f32 v52, v52, v101
  v_mul_f32 v53, v53, v101
  v_mul_f32 v54, v54, v101
  v_mul_f32 v55, v55, v101
  v_cvt_pk_bf16_f32 v242, v52, v53
  v_cvt_pk_bf16_f32 v243, v54, v55
  s_nop 0
  v_permlane16_swap_b32 v240, v242
  v_mov_b32 v40, v240
  s_nop 0
  v_mov_b32_dpp v240, v224 row_ror:8 row_mask:0xf bank_mask:0x3
  v_mov_b32_dpp v224, v40 row_ror:8 row_mask:0xf bank_mask:0xc
  v_permlane16_swap_b32 v241, v243
  v_mov_b32 v41, v241
  s_nop 0
  v_mov_b32_dpp v241, v225 row_ror:8 row_mask:0xf bank_mask:0x3
  v_mov_b32_dpp v225, v41 row_ror:8 row_mask:0xf bank_mask:0xc
  v_mov_b32 v42, v242
  v_mov_b32_dpp v242, v226 row_ror:8 row_mask:0xf bank_mask:0x3
  s_nop 0
  v_mov_b32_dpp v226, v42 row_ror:8 row_mask:0xf bank_mask:0xc
  v_mov_b32 v43, v243
  v_mov_b32_dpp v243, v227 row_ror:8 row_mask:0xf bank_mask:0x3
  s_nop 0
  v_mov_b32_dpp v227, v43 row_ror:8 row_mask:0xf bank_mask:0xc
  buffer_store_dwordx4 v[224:227], v169, s[20:23], s35 offen nt
  buffer_store_dwordx4 v[240:243], v169, s[20:23], s36 offen nt
L_finf:
  s_endpgm
L_slow:
  s_waitcnt vmcnt(0) lgkmcnt(0)
  s_barrier
  s_nop 7
  v_mbcnt_lo_u32_b32 v0, -1, 0
  v_mbcnt_hi_u32_b32 v0, -1, v0
  s_lshl_b32 s3, s24, 6
  v_add_u32 v0, s3, v0
  s_load_dwordx4 s[4:7], s[0:1], 0
  s_load_dwordx4 s[48:51], s[0:1], 16
  v_lshrrev_b32 v4, 6, v0
  v_and_b32 v5, 63, v0
  v_readfirstlane_b32 s24, v4
  s_getpc_b64 s[30:31]
  L_pcs:
  v_lshlrev_b32 v1, 7, v0
  v_add_u32 v2, 0x8000, v1
  v_min_u32 v2, L_fins-L_pcs, v2
  s_and_b32 s54, s2, 7
  s_lshr_b32 s55, s2, 3
  s_lshr_b32 s56, s55, 1
  s_lshl_b32 s54, s54, 4
  s_add_u32 s54, s54, s56
  s_and_b32 s55, s55, 1
  s_lshl_b32 s56, s54, 1
  s_add_u32 s56, s56, s55
  s_mul_i32 s56, s56, 196608
  s_mul_i32 s54, s54, 196608
  s_mov_b32 s25, 0x3db8aa3b
  s_mul_i32 s26, s24, 2112
  s_mul_i32 s27, s24, 25344
  s_add_u32 s27, s27, 59136
  s_mul_i32 s28, s24, 49152
  s_lshl_b32 s29, s24, 10
  v_lshrrev_b32 v6, 5, v5
  v_and_b32 v7, 31, v5
  v_xor_b32 v7, v7, v6
  v_lshlrev_b32 v7, 4, v7
  v_lshl_add_u32 v92, v6, 9, v7
  s_lshl_b32 s57, s24, 11
  v_add_u32 v118, s57, v92
  s_mov_b32 s10, 196608
  s_mov_b32 s11, 0x20000
  s_mov_b32 s14, 196608
  s_mov_b32 s15, 0x20000
  s_mov_b32 s18, 196608
  s_mov_b32 s19, 0x20000
  s_mov_b32 s22, 196608
  s_mov_b32 s23, 0x20000
  s_waitcnt lgkmcnt(0)
  s_add_u32 s8, s4, s56
  s_addc_u32 s9, s5, 0
  s_mov_b32 s33, 0
  s_add_u32 m0, s26, 0
  s_nop 0
  buffer_load_dwordx4 v118, s[8:11], s33 offen offset:0 nt lds
  s_add_u32 m0, s26, 32
  s_nop 0
  buffer_load_dwordx4 v118, s[8:11], s33 offen offset:1024 nt lds
  global_load_dword v3, v1, s[30:31]
  global_load_dword v4, v2, s[30:31]
  s_mov_b32 s34, 8192
  s_add_u32 m0, s26, 8448
  s_nop 0
  buffer_load_dwordx4 v118, s[8:11], s34 offen offset:0 nt lds
  s_add_u32 m0, s26, 8480
  s_nop 0
  buffer_load_dwordx4 v118, s[8:11], s34 offen offset:1024 nt lds
  s_mov_b32 s35, 16384
  s_add_u32 m0, s26, 16896
  s_nop 0
  buffer_load_dwordx4 v118, s[8:11], s35 offen offset:0 nt lds
  s_add_u32 m0, s26, 16928
  s_nop 0
  buffer_load_dwordx4 v118, s[8:11], s35 offen offset:1024 nt lds
  s_add_u32 s12, s6, s54
  s_addc_u32 s13, s7, 0
  s_add_u32 s16, s48, s54
  s_addc_u32 s17, s49, 0
  s_add_u32 s20, s50, s56
  s_addc_u32 s21, s51, 0
  s_add_u32 s36, s28, 0
  s_add_u32 m0, s27, 0
  s_nop 0
  buffer_load_dwordx4 v92, s[12:15], s36 offen offset:0 nt lds
  s_add_u32 m0, s27, 32
  s_nop 0
  buffer_load_dwordx4 v92, s[12:15], s36 offen offset:1024 nt lds
  s_add_u32 m0, s27, 64
  s_nop 0
  buffer_load_dwordx4 v92, s[12:15], s36 offen offset:2048 nt lds
  s_add_u32 m0, s27, 96
  s_nop 0
  buffer_load_dwordx4 v92, s[12:15], s36 offen offset:3072 nt lds
  s_add_u32 s37, s28, 4096
  s_add_u32 m0, s27, 4224
  s_nop 0
  buffer_load_dwordx4 v92, s[12:15], s37 offen offset:0 nt lds
  s_add_u32 m0, s27, 4256
  s_nop 0
  buffer_load_dwordx4 v92, s[12:15], s37 offen offset:1024 nt lds
  s_add_u32 m0, s27, 4288
  s_nop 0
  buffer_load_dwordx4 v92, s[12:15], s37 offen offset:2048 nt lds
  s_add_u32 m0, s27, 4320
  s_nop 0
  buffer_load_dwordx4 v92, s[12:15], s37 offen offset:3072 nt lds
  v_and_b32 v9, 15, v5
  v_lshrrev_b32 v10, 4, v5
  v_and_b32 v11, 1, v9
  v_xor_b32 v12, v10, v11
  v_lshlrev_b32 v12, 4, v12
  v_lshl_add_u32 v12, v11, 9, v12
  v_lshrrev_b32 v13, 1, v9
  v_mul_u32_u24 v13, 1056, v13
  v_add_u32 v112, v12, v13
  v_add_u32 v93, s27, v112
  v_lshlrev_b32 v15, 4, v5
  s_mul_i32 s57, s24, 3072
  s_add_u32 s57, s57, 59136
  v_add_u32 v113, s57, v15
  v_add_u32 v114, 49152, v113
  s_mul_i32 s57, s24, 12288
  s_add_u32 s57, s57, 59136
  v_add_u32 v115, s57, v15
  v_lshlrev_b32 v117, 4, v9
  v_add_u32 v117, 157440, v117
  v_lshl_add_u32 v116, v6, 8, v117
  s_lshl_b32 s57, s24, 2
  v_add_u32 v116, s57, v116
  v_lshrrev_b32 v16, 3, v5
  v_and_b32 v17, 6, v16
  v_and_b32 v18, 7, v5
  v_xor_b32 v17, v17, v18
  v_lshlrev_b32 v17, 4, v17
  v_lshl_add_u32 v17, v16, 9, v17
  s_lshl_b32 s57, s24, 12
  v_add_u32 v119, s57, v17
  s_add_u32 s38, s28, 8192
  s_add_u32 m0, s27, 8448
  s_nop 0
  buffer_load_dwordx4 v92, s[12:15], s38 offen offset:0 nt lds
  s_add_u32 m0, s27, 8480
  s_nop 0
  buffer_load_dwordx4 v92, s[12:15], s38 offen offset:1024 nt lds
  s_add_u32 m0, s27, 8512
  s_nop 0
  buffer_load_dwordx4 v92, s[12:15], s38 offen offset:2048 nt lds
  s_add_u32 m0, s27, 8544
  s_nop 0
  buffer_load_dwordx4 v92, s[12:15], s38 offen offset:3072 nt lds
  s_add_u32 s39, s28, 12288
  s_add_u32 m0, s27, 12672
  s_nop 0
  buffer_load_dwordx4 v92, s[12:15], s39 offen offset:0 nt lds
  s_add_u32 m0, s27, 12704
  s_nop 0
  buffer_load_dwordx4 v92, s[12:15], s39 offen offset:1024 nt lds
  s_add_u32 m0, s27, 12736
  s_nop 0
  buffer_load_dwordx4 v92, s[12:15], s39 offen offset:2048 nt lds
  s_add_u32 m0, s27, 12768
  s_nop 0
  buffer_load_dwordx4 v92, s[12:15], s39 offen offset:3072 nt lds
  s_waitcnt vmcnt(16)
  s_barrier
  ds_read_b128 a[0:3], v112 offset:0
  ds_read_b128 a[4:7], v112 offset:64
  ds_read_b128 a[8:11], v112 offset:128
  ds_read_b128 a[12:15], v112 offset:192
  ds_read_b128 a[16:19], v112 offset:256
  ds_read_b128 a[20:23], v112 offset:320
  ds_read_b128 a[24:27], v112 offset:384
  ds_read_b128 a[28:31], v112 offset:448
  ds_read_b128 a[32:35], v112 offset:8448
  ds_read_b128 a[36:39], v112 offset:8512
  ds_read_b128 a[40:43], v112 offset:8576
  ds_read_b128 a[44:47], v112 offset:8640
  ds_read_b128 a[48:51], v112 offset:8704
  ds_read_b128 a[52:55], v112 offset:8768
  ds_read_b128 a[56:59], v112 offset:8832
  ds_read_b128 a[60:63], v112 offset:8896
  ds_read_b128 a[64:67], v112 offset:16896
  ds_read_b128 a[68:71], v112 offset:16960
  ds_read_b128 a[72:75], v112 offset:17024
  ds_read_b128 a[76:79], v112 offset:17088
  ds_read_b128 a[80:83], v112 offset:17152
  ds_read_b128 a[84:87], v112 offset:17216
  ds_read_b128 a[88:91], v112 offset:17280
  ds_read_b128 a[92:95], v112 offset:17344
  s_waitcnt vmcnt(8)
  ds_read_b128 a[192:195], v93 offset:0
  ds_read_b128 a[196:199], v93 offset:64
  ds_read_b128 a[200:203], v93 offset:128
  ds_read_b128 a[204:207], v93 offset:192
  ds_read_b128 a[208:211], v93 offset:256
  ds_read_b128 a[212:215], v93 offset:320
  ds_read_b128 a[216:219], v93 offset:384
  ds_read_b128 a[220:223], v93 offset:448
  s_waitcnt lgkmcnt(7)
  v_mfma_f32_16x16x32_bf16 v[0:3], a[192:195], a[0:3], 0
  s_add_u32 s40, s28, 16384
  s_add_u32 m0, s27, 16896
  s_nop 0
  buffer_load_dwordx4 v92, s[12:15], s40 offen offset:0 nt lds
  v_mfma_f32_16x16x32_bf16 v[24:27], a[192:195], a[32:35], 0
  v_mfma_f32_16x16x32_bf16 v[48:51], a[192:195], a[64:67], 0
  s_waitcnt lgkmcnt(6)
  v_mfma_f32_16x16x32_bf16 v[0:3], a[196:199], a[4:7], v[0:3]
  s_add_u32 m0, s27, 16928
  s_nop 0
  buffer_load_dwordx4 v92, s[12:15], s40 offen offset:1024 nt lds
  v_mfma_f32_16x16x32_bf16 v[24:27], a[196:199], a[36:39], v[24:27]
  v_mfma_f32_16x16x32_bf16 v[48:51], a[196:199], a[68:71], v[48:51]
  s_waitcnt lgkmcnt(5)
  v_mfma_f32_16x16x32_bf16 v[0:3], a[200:203], a[8:11], v[0:3]
  s_add_u32 m0, s27, 16960
  s_nop 0
  buffer_load_dwordx4 v92, s[12:15], s40 offen offset:2048 nt lds
  v_mfma_f32_16x16x32_bf16 v[24:27], a[200:203], a[40:43], v[24:27]
  v_mfma_f32_16x16x32_bf16 v[48:51], a[200:203], a[72:75], v[48:51]
  s_waitcnt lgkmcnt(4)
  v_mfma_f32_16x16x32_bf16 v[0:3], a[204:207], a[12:15], v[0:3]
  s_add_u32 m0, s27, 16992
  s_nop 0
  buffer_load_dwordx4 v92, s[12:15], s40 offen offset:3072 nt lds
  v_mfma_f32_16x16x32_bf16 v[24:27], a[204:207], a[44:47], v[24:27]
  v_mfma_f32_16x16x32_bf16 v[48:51], a[204:207], a[76:79], v[48:51]
  s_waitcnt lgkmcnt(3)
  v_mfma_f32_16x16x32_bf16 v[0:3], a[208:211], a[16:19], v[0:3]
  s_add_u32 s41, s28, 20480
  s_add_u32 m0, s27, 21120
  s_nop 0
  buffer_load_dwordx4 v92, s[12:15], s41 offen offset:0 nt lds
  v_mfma_f32_16x16x32_bf16 v[24:27], a[208:211], a[48:51], v[24:27]
  v_mfma_f32_16x16x32_bf16 v[48:51], a[208:211], a[80:83], v[48:51]
  s_waitcnt lgkmcnt(2)
  v_mfma_f32_16x16x32_bf16 v[0:3], a[212:215], a[20:23], v[0:3]
  s_add_u32 m0, s27, 21152
  s_nop 0
  buffer_load_dwordx4 v92, s[12:15], s41 offen offset:1024 nt lds
  v_mfma_f32_16x16x32_bf16 v[24:27], a[212:215], a[52:55], v[24:27]
  v_mfma_f32_16x16x32_bf16 v[48:51], a[212:215], a[84:87], v[48:51]
  s_waitcnt lgkmcnt(1)
  v_mfma_f32_16x16x32_bf16 v[0:3], a[216:219], a[24:27], v[0:3]
  s_add_u32 m0, s27, 21184
  s_nop 0
  buffer_load_dwordx4 v92, s[12:15], s41 offen offset:2048 nt lds
  v_mfma_f32_16x16x32_bf16 v[24:27], a[216:219], a[56:59], v[24:27]
  v_mfma_f32_16x16x32_bf16 v[48:51], a[216:219], a[88:91], v[48:51]
  s_waitcnt lgkmcnt(0)
  v_mfma_f32_16x16x32_bf16 v[0:3], a[220:223], a[28:31], v[0:3]
  s_add_u32 m0, s27, 21216
  s_nop 0
  buffer_load_dwordx4 v92, s[12:15], s41 offen offset:3072 nt lds
  v_mfma_f32_16x16x32_bf16 v[24:27], a[220:223], a[60:63], v[24:27]
  v_mfma_f32_16x16x32_bf16 v[48:51], a[220:223], a[92:95], v[48:51]
  s_waitcnt vmcnt(8)
  ds_read_b128 a[224:227], v93 offset:8448
  ds_read_b128 a[228:231], v93 offset:8512
  ds_read_b128 a[232:235], v93 offset:8576
  ds_read_b128 a[236:239], v93 offset:8640
  ds_read_b128 a[240:243], v93 offset:8704
  ds_read_b128 a[244:247], v93 offset:8768
  ds_read_b128 a[248:251], v93 offset:8832
  ds_read_b128 a[252:255], v93 offset:8896
  s_waitcnt lgkmcnt(7)
  v_mfma_f32_16x16x32_bf16 v[4:7], a[224:227], a[0:3], 0
  s_add_u32 s42, s28, 24576
  s_add_u32 m0, s27, 0
  s_nop 0
  buffer_load_dwordx4 v92, s[12:15], s42 offen offset:0 nt lds
  v_mfma_f32_16x16x32_bf16 v[28:31], a[224:227], a[32:35], 0
  v_mfma_f32_16x16x32_bf16 v[52:55], a[224:227], a[64:67], 0
  s_waitcnt lgkmcnt(6)
  v_mfma_f32_16x16x32_bf16 v[4:7], a[228:231], a[4:7], v[4:7]
  s_add_u32 m0, s27, 32
  s_nop 0
  buffer_load_dwordx4 v92, s[12:15], s42 offen offset:1024 nt lds
  v_mfma_f32_16x16x32_bf16 v[28:31], a[228:231], a[36:39], v[28:31]
  v_mfma_f32_16x16x32_bf16 v[52:55], a[228:231], a[68:71], v[52:55]
  s_waitcnt lgkmcnt(5)
  v_mfma_f32_16x16x32_bf16 v[4:7], a[232:235], a[8:11], v[4:7]
  s_add_u32 m0, s27, 64
  s_nop 0
  buffer_load_dwordx4 v92, s[12:15], s42 offen offset:2048 nt lds
  v_max_f32 v124, v0, v1
  v_mfma_f32_16x16x32_bf16 v[28:31], a[232:235], a[40:43], v[28:31]
  v_max_f32 v125, v24, v25
  v_mfma_f32_16x16x32_bf16 v[52:55], a[232:235], a[72:75], v[52:55]
  s_waitcnt lgkmcnt(4)
  v_mfma_f32_16x16x32_bf16 v[4:7], a[236:239], a[12:15], v[4:7]
  s_add_u32 m0, s27, 96
  s_nop 0
  buffer_load_dwordx4 v92, s[12:15], s42 offen offset:3072 nt lds
  v_max3_f32 v124, v2, v3, v124
  v_mfma_f32_16x16x32_bf16 v[28:31], a[236:239], a[44:47], v[28:31]
  v_max3_f32 v125, v26, v27, v125
  v_mfma_f32_16x16x32_bf16 v[52:55], a[236:239], a[76:79], v[52:55]
  s_waitcnt lgkmcnt(3)
  v_mfma_f32_16x16x32_bf16 v[4:7], a[240:243], a[16:19], v[4:7]
  s_add_u32 s43, s28, 28672
  s_add_u32 m0, s27, 4224
  s_nop 0
  buffer_load_dwordx4 v92, s[12:15], s43 offen offset:0 nt lds
  v_mfma_f32_16x16x32_bf16 v[28:31], a[240:243], a[48:51], v[28:31]
  v_mfma_f32_16x16x32_bf16 v[52:55], a[240:243], a[80:83], v[52:55]
  s_waitcnt lgkmcnt(2)
  v_mfma_f32_16x16x32_bf16 v[4:7], a[244:247], a[20:23], v[4:7]
  s_add_u32 m0, s27, 4256
  s_nop 0
  buffer_load_dwordx4 v92, s[12:15], s43 offen offset:1024 nt lds
  v_mfma_f32_16x16x32_bf16 v[28:31], a[244:247], a[52:55], v[28:31]
  v_mfma_f32_16x16x32_bf16 v[52:55], a[244:247], a[84:87], v[52:55]
  s_waitcnt lgkmcnt(1)
  v_mfma_f32_16x16x32_bf16 v[4:7], a[248:251], a[24:27], v[4:7]
  s_add_u32 m0, s27, 4288
  s_nop 0
  buffer_load_dwordx4 v92, s[12:15], s43 offen offset:2048 nt lds
  v_mfma_f32_16x16x32_bf16 v[28:31], a[248:251], a[56:59], v[28:31]
  v_mfma_f32_16x16x32_bf16 v[52:55], a[248:251], a[88:91], v[52:55]
  s_waitcnt lgkmcnt(0)
  v_mfma_f32_16x16x32_bf16 v[4:7], a[252:255], a[28:31], v[4:7]
  s_add_u32 m0, s27, 4320
  s_nop 0
  buffer_load_dwordx4 v92, s[12:15], s43 offen offset:3072 nt lds
  v_mfma_f32_16x16x32_bf16 v[28:31], a[252:255], a[60:63], v[28:31]
  v_mfma_f32_16x16x32_bf16 v[52:55], a[252:255], a[92:95], v[52:55]
  s_waitcnt vmcnt(8)
  ds_read_b128 v[128:131], v93 offset:16896
  ds_read_b128 v[144:147], v93 offset:16960
  ds_read_b128 v[160:163], v93 offset:17024
  ds_read_b128 v[176:179], v93 offset:17088
  ds_read_b128 v[192:195], v93 offset:17152
  ds_read_b128 v[208:211], v93 offset:17216
  ds_read_b128 v[224:227], v93 offset:17280
  ds_read_b128 v[240:243], v93 offset:17344
  s_waitcnt lgkmcnt(7)
  v_mfma_f32_16x16x32_bf16 v[8:11], v[128:131], a[0:3], 0
  s_add_u32 s44, s28, 32768
  s_add_u32 m0, s27, 8448
  s_nop 0
  buffer_load_dwordx4 v92, s[12:15], s44 offen offset:0 nt lds
  v_mfma_f32_16x16x32_bf16 v[32:35], v[128:131], a[32:35], 0
  v_mfma_f32_16x16x32_bf16 v[56:59], v[128:131], a[64:67], 0
  s_waitcnt lgkmcnt(6)
  v_mfma_f32_16x16x32_bf16 v[8:11], v[144:147], a[4:7], v[8:11]
  s_add_u32 m0, s27, 8480
  s_nop 0
  buffer_load_dwordx4 v92, s[12:15], s44 offen offset:1024 nt lds
  v_mfma_f32_16x16x32_bf16 v[32:35], v[144:147], a[36:39], v[32:35]
  v_mfma_f32_16x16x32_bf16 v[56:59], v[144:147], a[68:71], v[56:59]
  s_waitcnt lgkmcnt(5)
  v_mfma_f32_16x16x32_bf16 v[8:11], v[160:163], a[8:11], v[8:11]
  s_add_u32 m0, s27, 8512
  s_nop 0
  buffer_load_dwordx4 v92, s[12:15], s44 offen offset:2048 nt lds
  v_max3_f32 v124, v4, v5, v124
  v_mfma_f32_16x16x32_bf16 v[32:35], v[160:163], a[40:43], v[32:35]
  v_max3_f32 v125, v28, v29, v125
  v_mfma_f32_16x16x32_bf16 v[56:59], v[160:163], a[72:75], v[56:59]
  s_waitcnt lgkmcnt(4)
  v_mfma_f32_16x16x32_bf16 v[8:11], v[176:179], a[12:15], v[8:11]
  s_add_u32 m0, s27, 8544
  s_nop 0
  buffer_load_dwordx4 v92, s[12:15], s44 offen offset:3072 nt lds
  v_max3_f32 v124, v6, v7, v124
  v_mfma_f32_16x16x32_bf16 v[32:35], v[176:179], a[44:47], v[32:35]
  v_max3_f32 v125, v30, v31, v125
  v_mfma_f32_16x16x32_bf16 v[56:59], v[176:179], a[76:79], v[56:59]
  s_waitcnt lgkmcnt(3)
  v_mfma_f32_16x16x32_bf16 v[8:11], v[192:195], a[16:19], v[8:11]
  s_add_u32 s45, s28, 36864
  s_add_u32 m0, s27, 12672
  s_nop 0
  buffer_load_dwordx4 v92, s[12:15], s45 offen offset:0 nt lds
  v_mfma_f32_16x16x32_bf16 v[32:35], v[192:195], a[48:51], v[32:35]
  v_mfma_f32_16x16x32_bf16 v[56:59], v[192:195], a[80:83], v[56:59]
  s_waitcnt lgkmcnt(2)
  v_mfma_f32_16x16x32_bf16 v[8:11], v[208:211], a[20:23], v[8:11]
  s_add_u32 m0, s27, 12704
  s_nop 0
  buffer_load_dwordx4 v92, s[12:15], s45 offen offset:1024 nt lds
  v_mfma_f32_16x16x32_bf16 v[32:35], v[208:211], a[52:55], v[32:35]
  v_mfma_f32_16x16x32_bf16 v[56:59], v[208:211], a[84:87], v[56:59]
  s_waitcnt lgkmcnt(1)
  v_mfma_f32_16x16x32_bf16 v[8:11], v[224:227], a[24:27], v[8:11]
  s_add_u32 m0, s27, 12736
  s_nop 0
  buffer_load_dwordx4 v92, s[12:15], s45 offen offset:2048 nt lds
  v_mfma_f32_16x16x32_bf16 v[32:35], v[224:227], a[56:59], v[32:35]
  v_mfma_f32_16x16x32_bf16 v[56:59], v[224:227], a[88:91], v[56:59]
  s_waitcnt lgkmcnt(0)
  v_mfma_f32_16x16x32_bf16 v[8:11], v[240:243], a[28:31], v[8:11]
  s_add_u32 m0, s27, 12768
  s_nop 0
  buffer_load_dwordx4 v92, s[12:15], s45 offen offset:3072 nt lds
  v_mfma_f32_16x16x32_bf16 v[32:35], v[240:243], a[60:63], v[32:35]
  v_mfma_f32_16x16x32_bf16 v[56:59], v[240:243], a[92:95], v[56:59]
  s_waitcnt vmcnt(8)
  ds_read_b128 v[132:135], v93 offset:0
  ds_read_b128 v[148:151], v93 offset:64
  ds_read_b128 v[164:167], v93 offset:128
  ds_read_b128 v[180:183], v93 offset:192
  ds_read_b128 v[196:199], v93 offset:256
  ds_read_b128 v[212:215], v93 offset:320
  ds_read_b128 v[228:231], v93 offset:384
  ds_read_b128 v[244:247], v93 offset:448
  s_waitcnt lgkmcnt(7)
  v_mfma_f32_16x16x32_bf16 v[12:15], v[132:135], a[0:3], 0
  s_add_u32 s46, s28, 40960
  s_add_u32 m0, s27, 16896
  s_nop 0
  buffer_load_dwordx4 v92, s[12:15], s46 offen offset:0 nt lds
  v_mfma_f32_16x16x32_bf16 v[36:39], v[132:135], a[32:35], 0
  v_mfma_f32_16x16x32_bf16 v[60:63], v[132:135], a[64:67], 0
  s_waitcnt lgkmcnt(6)
  v_mfma_f32_16x16x32_bf16 v[12:15], v[148:151], a[4:7], v[12:15]
  s_add_u32 m0, s27, 16928
  s_nop 0
  buffer_load_dwordx4 v92, s[12:15], s46 offen offset:1024 nt lds
  v_mfma_f32_16x16x32_bf16 v[36:39], v[148:151], a[36:39], v[36:39]
  v_mfma_f32_16x16x32_bf16 v[60:63], v[148:151], a[68:71], v[60:63]
  s_waitcnt lgkmcnt(5)
  v_mfma_f32_16x16x32_bf16 v[12:15], v[164:167], a[8:11], v[12:15]
  s_add_u32 m0, s27, 16960
  s_nop 0
  buffer_load_dwordx4 v92, s[12:15], s46 offen offset:2048 nt lds
  v_max3_f32 v124, v8, v9, v124
  v_mfma_f32_16x16x32_bf16 v[36:39], v[164:167], a[40:43], v[36:39]
  v_max3_f32 v125, v32, v33, v125
  v_mfma_f32_16x16x32_bf16 v[60:63], v[164:167], a[72:75], v[60:63]
  s_waitcnt lgkmcnt(4)
  v_mfma_f32_16x16x32_bf16 v[12:15], v[180:183], a[12:15], v[12:15]
  s_add_u32 m0, s27, 16992
  s_nop 0
  buffer_load_dwordx4 v92, s[12:15], s46 offen offset:3072 nt lds
  v_max3_f32 v124, v10, v11, v124
  v_mfma_f32_16x16x32_bf16 v[36:39], v[180:183], a[44:47], v[36:39]
  v_max3_f32 v125, v34, v35, v125
  v_mfma_f32_16x16x32_bf16 v[60:63], v[180:183], a[76:79], v[60:63]
  s_waitcnt lgkmcnt(3)
  v_mfma_f32_16x16x32_bf16 v[12:15], v[196:199], a[16:19], v[12:15]
  s_add_u32 s47, s28, 45056
  s_add_u32 m0, s27, 21120
  s_nop 0
  buffer_load_dwordx4 v92, s[12:15], s47 offen offset:0 nt lds
  v_mfma_f32_16x16x32_bf16 v[36:39], v[196:199], a[48:51], v[36:39]
  v_mfma_f32_16x16x32_bf16 v[60:63], v[196:199], a[80:83], v[60:63]
  s_waitcnt lgkmcnt(2)
  v_mfma_f32_16x16x32_bf16 v[12:15], v[212:215], a[20:23], v[12:15]
  s_add_u32 m0, s27, 21152
  s_nop 0
  buffer_load_dwordx4 v92, s[12:15], s47 offen offset:1024 nt lds
  v_mfma_f32_16x16x32_bf16 v[36:39], v[212:215], a[52:55], v[36:39]
  v_mfma_f32_16x16x32_bf16 v[60:63], v[212:215], a[84:87], v[60:63]
  s_waitcnt lgkmcnt(1)
  v_mfma_f32_16x16x32_bf16 v[12:15], v[228:231], a[24:27], v[12:15]
  s_add_u32 m0, s27, 21184
  s_nop 0
  buffer_load_dwordx4 v92, s[12:15], s47 offen offset:2048 nt lds
  v_mfma_f32_16x16x32_bf16 v[36:39], v[228:231], a[56:59], v[36:39]
  v_mfma_f32_16x16x32_bf16 v[60:63], v[228:231], a[88:91], v[60:63]
  s_waitcnt lgkmcnt(0)
  v_mfma_f32_16x16x32_bf16 v[12:15], v[244:247], a[28:31], v[12:15]
  s_add_u32 m0, s27, 21216
  s_nop 0
  buffer_load_dwordx4 v92, s[12:15], s47 offen offset:3072 nt lds
  v_mfma_f32_16x16x32_bf16 v[36:39], v[244:247], a[60:63], v[36:39]
  v_mfma_f32_16x16x32_bf16 v[60:63], v[244:247], a[92:95], v[60:63]
  s_waitcnt vmcnt(8)
  ds_read_b128 v[136:139], v93 offset:8448
  ds_read_b128 v[152:155], v93 offset:8512
  ds_read_b128 v[168:171], v93 offset:8576
  ds_read_b128 v[184:187], v93 offset:8640
  ds_read_b128 v[200:203], v93 offset:8704
  ds_read_b128 v[216:219], v93 offset:8768
  ds_read_b128 v[232:235], v93 offset:8832
  ds_read_b128 v[248:251], v93 offset:8896
  s_waitcnt lgkmcnt(7)
  v_mfma_f32_16x16x32_bf16 v[16:19], v[136:139], a[0:3], 0
  s_mov_b32 s32, 24576
  s_add_u32 m0, s26, 25344
  s_nop 0
  buffer_load_dwordx4 v118, s[8:11], s32 offen offset:0 nt lds
  s_add_u32 m0, s26, 25376
  s_nop 0
  buffer_load_dwordx4 v118, s[8:11], s32 offen offset:1024 nt lds
  v_mfma_f32_16x16x32_bf16 v[40:43], v[136:139], a[32:35], 0
  v_mfma_f32_16x16x32_bf16 v[64:67], v[136:139], a[64:67], 0
  s_waitcnt lgkmcnt(6)
  v_mfma_f32_16x16x32_bf16 v[16:19], v[152:155], a[4:7], v[16:19]
  v_mfma_f32_16x16x32_bf16 v[40:43], v[152:155], a[36:39], v[40:43]
  v_mfma_f32_16x16x32_bf16 v[64:67], v[152:155], a[68:71], v[64:67]
  s_waitcnt lgkmcnt(5)
  v_mfma_f32_16x16x32_bf16 v[16:19], v[168:171], a[8:11], v[16:19]
  s_mov_b32 s33, 32768
  s_add_u32 m0, s26, 33792
  s_nop 0
  buffer_load_dwordx4 v118, s[8:11], s33 offen offset:0 nt lds
  s_add_u32 m0, s26, 33824
  s_nop 0
  buffer_load_dwordx4 v118, s[8:11], s33 offen offset:1024 nt lds
  v_max3_f32 v124, v12, v13, v124
  v_mfma_f32_16x16x32_bf16 v[40:43], v[168:171], a[40:43], v[40:43]
  v_max3_f32 v125, v36, v37, v125
  v_mfma_f32_16x16x32_bf16 v[64:67], v[168:171], a[72:75], v[64:67]
  s_waitcnt lgkmcnt(4)
  v_mfma_f32_16x16x32_bf16 v[16:19], v[184:187], a[12:15], v[16:19]
  v_max3_f32 v124, v14, v15, v124
  v_mfma_f32_16x16x32_bf16 v[40:43], v[184:187], a[44:47], v[40:43]
  v_max3_f32 v125, v38, v39, v125
  v_mfma_f32_16x16x32_bf16 v[64:67], v[184:187], a[76:79], v[64:67]
  s_waitcnt lgkmcnt(3)
  v_mfma_f32_16x16x32_bf16 v[16:19], v[200:203], a[16:19], v[16:19]
  s_mov_b32 s34, 40960
  s_add_u32 m0, s26, 42240
  s_nop 0
  buffer_load_dwordx4 v118, s[8:11], s34 offen offset:0 nt lds
  s_add_u32 m0, s26, 42272
  s_nop 0
  buffer_load_dwordx4 v118, s[8:11], s34 offen offset:1024 nt lds
  v_mfma_f32_16x16x32_bf16 v[40:43], v[200:203], a[48:51], v[40:43]
  v_mfma_f32_16x16x32_bf16 v[64:67], v[200:203], a[80:83], v[64:67]
  s_waitcnt lgkmcnt(2)
  v_mfma_f32_16x16x32_bf16 v[16:19], v[216:219], a[20:23], v[16:19]
  v_mfma_f32_16x16x32_bf16 v[40:43], v[216:219], a[52:55], v[40:43]
  v_mfma_f32_16x16x32_bf16 v[64:67], v[216:219], a[84:87], v[64:67]
  s_waitcnt lgkmcnt(1)
  v_mfma_f32_16x16x32_bf16 v[16:19], v[232:235], a[24:27], v[16:19]
  s_mov_b32 s35, 49152
  s_add_u32 m0, s26, 50688
  s_nop 0
  buffer_load_dwordx4 v118, s[8:11], s35 offen offset:0 nt lds
  s_add_u32 m0, s26, 50720
  s_nop 0
  buffer_load_dwordx4 v118, s[8:11], s35 offen offset:1024 nt lds
  v_mfma_f32_16x16x32_bf16 v[40:43], v[232:235], a[56:59], v[40:43]
  v_mfma_f32_16x16x32_bf16 v[64:67], v[232:235], a[88:91], v[64:67]
  s_waitcnt lgkmcnt(0)
  v_mfma_f32_16x16x32_bf16 v[16:19], v[248:251], a[28:31], v[16:19]
  v_mfma_f32_16x16x32_bf16 v[40:43], v[248:251], a[60:63], v[40:43]
  v_mfma_f32_16x16x32_bf16 v[64:67], v[248:251], a[92:95], v[64:67]
  s_waitcnt vmcnt(8)
  ds_read_b128 v[140:143], v93 offset:16896
  ds_read_b128 v[156:159], v93 offset:16960
  ds_read_b128 v[172:175], v93 offset:17024
  ds_read_b128 v[188:191], v93 offset:17088
  ds_read_b128 v[204:207], v93 offset:17152
  ds_read_b128 v[220:223], v93 offset:17216
  ds_read_b128 v[236:239], v93 offset:17280
  ds_read_b128 v[252:255], v93 offset:17344
  s_waitcnt lgkmcnt(0) vmcnt(6)
  s_barrier
  ds_read_b128 v[96:99], v112 offset:25344
  ds_read_b128 v[100:103], v112 offset:25408
  s_waitcnt lgkmcnt(1)
  v_mfma_f32_16x16x32_bf16 v[72:75], a[192:195], v[96:99], 0
  ds_read_b128 v[104:107], v112 offset:25472
  v_max3_f32 v125, v40, v41, v125
  v_max3_f32 v125, v42, v43, v125
  v_mfma_f32_16x16x32_bf16 v[76:79], a[224:227], v[96:99], 0
  v_max3_f32 v124, v16, v17, v124
  v_max3_f32 v124, v18, v19, v124
  v_mfma_f32_16x16x32_bf16 v[80:83], v[128:131], v[96:99], 0
  v_mfma_f32_16x16x32_bf16 v[84:87], v[132:135], v[96:99], 0
  v_mfma_f32_16x16x32_bf16 v[88:91], v[136:139], v[96:99], 0
  v_mfma_f32_16x16x32_bf16 v[20:23], v[140:143], a[0:3], 0
  v_mfma_f32_16x16x32_bf16 v[44:47], v[140:143], a[32:35], 0
  v_mfma_f32_16x16x32_bf16 v[68:71], v[140:143], a[64:67], 0
  v_mfma_f32_16x16x32_bf16 v[92:95], v[140:143], v[96:99], 0
  s_waitcnt lgkmcnt(1)
  ds_read_b128 v[96:99], v112 offset:25536
  v_mfma_f32_16x16x32_bf16 v[72:75], a[196:199], v[100:103], v[72:75]
  v_mfma_f32_16x16x32_bf16 v[76:79], a[228:231], v[100:103], v[76:79]
  v_mfma_f32_16x16x32_bf16 v[80:83], v[144:147], v[100:103], v[80:83]
  v_mfma_f32_16x16x32_bf16 v[84:87], v[148:151], v[100:103], v[84:87]
  v_mfma_f32_16x16x32_bf16 v[88:91], v[152:155], v[100:103], v[88:91]
  v_mfma_f32_16x16x32_bf16 v[20:23], v[156:159], a[4:7], v[20:23]
  v_mfma_f32_16x16x32_bf16 v[44:47], v[156:159], a[36:39], v[44:47]
  v_mfma_f32_16x16x32_bf16 v[68:71], v[156:159], a[68:71], v[68:71]
  v_mfma_f32_16x16x32_bf16 v[92:95], v[156:159], v[100:103], v[92:95]
  s_waitcnt lgkmcnt(1)
  ds_read_b128 v[100:103], v112 offset:25600
  v_mfma_f32_16x16x32_bf16 v[72:75], a[200:203], v[104:107], v[72:75]
  v_mfma_f32_16x16x32_bf16 v[76:79], a[232:235], v[104:107], v[76:79]
  v_mfma_f32_16x16x32_bf16 v[80:83], v[160:163], v[104:107], v[80:83]
  v_mfma_f32_16x16x32_bf16 v[84:87], v[164:167], v[104:107], v[84:87]
  v_mfma_f32_16x16x32_bf16 v[88:91], v[168:171], v[104:107], v[88:91]
  v_mfma_f32_16x16x32_bf16 v[20:23], v[172:175], a[8:11], v[20:23]
  v_mfma_f32_16x16x32_bf16 v[44:47], v[172:175], a[40:43], v[44:47]
  v_mfma_f32_16x16x32_bf16 v[68:71], v[172:175], a[72:75], v[68:71]
  v_mfma_f32_16x16x32_bf16 v[92:95], v[172:175], v[104:107], v[92:95]
  s_waitcnt lgkmcnt(1)
  ds_read_b128 v[104:107], v112 offset:25664
  v_mfma_f32_16x16x32_bf16 v[72:75], a[204:207], v[96:99], v[72:75]
  v_mfma_f32_16x16x32_bf16 v[76:79], a[236:239], v[96:99], v[76:79]
  v_mfma_f32_16x16x32_bf16 v[80:83], v[176:179], v[96:99], v[80:83]
  v_mfma_f32_16x16x32_bf16 v[84:87], v[180:183], v[96:99], v[84:87]
  v_mfma_f32_16x16x32_bf16 v[88:91], v[184:187], v[96:99], v[88:91]
  v_mfma_f32_16x16x32_bf16 v[20:23], v[188:191], a[12:15], v[20:23]
  v_mfma_f32_16x16x32_bf16 v[44:47], v[188:191], a[44:47], v[44:47]
  v_mfma_f32_16x16x32_bf16 v[68:71], v[188:191], a[76:79], v[68:71]
  v_mfma_f32_16x16x32_bf16 v[92:95], v[188:191], v[96:99], v[92:95]
  s_waitcnt lgkmcnt(1)
  ds_read_b128 v[96:99], v112 offset:25728
  v_mfma_f32_16x16x32_bf16 v[72:75], a[208:211], v[100:103], v[72:75]
  v_mfma_f32_16x16x32_bf16 v[76:79], a[240:243], v[100:103], v[76:79]
  v_mfma_f32_16x16x32_bf16 v[80:83], v[192:195], v[100:103], v[80:83]
  v_mfma_f32_16x16x32_bf16 v[84:87], v[196:199], v[100:103], v[84:87]
  v_mfma_f32_16x16x32_bf16 v[88:91], v[200:203], v[100:103], v[88:91]
  v_mfma_f32_16x16x32_bf16 v[20:23], v[204:207], a[16:19], v[20:23]
  v_mfma_f32_16x16x32_bf16 v[44:47], v[204:207], a[48:51], v[44:47]
  v_mfma_f32_16x16x32_bf16 v[68:71], v[204:207], a[80:83], v[68:71]
  v_mfma_f32_16x16x32_bf16 v[92:95], v[204:207], v[100:103], v[92:95]
  s_waitcnt lgkmcnt(1)
  ds_read_b128 v[100:103], v112 offset:25792
  v_mfma_f32_16x16x32_bf16 v[72:75], a[212:215], v[104:107], v[72:75]
  v_mfma_f32_16x16x32_bf16 v[76:79], a[244:247], v[104:107], v[76:79]
  v_mfma_f32_16x16x32_bf16 v[80:83], v[208:211], v[104:107], v[80:83]
  v_mfma_f32_16x16x32_bf16 v[84:87], v[212:215], v[104:107], v[84:87]
  v_mfma_f32_16x16x32_bf16 v[88:91], v[216:219], v[104:107], v[88:91]
  v_mfma_f32_16x16x32_bf16 v[20:23], v[220:223], a[20:23], v[20:23]
  v_mfma_f32_16x16x32_bf16 v[44:47], v[220:223], a[52:55], v[44:47]
  v_mfma_f32_16x16x32_bf16 v[68:71], v[220:223], a[84:87], v[68:71]
  v_mfma_f32_16x16x32_bf16 v[92:95], v[220:223], v[104:107], v[92:95]
  s_waitcnt lgkmcnt(1)
  v_mfma_f32_16x16x32_bf16 v[72:75], a[216:219], v[96:99], v[72:75]
  v_mfma_f32_16x16x32_bf16 v[76:79], a[248:251], v[96:99], v[76:79]
  v_mfma_f32_16x16x32_bf16 v[80:83], v[224:227], v[96:99], v[80:83]
  v_mfma_f32_16x16x32_bf16 v[84:87], v[228:231], v[96:99], v[84:87]
  v_mfma_f32_16x16x32_bf16 v[88:91], v[232:235], v[96:99], v[88:91]
  v_mfma_f32_16x16x32_bf16 v[20:23], v[236:239], a[24:27], v[20:23]
  v_mfma_f32_16x16x32_bf16 v[44:47], v[236:239], a[56:59], v[44:47]
  v_mfma_f32_16x16x32_bf16 v[68:71], v[236:239], a[88:91], v[68:71]
  v_mfma_f32_16x16x32_bf16 v[92:95], v[236:239], v[96:99], v[92:95]
  s_waitcnt lgkmcnt(0)
  v_mfma_f32_16x16x32_bf16 v[72:75], a[220:223], v[100:103], v[72:75]
  v_mfma_f32_16x16x32_bf16 v[76:79], a[252:255], v[100:103], v[76:79]
  v_mfma_f32_16x16x32_bf16 v[80:83], v[240:243], v[100:103], v[80:83]
  v_mfma_f32_16x16x32_bf16 v[84:87], v[244:247], v[100:103], v[84:87]
  v_mfma_f32_16x16x32_bf16 v[88:91], v[248:251], v[100:103], v[88:91]
  v_mfma_f32_16x16x32_bf16 v[20:23], v[252:255], a[28:31], v[20:23]
  v_mfma_f32_16x16x32_bf16 v[44:47], v[252:255], a[60:63], v[44:47]
  v_mfma_f32_16x16x32_bf16 v[68:71], v[252:255], a[92:95], v[68:71]
  v_mfma_f32_16x16x32_bf16 v[92:95], v[252:255], v[100:103], v[92:95]
  s_nop 4
  v_max3_f32 v124, v20, v21, v124
  v_max3_f32 v124, v22, v23, v124
  v_max3_f32 v125, v44, v45, v125
  v_max3_f32 v125, v46, v47, v125
  s_nop 1
  v_permlane32_swap_b32 v124, v125
  v_max_f32 v126, v124, v125
  v_max_f32 v127, v124, v125
  s_nop 1
  v_permlane16_swap_b32 v126, v127
  v_max_f32 v126, v126, v127
  ds_write_b32 v116, v126 offset:0
  s_waitcnt vmcnt(4) lgkmcnt(0)
  s_barrier
  ds_read_b128 v[108:111], v117 offset:0
  s_waitcnt lgkmcnt(0)
  v_max3_f32 v108, v108, v109, v110
  v_max_f32 v108, v108, v111
  v_mul_f32 v120, s25, v108
  v_fma_f32 v0, v0, s25, -v120
  v_exp_f32 v0, v0
  v_fma_f32 v1, v1, s25, -v120
  v_exp_f32 v1, v1
  s_nop 0
  v_cvt_pk_bf16_f32 v0, v0, v1
  v_fma_f32 v2, v2, s25, -v120
  v_exp_f32 v2, v2
  v_fma_f32 v3, v3, s25, -v120
  v_exp_f32 v3, v3
  s_nop 0
  v_cvt_pk_bf16_f32 v1, v2, v3
  v_fma_f32 v4, v4, s25, -v120
  v_exp_f32 v4, v4
  v_fma_f32 v5, v5, s25, -v120
  v_exp_f32 v5, v5
  s_nop 0
  v_cvt_pk_bf16_f32 v2, v4, v5
  v_fma_f32 v6, v6, s25, -v120
  v_exp_f32 v6, v6
  v_fma_f32 v7, v7, s25, -v120
  v_exp_f32 v7, v7
  s_nop 0
  v_cvt_pk_bf16_f32 v3, v6, v7
  ds_write_b128 v113, v[0:3] offset:0
  ds_read_b128 v[104:107], v112 offset:33792
  s_waitcnt lgkmcnt(0)
  v_mfma_f32_16x16x32_bf16 v[0:3], a[192:195], v[104:107], 0
  ds_read_b128 v[124:127], v117 offset:256
  s_mov_b32 s36, 57344
  v_fma_f32 v8, v8, s25, -v120
  v_fma_f32 v9, v9, s25, -v120
  v_mfma_f32_16x16x32_bf16 v[4:7], a[224:227], v[104:107], 0
  ds_read_b128 v[96:99], v112 offset:33856
  s_add_u32 m0, s26, 0
  v_exp_f32 v8, v8
  v_exp_f32 v9, v9
  s_nop 0
  v_cvt_pk_bf16_f32 v8, v8, v9
  v_fma_f32 v10, v10, s25, -v120
  v_exp_f32 v10, v10
  v_fma_f32 v11, v11, s25, -v120
  v_exp_f32 v11, v11
  s_nop 0
  v_cvt_pk_bf16_f32 v9, v10, v11
  v_fma_f32 v12, v12, s25, -v120
  v_exp_f32 v12, v12
  v_fma_f32 v13, v13, s25, -v120
  v_exp_f32 v13, v13
  s_nop 0
  v_cvt_pk_bf16_f32 v10, v12, v13
  v_fma_f32 v14, v14, s25, -v120
  v_exp_f32 v14, v14
  v_fma_f32 v15, v15, s25, -v120
  v_exp_f32 v15, v15
  s_nop 0
  v_cvt_pk_bf16_f32 v11, v14, v15
  ds_write_b128 v113, v[8:11] offset:1024
  s_nop 1
  v_mfma_f32_16x16x32_bf16 v[8:11], v[128:131], v[104:107], 0
  buffer_load_dwordx4 v118, s[8:11], s36 offen offset:0 nt lds
  s_add_u32 m0, s26, 32
  v_fma_f32 v16, v16, s25, -v120
  v_fma_f32 v17, v17, s25, -v120
  v_mfma_f32_16x16x32_bf16 v[12:15], v[132:135], v[104:107], 0
  buffer_load_dwordx4 v118, s[8:11], s36 offen offset:1024 nt lds
  s_mov_b32 s37, 65536
  v_exp_f32 v16, v16
  v_exp_f32 v17, v17
  s_nop 0
  v_cvt_pk_bf16_f32 v16, v16, v17
  v_fma_f32 v18, v18, s25, -v120
  v_exp_f32 v18, v18
  v_fma_f32 v19, v19, s25, -v120
  v_exp_f32 v19, v19
  s_nop 0
  v_cvt_pk_bf16_f32 v17, v18, v19
  v_fma_f32 v20, v20, s25, -v120
  v_exp_f32 v20, v20
  v_fma_f32 v21, v21, s25, -v120
  v_exp_f32 v21, v21
  s_nop 0
  v_cvt_pk_bf16_f32 v18, v20, v21
  v_fma_f32 v22, v22, s25, -v120
  v_exp_f32 v22, v22
  v_fma_f32 v23, v23, s25, -v120
  v_exp_f32 v23, v23
  s_nop 0
  v_cvt_pk_bf16_f32 v19, v22, v23
  ds_write_b128 v113, v[16:19] offset:2048
  s_nop 1
  v_mfma_f32_16x16x32_bf16 v[16:19], v[136:139], v[104:107], 0
  ds_read_b128 v[100:103], v112 offset:33920
  s_add_u32 m0, s26, 8448
  v_mfma_f32_16x16x32_bf16 v[20:23], v[140:143], v[104:107], 0
  s_waitcnt lgkmcnt(3)
  buffer_load_dwordx4 v118, s[8:11], s37 offen offset:0 nt lds
  s_add_u32 m0, s26, 8480
  v_mfma_f32_16x16x32_bf16 v[0:3], a[196:199], v[96:99], v[0:3]
  buffer_load_dwordx4 v118, s[8:11], s37 offen offset:1024 nt lds
  v_mfma_f32_16x16x32_bf16 v[4:7], a[228:231], v[96:99], v[4:7]
  ds_read_b128 v[104:107], v112 offset:33984
  v_max3_f32 v124, v124, v125, v126
  v_max_f32 v124, v124, v127
  v_mfma_f32_16x16x32_bf16 v[8:11], v[144:147], v[96:99], v[8:11]
  v_mul_f32 v121, s25, v124
  v_max3_f32 v124, v48, v49, v50
  v_mfma_f32_16x16x32_bf16 v[12:15], v[148:151], v[96:99], v[12:15]
  v_max3_f32 v124, v51, v52, v124
  v_max3_f32 v124, v53, v54, v124
  v_mfma_f32_16x16x32_bf16 v[16:19], v[152:155], v[96:99], v[16:19]
  v_max3_f32 v124, v55, v56, v124
  v_max3_f32 v124, v57, v58, v124
  v_mfma_f32_16x16x32_bf16 v[20:23], v[156:159], v[96:99], v[20:23]
  s_waitcnt lgkmcnt(1)
  ds_read_b128 v[96:99], v112 offset:34048
  v_max3_f32 v124, v59, v60, v124
  v_max3_f32 v124, v61, v62, v124
  v_mfma_f32_16x16x32_bf16 v[0:3], a[200:203], v[100:103], v[0:3]
  v_max3_f32 v124, v63, v64, v124
  v_max3_f32 v124, v65, v66, v124
  v_mfma_f32_16x16x32_bf16 v[4:7], a[232:235], v[100:103], v[4:7]
  v_max3_f32 v124, v67, v68, v124
  v_max3_f32 v124, v69, v70, v124
  v_mfma_f32_16x16x32_bf16 v[8:11], v[160:163], v[100:103], v[8:11]
  v_max_f32 v124, v71, v124
  v_max3_f32 v125, v72, v73, v74
  v_mfma_f32_16x16x32_bf16 v[12:15], v[164:167], v[100:103], v[12:15]
  v_max3_f32 v125, v75, v76, v125
  v_max3_f32 v125, v77, v78, v125
  v_mfma_f32_16x16x32_bf16 v[16:19], v[168:171], v[100:103], v[16:19]
  v_max3_f32 v125, v79, v80, v125
  v_max3_f32 v125, v81, v82, v125
  v_mfma_f32_16x16x32_bf16 v[20:23], v[172:175], v[100:103], v[20:23]
  s_waitcnt lgkmcnt(1)
  ds_read_b128 v[100:103], v112 offset:34112
  v_max3_f32 v125, v83, v84, v125
  v_max3_f32 v125, v85, v86, v125
  v_mfma_f32_16x16x32_bf16 v[0:3], a[204:207], v[104:107], v[0:3]
  v_max3_f32 v125, v87, v88, v125
  v_max3_f32 v125, v89, v90, v125
  v_mfma_f32_16x16x32_bf16 v[4:7], a[236:239], v[104:107], v[4:7]
  v_max3_f32 v125, v91, v92, v125
  v_max3_f32 v125, v93, v94, v125
  v_mfma_f32_16x16x32_bf16 v[8:11], v[176:179], v[104:107], v[8:11]
  v_max_f32 v125, v95, v125
  v_fma_f32 v24, v24, s25, -v121
  v_mfma_f32_16x16x32_bf16 v[12:15], v[180:183], v[104:107], v[12:15]
  v_permlane32_swap_b32 v124, v125
  v_mfma_f32_16x16x32_bf16 v[16:19], v[184:187], v[104:107], v[16:19]
  v_max_f32 v126, v124, v125
  v_max_f32 v127, v124, v125
  v_mfma_f32_16x16x32_bf16 v[20:23], v[188:191], v[104:107], v[20:23]
  s_waitcnt lgkmcnt(1)
  ds_read_b128 v[104:107], v112 offset:34176
  v_permlane16_swap_b32 v126, v127
  v_mfma_f32_16x16x32_bf16 v[0:3], a[208:211], v[96:99], v[0:3]
  v_max_f32 v126, v126, v127
  v_fma_f32 v25, v25, s25, -v121
  v_mfma_f32_16x16x32_bf16 v[4:7], a[240:243], v[96:99], v[4:7]
  ds_write_b32 v116, v126 offset:512
  v_exp_f32 v24, v24
  v_mfma_f32_16x16x32_bf16 v[8:11], v[192:195], v[96:99], v[8:11]
  v_fma_f32 v26, v26, s25, -v121
  v_exp_f32 v25, v25
  v_mfma_f32_16x16x32_bf16 v[12:15], v[196:199], v[96:99], v[12:15]
  v_fma_f32 v27, v27, s25, -v121
  v_exp_f32 v26, v26
  v_mfma_f32_16x16x32_bf16 v[16:19], v[200:203], v[96:99], v[16:19]
  s_waitcnt vmcnt(4) lgkmcnt(0)
  s_barrier
  v_fma_f32 v28, v28, s25, -v121
  v_cvt_pk_bf16_f32 v24, v24, v25
  v_mfma_f32_16x16x32_bf16 v[20:23], v[204:207], v[96:99], v[20:23]
  ds_read_b128 v[108:111], v117 offset:512
  ds_read_b128 v[124:127], v117 offset:768
  s_mov_b32 s38, 73728
  v_exp_f32 v27, v27
  v_mfma_f32_16x16x32_bf16 v[0:3], a[212:215], v[100:103], v[0:3]
  ds_read_b128 v[96:99], v112 offset:34240
  s_add_u32 m0, s26, 16896
  v_fma_f32 v29, v29, s25, -v121
  v_exp_f32 v28, v28
  v_mfma_f32_16x16x32_bf16 v[4:7], a[244:247], v[100:103], v[4:7]
  buffer_load_dwordx4 v118, s[8:11], s38 offen offset:0 nt lds
  s_add_u32 m0, s26, 16928
  v_fma_f32 v30, v30, s25, -v121
  v_cvt_pk_bf16_f32 v25, v26, v27
  v_mfma_f32_16x16x32_bf16 v[8:11], v[208:211], v[100:103], v[8:11]
  buffer_load_dwordx4 v118, s[8:11], s38 offen offset:1024 nt lds
  s_mov_b32 s39, 81920
  v_exp_f32 v29, v29
  v_mfma_f32_16x16x32_bf16 v[12:15], v[212:215], v[100:103], v[12:15]
  v_fma_f32 v31, v31, s25, -v121
  v_exp_f32 v30, v30
  v_mfma_f32_16x16x32_bf16 v[16:19], v[216:219], v[100:103], v[16:19]
  s_add_u32 m0, s26, 25344
  v_cvt_pk_bf16_f32 v26, v28, v29
  v_exp_f32 v31, v31
  v_mfma_f32_16x16x32_bf16 v[20:23], v[220:223], v[100:103], v[20:23]
  ds_read_b128 v[100:103], v112 offset:42240
  v_fma_f32 v32, v32, s25, -v121
  v_cvt_pk_bf16_f32 v27, v30, v31
  v_mfma_f32_16x16x32_bf16 v[0:3], a[216:219], v[104:107], v[0:3]
  s_waitcnt lgkmcnt(3)
  ds_write_b128 v113, v[24:27] offset:12288
  v_max3_f32 v108, v108, v109, v110
  v_max_f32 v108, v108, v111
  v_mfma_f32_16x16x32_bf16 v[4:7], a[248:251], v[104:107], v[4:7]
  s_waitcnt lgkmcnt(3)
  buffer_load_dwordx4 v118, s[8:11], s39 offen offset:0 nt lds
  v_mul_f32 v122, s25, v108
  v_max3_f32 v124, v124, v125, v126
  v_mfma_f32_16x16x32_bf16 v[8:11], v[224:227], v[104:107], v[8:11]
  v_max_f32 v124, v124, v127
  v_mul_f32 v123, s25, v124
  v_mfma_f32_16x16x32_bf16 v[12:15], v[228:231], v[104:107], v[12:15]
  v_fma_f32 v33, v33, s25, -v121
  v_exp_f32 v32, v32
  v_mfma_f32_16x16x32_bf16 v[16:19], v[232:235], v[104:107], v[16:19]
  v_fma_f32 v34, v34, s25, -v121
  v_exp_f32 v33, v33
  v_mfma_f32_16x16x32_bf16 v[20:23], v[236:239], v[104:107], v[20:23]
  s_waitcnt lgkmcnt(2)
  ds_read_b128 v[104:107], v112 offset:42304
  v_fma_f32 v35, v35, s25, -v121
  v_exp_f32 v34, v34
  v_mfma_f32_16x16x32_bf16 v[0:3], a[220:223], v[96:99], v[0:3]
  v_fma_f32 v36, v36, s25, -v121
  v_cvt_pk_bf16_f32 v32, v32, v33
  v_mfma_f32_16x16x32_bf16 v[4:7], a[252:255], v[96:99], v[4:7]
  v_exp_f32 v35, v35
  v_mfma_f32_16x16x32_bf16 v[8:11], v[240:243], v[96:99], v[8:11]
  s_add_u32 m0, s26, 25376
  v_fma_f32 v37, v37, s25, -v121
  v_exp_f32 v36, v36
  v_mfma_f32_16x16x32_bf16 v[12:15], v[244:247], v[96:99], v[12:15]
  v_fma_f32 v38, v38, s25, -v121
  v_cvt_pk_bf16_f32 v33, v34, v35
  v_mfma_f32_16x16x32_bf16 v[16:19], v[248:251], v[96:99], v[16:19]
  buffer_load_dwordx4 v118, s[8:11], s39 offen offset:1024 nt lds
  v_exp_f32 v37, v37
  v_mfma_f32_16x16x32_bf16 v[20:23], v[252:255], v[96:99], v[20:23]
  s_waitcnt lgkmcnt(2)
  ds_read_b128 v[96:99], v112 offset:42368
  v_fma_f32 v39, v39, s25, -v121
  v_exp_f32 v38, v38
  v_mfma_f32_16x16x32_bf16 v[24:27], a[192:195], v[100:103], 0
  v_cvt_pk_bf16_f32 v34, v36, v37
  v_exp_f32 v39, v39
  v_mfma_f32_16x16x32_bf16 v[28:31], a[224:227], v[100:103], 0
  v_fma_f32 v40, v40, s25, -v121
  v_cvt_pk_bf16_f32 v35, v38, v39
  ds_write_b128 v113, v[32:35] offset:13312
  s_nop 1
  v_mfma_f32_16x16x32_bf16 v[32:35], v[128:131], v[100:103], 0
  v_fma_f32 v41, v41, s25, -v121
  v_exp_f32 v40, v40
  v_mfma_f32_16x16x32_bf16 v[36:39], v[132:135], v[100:103], 0
  v_fma_f32 v42, v42, s25, -v121
  v_exp_f32 v41, v41
  s_nop 0
  v_cvt_pk_bf16_f32 v40, v40, v41
  v_exp_f32 v42, v42
  v_fma_f32 v43, v43, s25, -v121
  v_exp_f32 v43, v43
  s_nop 0
  v_cvt_pk_bf16_f32 v41, v42, v43
  v_fma_f32 v44, v44, s25, -v121
  v_exp_f32 v44, v44
  v_fma_f32 v45, v45, s25, -v121
  v_exp_f32 v45, v45
  s_nop 0
  v_cvt_pk_bf16_f32 v42, v44, v45
  v_fma_f32 v46, v46, s25, -v121
  v_exp_f32 v46, v46
  v_fma_f32 v47, v47, s25, -v121
  v_exp_f32 v47, v47
  s_nop 0
  v_cvt_pk_bf16_f32 v43, v46, v47
  ds_write_b128 v113, v[40:43] offset:14336
  s_nop 1
  v_mfma_f32_16x16x32_bf16 v[40:43], v[136:139], v[100:103], 0
  v_max3_f32 v124, v0, v1, v2
  v_max3_f32 v124, v3, v4, v124
  v_mfma_f32_16x16x32_bf16 v[44:47], v[140:143], v[100:103], 0
  s_waitcnt lgkmcnt(3)
  ds_read_b128 v[100:103], v112 offset:42432
  v_fma_f32 v48, v48, s25, -v122
  v_max3_f32 v124, v5, v6, v124
  v_mfma_f32_16x16x32_bf16 v[24:27], a[196:199], v[104:107], v[24:27]
  v_fma_f32 v49, v49, s25, -v122
  v_exp_f32 v48, v48
  v_mfma_f32_16x16x32_bf16 v[28:31], a[228:231], v[104:107], v[28:31]
  v_max3_f32 v124, v7, v8, v124
  v_fma_f32 v50, v50, s25, -v122
  v_mfma_f32_16x16x32_bf16 v[32:35], v[144:147], v[104:107], v[32:35]
  v_exp_f32 v49, v49
  v_mfma_f32_16x16x32_bf16 v[36:39], v[148:151], v[104:107], v[36:39]
  v_fma_f32 v51, v51, s25, -v122
  v_max3_f32 v124, v9, v10, v124
  v_mfma_f32_16x16x32_bf16 v[40:43], v[152:155], v[104:107], v[40:43]
  v_exp_f32 v50, v50
  v_mfma_f32_16x16x32_bf16 v[44:47], v[156:159], v[104:107], v[44:47]
  s_waitcnt lgkmcnt(3)
  ds_read_b128 v[104:107], v112 offset:42496
  v_fma_f32 v52, v52, s25, -v122
  v_cvt_pk_bf16_f32 v48, v48, v49
  v_mfma_f32_16x16x32_bf16 v[24:27], a[200:203], v[96:99], v[24:27]
  v_max3_f32 v124, v11, v12, v124
  v_exp_f32 v51, v51
  v_mfma_f32_16x16x32_bf16 v[28:31], a[232:235], v[96:99], v[28:31]
  v_fma_f32 v53, v53, s25, -v122
  v_exp_f32 v52, v52
  v_mfma_f32_16x16x32_bf16 v[32:35], v[160:163], v[96:99], v[32:35]
  v_max3_f32 v124, v13, v14, v124
  v_fma_f32 v54, v54, s25, -v122
  v_mfma_f32_16x16x32_bf16 v[36:39], v[164:167], v[96:99], v[36:39]
  v_cvt_pk_bf16_f32 v49, v50, v51
  v_exp_f32 v53, v53
  v_mfma_f32_16x16x32_bf16 v[40:43], v[168:171], v[96:99], v[40:43]
  v_max3_f32 v124, v15, v16, v124
  v_fma_f32 v55, v55, s25, -v122
  v_mfma_f32_16x16x32_bf16 v[44:47], v[172:175], v[96:99], v[44:47]
  s_waitcnt lgkmcnt(1)
  ds_read_b128 v[96:99], v112 offset:42560
  v_exp_f32 v54, v54
  v_mfma_f32_16x16x32_bf16 v[24:27], a[204:207], v[100:103], v[24:27]
  v_cvt_pk_bf16_f32 v50, v52, v53
  v_max3_f32 v124, v17, v18, v124
  v_mfma_f32_16x16x32_bf16 v[28:31], a[236:239], v[100:103], v[28:31]
  v_exp_f32 v55, v55
  v_mfma_f32_16x16x32_bf16 v[32:35], v[176:179], v[100:103], v[32:35]
  v_max3_f32 v124, v19, v20, v124
  v_fma_f32 v56, v56, s25, -v122
  v_mfma_f32_16x16x32_bf16 v[36:39], v[180:183], v[100:103], v[36:39]
  v_cvt_pk_bf16_f32 v51, v54, v55
  v_max3_f32 v124, v21, v22, v124
  v_mfma_f32_16x16x32_bf16 v[40:43], v[184:187], v[100:103], v[40:43]
  ds_write_b128 v113, v[48:51] offset:24576
  v_fma_f32 v57, v57, s25, -v122
  v_exp_f32 v56, v56
  v_mfma_f32_16x16x32_bf16 v[44:47], v[188:191], v[100:103], v[44:47]
  s_waitcnt lgkmcnt(2)
  ds_read_b128 v[100:103], v112 offset:42624
  v_max_f32 v124, v23, v124
  v_fma_f32 v58, v58, s25, -v122
  v_mfma_f32_16x16x32_bf16 v[24:27], a[208:211], v[104:107], v[24:27]
  v_exp_f32 v57, v57
  v_mfma_f32_16x16x32_bf16 v[28:31], a[240:243], v[104:107], v[28:31]
  v_fma_f32 v59, v59, s25, -v122
  v_exp_f32 v58, v58
  v_mfma_f32_16x16x32_bf16 v[32:35], v[192:195], v[104:107], v[32:35]
  v_fma_f32 v60, v60, s25, -v122
  v_cvt_pk_bf16_f32 v56, v56, v57
  v_mfma_f32_16x16x32_bf16 v[36:39], v[196:199], v[104:107], v[36:39]
  v_exp_f32 v59, v59
  v_mfma_f32_16x16x32_bf16 v[40:43], v[200:203], v[104:107], v[40:43]
  v_fma_f32 v61, v61, s25, -v122
  v_exp_f32 v60, v60
  v_mfma_f32_16x16x32_bf16 v[44:47], v[204:207], v[104:107], v[44:47]
  s_waitcnt lgkmcnt(2)
  ds_read_b128 v[104:107], v112 offset:42688
  v_fma_f32 v62, v62, s25, -v122
  v_cvt_pk_bf16_f32 v57, v58, v59
  v_mfma_f32_16x16x32_bf16 v[24:27], a[212:215], v[96:99], v[24:27]
  v_exp_f32 v61, v61
  v_mfma_f32_16x16x32_bf16 v[28:31], a[244:247], v[96:99], v[28:31]
  v_fma_f32 v63, v63, s25, -v122
  v_exp_f32 v62, v62
  v_mfma_f32_16x16x32_bf16 v[32:35], v[208:211], v[96:99], v[32:35]
  v_cvt_pk_bf16_f32 v58, v60, v61
  v_exp_f32 v63, v63
  v_mfma_f32_16x16x32_bf16 v[36:39], v[212:215], v[96:99], v[36:39]
  v_fma_f32 v64, v64, s25, -v122
  v_cvt_pk_bf16_f32 v59, v62, v63
  v_mfma_f32_16x16x32_bf16 v[40:43], v[216:219], v[96:99], v[40:43]
  ds_write_b128 v113, v[56:59] offset:25600
  v_fma_f32 v65, v65, s25, -v122
  v_exp_f32 v64, v64
  v_mfma_f32_16x16x32_bf16 v[44:47], v[220:223], v[96:99], v[44:47]
  s_waitcnt lgkmcnt(2)
  ds_read_b128 v[96:99], v112 offset:50688
  v_fma_f32 v66, v66, s25, -v122
  v_exp_f32 v65, v65
  v_mfma_f32_16x16x32_bf16 v[24:27], a[216:219], v[100:103], v[24:27]
  v_fma_f32 v67, v67, s25, -v122
  v_exp_f32 v66, v66
  v_mfma_f32_16x16x32_bf16 v[28:31], a[248:251], v[100:103], v[28:31]
  v_fma_f32 v68, v68, s25, -v122
  v_cvt_pk_bf16_f32 v64, v64, v65
  v_mfma_f32_16x16x32_bf16 v[32:35], v[224:227], v[100:103], v[32:35]
  v_exp_f32 v67, v67
  v_mfma_f32_16x16x32_bf16 v[36:39], v[228:231], v[100:103], v[36:39]
  v_fma_f32 v69, v69, s25, -v122
  v_exp_f32 v68, v68
  v_mfma_f32_16x16x32_bf16 v[40:43], v[232:235], v[100:103], v[40:43]
  v_fma_f32 v70, v70, s25, -v122
  v_cvt_pk_bf16_f32 v65, v66, v67
  v_mfma_f32_16x16x32_bf16 v[44:47], v[236:239], v[100:103], v[44:47]
  s_waitcnt lgkmcnt(2)
  ds_read_b128 v[100:103], v112 offset:50752
  v_exp_f32 v69, v69
  v_mfma_f32_16x16x32_bf16 v[24:27], a[220:223], v[104:107], v[24:27]
  v_fma_f32 v71, v71, s25, -v122
  v_exp_f32 v70, v70
  v_mfma_f32_16x16x32_bf16 v[28:31], a[252:255], v[104:107], v[28:31]
  v_cvt_pk_bf16_f32 v66, v68, v69
  v_exp_f32 v71, v71
  v_mfma_f32_16x16x32_bf16 v[32:35], v[240:243], v[104:107], v[32:35]
  v_fma_f32 v72, v72, s25, -v123
  v_cvt_pk_bf16_f32 v67, v70, v71
  v_mfma_f32_16x16x32_bf16 v[36:39], v[244:247], v[104:107], v[36:39]
  ds_write_b128 v113, v[64:67] offset:26624
  v_max3_f32 v125, v24, v25, v26
  v_max3_f32 v125, v27, v28, v125
  v_mfma_f32_16x16x32_bf16 v[40:43], v[248:251], v[104:107], v[40:43]
  v_max3_f32 v125, v29, v30, v125
  v_max3_f32 v125, v31, v32, v125
  v_mfma_f32_16x16x32_bf16 v[44:47], v[252:255], v[104:107], v[44:47]
  s_waitcnt lgkmcnt(2)
  ds_read_b128 v[104:107], v112 offset:50816
  v_max3_f32 v125, v33, v34, v125
  v_max3_f32 v125, v35, v36, v125
  v_mfma_f32_16x16x32_bf16 v[48:51], a[192:195], v[96:99], 0
  v_max3_f32 v125, v37, v38, v125
  v_max3_f32 v125, v39, v40, v125
  v_mfma_f32_16x16x32_bf16 v[52:55], a[224:227], v[96:99], 0
  v_max3_f32 v125, v41, v42, v125
  v_max3_f32 v125, v43, v44, v125
  v_mfma_f32_16x16x32_bf16 v[56:59], v[128:131], v[96:99], 0
  v_max3_f32 v125, v45, v46, v125
  v_max_f32 v125, v47, v125
  v_mfma_f32_16x16x32_bf16 v[60:63], v[132:135], v[96:99], 0
  v_fma_f32 v73, v73, s25, -v123
  v_permlane32_swap_b32 v124, v125
  v_mfma_f32_16x16x32_bf16 v[64:67], v[136:139], v[96:99], 0
  v_max_f32 v126, v124, v125
  v_max_f32 v127, v124, v125
  v_mfma_f32_16x16x32_bf16 v[68:71], v[140:143], v[96:99], 0
  s_waitcnt lgkmcnt(2)
  ds_read_b128 v[96:99], v112 offset:50880
  v_permlane16_swap_b32 v126, v127
  v_mfma_f32_16x16x32_bf16 v[48:51], a[196:199], v[100:103], v[48:51]
  v_max_f32 v126, v126, v127
  v_exp_f32 v72, v72
  v_mfma_f32_16x16x32_bf16 v[52:55], a[228:231], v[100:103], v[52:55]
  ds_write_b32 v116, v126 offset:0
  v_fma_f32 v74, v74, s25, -v123
  v_exp_f32 v73, v73
  v_mfma_f32_16x16x32_bf16 v[56:59], v[144:147], v[100:103], v[56:59]
  v_fma_f32 v75, v75, s25, -v123
  v_exp_f32 v74, v74
  v_mfma_f32_16x16x32_bf16 v[60:63], v[148:151], v[100:103], v[60:63]
  v_fma_f32 v76, v76, s25, -v123
  v_cvt_pk_bf16_f32 v72, v72, v73
  v_mfma_f32_16x16x32_bf16 v[64:67], v[152:155], v[100:103], v[64:67]
  s_waitcnt lgkmcnt(0) vmcnt(4)
  s_barrier
  v_exp_f32 v75, v75
  v_mfma_f32_16x16x32_bf16 v[68:71], v[156:159], v[100:103], v[68:71]
  ds_read_b128 v[108:111], v117 offset:0
  ds_read_b128 v[124:127], v117 offset:256
  s_mov_b32 s40, 90112
  v_fma_f32 v77, v77, s25, -v123
  v_exp_f32 v76, v76
  v_mfma_f32_16x16x32_bf16 v[48:51], a[200:203], v[104:107], v[48:51]
  ds_read_b128 v[100:103], v112 offset:50944
  s_mov_b32 s41, 98304
  v_fma_f32 v78, v78, s25, -v123
  v_cvt_pk_bf16_f32 v73, v74, v75
  v_mfma_f32_16x16x32_bf16 v[52:55], a[232:235], v[104:107], v[52:55]
  v_exp_f32 v77, v77
  v_mfma_f32_16x16x32_bf16 v[56:59], v[160:163], v[104:107], v[56:59]
  s_add_u32 m0, s26, 33792
  v_fma_f32 v79, v79, s25, -v123
  v_exp_f32 v78, v78
  v_mfma_f32_16x16x32_bf16 v[60:63], v[164:167], v[104:107], v[60:63]
  v_cvt_pk_bf16_f32 v74, v76, v77
  v_exp_f32 v79, v79
  v_mfma_f32_16x16x32_bf16 v[64:67], v[168:171], v[104:107], v[64:67]
  buffer_load_dwordx4 v118, s[8:11], s40 offen offset:0 nt lds
  v_fma_f32 v80, v80, s25, -v123
  v_cvt_pk_bf16_f32 v75, v78, v79
  v_mfma_f32_16x16x32_bf16 v[68:71], v[172:175], v[104:107], v[68:71]
  ds_write_b128 v113, v[72:75] offset:36864
  v_fma_f32 v81, v81, s25, -v123
  v_exp_f32 v80, v80
  v_mfma_f32_16x16x32_bf16 v[48:51], a[204:207], v[96:99], v[48:51]
  s_waitcnt lgkmcnt(3)
  ds_read_b128 v[104:107], v112 offset:51008
  v_max3_f32 v108, v108, v109, v110
  v_max_f32 v108, v108, v111
  v_mfma_f32_16x16x32_bf16 v[52:55], a[236:239], v[96:99], v[52:55]
  s_waitcnt lgkmcnt(3)
  v_mul_f32 v120, s25, v108
  v_max3_f32 v124, v124, v125, v126
  v_mfma_f32_16x16x32_bf16 v[56:59], v[176:179], v[96:99], v[56:59]
  v_max_f32 v124, v124, v127
  v_mul_f32 v121, s25, v124
  v_mfma_f32_16x16x32_bf16 v[60:63], v[180:183], v[96:99], v[60:63]
  v_fma_f32 v82, v82, s25, -v123
  v_exp_f32 v81, v81
  v_mfma_f32_16x16x32_bf16 v[64:67], v[184:187], v[96:99], v[64:67]
  v_fma_f32 v83, v83, s25, -v123
  v_exp_f32 v82, v82
  v_mfma_f32_16x16x32_bf16 v[68:71], v[188:191], v[96:99], v[68:71]
  s_waitcnt lgkmcnt(2)
  ds_read_b128 v[96:99], v112 offset:51072
  v_fma_f32 v84, v84, s25, -v123
  v_cvt_pk_bf16_f32 v80, v80, v81
  v_mfma_f32_16x16x32_bf16 v[48:51], a[208:211], v[100:103], v[48:51]
  s_add_u32 m0, s26, 33824
  v_exp_f32 v83, v83
  v_mfma_f32_16x16x32_bf16 v[52:55], a[240:243], v[100:103], v[52:55]
  v_fma_f32 v85, v85, s25, -v123
  v_exp_f32 v84, v84
  v_mfma_f32_16x16x32_bf16 v[56:59], v[192:195], v[100:103], v[56:59]
  buffer_load_dwordx4 v118, s[8:11], s40 offen offset:1024 nt lds
  v_fma_f32 v86, v86, s25, -v123
  v_cvt_pk_bf16_f32 v81, v82, v83
  v_mfma_f32_16x16x32_bf16 v[60:63], v[196:199], v[100:103], v[60:63]
  v_exp_f32 v85, v85
  v_mfma_f32_16x16x32_bf16 v[64:67], v[200:203], v[100:103], v[64:67]
  v_fma_f32 v87, v87, s25, -v123
  v_exp_f32 v86, v86
  v_mfma_f32_16x16x32_bf16 v[68:71], v[204:207], v[100:103], v[68:71]
  s_waitcnt lgkmcnt(1)
  ds_read_b128 v[100:103], v112 offset:51136
  v_cvt_pk_bf16_f32 v82, v84, v85
  v_exp_f32 v87, v87
  v_mfma_f32_16x16x32_bf16 v[48:51], a[212:215], v[104:107], v[48:51]
  v_fma_f32 v88, v88, s25, -v123
  v_cvt_pk_bf16_f32 v83, v86, v87
  v_mfma_f32_16x16x32_bf16 v[52:55], a[244:247], v[104:107], v[52:55]
  ds_write_b128 v113, v[80:83] offset:37888
  v_fma_f32 v89, v89, s25, -v123
  v_exp_f32 v88, v88
  v_mfma_f32_16x16x32_bf16 v[56:59], v[208:211], v[104:107], v[56:59]
  v_fma_f32 v90, v90, s25, -v123
  v_exp_f32 v89, v89
  v_mfma_f32_16x16x32_bf16 v[60:63], v[212:215], v[104:107], v[60:63]
  v_fma_f32 v91, v91, s25, -v123
  v_exp_f32 v90, v90
  v_mfma_f32_16x16x32_bf16 v[64:67], v[216:219], v[104:107], v[64:67]
  s_add_u32 m0, s26, 42240
  v_fma_f32 v92, v92, s25, -v123
  v_cvt_pk_bf16_f32 v88, v88, v89
  v_mfma_f32_16x16x32_bf16 v[68:71], v[220:223], v[104:107], v[68:71]
  s_waitcnt lgkmcnt(2)
  ds_read_b128 v[104:107], v112 offset:0
  v_exp_f32 v91, v91
  v_mfma_f32_16x16x32_bf16 v[48:51], a[216:219], v[96:99], v[48:51]
  buffer_load_dwordx4 v118, s[8:11], s41 offen offset:0 nt lds
  v_fma_f32 v93, v93, s25, -v123
  v_exp_f32 v92, v92
  v_mfma_f32_16x16x32_bf16 v[52:55], a[248:251], v[96:99], v[52:55]
  v_fma_f32 v94, v94, s25, -v123
  v_cvt_pk_bf16_f32 v89, v90, v91
  v_mfma_f32_16x16x32_bf16 v[56:59], v[224:227], v[96:99], v[56:59]
  v_exp_f32 v93, v93
  v_mfma_f32_16x16x32_bf16 v[60:63], v[228:231], v[96:99], v[60:63]
  v_fma_f32 v95, v95, s25, -v123
  v_exp_f32 v94, v94
  v_mfma_f32_16x16x32_bf16 v[64:67], v[232:235], v[96:99], v[64:67]
  v_cvt_pk_bf16_f32 v90, v92, v93
  v_exp_f32 v95, v95
  v_mfma_f32_16x16x32_bf16 v[68:71], v[236:239], v[96:99], v[68:71]
  s_waitcnt lgkmcnt(2)
  ds_read_b128 v[96:99], v112 offset:64
  v_fma_f32 v0, v0, s25, -v120
  v_cvt_pk_bf16_f32 v91, v94, v95
  v_mfma_f32_16x16x32_bf16 v[48:51], a[220:223], v[100:103], v[48:51]
  ds_write_b128 v113, v[88:91] offset:38912
  v_fma_f32 v1, v1, s25, -v120
  v_exp_f32 v0, v0
  v_mfma_f32_16x16x32_bf16 v[52:55], a[252:255], v[100:103], v[52:55]
  v_fma_f32 v2, v2, s25, -v120
  v_exp_f32 v1, v1
  v_mfma_f32_16x16x32_bf16 v[56:59], v[240:243], v[100:103], v[56:59]
  s_add_u32 m0, s26, 42272
  v_max3_f32 v124, v48, v49, v50
  v_fma_f32 v3, v3, s25, -v120
  v_mfma_f32_16x16x32_bf16 v[60:63], v[244:247], v[100:103], v[60:63]
  v_exp_f32 v2, v2
  v_mfma_f32_16x16x32_bf16 v[64:67], v[248:251], v[100:103], v[64:67]
  buffer_load_dwordx4 v118, s[8:11], s41 offen offset:1024 nt lds
  v_max3_f32 v124, v51, v52, v124
  v_max3_f32 v124, v53, v54, v124
  v_mfma_f32_16x16x32_bf16 v[68:71], v[252:255], v[100:103], v[68:71]
  s_waitcnt lgkmcnt(2)
  ds_read_b128 v[100:103], v112 offset:128
  v_max3_f32 v124, v55, v56, v124
  v_max3_f32 v124, v57, v58, v124
  v_mfma_f32_16x16x32_bf16 v[72:75], a[192:195], v[104:107], 0
  v_fma_f32 v4, v4, s25, -v120
  v_cvt_pk_bf16_f32 v0, v0, v1
  v_mfma_f32_16x16x32_bf16 v[76:79], a[224:227], v[104:107], 0
  v_max3_f32 v124, v59, v60, v124
  v_exp_f32 v3, v3
  v_mfma_f32_16x16x32_bf16 v[80:83], v[128:131], v[104:107], 0
  v_fma_f32 v5, v5, s25, -v120
  v_exp_f32 v4, v4
  v_mfma_f32_16x16x32_bf16 v[84:87], v[132:135], v[104:107], 0
  v_max3_f32 v124, v61, v62, v124
  v_fma_f32 v6, v6, s25, -v120
  v_mfma_f32_16x16x32_bf16 v[88:91], v[136:139], v[104:107], 0
  v_cvt_pk_bf16_f32 v1, v2, v3
  v_exp_f32 v5, v5
  v_mfma_f32_16x16x32_bf16 v[92:95], v[140:143], v[104:107], 0
  s_waitcnt lgkmcnt(2)
  ds_read_b128 v[104:107], v112 offset:192
  v_max3_f32 v124, v63, v64, v124
  v_fma_f32 v7, v7, s25, -v120
  v_mfma_f32_16x16x32_bf16 v[72:75], a[196:199], v[96:99], v[72:75]
  v_exp_f32 v6, v6
  v_mfma_f32_16x16x32_bf16 v[76:79], a[228:231], v[96:99], v[76:79]
  v_max3_f32 v124, v65, v66, v124
  v_cvt_pk_bf16_f32 v2, v4, v5
  v_mfma_f32_16x16x32_bf16 v[80:83], v[144:147], v[96:99], v[80:83]
  v_exp_f32 v7, v7
  v_mfma_f32_16x16x32_bf16 v[84:87], v[148:151], v[96:99], v[84:87]
  v_max3_f32 v124, v67, v68, v124
  v_fma_f32 v8, v8, s25, -v120
  v_mfma_f32_16x16x32_bf16 v[88:91], v[152:155], v[96:99], v[88:91]
  v_cvt_pk_bf16_f32 v3, v6, v7
  v_max3_f32 v124, v69, v70, v124
  v_mfma_f32_16x16x32_bf16 v[92:95], v[156:159], v[96:99], v[92:95]
  s_waitcnt lgkmcnt(1)
  ds_write_b128 v114, v[0:3] offset:0
  v_fma_f32 v9, v9, s25, -v120
  v_exp_f32 v8, v8
  v_mfma_f32_16x16x32_bf16 v[72:75], a[200:203], v[100:103], v[72:75]
  ds_read_b128 v[96:99], v112 offset:256
  v_max_f32 v124, v71, v124
  v_fma_f32 v10, v10, s25, -v120
  v_mfma_f32_16x16x32_bf16 v[76:79], a[232:235], v[100:103], v[76:79]
  v_exp_f32 v9, v9
  v_mfma_f32_16x16x32_bf16 v[80:83], v[160:163], v[100:103], v[80:83]
  v_fma_f32 v11, v11, s25, -v120
  v_exp_f32 v10, v10
  v_mfma_f32_16x16x32_bf16 v[84:87], v[164:167], v[100:103], v[84:87]
  v_fma_f32 v12, v12, s25, -v120
  v_cvt_pk_bf16_f32 v8, v8, v9
  v_mfma_f32_16x16x32_bf16 v[88:91], v[168:171], v[100:103], v[88:91]
  v_exp_f32 v11, v11
  v_mfma_f32_16x16x32_bf16 v[92:95], v[172:175], v[100:103], v[92:95]
  s_waitcnt lgkmcnt(2)
  ds_read_b128 v[100:103], v112 offset:320
  v_fma_f32 v13, v13, s25, -v120
  v_exp_f32 v12, v12
  v_mfma_f32_16x16x32_bf16 v[72:75], a[204:207], v[104:107], v[72:75]
  v_fma_f32 v14, v14, s25, -v120
  v_cvt_pk_bf16_f32 v9, v10, v11
  v_mfma_f32_16x16x32_bf16 v[76:79], a[236:239], v[104:107], v[76:79]
  v_exp_f32 v13, v13
  v_mfma_f32_16x16x32_bf16 v[80:83], v[176:179], v[104:107], v[80:83]
  v_fma_f32 v15, v15, s25, -v120
  v_exp_f32 v14, v14
  v_mfma_f32_16x16x32_bf16 v[84:87], v[180:183], v[104:107], v[84:87]
  v_cvt_pk_bf16_f32 v10, v12, v13
  v_exp_f32 v15, v15
  v_mfma_f32_16x16x32_bf16 v[88:91], v[184:187], v[104:107], v[88:91]
  v_fma_f32 v16, v16, s25, -v120
  v_cvt_pk_bf16_f32 v11, v14, v15
  v_mfma_f32_16x16x32_bf16 v[92:95], v[188:191], v[104:107], v[92:95]
  s_waitcnt lgkmcnt(1)
  ds_write_b128 v114, v[8:11] offset:1024
  v_fma_f32 v17, v17, s25, -v120
  v_exp_f32 v16, v16
  v_mfma_f32_16x16x32_bf16 v[72:75], a[208:211], v[96:99], v[72:75]
  ds_read_b128 v[104:107], v112 offset:384
  v_fma_f32 v18, v18, s25, -v120
  v_exp_f32 v17, v17
  v_mfma_f32_16x16x32_bf16 v[76:79], a[240:243], v[96:99], v[76:79]
  v_fma_f32 v19, v19, s25, -v120
  v_exp_f32 v18, v18
  v_mfma_f32_16x16x32_bf16 v[80:83], v[192:195], v[96:99], v[80:83]
  v_fma_f32 v20, v20, s25, -v120
  v_cvt_pk_bf16_f32 v16, v16, v17
  v_mfma_f32_16x16x32_bf16 v[84:87], v[196:199], v[96:99], v[84:87]
  v_exp_f32 v19, v19
  v_mfma_f32_16x16x32_bf16 v[88:91], v[200:203], v[96:99], v[88:91]
  v_fma_f32 v21, v21, s25, -v120
  v_exp_f32 v20, v20
  v_mfma_f32_16x16x32_bf16 v[92:95], v[204:207], v[96:99], v[92:95]
  s_waitcnt lgkmcnt(2)
  ds_read_b128 v[96:99], v112 offset:448
  v_fma_f32 v22, v22, s25, -v120
  v_cvt_pk_bf16_f32 v17, v18, v19
  v_mfma_f32_16x16x32_bf16 v[72:75], a[212:215], v[100:103], v[72:75]
  v_exp_f32 v21, v21
  v_mfma_f32_16x16x32_bf16 v[76:79], a[244:247], v[100:103], v[76:79]
  v_fma_f32 v23, v23, s25, -v120
  v_exp_f32 v22, v22
  v_mfma_f32_16x16x32_bf16 v[80:83], v[208:211], v[100:103], v[80:83]
  v_cvt_pk_bf16_f32 v18, v20, v21
  v_exp_f32 v23, v23
  v_mfma_f32_16x16x32_bf16 v[84:87], v[212:215], v[100:103], v[84:87]
  v_fma_f32 v24, v24, s25, -v121
  v_cvt_pk_bf16_f32 v19, v22, v23
  v_mfma_f32_16x16x32_bf16 v[88:91], v[216:219], v[100:103], v[88:91]
  ds_write_b128 v114, v[16:19] offset:2048
  v_fma_f32 v25, v25, s25, -v121
  v_exp_f32 v24, v24
  v_mfma_f32_16x16x32_bf16 v[92:95], v[220:223], v[100:103], v[92:95]
  s_waitcnt lgkmcnt(2)
  ds_read_b128 v[100:103], v112 offset:8448
  v_fma_f32 v26, v26, s25, -v121
  v_exp_f32 v25, v25
  v_mfma_f32_16x16x32_bf16 v[72:75], a[216:219], v[104:107], v[72:75]
  v_fma_f32 v27, v27, s25, -v121
  v_exp_f32 v26, v26
  v_mfma_f32_16x16x32_bf16 v[76:79], a[248:251], v[104:107], v[76:79]
  v_fma_f32 v28, v28, s25, -v121
  v_cvt_pk_bf16_f32 v24, v24, v25
  v_mfma_f32_16x16x32_bf16 v[80:83], v[224:227], v[104:107], v[80:83]
  v_exp_f32 v27, v27
  v_mfma_f32_16x16x32_bf16 v[84:87], v[228:231], v[104:107], v[84:87]
  v_fma_f32 v29, v29, s25, -v121
  v_exp_f32 v28, v28
  v_mfma_f32_16x16x32_bf16 v[88:91], v[232:235], v[104:107], v[88:91]
  v_fma_f32 v30, v30, s25, -v121
  v_cvt_pk_bf16_f32 v25, v26, v27
  v_mfma_f32_16x16x32_bf16 v[92:95], v[236:239], v[104:107], v[92:95]
  s_waitcnt lgkmcnt(2)
  ds_read_b128 v[104:107], v112 offset:8512
  v_exp_f32 v29, v29
  v_mfma_f32_16x16x32_bf16 v[72:75], a[220:223], v[96:99], v[72:75]
  v_fma_f32 v31, v31, s25, -v121
  v_exp_f32 v30, v30
  v_mfma_f32_16x16x32_bf16 v[76:79], a[252:255], v[96:99], v[76:79]
  v_cvt_pk_bf16_f32 v26, v28, v29
  v_exp_f32 v31, v31
  v_mfma_f32_16x16x32_bf16 v[80:83], v[240:243], v[96:99], v[80:83]
  v_fma_f32 v32, v32, s25, -v121
  v_cvt_pk_bf16_f32 v27, v30, v31
  v_mfma_f32_16x16x32_bf16 v[84:87], v[244:247], v[96:99], v[84:87]
  ds_write_b128 v114, v[24:27] offset:12288
  v_max3_f32 v125, v72, v73, v74
  v_max3_f32 v125, v75, v76, v125
  v_mfma_f32_16x16x32_bf16 v[88:91], v[248:251], v[96:99], v[88:91]
  v_max3_f32 v125, v77, v78, v125
  v_max3_f32 v125, v79, v80, v125
  v_mfma_f32_16x16x32_bf16 v[92:95], v[252:255], v[96:99], v[92:95]
  s_waitcnt lgkmcnt(2)
  ds_read_b128 v[96:99], v112 offset:8576
  v_max3_f32 v125, v81, v82, v125
  v_max3_f32 v125, v83, v84, v125
  v_mfma_f32_16x16x32_bf16 v[0:3], a[192:195], v[100:103], 0
  v_max3_f32 v125, v85, v86, v125
  v_max3_f32 v125, v87, v88, v125
  v_mfma_f32_16x16x32_bf16 v[4:7], a[224:227], v[100:103], 0
  v_max3_f32 v125, v89, v90, v125
  v_max3_f32 v125, v91, v92, v125
  v_mfma_f32_16x16x32_bf16 v[8:11], v[128:131], v[100:103], 0
  v_max3_f32 v125, v93, v94, v125
  v_max_f32 v125, v95, v125
  v_mfma_f32_16x16x32_bf16 v[12:15], v[132:135], v[100:103], 0
  v_fma_f32 v33, v33, s25, -v121
  v_permlane32_swap_b32 v124, v125
  v_mfma_f32_16x16x32_bf16 v[16:19], v[136:139], v[100:103], 0
  v_max_f32 v126, v124, v125
  v_max_f32 v127, v124, v125
  v_mfma_f32_16x16x32_bf16 v[20:23], v[140:143], v[100:103], 0
  s_waitcnt lgkmcnt(2)
  ds_read_b128 v[100:103], v112 offset:8640
  v_permlane16_swap_b32 v126, v127
  v_mfma_f32_16x16x32_bf16 v[0:3], a[196:199], v[104:107], v[0:3]
  v_max_f32 v126, v126, v127
  v_exp_f32 v32, v32
  v_mfma_f32_16x16x32_bf16 v[4:7], a[228:231], v[104:107], v[4:7]
  ds_write_b32 v116, v126 offset:512
  v_fma_f32 v34, v34, s25, -v121
  v_exp_f32 v33, v33
  v_mfma_f32_16x16x32_bf16 v[8:11], v[144:147], v[104:107], v[8:11]
  v_fma_f32 v35, v35, s25, -v121
  v_exp_f32 v34, v34
  v_mfma_f32_16x16x32_bf16 v[12:15], v[148:151], v[104:107], v[12:15]
  v_fma_f32 v36, v36, s25, -v121
  v_cvt_pk_bf16_f32 v32, v32, v33
  v_mfma_f32_16x16x32_bf16 v[16:19], v[152:155], v[104:107], v[16:19]
  s_waitcnt vmcnt(4) lgkmcnt(0)
  s_barrier
  v_exp_f32 v35, v35
  v_mfma_f32_16x16x32_bf16 v[20:23], v[156:159], v[104:107], v[20:23]
  ds_read_b128 v[108:111], v117 offset:512
  ds_read_b128 v[124:127], v117 offset:768
  s_mov_b32 s42, 106496
  v_fma_f32 v37, v37, s25, -v121
  v_exp_f32 v36, v36
  v_mfma_f32_16x16x32_bf16 v[0:3], a[200:203], v[96:99], v[0:3]
  ds_read_b128 v[104:107], v112 offset:8704
  s_mov_b32 s43, 114688
  v_fma_f32 v38, v38, s25, -v121
  v_cvt_pk_bf16_f32 v33, v34, v35
  v_mfma_f32_16x16x32_bf16 v[4:7], a[232:235], v[96:99], v[4:7]
  v_exp_f32 v37, v37
  v_mfma_f32_16x16x32_bf16 v[8:11], v[160:163], v[96:99], v[8:11]
  s_add_u32 m0, s26, 50688
  v_fma_f32 v39, v39, s25, -v121
  v_exp_f32 v38, v38
  v_mfma_f32_16x16x32_bf16 v[12:15], v[164:167], v[96:99], v[12:15]
  v_cvt_pk_bf16_f32 v34, v36, v37
  v_exp_f32 v39, v39
  v_mfma_f32_16x16x32_bf16 v[16:19], v[168:171], v[96:99], v[16:19]
  buffer_load_dwordx4 v118, s[8:11], s42 offen offset:0 nt lds
  v_fma_f32 v40, v40, s25, -v121
  v_cvt_pk_bf16_f32 v35, v38, v39
  v_mfma_f32_16x16x32_bf16 v[20:23], v[172:175], v[96:99], v[20:23]
  ds_write_b128 v114, v[32:35] offset:13312
  v_fma_f32 v41, v41, s25, -v121
  v_exp_f32 v40, v40
  v_mfma_f32_16x16x32_bf16 v[0:3], a[204:207], v[100:103], v[0:3]
  s_waitcnt lgkmcnt(3)
  ds_read_b128 v[96:99], v112 offset:8768
  v_max3_f32 v108, v108, v109, v110
  v_max_f32 v108, v108, v111
  v_mfma_f32_16x16x32_bf16 v[4:7], a[236:239], v[100:103], v[4:7]
  s_waitcnt lgkmcnt(3)
  v_mul_f32 v122, s25, v108
  v_max3_f32 v124, v124, v125, v126
  v_mfma_f32_16x16x32_bf16 v[8:11], v[176:179], v[100:103], v[8:11]
  ds_read_b128 a[0:3], v115 offset:0
  v_max_f32 v124, v124, v127
  v_mul_f32 v123, s25, v124
  v_mfma_f32_16x16x32_bf16 v[12:15], v[180:183], v[100:103], v[12:15]
  v_fma_f32 v42, v42, s25, -v121
  v_exp_f32 v41, v41
  v_mfma_f32_16x16x32_bf16 v[16:19], v[184:187], v[100:103], v[16:19]
  v_fma_f32 v43, v43, s25, -v121
  v_exp_f32 v42, v42
  v_mfma_f32_16x16x32_bf16 v[20:23], v[188:191], v[100:103], v[20:23]
  s_waitcnt lgkmcnt(3)
  ds_read_b128 v[100:103], v112 offset:8832
  v_fma_f32 v44, v44, s25, -v121
  v_cvt_pk_bf16_f32 v40, v40, v41
  v_mfma_f32_16x16x32_bf16 v[0:3], a[208:211], v[104:107], v[0:3]
  s_add_u32 m0, s26, 50720
  v_exp_f32 v43, v43
  v_mfma_f32_16x16x32_bf16 v[4:7], a[240:243], v[104:107], v[4:7]
  ds_read_b128 a[4:7], v115 offset:1024
  v_fma_f32 v45, v45, s25, -v121
  v_exp_f32 v44, v44
  v_mfma_f32_16x16x32_bf16 v[8:11], v[192:195], v[104:107], v[8:11]
  buffer_load_dwordx4 v118, s[8:11], s42 offen offset:1024 nt lds
  v_fma_f32 v46, v46, s25, -v121
  v_cvt_pk_bf16_f32 v41, v42, v43
  v_mfma_f32_16x16x32_bf16 v[12:15], v[196:199], v[104:107], v[12:15]
  v_exp_f32 v45, v45
  v_mfma_f32_16x16x32_bf16 v[16:19], v[200:203], v[104:107], v[16:19]
  v_fma_f32 v47, v47, s25, -v121
  v_exp_f32 v46, v46
  v_mfma_f32_16x16x32_bf16 v[20:23], v[204:207], v[104:107], v[20:23]
  s_waitcnt lgkmcnt(3)
  ds_read_b128 v[104:107], v112 offset:8896
  v_cvt_pk_bf16_f32 v42, v44, v45
  v_exp_f32 v47, v47
  v_mfma_f32_16x16x32_bf16 v[0:3], a[212:215], v[96:99], v[0:3]
  v_fma_f32 v48, v48, s25, -v122
  v_cvt_pk_bf16_f32 v43, v46, v47
  v_mfma_f32_16x16x32_bf16 v[4:7], a[244:247], v[96:99], v[4:7]
  ds_write_b128 v114, v[40:43] offset:14336
  v_fma_f32 v49, v49, s25, -v122
  v_exp_f32 v48, v48
  v_mfma_f32_16x16x32_bf16 v[8:11], v[208:211], v[96:99], v[8:11]
  ds_read_b128 a[8:11], v115 offset:2048
  v_fma_f32 v50, v50, s25, -v122
  v_exp_f32 v49, v49
  v_mfma_f32_16x16x32_bf16 v[12:15], v[212:215], v[96:99], v[12:15]
  v_fma_f32 v51, v51, s25, -v122
  v_exp_f32 v50, v50
  v_mfma_f32_16x16x32_bf16 v[16:19], v[216:219], v[96:99], v[16:19]
  s_add_u32 m0, s26, 0
  v_fma_f32 v52, v52, s25, -v122
  v_cvt_pk_bf16_f32 v48, v48, v49
  v_mfma_f32_16x16x32_bf16 v[20:23], v[220:223], v[96:99], v[20:23]
  s_waitcnt lgkmcnt(4)
  ds_read_b128 v[96:99], v112 offset:16896
  v_exp_f32 v51, v51
  v_mfma_f32_16x16x32_bf16 v[0:3], a[216:219], v[100:103], v[0:3]
  buffer_load_dwordx4 v118, s[8:11], s43 offen offset:0 nt lds
  v_fma_f32 v53, v53, s25, -v122
  v_exp_f32 v52, v52
  v_mfma_f32_16x16x32_bf16 v[4:7], a[248:251], v[100:103], v[4:7]
  ds_read_b128 a[12:15], v115 offset:3072
  v_fma_f32 v54, v54, s25, -v122
  v_cvt_pk_bf16_f32 v49, v50, v51
  v_mfma_f32_16x16x32_bf16 v[8:11], v[224:227], v[100:103], v[8:11]
  v_exp_f32 v53, v53
  v_mfma_f32_16x16x32_bf16 v[12:15], v[228:231], v[100:103], v[12:15]
  v_fma_f32 v55, v55, s25, -v122
  v_exp_f32 v54, v54
  v_mfma_f32_16x16x32_bf16 v[16:19], v[232:235], v[100:103], v[16:19]
  v_cvt_pk_bf16_f32 v50, v52, v53
  v_exp_f32 v55, v55
  v_mfma_f32_16x16x32_bf16 v[20:23], v[236:239], v[100:103], v[20:23]
  s_waitcnt lgkmcnt(4)
  ds_read_b128 v[100:103], v112 offset:16960
  v_fma_f32 v56, v56, s25, -v122
  v_cvt_pk_bf16_f32 v51, v54, v55
  v_mfma_f32_16x16x32_bf16 v[0:3], a[220:223], v[104:107], v[0:3]
  ds_write_b128 v114, v[48:51] offset:24576
  v_fma_f32 v57, v57, s25, -v122
  v_exp_f32 v56, v56
  v_mfma_f32_16x16x32_bf16 v[4:7], a[252:255], v[104:107], v[4:7]
  ds_read_b128 a[16:19], v115 offset:4096
  v_fma_f32 v58, v58, s25, -v122
  v_exp_f32 v57, v57
  v_mfma_f32_16x16x32_bf16 v[8:11], v[240:243], v[104:107], v[8:11]
  s_add_u32 m0, s26, 32
  v_max3_f32 v124, v0, v1, v2
  v_fma_f32 v59, v59, s25, -v122
  v_mfma_f32_16x16x32_bf16 v[12:15], v[244:247], v[104:107], v[12:15]
  v_max3_f32 v124, v3, v4, v124
  v_max3_f32 v124, v5, v6, v124
  v_mfma_f32_16x16x32_bf16 v[16:19], v[248:251], v[104:107], v[16:19]
  buffer_load_dwordx4 v118, s[8:11], s43 offen offset:1024 nt lds
  v_max3_f32 v124, v7, v8, v124
  v_max3_f32 v124, v9, v10, v124
  v_mfma_f32_16x16x32_bf16 v[20:23], v[252:255], v[104:107], v[20:23]
  s_waitcnt lgkmcnt(4)
  ds_read_b128 v[104:107], v112 offset:17024
  v_max3_f32 v124, v11, v12, v124
  v_max3_f32 v124, v13, v14, v124
  v_mfma_f32_16x16x32_bf16 v[24:27], a[192:195], v[96:99], 0
  v_max3_f32 v124, v15, v16, v124
  v_max3_f32 v124, v17, v18, v124
  v_mfma_f32_16x16x32_bf16 v[28:31], a[224:227], v[96:99], 0
  ds_read_b128 a[20:23], v115 offset:5120
  v_max3_f32 v124, v19, v20, v124
  v_max3_f32 v124, v21, v22, v124
  v_mfma_f32_16x16x32_bf16 v[32:35], v[128:131], v[96:99], 0
  v_max_f32 v124, v23, v124
  v_exp_f32 v58, v58
  v_mfma_f32_16x16x32_bf16 v[36:39], v[132:135], v[96:99], 0
  v_fma_f32 v60, v60, s25, -v122
  v_cvt_pk_bf16_f32 v56, v56, v57
  v_mfma_f32_16x16x32_bf16 v[40:43], v[136:139], v[96:99], 0
  v_exp_f32 v59, v59
  v_mfma_f32_16x16x32_bf16 v[44:47], v[140:143], v[96:99], 0
  s_waitcnt lgkmcnt(4)
  ds_read_b128 v[96:99], v112 offset:17088
  v_fma_f32 v61, v61, s25, -v122
  v_exp_f32 v60, v60
  v_mfma_f32_16x16x32_bf16 v[24:27], a[196:199], v[100:103], v[24:27]
  v_fma_f32 v62, v62, s25, -v122
  v_cvt_pk_bf16_f32 v57, v58, v59
  v_mfma_f32_16x16x32_bf16 v[28:31], a[228:231], v[100:103], v[28:31]
  ds_read_b128 a[24:27], v115 offset:6144
  v_exp_f32 v61, v61
  v_mfma_f32_16x16x32_bf16 v[32:35], v[144:147], v[100:103], v[32:35]
  v_fma_f32 v63, v63, s25, -v122
  v_exp_f32 v62, v62
  v_mfma_f32_16x16x32_bf16 v[36:39], v[148:151], v[100:103], v[36:39]
  v_cvt_pk_bf16_f32 v58, v60, v61
  v_exp_f32 v63, v63
  v_mfma_f32_16x16x32_bf16 v[40:43], v[152:155], v[100:103], v[40:43]
  v_fma_f32 v64, v64, s25, -v122
  v_cvt_pk_bf16_f32 v59, v62, v63
  v_mfma_f32_16x16x32_bf16 v[44:47], v[156:159], v[100:103], v[44:47]
  s_waitcnt lgkmcnt(3)
  ds_write_b128 v114, v[56:59] offset:25600
  v_fma_f32 v65, v65, s25, -v122
  v_exp_f32 v64, v64
  v_mfma_f32_16x16x32_bf16 v[24:27], a[200:203], v[104:107], v[24:27]
  ds_read_b128 v[100:103], v112 offset:17152
  v_fma_f32 v66, v66, s25, -v122
  v_exp_f32 v65, v65
  v_mfma_f32_16x16x32_bf16 v[28:31], a[232:235], v[104:107], v[28:31]
  ds_read_b128 a[28:31], v115 offset:7168
  v_fma_f32 v67, v67, s25, -v122
  v_exp_f32 v66, v66
  v_mfma_f32_16x16x32_bf16 v[32:35], v[160:163], v[104:107], v[32:35]
  v_fma_f32 v68, v68, s25, -v122
  v_cvt_pk_bf16_f32 v64, v64, v65
  v_mfma_f32_16x16x32_bf16 v[36:39], v[164:167], v[104:107], v[36:39]
  v_exp_f32 v67, v67
  v_mfma_f32_16x16x32_bf16 v[40:43], v[168:171], v[104:107], v[40:43]
  v_fma_f32 v69, v69, s25, -v122
  v_exp_f32 v68, v68
  v_mfma_f32_16x16x32_bf16 v[44:47], v[172:175], v[104:107], v[44:47]
  s_waitcnt lgkmcnt(4)
  ds_read_b128 v[104:107], v112 offset:17216
  v_fma_f32 v70, v70, s25, -v122
  v_cvt_pk_bf16_f32 v65, v66, v67
  v_mfma_f32_16x16x32_bf16 v[24:27], a[204:207], v[96:99], v[24:27]
  ds_read_b128 a[32:35], v115 offset:8192
  v_exp_f32 v69, v69
  v_mfma_f32_16x16x32_bf16 v[28:31], a[236:239], v[96:99], v[28:31]
  v_fma_f32 v71, v71, s25, -v122
  v_exp_f32 v70, v70
  v_mfma_f32_16x16x32_bf16 v[32:35], v[176:179], v[96:99], v[32:35]
  v_cvt_pk_bf16_f32 v66, v68, v69
  v_exp_f32 v71, v71
  v_mfma_f32_16x16x32_bf16 v[36:39], v[180:183], v[96:99], v[36:39]
  v_fma_f32 v72, v72, s25, -v123
  v_cvt_pk_bf16_f32 v67, v70, v71
  v_mfma_f32_16x16x32_bf16 v[40:43], v[184:187], v[96:99], v[40:43]
  ds_write_b128 v114, v[64:67] offset:26624
  v_fma_f32 v73, v73, s25, -v123
  v_exp_f32 v72, v72
  v_mfma_f32_16x16x32_bf16 v[44:47], v[188:191], v[96:99], v[44:47]
  s_waitcnt lgkmcnt(4)
  ds_read_b128 v[96:99], v112 offset:17280
  v_fma_f32 v74, v74, s25, -v123
  v_exp_f32 v73, v73
  v_mfma_f32_16x16x32_bf16 v[24:27], a[208:211], v[100:103], v[24:27]
  ds_read_b128 a[36:39], v115 offset:9216
  v_fma_f32 v75, v75, s25, -v123
  v_exp_f32 v74, v74
  v_mfma_f32_16x16x32_bf16 v[28:31], a[240:243], v[100:103], v[28:31]
  v_fma_f32 v76, v76, s25, -v123
  v_cvt_pk_bf16_f32 v72, v72, v73
  v_mfma_f32_16x16x32_bf16 v[32:35], v[192:195], v[100:103], v[32:35]
  v_exp_f32 v75, v75
  v_mfma_f32_16x16x32_bf16 v[36:39], v[196:199], v[100:103], v[36:39]
  v_fma_f32 v77, v77, s25, -v123
  v_exp_f32 v76, v76
  v_mfma_f32_16x16x32_bf16 v[40:43], v[200:203], v[100:103], v[40:43]
  v_fma_f32 v78, v78, s25, -v123
  v_cvt_pk_bf16_f32 v73, v74, v75
  v_mfma_f32_16x16x32_bf16 v[44:47], v[204:207], v[100:103], v[44:47]
  s_waitcnt lgkmcnt(4)
  ds_read_b128 v[100:103], v112 offset:17344
  v_exp_f32 v77, v77
  v_mfma_f32_16x16x32_bf16 v[24:27], a[212:215], v[104:107], v[24:27]
  ds_read_b128 a[40:43], v115 offset:10240
  v_fma_f32 v79, v79, s25, -v123
  v_exp_f32 v78, v78
  v_mfma_f32_16x16x32_bf16 v[28:31], a[244:247], v[104:107], v[28:31]
  v_cvt_pk_bf16_f32 v74, v76, v77
  v_exp_f32 v79, v79
  v_mfma_f32_16x16x32_bf16 v[32:35], v[208:211], v[104:107], v[32:35]
  v_fma_f32 v80, v80, s25, -v123
  v_cvt_pk_bf16_f32 v75, v78, v79
  v_mfma_f32_16x16x32_bf16 v[36:39], v[212:215], v[104:107], v[36:39]
  ds_write_b128 v114, v[72:75] offset:36864
  v_fma_f32 v81, v81, s25, -v123
  v_exp_f32 v80, v80
  v_mfma_f32_16x16x32_bf16 v[40:43], v[216:219], v[104:107], v[40:43]
  v_fma_f32 v82, v82, s25, -v123
  v_exp_f32 v81, v81
  v_mfma_f32_16x16x32_bf16 v[44:47], v[220:223], v[104:107], v[44:47]
  s_waitcnt lgkmcnt(4)
  ds_read_b128 v[104:107], v112 offset:25344
  v_fma_f32 v83, v83, s25, -v123
  v_exp_f32 v82, v82
  v_mfma_f32_16x16x32_bf16 v[24:27], a[216:219], v[96:99], v[24:27]
  ds_read_b128 a[44:47], v115 offset:11264
  v_fma_f32 v84, v84, s25, -v123
  v_cvt_pk_bf16_f32 v80, v80, v81
  v_mfma_f32_16x16x32_bf16 v[28:31], a[248:251], v[96:99], v[28:31]
  v_exp_f32 v83, v83
  v_mfma_f32_16x16x32_bf16 v[32:35], v[224:227], v[96:99], v[32:35]
  v_fma_f32 v85, v85, s25, -v123
  v_exp_f32 v84, v84
  v_mfma_f32_16x16x32_bf16 v[36:39], v[228:231], v[96:99], v[36:39]
  v_fma_f32 v86, v86, s25, -v123
  v_cvt_pk_bf16_f32 v81, v82, v83
  v_mfma_f32_16x16x32_bf16 v[40:43], v[232:235], v[96:99], v[40:43]
  v_exp_f32 v85, v85
  v_mfma_f32_16x16x32_bf16 v[44:47], v[236:239], v[96:99], v[44:47]
  s_waitcnt lgkmcnt(4)
  ds_read_b128 v[96:99], v112 offset:25408
  v_fma_f32 v87, v87, s25, -v123
  v_exp_f32 v86, v86
  v_mfma_f32_16x16x32_bf16 v[24:27], a[220:223], v[100:103], v[24:27]
  v_cvt_pk_bf16_f32 v82, v84, v85
  v_exp_f32 v87, v87
  v_mfma_f32_16x16x32_bf16 v[28:31], a[252:255], v[100:103], v[28:31]
  v_fma_f32 v88, v88, s25, -v123
  v_cvt_pk_bf16_f32 v83, v86, v87
  v_mfma_f32_16x16x32_bf16 v[32:35], v[240:243], v[100:103], v[32:35]
  ds_write_b128 v114, v[80:83] offset:37888
  v_fma_f32 v89, v89, s25, -v123
  v_max3_f32 v125, v24, v25, v26
  v_mfma_f32_16x16x32_bf16 v[36:39], v[244:247], v[100:103], v[36:39]
  v_exp_f32 v88, v88
  v_mfma_f32_16x16x32_bf16 v[40:43], v[248:251], v[100:103], v[40:43]
  v_max3_f32 v125, v27, v28, v125
  v_max3_f32 v125, v29, v30, v125
  v_mfma_f32_16x16x32_bf16 v[44:47], v[252:255], v[100:103], v[44:47]
  s_waitcnt lgkmcnt(3)
  ds_read_b128 v[100:103], v112 offset:25472
  v_max3_f32 v125, v31, v32, v125
  v_max3_f32 v125, v33, v34, v125
  v_mfma_f32_16x16x32_bf16 v[48:51], a[192:195], v[104:107], 0
  v_max3_f32 v125, v35, v36, v125
  v_max3_f32 v125, v37, v38, v125
  v_mfma_f32_16x16x32_bf16 v[52:55], a[224:227], v[104:107], 0
  v_max3_f32 v125, v39, v40, v125
  v_max3_f32 v125, v41, v42, v125
  v_mfma_f32_16x16x32_bf16 v[56:59], v[128:131], v[104:107], 0
  v_max3_f32 v125, v43, v44, v125
  v_max3_f32 v125, v45, v46, v125
  v_mfma_f32_16x16x32_bf16 v[60:63], v[132:135], v[104:107], 0
  v_max_f32 v125, v47, v125
  v_fma_f32 v90, v90, s25, -v123
  v_mfma_f32_16x16x32_bf16 v[64:67], v[136:139], v[104:107], 0
  v_permlane32_swap_b32 v124, v125
  v_mfma_f32_16x16x32_bf16 v[68:71], v[140:143], v[104:107], 0
  s_waitcnt lgkmcnt(2)
  ds_read_b128 v[104:107], v112 offset:25536
  v_max_f32 v126, v124, v125
  v_max_f32 v127, v124, v125
  v_mfma_f32_16x16x32_bf16 v[48:51], a[196:199], v[96:99], v[48:51]
  v_exp_f32 v89, v89
  v_mfma_f32_16x16x32_bf16 v[52:55], a[228:231], v[96:99], v[52:55]
  v_permlane16_swap_b32 v126, v127
  v_mfma_f32_16x16x32_bf16 v[56:59], v[144:147], v[96:99], v[56:59]
  v_max_f32 v126, v126, v127
  v_fma_f32 v91, v91, s25, -v123
  v_mfma_f32_16x16x32_bf16 v[60:63], v[148:151], v[96:99], v[60:63]
  ds_write_b32 v116, v126 offset:0
  v_exp_f32 v90, v90
  v_mfma_f32_16x16x32_bf16 v[64:67], v[152:155], v[96:99], v[64:67]
  v_fma_f32 v92, v92, s25, -v123
  v_cvt_pk_bf16_f32 v88, v88, v89
  v_mfma_f32_16x16x32_bf16 v[68:71], v[156:159], v[96:99], v[68:71]
  s_waitcnt lgkmcnt(2)
  ds_read_b128 v[96:99], v112 offset:25600
  v_exp_f32 v91, v91
  v_mfma_f32_16x16x32_bf16 v[48:51], a[200:203], v[100:103], v[48:51]
  s_waitcnt vmcnt(4) lgkmcnt(1)
  s_barrier
  v_fma_f32 v93, v93, s25, -v123
  v_exp_f32 v92, v92
  v_mfma_f32_16x16x32_bf16 v[52:55], a[232:235], v[100:103], v[52:55]
  ds_read_b128 v[108:111], v117 offset:0
  ds_read_b128 v[124:127], v117 offset:256
  s_mov_b32 s44, 122880
  v_fma_f32 v94, v94, s25, -v123
  v_cvt_pk_bf16_f32 v89, v90, v91
  v_mfma_f32_16x16x32_bf16 v[56:59], v[160:163], v[100:103], v[56:59]
  s_add_u32 m0, s26, 8448
  v_exp_f32 v93, v93
  v_mfma_f32_16x16x32_bf16 v[60:63], v[164:167], v[100:103], v[60:63]
  s_mov_b32 s45, 131072
  v_fma_f32 v95, v95, s25, -v123
  v_exp_f32 v94, v94
  v_mfma_f32_16x16x32_bf16 v[64:67], v[168:171], v[100:103], v[64:67]
  buffer_load_dwordx4 v118, s[8:11], s44 offen offset:0 nt lds
  v_cvt_pk_bf16_f32 v90, v92, v93
  v_exp_f32 v95, v95
  v_mfma_f32_16x16x32_bf16 v[68:71], v[172:175], v[100:103], v[68:71]
  ds_read_b128 v[100:103], v112 offset:25664
  v_cvt_pk_bf16_f32 v91, v94, v95
  v_mfma_f32_16x16x32_bf16 v[48:51], a[204:207], v[104:107], v[48:51]
  ds_write_b128 v114, v[88:91] offset:38912
  v_mfma_f32_16x16x32_bf16 v[52:55], a[236:239], v[104:107], v[52:55]
  v_mfma_f32_16x16x32_bf16 v[56:59], v[176:179], v[104:107], v[56:59]
  s_waitcnt lgkmcnt(3)
  v_max3_f32 v108, v108, v109, v110
  v_max_f32 v108, v108, v111
  v_mfma_f32_16x16x32_bf16 v[60:63], v[180:183], v[104:107], v[60:63]
  s_waitcnt lgkmcnt(2)
  v_mul_f32 v120, s25, v108
  v_max3_f32 v124, v124, v125, v126
  v_mfma_f32_16x16x32_bf16 v[64:67], v[184:187], v[104:107], v[64:67]
  v_max_f32 v124, v124, v127
  v_mul_f32 v121, s25, v124
  v_mfma_f32_16x16x32_bf16 v[68:71], v[188:191], v[104:107], v[68:71]
  ds_read_b128 v[104:107], v112 offset:25728
  v_fma_f32 v0, v0, s25, -v120
  v_fma_f32 v1, v1, s25, -v120
  v_mfma_f32_16x16x32_bf16 v[48:51], a[208:211], v[96:99], v[48:51]
  s_add_u32 m0, s26, 8480
  v_exp_f32 v0, v0
  v_mfma_f32_16x16x32_bf16 v[52:55], a[240:243], v[96:99], v[52:55]
  v_fma_f32 v2, v2, s25, -v120
  v_exp_f32 v1, v1
  v_mfma_f32_16x16x32_bf16 v[56:59], v[192:195], v[96:99], v[56:59]
  buffer_load_dwordx4 v118, s[8:11], s44 offen offset:1024 nt lds
  v_fma_f32 v3, v3, s25, -v120
  v_exp_f32 v2, v2
  v_mfma_f32_16x16x32_bf16 v[60:63], v[196:199], v[96:99], v[60:63]
  v_fma_f32 v4, v4, s25, -v120
  v_cvt_pk_bf16_f32 v0, v0, v1
  v_mfma_f32_16x16x32_bf16 v[64:67], v[200:203], v[96:99], v[64:67]
  v_exp_f32 v3, v3
  v_mfma_f32_16x16x32_bf16 v[68:71], v[204:207], v[96:99], v[68:71]
  s_waitcnt lgkmcnt(2)
  ds_read_b128 v[96:99], v112 offset:25792
  v_fma_f32 v5, v5, s25, -v120
  v_exp_f32 v4, v4
  v_mfma_f32_16x16x32_bf16 v[48:51], a[212:215], v[100:103], v[48:51]
  v_fma_f32 v6, v6, s25, -v120
  v_cvt_pk_bf16_f32 v1, v2, v3
  v_mfma_f32_16x16x32_bf16 v[52:55], a[244:247], v[100:103], v[52:55]
  v_exp_f32 v5, v5
  v_mfma_f32_16x16x32_bf16 v[56:59], v[208:211], v[100:103], v[56:59]
  v_fma_f32 v7, v7, s25, -v120
  v_exp_f32 v6, v6
  v_mfma_f32_16x16x32_bf16 v[60:63], v[212:215], v[100:103], v[60:63]
  v_cvt_pk_bf16_f32 v2, v4, v5
  v_exp_f32 v7, v7
  v_mfma_f32_16x16x32_bf16 v[64:67], v[216:219], v[100:103], v[64:67]
  s_add_u32 m0, s26, 16896
  v_fma_f32 v8, v8, s25, -v120
  v_cvt_pk_bf16_f32 v3, v6, v7
  v_mfma_f32_16x16x32_bf16 v[68:71], v[220:223], v[100:103], v[68:71]
  s_waitcnt lgkmcnt(1)
  ds_read_b128 v[100:103], v112 offset:33792
  v_fma_f32 v9, v9, s25, -v120
  v_exp_f32 v8, v8
  v_mfma_f32_16x16x32_bf16 v[48:51], a[216:219], v[104:107], v[48:51]
  buffer_load_dwordx4 v118, s[8:11], s45 offen offset:0 nt lds
  v_fma_f32 v10, v10, s25, -v120
  v_exp_f32 v9, v9
  v_mfma_f32_16x16x32_bf16 v[52:55], a[248:251], v[104:107], v[52:55]
  ds_write_b128 v113, v[0:3] offset:0
  v_fma_f32 v11, v11, s25, -v120
  v_exp_f32 v10, v10
  v_mfma_f32_16x16x32_bf16 v[56:59], v[224:227], v[104:107], v[56:59]
  v_fma_f32 v12, v12, s25, -v120
  v_cvt_pk_bf16_f32 v8, v8, v9
  v_mfma_f32_16x16x32_bf16 v[60:63], v[228:231], v[104:107], v[60:63]
  v_exp_f32 v11, v11
  v_mfma_f32_16x16x32_bf16 v[64:67], v[232:235], v[104:107], v[64:67]
  v_fma_f32 v13, v13, s25, -v120
  v_exp_f32 v12, v12
  v_mfma_f32_16x16x32_bf16 v[68:71], v[236:239], v[104:107], v[68:71]
  s_waitcnt lgkmcnt(2)
  ds_read_b128 v[104:107], v112 offset:33856
  v_fma_f32 v14, v14, s25, -v120
  v_cvt_pk_bf16_f32 v9, v10, v11
  v_mfma_f32_16x16x32_bf16 v[48:51], a[220:223], v[96:99], v[48:51]
  v_exp_f32 v13, v13
  v_mfma_f32_16x16x32_bf16 v[52:55], a[252:255], v[96:99], v[52:55]
  v_fma_f32 v15, v15, s25, -v120
  v_exp_f32 v14, v14
  v_mfma_f32_16x16x32_bf16 v[56:59], v[240:243], v[96:99], v[56:59]
  s_add_u32 m0, s26, 16928
  v_cvt_pk_bf16_f32 v10, v12, v13
  v_exp_f32 v15, v15
  v_mfma_f32_16x16x32_bf16 v[60:63], v[244:247], v[96:99], v[60:63]
  v_max3_f32 v124, v48, v49, v50
  v_max3_f32 v124, v51, v52, v124
  v_mfma_f32_16x16x32_bf16 v[64:67], v[248:251], v[96:99], v[64:67]
  buffer_load_dwordx4 v118, s[8:11], s45 offen offset:1024 nt lds
  v_max3_f32 v124, v53, v54, v124
  v_max3_f32 v124, v55, v56, v124
  v_mfma_f32_16x16x32_bf16 v[68:71], v[252:255], v[96:99], v[68:71]
  s_waitcnt lgkmcnt(2)
  ds_read_b128 v[96:99], v112 offset:33920
  v_max3_f32 v124, v57, v58, v124
  v_max3_f32 v124, v59, v60, v124
  v_mfma_f32_16x16x32_bf16 v[72:75], a[192:195], v[100:103], 0
  v_max3_f32 v124, v61, v62, v124
  v_max3_f32 v124, v63, v64, v124
  v_mfma_f32_16x16x32_bf16 v[76:79], a[224:227], v[100:103], 0
  v_max3_f32 v124, v65, v66, v124
  v_max3_f32 v124, v67, v68, v124
  v_mfma_f32_16x16x32_bf16 v[80:83], v[128:131], v[100:103], 0
  v_max3_f32 v124, v69, v70, v124
  v_max_f32 v124, v71, v124
  v_mfma_f32_16x16x32_bf16 v[84:87], v[132:135], v[100:103], 0
  v_fma_f32 v16, v16, s25, -v120
  v_cvt_pk_bf16_f32 v11, v14, v15
  v_mfma_f32_16x16x32_bf16 v[88:91], v[136:139], v[100:103], 0
  ds_write_b128 v113, v[8:11] offset:1024
  v_fma_f32 v17, v17, s25, -v120
  v_exp_f32 v16, v16
  v_mfma_f32_16x16x32_bf16 v[92:95], v[140:143], v[100:103], 0
  s_waitcnt lgkmcnt(2)
  ds_read_b128 v[100:103], v112 offset:33984
  v_fma_f32 v18, v18, s25, -v120
  v_exp_f32 v17, v17
  v_mfma_f32_16x16x32_bf16 v[72:75], a[196:199], v[104:107], v[72:75]
  v_fma_f32 v19, v19, s25, -v120
  v_exp_f32 v18, v18
  v_mfma_f32_16x16x32_bf16 v[76:79], a[228:231], v[104:107], v[76:79]
  v_fma_f32 v20, v20, s25, -v120
  v_cvt_pk_bf16_f32 v16, v16, v17
  v_mfma_f32_16x16x32_bf16 v[80:83], v[144:147], v[104:107], v[80:83]
  v_exp_f32 v19, v19
  v_mfma_f32_16x16x32_bf16 v[84:87], v[148:151], v[104:107], v[84:87]
  v_fma_f32 v21, v21, s25, -v120
  v_exp_f32 v20, v20
  v_mfma_f32_16x16x32_bf16 v[88:91], v[152:155], v[104:107], v[88:91]
  v_fma_f32 v22, v22, s25, -v120
  v_cvt_pk_bf16_f32 v17, v18, v19
  v_mfma_f32_16x16x32_bf16 v[92:95], v[156:159], v[104:107], v[92:95]
  s_waitcnt lgkmcnt(2)
  ds_read_b128 v[104:107], v112 offset:34048
  v_exp_f32 v21, v21
  v_mfma_f32_16x16x32_bf16 v[72:75], a[200:203], v[96:99], v[72:75]
  v_fma_f32 v23, v23, s25, -v120
  v_exp_f32 v22, v22
  v_mfma_f32_16x16x32_bf16 v[76:79], a[232:235], v[96:99], v[76:79]
  v_cvt_pk_bf16_f32 v18, v20, v21
  v_exp_f32 v23, v23
  v_mfma_f32_16x16x32_bf16 v[80:83], v[160:163], v[96:99], v[80:83]
  v_fma_f32 v24, v24, s25, -v121
  v_cvt_pk_bf16_f32 v19, v22, v23
  v_mfma_f32_16x16x32_bf16 v[84:87], v[164:167], v[96:99], v[84:87]
  ds_write_b128 v113, v[16:19] offset:2048
  v_fma_f32 v25, v25, s25, -v121
  v_exp_f32 v24, v24
  v_mfma_f32_16x16x32_bf16 v[88:91], v[168:171], v[96:99], v[88:91]
  v_fma_f32 v26, v26, s25, -v121
  v_exp_f32 v25, v25
  v_mfma_f32_16x16x32_bf16 v[92:95], v[172:175], v[96:99], v[92:95]
  s_waitcnt lgkmcnt(2)
  ds_read_b128 v[96:99], v112 offset:34112
  v_fma_f32 v27, v27, s25, -v121
  v_exp_f32 v26, v26
  v_mfma_f32_16x16x32_bf16 v[72:75], a[204:207], v[100:103], v[72:75]
  v_fma_f32 v28, v28, s25, -v121
  v_cvt_pk_bf16_f32 v24, v24, v25
  v_mfma_f32_16x16x32_bf16 v[76:79], a[236:239], v[100:103], v[76:79]
  v_exp_f32 v27, v27
  v_mfma_f32_16x16x32_bf16 v[80:83], v[176:179], v[100:103], v[80:83]
  v_fma_f32 v29, v29, s25, -v121
  v_exp_f32 v28, v28
  v_mfma_f32_16x16x32_bf16 v[84:87], v[180:183], v[100:103], v[84:87]
  v_fma_f32 v30, v30, s25, -v121
  v_cvt_pk_bf16_f32 v25, v26, v27
  v_mfma_f32_16x16x32_bf16 v[88:91], v[184:187], v[100:103], v[88:91]
  v_exp_f32 v29, v29
  v_mfma_f32_16x16x32_bf16 v[92:95], v[188:191], v[100:103], v[92:95]
  s_waitcnt lgkmcnt(2)
  ds_read_b128 v[100:103], v112 offset:34176
  v_fma_f32 v31, v31, s25, -v121
  v_exp_f32 v30, v30
  v_mfma_f32_16x16x32_bf16 v[72:75], a[208:211], v[104:107], v[72:75]
  v_cvt_pk_bf16_f32 v26, v28, v29
  v_exp_f32 v31, v31
  v_mfma_f32_16x16x32_bf16 v[76:79], a[240:243], v[104:107], v[76:79]
  v_fma_f32 v32, v32, s25, -v121
  v_cvt_pk_bf16_f32 v27, v30, v31
  v_mfma_f32_16x16x32_bf16 v[80:83], v[192:195], v[104:107], v[80:83]
  ds_write_b128 v113, v[24:27] offset:12288
  v_fma_f32 v33, v33, s25, -v121
  v_exp_f32 v32, v32
  v_mfma_f32_16x16x32_bf16 v[84:87], v[196:199], v[104:107], v[84:87]
  v_fma_f32 v34, v34, s25, -v121
  v_exp_f32 v33, v33
  v_mfma_f32_16x16x32_bf16 v[88:91], v[200:203], v[104:107], v[88:91]
  v_fma_f32 v35, v35, s25, -v121
  v_exp_f32 v34, v34
  v_mfma_f32_16x16x32_bf16 v[92:95], v[204:207], v[104:107], v[92:95]
  s_waitcnt lgkmcnt(2)
  ds_read_b128 v[104:107], v112 offset:34240
  v_fma_f32 v36, v36, s25, -v121
  v_cvt_pk_bf16_f32 v32, v32, v33
  v_mfma_f32_16x16x32_bf16 v[72:75], a[212:215], v[96:99], v[72:75]
  v_exp_f32 v35, v35
  v_mfma_f32_16x16x32_bf16 v[76:79], a[244:247], v[96:99], v[76:79]
  v_fma_f32 v37, v37, s25, -v121
  v_exp_f32 v36, v36
  v_mfma_f32_16x16x32_bf16 v[80:83], v[208:211], v[96:99], v[80:83]
  v_fma_f32 v38, v38, s25, -v121
  v_cvt_pk_bf16_f32 v33, v34, v35
  v_mfma_f32_16x16x32_bf16 v[84:87], v[212:215], v[96:99], v[84:87]
  v_exp_f32 v37, v37
  v_mfma_f32_16x16x32_bf16 v[88:91], v[216:219], v[96:99], v[88:91]
  v_fma_f32 v39, v39, s25, -v121
  v_exp_f32 v38, v38
  v_mfma_f32_16x16x32_bf16 v[92:95], v[220:223], v[96:99], v[92:95]
  s_waitcnt lgkmcnt(2)
  ds_read_b128 v[96:99], v112 offset:42240
  v_cvt_pk_bf16_f32 v34, v36, v37
  v_exp_f32 v39, v39
  v_mfma_f32_16x16x32_bf16 v[72:75], a[216:219], v[100:103], v[72:75]
  v_fma_f32 v40, v40, s25, -v121
  v_cvt_pk_bf16_f32 v35, v38, v39
  v_mfma_f32_16x16x32_bf16 v[76:79], a[248:251], v[100:103], v[76:79]
  ds_write_b128 v113, v[32:35] offset:13312
  v_fma_f32 v41, v41, s25, -v121
  v_exp_f32 v40, v40
  v_mfma_f32_16x16x32_bf16 v[80:83], v[224:227], v[100:103], v[80:83]
  v_fma_f32 v42, v42, s25, -v121
  v_exp_f32 v41, v41
  v_mfma_f32_16x16x32_bf16 v[84:87], v[228:231], v[100:103], v[84:87]
  v_fma_f32 v43, v43, s25, -v121
  v_exp_f32 v42, v42
  v_mfma_f32_16x16x32_bf16 v[88:91], v[232:235], v[100:103], v[88:91]
  v_fma_f32 v44, v44, s25, -v121
  v_cvt_pk_bf16_f32 v40, v40, v41
  v_mfma_f32_16x16x32_bf16 v[92:95], v[236:239], v[100:103], v[92:95]
  s_waitcnt lgkmcnt(2)
  ds_read_b128 v[100:103], v112 offset:42304
  v_exp_f32 v43, v43
  v_mfma_f32_16x16x32_bf16 v[72:75], a[220:223], v[104:107], v[72:75]
  v_fma_f32 v45, v45, s25, -v121
  v_exp_f32 v44, v44
  v_mfma_f32_16x16x32_bf16 v[76:79], a[252:255], v[104:107], v[76:79]
  v_fma_f32 v46, v46, s25, -v121
  v_cvt_pk_bf16_f32 v41, v42, v43
  v_mfma_f32_16x16x32_bf16 v[80:83], v[240:243], v[104:107], v[80:83]
  v_exp_f32 v45, v45
  v_mfma_f32_16x16x32_bf16 v[84:87], v[244:247], v[104:107], v[84:87]
  v_max3_f32 v125, v72, v73, v74
  v_fma_f32 v47, v47, s25, -v121
  v_mfma_f32_16x16x32_bf16 v[88:91], v[248:251], v[104:107], v[88:91]
  v_max3_f32 v125, v75, v76, v125
  v_max3_f32 v125, v77, v78, v125
  v_mfma_f32_16x16x32_bf16 v[92:95], v[252:255], v[104:107], v[92:95]
  s_waitcnt lgkmcnt(2)
  ds_read_b128 v[104:107], v112 offset:42368
  v_max3_f32 v125, v79, v80, v125
  v_max3_f32 v125, v81, v82, v125
  v_mfma_f32_16x16x32_bf16 v[0:3], a[192:195], v[96:99], 0
  v_max3_f32 v125, v83, v84, v125
  v_max3_f32 v125, v85, v86, v125
  v_mfma_f32_16x16x32_bf16 v[4:7], a[224:227], v[96:99], 0
  v_max3_f32 v125, v87, v88, v125
  v_max3_f32 v125, v89, v90, v125
  v_mfma_f32_16x16x32_bf16 v[8:11], v[128:131], v[96:99], 0
  v_max3_f32 v125, v91, v92, v125
  v_max3_f32 v125, v93, v94, v125
  v_mfma_f32_16x16x32_bf16 v[12:15], v[132:135], v[96:99], 0
  v_max_f32 v125, v95, v125
  v_exp_f32 v46, v46
  v_mfma_f32_16x16x32_bf16 v[16:19], v[136:139], v[96:99], 0
  v_permlane32_swap_b32 v124, v125
  v_mfma_f32_16x16x32_bf16 v[20:23], v[140:143], v[96:99], 0
  s_waitcnt lgkmcnt(1)
  ds_read_b128 v[96:99], v112 offset:42432
  v_max_f32 v126, v124, v125
  v_max_f32 v127, v124, v125
  v_mfma_f32_16x16x32_bf16 v[0:3], a[196:199], v[100:103], v[0:3]
  v_cvt_pk_bf16_f32 v42, v44, v45
  v_permlane16_swap_b32 v126, v127
  v_mfma_f32_16x16x32_bf16 v[4:7], a[228:231], v[100:103], v[4:7]
  v_max_f32 v126, v126, v127
  v_exp_f32 v47, v47
  v_mfma_f32_16x16x32_bf16 v[8:11], v[144:147], v[100:103], v[8:11]
  ds_write_b32 v116, v126 offset:512
  v_cvt_pk_bf16_f32 v43, v46, v47
  v_mfma_f32_16x16x32_bf16 v[12:15], v[148:151], v[100:103], v[12:15]
  ds_write_b128 v113, v[40:43] offset:14336
  v_mfma_f32_16x16x32_bf16 v[16:19], v[152:155], v[100:103], v[16:19]
  v_mfma_f32_16x16x32_bf16 v[20:23], v[156:159], v[100:103], v[20:23]
  ds_read_b128 v[100:103], v112 offset:42496
  s_waitcnt vmcnt(4) lgkmcnt(2)
  s_barrier
  v_mfma_f32_16x16x32_bf16 v[0:3], a[200:203], v[104:107], v[0:3]
  ds_read_b128 v[108:111], v117 offset:512
  ds_read_b128 v[124:127], v117 offset:768
  s_mov_b32 s46, 139264
  v_mfma_f32_16x16x32_bf16 v[4:7], a[232:235], v[104:107], v[4:7]
  s_mov_b32 s47, 147456
  v_mfma_f32_16x16x32_bf16 v[8:11], v[160:163], v[104:107], v[8:11]
  s_add_u32 m0, s26, 25344
  v_mfma_f32_16x16x32_bf16 v[12:15], v[164:167], v[104:107], v[12:15]
  v_mfma_f32_16x16x32_bf16 v[16:19], v[168:171], v[104:107], v[16:19]
  buffer_load_dwordx4 v118, s[8:11], s46 offen offset:0 nt lds
  v_mfma_f32_16x16x32_bf16 v[20:23], v[172:175], v[104:107], v[20:23]
  ds_read_b128 v[104:107], v112 offset:42560
  v_mfma_f32_16x16x32_bf16 v[0:3], a[204:207], v[96:99], v[0:3]
  v_mfma_f32_16x16x32_bf16 v[4:7], a[236:239], v[96:99], v[4:7]
  s_waitcnt lgkmcnt(2)
  v_max3_f32 v108, v108, v109, v110
  v_max_f32 v108, v108, v111
  v_mfma_f32_16x16x32_bf16 v[8:11], v[176:179], v[96:99], v[8:11]
  s_waitcnt lgkmcnt(1)
  ds_read_b128 a[48:51], v115 offset:49152
  v_mul_f32 v122, s25, v108
  v_max3_f32 v124, v124, v125, v126
  v_mfma_f32_16x16x32_bf16 v[12:15], v[180:183], v[96:99], v[12:15]
  v_max_f32 v124, v124, v127
  v_mul_f32 v123, s25, v124
  v_mfma_f32_16x16x32_bf16 v[16:19], v[184:187], v[96:99], v[16:19]
  v_fma_f32 v48, v48, s25, -v122
  v_fma_f32 v49, v49, s25, -v122
  v_mfma_f32_16x16x32_bf16 v[20:23], v[188:191], v[96:99], v[20:23]
  ds_read_b128 v[96:99], v112 offset:42624
  v_exp_f32 v48, v48
  v_mfma_f32_16x16x32_bf16 v[0:3], a[208:211], v[100:103], v[0:3]
  s_add_u32 m0, s26, 25376
  v_fma_f32 v50, v50, s25, -v122
  v_exp_f32 v49, v49
  v_mfma_f32_16x16x32_bf16 v[4:7], a[240:243], v[100:103], v[4:7]
  ds_read_b128 a[52:55], v115 offset:50176
  v_fma_f32 v51, v51, s25, -v122
  v_exp_f32 v50, v50
  v_mfma_f32_16x16x32_bf16 v[8:11], v[192:195], v[100:103], v[8:11]
  buffer_load_dwordx4 v118, s[8:11], s46 offen offset:1024 nt lds
  v_fma_f32 v52, v52, s25, -v122
  v_cvt_pk_bf16_f32 v48, v48, v49
  v_mfma_f32_16x16x32_bf16 v[12:15], v[196:199], v[100:103], v[12:15]
  v_exp_f32 v51, v51
  v_mfma_f32_16x16x32_bf16 v[16:19], v[200:203], v[100:103], v[16:19]
  v_fma_f32 v53, v53, s25, -v122
  v_exp_f32 v52, v52
  v_mfma_f32_16x16x32_bf16 v[20:23], v[204:207], v[100:103], v[20:23]
  s_waitcnt lgkmcnt(3)
  ds_read_b128 v[100:103], v112 offset:42688
  v_fma_f32 v54, v54, s25, -v122
  v_cvt_pk_bf16_f32 v49, v50, v51
  v_mfma_f32_16x16x32_bf16 v[0:3], a[212:215], v[104:107], v[0:3]
  v_exp_f32 v53, v53
  v_mfma_f32_16x16x32_bf16 v[4:7], a[244:247], v[104:107], v[4:7]
  ds_read_b128 a[56:59], v115 offset:51200
  v_fma_f32 v55, v55, s25, -v122
  v_exp_f32 v54, v54
  v_mfma_f32_16x16x32_bf16 v[8:11], v[208:211], v[104:107], v[8:11]
  v_cvt_pk_bf16_f32 v50, v52, v53
  v_exp_f32 v55, v55
  v_mfma_f32_16x16x32_bf16 v[12:15], v[212:215], v[104:107], v[12:15]
  v_fma_f32 v56, v56, s25, -v122
  v_cvt_pk_bf16_f32 v51, v54, v55
  v_mfma_f32_16x16x32_bf16 v[16:19], v[216:219], v[104:107], v[16:19]
  ds_write_b128 v113, v[48:51] offset:24576
  s_add_u32 m0, s26, 33792
  v_fma_f32 v57, v57, s25, -v122
  v_exp_f32 v56, v56
  v_mfma_f32_16x16x32_bf16 v[20:23], v[220:223], v[104:107], v[20:23]
  s_waitcnt lgkmcnt(4)
  ds_read_b128 v[104:107], v112 offset:50688
  v_fma_f32 v58, v58, s25, -v122
  v_exp_f32 v57, v57
  v_mfma_f32_16x16x32_bf16 v[0:3], a[216:219], v[96:99], v[0:3]
  buffer_load_dwordx4 v118, s[8:11], s47 offen offset:0 nt lds
  v_fma_f32 v59, v59, s25, -v122
  v_exp_f32 v58, v58
  v_mfma_f32_16x16x32_bf16 v[4:7], a[248:251], v[96:99], v[4:7]
  ds_read_b128 a[60:63], v115 offset:52224
  v_fma_f32 v60, v60, s25, -v122
  v_cvt_pk_bf16_f32 v56, v56, v57
  v_mfma_f32_16x16x32_bf16 v[8:11], v[224:227], v[96:99], v[8:11]
  v_exp_f32 v59, v59
  v_mfma_f32_16x16x32_bf16 v[12:15], v[228:231], v[96:99], v[12:15]
  v_fma_f32 v61, v61, s25, -v122
  v_exp_f32 v60, v60
  v_mfma_f32_16x16x32_bf16 v[16:19], v[232:235], v[96:99], v[16:19]
  v_fma_f32 v62, v62, s25, -v122
  v_cvt_pk_bf16_f32 v57, v58, v59
  v_mfma_f32_16x16x32_bf16 v[20:23], v[236:239], v[96:99], v[20:23]
  s_waitcnt lgkmcnt(4)
  ds_read_b128 v[96:99], v112 offset:50752
  v_exp_f32 v61, v61
  v_mfma_f32_16x16x32_bf16 v[0:3], a[220:223], v[100:103], v[0:3]
  v_fma_f32 v63, v63, s25, -v122
  v_exp_f32 v62, v62
  v_mfma_f32_16x16x32_bf16 v[4:7], a[252:255], v[100:103], v[4:7]
  ds_read_b128 a[64:67], v115 offset:53248
  v_cvt_pk_bf16_f32 v58, v60, v61
  v_exp_f32 v63, v63
  v_mfma_f32_16x16x32_bf16 v[8:11], v[240:243], v[100:103], v[8:11]
  s_add_u32 m0, s26, 33824
  v_max3_f32 v124, v0, v1, v2
  v_fma_f32 v64, v64, s25, -v122
  v_mfma_f32_16x16x32_bf16 v[12:15], v[244:247], v[100:103], v[12:15]
  v_max3_f32 v124, v3, v4, v124
  v_max3_f32 v124, v5, v6, v124
  v_mfma_f32_16x16x32_bf16 v[16:19], v[248:251], v[100:103], v[16:19]
  buffer_load_dwordx4 v118, s[8:11], s47 offen offset:1024 nt lds
  v_max3_f32 v124, v7, v8, v124
  v_max3_f32 v124, v9, v10, v124
  v_mfma_f32_16x16x32_bf16 v[20:23], v[252:255], v[100:103], v[20:23]
  s_waitcnt lgkmcnt(3)
  ds_read_b128 v[100:103], v112 offset:50816
  v_max3_f32 v124, v11, v12, v124
  v_max3_f32 v124, v13, v14, v124
  v_mfma_f32_16x16x32_bf16 v[24:27], a[192:195], v[104:107], 0
  v_max3_f32 v124, v15, v16, v124
  v_max3_f32 v124, v17, v18, v124
  v_mfma_f32_16x16x32_bf16 v[28:31], a[224:227], v[104:107], 0
  ds_read_b128 a[68:71], v115 offset:54272
  v_max3_f32 v124, v19, v20, v124
  v_max3_f32 v124, v21, v22, v124
  v_mfma_f32_16x16x32_bf16 v[32:35], v[128:131], v[104:107], 0
  v_max_f32 v124, v23, v124
  v_cvt_pk_bf16_f32 v59, v62, v63
  v_mfma_f32_16x16x32_bf16 v[36:39], v[132:135], v[104:107], 0
  ds_write_b128 v113, v[56:59] offset:25600
  v_fma_f32 v65, v65, s25, -v122
  v_exp_f32 v64, v64
  v_mfma_f32_16x16x32_bf16 v[40:43], v[136:139], v[104:107], 0
  v_fma_f32 v66, v66, s25, -v122
  v_exp_f32 v65, v65
  v_mfma_f32_16x16x32_bf16 v[44:47], v[140:143], v[104:107], 0
  s_waitcnt lgkmcnt(4)
  ds_read_b128 v[104:107], v112 offset:50880
  v_fma_f32 v67, v67, s25, -v122
  v_exp_f32 v66, v66
  v_mfma_f32_16x16x32_bf16 v[24:27], a[196:199], v[96:99], v[24:27]
  v_fma_f32 v68, v68, s25, -v122
  v_cvt_pk_bf16_f32 v64, v64, v65
  v_mfma_f32_16x16x32_bf16 v[28:31], a[228:231], v[96:99], v[28:31]
  ds_read_b128 a[72:75], v115 offset:55296
  v_exp_f32 v67, v67
  v_mfma_f32_16x16x32_bf16 v[32:35], v[144:147], v[96:99], v[32:35]
  v_fma_f32 v69, v69, s25, -v122
  v_exp_f32 v68, v68
  v_mfma_f32_16x16x32_bf16 v[36:39], v[148:151], v[96:99], v[36:39]
  v_fma_f32 v70, v70, s25, -v122
  v_cvt_pk_bf16_f32 v65, v66, v67
  v_mfma_f32_16x16x32_bf16 v[40:43], v[152:155], v[96:99], v[40:43]
  v_exp_f32 v69, v69
  v_mfma_f32_16x16x32_bf16 v[44:47], v[156:159], v[96:99], v[44:47]
  s_waitcnt lgkmcnt(4)
  ds_read_b128 v[96:99], v112 offset:50944
  v_fma_f32 v71, v71, s25, -v122
  v_exp_f32 v70, v70
  v_mfma_f32_16x16x32_bf16 v[24:27], a[200:203], v[100:103], v[24:27]
  ds_read_b128 a[76:79], v115 offset:56320
  v_cvt_pk_bf16_f32 v66, v68, v69
  v_exp_f32 v71, v71
  v_mfma_f32_16x16x32_bf16 v[28:31], a[232:235], v[100:103], v[28:31]
  v_fma_f32 v72, v72, s25, -v123
  v_cvt_pk_bf16_f32 v67, v70, v71
  v_mfma_f32_16x16x32_bf16 v[32:35], v[160:163], v[100:103], v[32:35]
  ds_write_b128 v113, v[64:67] offset:26624
  v_fma_f32 v73, v73, s25, -v123
  v_exp_f32 v72, v72
  v_mfma_f32_16x16x32_bf16 v[36:39], v[164:167], v[100:103], v[36:39]
  v_fma_f32 v74, v74, s25, -v123
  v_exp_f32 v73, v73
  v_mfma_f32_16x16x32_bf16 v[40:43], v[168:171], v[100:103], v[40:43]
  v_fma_f32 v75, v75, s25, -v123
  v_exp_f32 v74, v74
  v_mfma_f32_16x16x32_bf16 v[44:47], v[172:175], v[100:103], v[44:47]
  s_waitcnt lgkmcnt(4)
  ds_read_b128 v[100:103], v112 offset:51008
  v_fma_f32 v76, v76, s25, -v123
  v_cvt_pk_bf16_f32 v72, v72, v73
  v_mfma_f32_16x16x32_bf16 v[24:27], a[204:207], v[104:107], v[24:27]
  ds_read_b128 a[80:83], v115 offset:57344
  v_exp_f32 v75, v75
  v_mfma_f32_16x16x32_bf16 v[28:31], a[236:239], v[104:107], v[28:31]
  v_fma_f32 v77, v77, s25, -v123
  v_exp_f32 v76, v76
  v_mfma_f32_16x16x32_bf16 v[32:35], v[176:179], v[104:107], v[32:35]
  v_fma_f32 v78, v78, s25, -v123
  v_cvt_pk_bf16_f32 v73, v74, v75
  v_mfma_f32_16x16x32_bf16 v[36:39], v[180:183], v[104:107], v[36:39]
  v_exp_f32 v77, v77
  v_mfma_f32_16x16x32_bf16 v[40:43], v[184:187], v[104:107], v[40:43]
  v_fma_f32 v79, v79, s25, -v123
  v_exp_f32 v78, v78
  v_mfma_f32_16x16x32_bf16 v[44:47], v[188:191], v[104:107], v[44:47]
  s_waitcnt lgkmcnt(4)
  ds_read_b128 v[104:107], v112 offset:51072
  v_cvt_pk_bf16_f32 v74, v76, v77
  v_exp_f32 v79, v79
  v_mfma_f32_16x16x32_bf16 v[24:27], a[208:211], v[96:99], v[24:27]
  ds_read_b128 a[84:87], v115 offset:58368
  v_fma_f32 v80, v80, s25, -v123
  v_cvt_pk_bf16_f32 v75, v78, v79
  v_mfma_f32_16x16x32_bf16 v[28:31], a[240:243], v[96:99], v[28:31]
  ds_write_b128 v113, v[72:75] offset:36864
  v_fma_f32 v81, v81, s25, -v123
  v_exp_f32 v80, v80
  v_mfma_f32_16x16x32_bf16 v[32:35], v[192:195], v[96:99], v[32:35]
  v_fma_f32 v82, v82, s25, -v123
  v_exp_f32 v81, v81
  v_mfma_f32_16x16x32_bf16 v[36:39], v[196:199], v[96:99], v[36:39]
  v_fma_f32 v83, v83, s25, -v123
  v_exp_f32 v82, v82
  v_mfma_f32_16x16x32_bf16 v[40:43], v[200:203], v[96:99], v[40:43]
  v_fma_f32 v84, v84, s25, -v123
  v_cvt_pk_bf16_f32 v80, v80, v81
  v_mfma_f32_16x16x32_bf16 v[44:47], v[204:207], v[96:99], v[44:47]
  s_waitcnt lgkmcnt(4)
  ds_read_b128 v[96:99], v112 offset:51136
  v_exp_f32 v83, v83
  v_mfma_f32_16x16x32_bf16 v[24:27], a[212:215], v[100:103], v[24:27]
  ds_read_b128 a[88:91], v115 offset:59392
  v_fma_f32 v85, v85, s25, -v123
  v_exp_f32 v84, v84
  v_mfma_f32_16x16x32_bf16 v[28:31], a[244:247], v[100:103], v[28:31]
  v_fma_f32 v86, v86, s25, -v123
  v_cvt_pk_bf16_f32 v81, v82, v83
  v_mfma_f32_16x16x32_bf16 v[32:35], v[208:211], v[100:103], v[32:35]
  v_exp_f32 v85, v85
  v_mfma_f32_16x16x32_bf16 v[36:39], v[212:215], v[100:103], v[36:39]
  v_fma_f32 v87, v87, s25, -v123
  v_exp_f32 v86, v86
  v_mfma_f32_16x16x32_bf16 v[40:43], v[216:219], v[100:103], v[40:43]
  v_cvt_pk_bf16_f32 v82, v84, v85
  v_exp_f32 v87, v87
  v_mfma_f32_16x16x32_bf16 v[44:47], v[220:223], v[100:103], v[44:47]
  s_waitcnt lgkmcnt(4)
  ds_read_b128 v[100:103], v112 offset:0
  v_fma_f32 v88, v88, s25, -v123
  v_cvt_pk_bf16_f32 v83, v86, v87
  v_mfma_f32_16x16x32_bf16 v[24:27], a[216:219], v[104:107], v[24:27]
  ds_read_b128 a[92:95], v115 offset:60416
  v_fma_f32 v89, v89, s25, -v123
  v_exp_f32 v88, v88
  v_mfma_f32_16x16x32_bf16 v[28:31], a[248:251], v[104:107], v[28:31]
  ds_write_b128 v113, v[80:83] offset:37888
  v_fma_f32 v90, v90, s25, -v123
  v_exp_f32 v89, v89
  v_mfma_f32_16x16x32_bf16 v[32:35], v[224:227], v[104:107], v[32:35]
  v_fma_f32 v91, v91, s25, -v123
  v_exp_f32 v90, v90
  v_mfma_f32_16x16x32_bf16 v[36:39], v[228:231], v[104:107], v[36:39]
  v_fma_f32 v92, v92, s25, -v123
  v_cvt_pk_bf16_f32 v88, v88, v89
  v_mfma_f32_16x16x32_bf16 v[40:43], v[232:235], v[104:107], v[40:43]
  v_exp_f32 v91, v91
  v_mfma_f32_16x16x32_bf16 v[44:47], v[236:239], v[104:107], v[44:47]
  s_waitcnt lgkmcnt(4)
  ds_read_b128 v[104:107], v112 offset:64
  v_fma_f32 v93, v93, s25, -v123
  v_exp_f32 v92, v92
  v_mfma_f32_16x16x32_bf16 v[24:27], a[220:223], v[96:99], v[24:27]
  v_fma_f32 v94, v94, s25, -v123
  v_cvt_pk_bf16_f32 v89, v90, v91
  v_mfma_f32_16x16x32_bf16 v[28:31], a[252:255], v[96:99], v[28:31]
  v_exp_f32 v93, v93
  v_mfma_f32_16x16x32_bf16 v[32:35], v[240:243], v[96:99], v[32:35]
  v_fma_f32 v95, v95, s25, -v123
  v_exp_f32 v94, v94
  v_mfma_f32_16x16x32_bf16 v[36:39], v[244:247], v[96:99], v[36:39]
  v_max3_f32 v125, v24, v25, v26
  v_cvt_pk_bf16_f32 v90, v92, v93
  v_mfma_f32_16x16x32_bf16 v[40:43], v[248:251], v[96:99], v[40:43]
  v_max3_f32 v125, v27, v28, v125
  v_max3_f32 v125, v29, v30, v125
  v_mfma_f32_16x16x32_bf16 v[44:47], v[252:255], v[96:99], v[44:47]
  s_waitcnt lgkmcnt(3)
  ds_read_b128 v[96:99], v112 offset:128
  v_max3_f32 v125, v31, v32, v125
  v_max3_f32 v125, v33, v34, v125
  v_mfma_f32_16x16x32_bf16 v[48:51], a[192:195], v[100:103], 0
  v_max3_f32 v125, v35, v36, v125
  v_max3_f32 v125, v37, v38, v125
  v_mfma_f32_16x16x32_bf16 v[52:55], a[224:227], v[100:103], 0
  v_max3_f32 v125, v39, v40, v125
  v_max3_f32 v125, v41, v42, v125
  v_mfma_f32_16x16x32_bf16 v[56:59], v[128:131], v[100:103], 0
  v_max3_f32 v125, v43, v44, v125
  v_max3_f32 v125, v45, v46, v125
  v_mfma_f32_16x16x32_bf16 v[60:63], v[132:135], v[100:103], 0
  v_max_f32 v125, v47, v125
  v_exp_f32 v95, v95
  v_mfma_f32_16x16x32_bf16 v[64:67], v[136:139], v[100:103], 0
  v_permlane32_swap_b32 v124, v125
  v_mfma_f32_16x16x32_bf16 v[68:71], v[140:143], v[100:103], 0
  s_waitcnt lgkmcnt(1)
  ds_read_b128 v[100:103], v112 offset:192
  v_max_f32 v126, v124, v125
  v_max_f32 v127, v124, v125
  v_mfma_f32_16x16x32_bf16 v[48:51], a[196:199], v[104:107], v[48:51]
  v_cvt_pk_bf16_f32 v91, v94, v95
  v_permlane16_swap_b32 v126, v127
  v_mfma_f32_16x16x32_bf16 v[52:55], a[228:231], v[104:107], v[52:55]
  ds_write_b128 v113, v[88:91] offset:38912
  v_max_f32 v126, v126, v127
  v_mfma_f32_16x16x32_bf16 v[56:59], v[144:147], v[104:107], v[56:59]
  ds_write_b32 v116, v126 offset:0
  v_mfma_f32_16x16x32_bf16 v[60:63], v[148:151], v[104:107], v[60:63]
  v_mfma_f32_16x16x32_bf16 v[64:67], v[152:155], v[104:107], v[64:67]
  v_mfma_f32_16x16x32_bf16 v[68:71], v[156:159], v[104:107], v[68:71]
  ds_read_b128 v[104:107], v112 offset:256
  s_waitcnt lgkmcnt(1) vmcnt(4)
  s_barrier
  v_mfma_f32_16x16x32_bf16 v[48:51], a[200:203], v[96:99], v[48:51]
  ds_read_b128 v[108:111], v117 offset:0
  ds_read_b128 v[124:127], v117 offset:256
  s_mov_b32 s32, 155648
  v_mfma_f32_16x16x32_bf16 v[52:55], a[232:235], v[96:99], v[52:55]
  s_mov_b32 s33, 163840
  v_mfma_f32_16x16x32_bf16 v[56:59], v[160:163], v[96:99], v[56:59]
  s_add_u32 m0, s26, 42240
  v_mfma_f32_16x16x32_bf16 v[60:63], v[164:167], v[96:99], v[60:63]
  v_mfma_f32_16x16x32_bf16 v[64:67], v[168:171], v[96:99], v[64:67]
  buffer_load_dwordx4 v118, s[8:11], s32 offen offset:0 nt lds
  v_mfma_f32_16x16x32_bf16 v[68:71], v[172:175], v[96:99], v[68:71]
  ds_read_b128 v[96:99], v112 offset:320
  v_mfma_f32_16x16x32_bf16 v[48:51], a[204:207], v[100:103], v[48:51]
  v_mfma_f32_16x16x32_bf16 v[52:55], a[236:239], v[100:103], v[52:55]
  s_waitcnt lgkmcnt(2)
  v_max3_f32 v108, v108, v109, v110
  v_max_f32 v108, v108, v111
  v_mfma_f32_16x16x32_bf16 v[56:59], v[176:179], v[100:103], v[56:59]
  s_waitcnt lgkmcnt(1)
  v_mul_f32 v120, s25, v108
  v_max3_f32 v124, v124, v125, v126
  v_mfma_f32_16x16x32_bf16 v[60:63], v[180:183], v[100:103], v[60:63]
  v_max_f32 v124, v124, v127
  v_mul_f32 v121, s25, v124
  v_mfma_f32_16x16x32_bf16 v[64:67], v[184:187], v[100:103], v[64:67]
  v_fma_f32 v0, v0, s25, -v120
  v_fma_f32 v1, v1, s25, -v120
  v_mfma_f32_16x16x32_bf16 v[68:71], v[188:191], v[100:103], v[68:71]
  ds_read_b128 v[100:103], v112 offset:384
  v_exp_f32 v0, v0
  v_mfma_f32_16x16x32_bf16 v[48:51], a[208:211], v[104:107], v[48:51]
  s_add_u32 m0, s26, 42272
  v_fma_f32 v2, v2, s25, -v120
  v_exp_f32 v1, v1
  v_mfma_f32_16x16x32_bf16 v[52:55], a[240:243], v[104:107], v[52:55]
  v_fma_f32 v3, v3, s25, -v120
  v_exp_f32 v2, v2
  v_mfma_f32_16x16x32_bf16 v[56:59], v[192:195], v[104:107], v[56:59]
  buffer_load_dwordx4 v118, s[8:11], s32 offen offset:1024 nt lds
  v_fma_f32 v4, v4, s25, -v120
  v_cvt_pk_bf16_f32 v0, v0, v1
  v_mfma_f32_16x16x32_bf16 v[60:63], v[196:199], v[104:107], v[60:63]
  v_exp_f32 v3, v3
  v_mfma_f32_16x16x32_bf16 v[64:67], v[200:203], v[104:107], v[64:67]
  v_fma_f32 v5, v5, s25, -v120
  v_exp_f32 v4, v4
  v_mfma_f32_16x16x32_bf16 v[68:71], v[204:207], v[104:107], v[68:71]
  s_waitcnt lgkmcnt(1)
  ds_read_b128 v[104:107], v112 offset:448
  v_fma_f32 v6, v6, s25, -v120
  v_cvt_pk_bf16_f32 v1, v2, v3
  v_mfma_f32_16x16x32_bf16 v[48:51], a[212:215], v[96:99], v[48:51]
  v_exp_f32 v5, v5
  v_mfma_f32_16x16x32_bf16 v[52:55], a[244:247], v[96:99], v[52:55]
  v_fma_f32 v7, v7, s25, -v120
  v_exp_f32 v6, v6
  v_mfma_f32_16x16x32_bf16 v[56:59], v[208:211], v[96:99], v[56:59]
  v_cvt_pk_bf16_f32 v2, v4, v5
  v_exp_f32 v7, v7
  v_mfma_f32_16x16x32_bf16 v[60:63], v[212:215], v[96:99], v[60:63]
  v_fma_f32 v8, v8, s25, -v120
  v_cvt_pk_bf16_f32 v3, v6, v7
  v_mfma_f32_16x16x32_bf16 v[64:67], v[216:219], v[96:99], v[64:67]
  ds_write_b128 v114, v[0:3] offset:0
  s_add_u32 m0, s26, 50688
  v_fma_f32 v9, v9, s25, -v120
  v_exp_f32 v8, v8
  v_mfma_f32_16x16x32_bf16 v[68:71], v[220:223], v[96:99], v[68:71]
  s_waitcnt lgkmcnt(2)
  ds_read_b128 v[96:99], v112 offset:8448
  v_fma_f32 v10, v10, s25, -v120
  v_exp_f32 v9, v9
  v_mfma_f32_16x16x32_bf16 v[48:51], a[216:219], v[100:103], v[48:51]
  buffer_load_dwordx4 v118, s[8:11], s33 offen offset:0 nt lds
  v_fma_f32 v11, v11, s25, -v120
  v_exp_f32 v10, v10
  v_mfma_f32_16x16x32_bf16 v[52:55], a[248:251], v[100:103], v[52:55]
  v_fma_f32 v12, v12, s25, -v120
  v_cvt_pk_bf16_f32 v8, v8, v9
  v_mfma_f32_16x16x32_bf16 v[56:59], v[224:227], v[100:103], v[56:59]
  v_exp_f32 v11, v11
  v_mfma_f32_16x16x32_bf16 v[60:63], v[228:231], v[100:103], v[60:63]
  v_fma_f32 v13, v13, s25, -v120
  v_exp_f32 v12, v12
  v_mfma_f32_16x16x32_bf16 v[64:67], v[232:235], v[100:103], v[64:67]
  v_fma_f32 v14, v14, s25, -v120
  v_cvt_pk_bf16_f32 v9, v10, v11
  v_mfma_f32_16x16x32_bf16 v[68:71], v[236:239], v[100:103], v[68:71]
  s_waitcnt lgkmcnt(2)
  ds_read_b128 v[100:103], v112 offset:8512
  v_exp_f32 v13, v13
  v_mfma_f32_16x16x32_bf16 v[48:51], a[220:223], v[104:107], v[48:51]
  v_fma_f32 v15, v15, s25, -v120
  v_exp_f32 v14, v14
  v_mfma_f32_16x16x32_bf16 v[52:55], a[252:255], v[104:107], v[52:55]
  v_cvt_pk_bf16_f32 v10, v12, v13
  v_exp_f32 v15, v15
  v_mfma_f32_16x16x32_bf16 v[56:59], v[240:243], v[104:107], v[56:59]
  s_add_u32 m0, s26, 50720
  v_fma_f32 v16, v16, s25, -v120
  v_max3_f32 v124, v48, v49, v50
  v_mfma_f32_16x16x32_bf16 v[60:63], v[244:247], v[104:107], v[60:63]
  v_cvt_pk_bf16_f32 v11, v14, v15
  v_max3_f32 v124, v51, v52, v124
  v_mfma_f32_16x16x32_bf16 v[64:67], v[248:251], v[104:107], v[64:67]
  buffer_load_dwordx4 v118, s[8:11], s33 offen offset:1024 nt lds
  v_max3_f32 v124, v53, v54, v124
  v_max3_f32 v124, v55, v56, v124
  v_mfma_f32_16x16x32_bf16 v[68:71], v[252:255], v[104:107], v[68:71]
  s_waitcnt lgkmcnt(1)
  ds_read_b128 v[104:107], v112 offset:8576
  v_max3_f32 v124, v57, v58, v124
  v_max3_f32 v124, v59, v60, v124
  v_mfma_f32_16x16x32_bf16 v[72:75], a[192:195], v[96:99], 0
  ds_write_b128 v114, v[8:11] offset:1024
  v_max3_f32 v124, v61, v62, v124
  v_max3_f32 v124, v63, v64, v124
  v_mfma_f32_16x16x32_bf16 v[76:79], a[224:227], v[96:99], 0
  v_max3_f32 v124, v65, v66, v124
  v_max3_f32 v124, v67, v68, v124
  v_mfma_f32_16x16x32_bf16 v[80:83], v[128:131], v[96:99], 0
  v_max3_f32 v124, v69, v70, v124
  v_max_f32 v124, v71, v124
  v_mfma_f32_16x16x32_bf16 v[84:87], v[132:135], v[96:99], 0
  v_fma_f32 v17, v17, s25, -v120
  v_exp_f32 v16, v16
  v_mfma_f32_16x16x32_bf16 v[88:91], v[136:139], v[96:99], 0
  v_fma_f32 v18, v18, s25, -v120
  v_exp_f32 v17, v17
  v_mfma_f32_16x16x32_bf16 v[92:95], v[140:143], v[96:99], 0
  s_waitcnt lgkmcnt(2)
  ds_read_b128 v[96:99], v112 offset:8640
  v_fma_f32 v19, v19, s25, -v120
  v_exp_f32 v18, v18
  v_mfma_f32_16x16x32_bf16 v[72:75], a[196:199], v[100:103], v[72:75]
  v_fma_f32 v20, v20, s25, -v120
  v_cvt_pk_bf16_f32 v16, v16, v17
  v_mfma_f32_16x16x32_bf16 v[76:79], a[228:231], v[100:103], v[76:79]
  v_exp_f32 v19, v19
  v_mfma_f32_16x16x32_bf16 v[80:83], v[144:147], v[100:103], v[80:83]
  v_fma_f32 v21, v21, s25, -v120
  v_exp_f32 v20, v20
  v_mfma_f32_16x16x32_bf16 v[84:87], v[148:151], v[100:103], v[84:87]
  v_fma_f32 v22, v22, s25, -v120
  v_cvt_pk_bf16_f32 v17, v18, v19
  v_mfma_f32_16x16x32_bf16 v[88:91], v[152:155], v[100:103], v[88:91]
  v_exp_f32 v21, v21
  v_mfma_f32_16x16x32_bf16 v[92:95], v[156:159], v[100:103], v[92:95]
  s_waitcnt lgkmcnt(2)
  ds_read_b128 v[100:103], v112 offset:8704
  v_fma_f32 v23, v23, s25, -v120
  v_exp_f32 v22, v22
  v_mfma_f32_16x16x32_bf16 v[72:75], a[200:203], v[104:107], v[72:75]
  v_cvt_pk_bf16_f32 v18, v20, v21
  v_exp_f32 v23, v23
  v_mfma_f32_16x16x32_bf16 v[76:79], a[232:235], v[104:107], v[76:79]
  v_fma_f32 v24, v24, s25, -v121
  v_cvt_pk_bf16_f32 v19, v22, v23
  v_mfma_f32_16x16x32_bf16 v[80:83], v[160:163], v[104:107], v[80:83]
  ds_write_b128 v114, v[16:19] offset:2048
  v_fma_f32 v25, v25, s25, -v121
  v_exp_f32 v24, v24
  v_mfma_f32_16x16x32_bf16 v[84:87], v[164:167], v[104:107], v[84:87]
  v_fma_f32 v26, v26, s25, -v121
  v_exp_f32 v25, v25
  v_mfma_f32_16x16x32_bf16 v[88:91], v[168:171], v[104:107], v[88:91]
  v_fma_f32 v27, v27, s25, -v121
  v_exp_f32 v26, v26
  v_mfma_f32_16x16x32_bf16 v[92:95], v[172:175], v[104:107], v[92:95]
  s_waitcnt lgkmcnt(2)
  ds_read_b128 v[104:107], v112 offset:8768
  v_fma_f32 v28, v28, s25, -v121
  v_cvt_pk_bf16_f32 v24, v24, v25
  v_mfma_f32_16x16x32_bf16 v[72:75], a[204:207], v[96:99], v[72:75]
  v_exp_f32 v27, v27
  v_mfma_f32_16x16x32_bf16 v[76:79], a[236:239], v[96:99], v[76:79]
  v_fma_f32 v29, v29, s25, -v121
  v_exp_f32 v28, v28
  v_mfma_f32_16x16x32_bf16 v[80:83], v[176:179], v[96:99], v[80:83]
  v_fma_f32 v30, v30, s25, -v121
  v_cvt_pk_bf16_f32 v25, v26, v27
  v_mfma_f32_16x16x32_bf16 v[84:87], v[180:183], v[96:99], v[84:87]
  v_exp_f32 v29, v29
  v_mfma_f32_16x16x32_bf16 v[88:91], v[184:187], v[96:99], v[88:91]
  v_fma_f32 v31, v31, s25, -v121
  v_exp_f32 v30, v30
  v_mfma_f32_16x16x32_bf16 v[92:95], v[188:191], v[96:99], v[92:95]
  s_waitcnt lgkmcnt(2)
  ds_read_b128 v[96:99], v112 offset:8832
  v_cvt_pk_bf16_f32 v26, v28, v29
  v_exp_f32 v31, v31
  v_mfma_f32_16x16x32_bf16 v[72:75], a[208:211], v[100:103], v[72:75]
  v_fma_f32 v32, v32, s25, -v121
  v_cvt_pk_bf16_f32 v27, v30, v31
  v_mfma_f32_16x16x32_bf16 v[76:79], a[240:243], v[100:103], v[76:79]
  ds_write_b128 v114, v[24:27] offset:12288
  v_fma_f32 v33, v33, s25, -v121
  v_exp_f32 v32, v32
  v_mfma_f32_16x16x32_bf16 v[80:83], v[192:195], v[100:103], v[80:83]
  v_fma_f32 v34, v34, s25, -v121
  v_exp_f32 v33, v33
  v_mfma_f32_16x16x32_bf16 v[84:87], v[196:199], v[100:103], v[84:87]
  v_fma_f32 v35, v35, s25, -v121
  v_exp_f32 v34, v34
  v_mfma_f32_16x16x32_bf16 v[88:91], v[200:203], v[100:103], v[88:91]
  v_fma_f32 v36, v36, s25, -v121
  v_cvt_pk_bf16_f32 v32, v32, v33
  v_mfma_f32_16x16x32_bf16 v[92:95], v[204:207], v[100:103], v[92:95]
  s_waitcnt lgkmcnt(2)
  ds_read_b128 v[100:103], v112 offset:8896
  v_exp_f32 v35, v35
  v_mfma_f32_16x16x32_bf16 v[72:75], a[212:215], v[104:107], v[72:75]
  v_fma_f32 v37, v37, s25, -v121
  v_exp_f32 v36, v36
  v_mfma_f32_16x16x32_bf16 v[76:79], a[244:247], v[104:107], v[76:79]
  v_fma_f32 v38, v38, s25, -v121
  v_cvt_pk_bf16_f32 v33, v34, v35
  v_mfma_f32_16x16x32_bf16 v[80:83], v[208:211], v[104:107], v[80:83]
  v_exp_f32 v37, v37
  v_mfma_f32_16x16x32_bf16 v[84:87], v[212:215], v[104:107], v[84:87]
  v_fma_f32 v39, v39, s25, -v121
  v_exp_f32 v38, v38
  v_mfma_f32_16x16x32_bf16 v[88:91], v[216:219], v[104:107], v[88:91]
  v_cvt_pk_bf16_f32 v34, v36, v37
  v_exp_f32 v39, v39
  v_mfma_f32_16x16x32_bf16 v[92:95], v[220:223], v[104:107], v[92:95]
  s_waitcnt lgkmcnt(2)
  ds_read_b128 v[104:107], v112 offset:16896
  v_fma_f32 v40, v40, s25, -v121
  v_cvt_pk_bf16_f32 v35, v38, v39
  v_mfma_f32_16x16x32_bf16 v[72:75], a[216:219], v[96:99], v[72:75]
  ds_write_b128 v114, v[32:35] offset:13312
  v_fma_f32 v41, v41, s25, -v121
  v_exp_f32 v40, v40
  v_mfma_f32_16x16x32_bf16 v[76:79], a[248:251], v[96:99], v[76:79]
  v_fma_f32 v42, v42, s25, -v121
  v_exp_f32 v41, v41
  v_mfma_f32_16x16x32_bf16 v[80:83], v[224:227], v[96:99], v[80:83]
  v_fma_f32 v43, v43, s25, -v121
  v_exp_f32 v42, v42
  v_mfma_f32_16x16x32_bf16 v[84:87], v[228:231], v[96:99], v[84:87]
  v_fma_f32 v44, v44, s25, -v121
  v_cvt_pk_bf16_f32 v40, v40, v41
  v_mfma_f32_16x16x32_bf16 v[88:91], v[232:235], v[96:99], v[88:91]
  v_exp_f32 v43, v43
  v_mfma_f32_16x16x32_bf16 v[92:95], v[236:239], v[96:99], v[92:95]
  s_waitcnt lgkmcnt(2)
  ds_read_b128 v[96:99], v112 offset:16960
  v_fma_f32 v45, v45, s25, -v121
  v_exp_f32 v44, v44
  v_mfma_f32_16x16x32_bf16 v[72:75], a[220:223], v[100:103], v[72:75]
  v_fma_f32 v46, v46, s25, -v121
  v_cvt_pk_bf16_f32 v41, v42, v43
  v_mfma_f32_16x16x32_bf16 v[76:79], a[252:255], v[100:103], v[76:79]
  v_exp_f32 v45, v45
  v_mfma_f32_16x16x32_bf16 v[80:83], v[240:243], v[100:103], v[80:83]
  v_fma_f32 v47, v47, s25, -v121
  v_exp_f32 v46, v46
  v_mfma_f32_16x16x32_bf16 v[84:87], v[244:247], v[100:103], v[84:87]
  v_max3_f32 v125, v72, v73, v74
  v_cvt_pk_bf16_f32 v42, v44, v45
  v_mfma_f32_16x16x32_bf16 v[88:91], v[248:251], v[100:103], v[88:91]
  v_max3_f32 v125, v75, v76, v125
  v_max3_f32 v125, v77, v78, v125
  v_mfma_f32_16x16x32_bf16 v[92:95], v[252:255], v[100:103], v[92:95]
  s_waitcnt lgkmcnt(2)
  ds_read_b128 v[100:103], v112 offset:17024
  v_max3_f32 v125, v79, v80, v125
  v_max3_f32 v125, v81, v82, v125
  v_mfma_f32_16x16x32_bf16 v[0:3], a[192:195], v[104:107], 0
  v_max3_f32 v125, v83, v84, v125
  v_max3_f32 v125, v85, v86, v125
  v_mfma_f32_16x16x32_bf16 v[4:7], a[224:227], v[104:107], 0
  v_max3_f32 v125, v87, v88, v125
  v_max3_f32 v125, v89, v90, v125
  v_mfma_f32_16x16x32_bf16 v[8:11], v[128:131], v[104:107], 0
  v_max3_f32 v125, v91, v92, v125
  v_max3_f32 v125, v93, v94, v125
  v_mfma_f32_16x16x32_bf16 v[12:15], v[132:135], v[104:107], 0
  v_max_f32 v125, v95, v125
  v_exp_f32 v47, v47
  v_mfma_f32_16x16x32_bf16 v[16:19], v[136:139], v[104:107], 0
  v_permlane32_swap_b32 v124, v125
  v_mfma_f32_16x16x32_bf16 v[20:23], v[140:143], v[104:107], 0
  s_waitcnt lgkmcnt(1)
  ds_read_b128 v[104:107], v112 offset:17088
  v_max_f32 v126, v124, v125
  v_max_f32 v127, v124, v125
  v_mfma_f32_16x16x32_bf16 v[0:3], a[196:199], v[96:99], v[0:3]
  s_lshl_b32 s58, s24, 13
  v_permlane16_swap_b32 v126, v127
  v_mfma_f32_16x16x32_bf16 v[4:7], a[228:231], v[96:99], v[4:7]
  v_max_f32 v126, v126, v127
  v_cvt_pk_bf16_f32 v43, v46, v47
  v_mfma_f32_16x16x32_bf16 v[8:11], v[144:147], v[96:99], v[8:11]
  ds_write_b32 v116, v126 offset:512
  v_mfma_f32_16x16x32_bf16 v[12:15], v[148:151], v[96:99], v[12:15]
  ds_write_b128 v114, v[40:43] offset:14336
  v_mfma_f32_16x16x32_bf16 v[16:19], v[152:155], v[96:99], v[16:19]
  v_mfma_f32_16x16x32_bf16 v[20:23], v[156:159], v[96:99], v[20:23]
  ds_read_b128 v[96:99], v112 offset:17152
  s_waitcnt vmcnt(4) lgkmcnt(2)
  s_barrier
  v_mfma_f32_16x16x32_bf16 v[0:3], a[200:203], v[100:103], v[0:3]
  ds_read_b128 v[108:111], v117 offset:512
  ds_read_b128 v[124:127], v117 offset:768
  s_mov_b32 s34, 172032
  v_mfma_f32_16x16x32_bf16 v[4:7], a[232:235], v[100:103], v[4:7]
  s_mov_b32 s35, 180224
  v_mfma_f32_16x16x32_bf16 v[8:11], v[160:163], v[100:103], v[8:11]
  s_add_u32 m0, s26, 0
  v_mfma_f32_16x16x32_bf16 v[12:15], v[164:167], v[100:103], v[12:15]
  v_mfma_f32_16x16x32_bf16 v[16:19], v[168:171], v[100:103], v[16:19]
  buffer_load_dwordx4 v118, s[8:11], s34 offen offset:0 nt lds
  v_mfma_f32_16x16x32_bf16 v[20:23], v[172:175], v[100:103], v[20:23]
  ds_read_b128 v[100:103], v112 offset:17216
  v_mfma_f32_16x16x32_bf16 v[0:3], a[204:207], v[104:107], v[0:3]
  v_mfma_f32_16x16x32_bf16 v[4:7], a[236:239], v[104:107], v[4:7]
  s_waitcnt lgkmcnt(2)
  v_max3_f32 v108, v108, v109, v110
  v_max_f32 v108, v108, v111
  v_mfma_f32_16x16x32_bf16 v[8:11], v[176:179], v[104:107], v[8:11]
  s_waitcnt lgkmcnt(1)
  ds_read_b128 a[96:99], v115 offset:0
  v_mul_f32 v122, s25, v108
  v_max3_f32 v124, v124, v125, v126
  v_mfma_f32_16x16x32_bf16 v[12:15], v[180:183], v[104:107], v[12:15]
  v_max_f32 v124, v124, v127
  v_mul_f32 v123, s25, v124
  v_mfma_f32_16x16x32_bf16 v[16:19], v[184:187], v[104:107], v[16:19]
  v_fma_f32 v48, v48, s25, -v122
  v_fma_f32 v49, v49, s25, -v122
  v_mfma_f32_16x16x32_bf16 v[20:23], v[188:191], v[104:107], v[20:23]
  ds_read_b128 v[104:107], v112 offset:17280
  v_exp_f32 v48, v48
  v_mfma_f32_16x16x32_bf16 v[0:3], a[208:211], v[96:99], v[0:3]
  s_add_u32 m0, s26, 32
  v_fma_f32 v50, v50, s25, -v122
  v_exp_f32 v49, v49
  v_mfma_f32_16x16x32_bf16 v[4:7], a[240:243], v[96:99], v[4:7]
  ds_read_b128 a[100:103], v115 offset:1024
  v_fma_f32 v51, v51, s25, -v122
  v_exp_f32 v50, v50
  v_mfma_f32_16x16x32_bf16 v[8:11], v[192:195], v[96:99], v[8:11]
  buffer_load_dwordx4 v118, s[8:11], s34 offen offset:1024 nt lds
  v_fma_f32 v52, v52, s25, -v122
  v_cvt_pk_bf16_f32 v48, v48, v49
  v_mfma_f32_16x16x32_bf16 v[12:15], v[196:199], v[96:99], v[12:15]
  v_exp_f32 v51, v51
  v_mfma_f32_16x16x32_bf16 v[16:19], v[200:203], v[96:99], v[16:19]
  v_fma_f32 v53, v53, s25, -v122
  v_exp_f32 v52, v52
  v_mfma_f32_16x16x32_bf16 v[20:23], v[204:207], v[96:99], v[20:23]
  s_waitcnt lgkmcnt(3)
  ds_read_b128 v[96:99], v112 offset:17344
  v_fma_f32 v54, v54, s25, -v122
  v_cvt_pk_bf16_f32 v49, v50, v51
  v_mfma_f32_16x16x32_bf16 v[0:3], a[212:215], v[100:103], v[0:3]
  v_exp_f32 v53, v53
  v_mfma_f32_16x16x32_bf16 v[4:7], a[244:247], v[100:103], v[4:7]
  ds_read_b128 a[104:107], v115 offset:2048
  v_fma_f32 v55, v55, s25, -v122
  v_exp_f32 v54, v54
  v_mfma_f32_16x16x32_bf16 v[8:11], v[208:211], v[100:103], v[8:11]
  v_cvt_pk_bf16_f32 v50, v52, v53
  v_exp_f32 v55, v55
  v_mfma_f32_16x16x32_bf16 v[12:15], v[212:215], v[100:103], v[12:15]
  v_fma_f32 v56, v56, s25, -v122
  v_cvt_pk_bf16_f32 v51, v54, v55
  v_mfma_f32_16x16x32_bf16 v[16:19], v[216:219], v[100:103], v[16:19]
  ds_write_b128 v114, v[48:51] offset:24576
  s_add_u32 m0, s26, 8448
  v_fma_f32 v57, v57, s25, -v122
  v_exp_f32 v56, v56
  v_mfma_f32_16x16x32_bf16 v[20:23], v[220:223], v[100:103], v[20:23]
  s_waitcnt lgkmcnt(4)
  ds_read_b128 v[100:103], v112 offset:25344
  s_mov_b32 s36, 0
  v_fma_f32 v58, v58, s25, -v122
  v_exp_f32 v57, v57
  v_mfma_f32_16x16x32_bf16 v[0:3], a[216:219], v[104:107], v[0:3]
  buffer_load_dwordx4 v118, s[8:11], s35 offen offset:0 nt lds
  v_fma_f32 v59, v59, s25, -v122
  v_exp_f32 v58, v58
  v_mfma_f32_16x16x32_bf16 v[4:7], a[248:251], v[104:107], v[4:7]
  ds_read_b128 a[108:111], v115 offset:3072
  v_fma_f32 v60, v60, s25, -v122
  v_cvt_pk_bf16_f32 v56, v56, v57
  v_mfma_f32_16x16x32_bf16 v[8:11], v[224:227], v[104:107], v[8:11]
  v_exp_f32 v59, v59
  v_mfma_f32_16x16x32_bf16 v[12:15], v[228:231], v[104:107], v[12:15]
  v_fma_f32 v61, v61, s25, -v122
  v_exp_f32 v60, v60
  v_mfma_f32_16x16x32_bf16 v[16:19], v[232:235], v[104:107], v[16:19]
  v_fma_f32 v62, v62, s25, -v122
  v_cvt_pk_bf16_f32 v57, v58, v59
  v_mfma_f32_16x16x32_bf16 v[20:23], v[236:239], v[104:107], v[20:23]
  s_waitcnt lgkmcnt(4)
  ds_read_b128 v[104:107], v112 offset:25408
  v_exp_f32 v61, v61
  v_mfma_f32_16x16x32_bf16 v[0:3], a[220:223], v[96:99], v[0:3]
  v_fma_f32 v63, v63, s25, -v122
  v_exp_f32 v62, v62
  v_mfma_f32_16x16x32_bf16 v[4:7], a[252:255], v[96:99], v[4:7]
  ds_read_b128 a[112:115], v115 offset:4096
  v_cvt_pk_bf16_f32 v58, v60, v61
  v_exp_f32 v63, v63
  v_mfma_f32_16x16x32_bf16 v[8:11], v[240:243], v[96:99], v[8:11]
  s_add_u32 m0, s26, 8480
  v_max3_f32 v124, v0, v1, v2
  v_fma_f32 v64, v64, s25, -v122
  v_mfma_f32_16x16x32_bf16 v[12:15], v[244:247], v[96:99], v[12:15]
  v_max3_f32 v124, v3, v4, v124
  v_max3_f32 v124, v5, v6, v124
  v_mfma_f32_16x16x32_bf16 v[16:19], v[248:251], v[96:99], v[16:19]
  buffer_load_dwordx4 v118, s[8:11], s35 offen offset:1024 nt lds
  s_add_u32 m0, s29, 158464
  v_max3_f32 v124, v7, v8, v124
  v_max3_f32 v124, v9, v10, v124
  v_mfma_f32_16x16x32_bf16 v[20:23], v[252:255], v[96:99], v[20:23]
  s_waitcnt lgkmcnt(3)
  buffer_load_dwordx4 v119, s[16:19], s36 offen nt lds
  v_max3_f32 v124, v11, v12, v124
  v_max3_f32 v124, v13, v14, v124
  v_mfma_f32_16x16x32_bf16 v[24:27], a[192:195], v[100:103], 0
  ds_read_b128 v[96:99], v112 offset:25472
  v_max3_f32 v124, v15, v16, v124
  v_max3_f32 v124, v17, v18, v124
  v_mfma_f32_16x16x32_bf16 v[28:31], a[224:227], v[100:103], 0
  ds_read_b128 a[116:119], v115 offset:5120
  v_max3_f32 v124, v19, v20, v124
  v_max3_f32 v124, v21, v22, v124
  v_mfma_f32_16x16x32_bf16 v[32:35], v[128:131], v[100:103], 0
  v_max_f32 v124, v23, v124
  v_cvt_pk_bf16_f32 v59, v62, v63
  v_mfma_f32_16x16x32_bf16 v[36:39], v[132:135], v[100:103], 0
  ds_write_b128 v114, v[56:59] offset:25600
  v_fma_f32 v65, v65, s25, -v122
  v_exp_f32 v64, v64
  v_mfma_f32_16x16x32_bf16 v[40:43], v[136:139], v[100:103], 0
  v_fma_f32 v66, v66, s25, -v122
  v_exp_f32 v65, v65
  v_mfma_f32_16x16x32_bf16 v[44:47], v[140:143], v[100:103], 0
  s_waitcnt lgkmcnt(4)
  ds_read_b128 v[100:103], v112 offset:25536
  v_fma_f32 v67, v67, s25, -v122
  v_exp_f32 v66, v66
  v_mfma_f32_16x16x32_bf16 v[24:27], a[196:199], v[104:107], v[24:27]
  v_fma_f32 v68, v68, s25, -v122
  v_cvt_pk_bf16_f32 v64, v64, v65
  v_mfma_f32_16x16x32_bf16 v[28:31], a[228:231], v[104:107], v[28:31]
  ds_read_b128 a[120:123], v115 offset:6144
  v_exp_f32 v67, v67
  v_mfma_f32_16x16x32_bf16 v[32:35], v[144:147], v[104:107], v[32:35]
  v_fma_f32 v69, v69, s25, -v122
  v_exp_f32 v68, v68
  v_mfma_f32_16x16x32_bf16 v[36:39], v[148:151], v[104:107], v[36:39]
  v_fma_f32 v70, v70, s25, -v122
  v_cvt_pk_bf16_f32 v65, v66, v67
  v_mfma_f32_16x16x32_bf16 v[40:43], v[152:155], v[104:107], v[40:43]
  v_exp_f32 v69, v69
  v_mfma_f32_16x16x32_bf16 v[44:47], v[156:159], v[104:107], v[44:47]
  s_waitcnt lgkmcnt(4)
  ds_read_b128 v[104:107], v112 offset:25600
  v_fma_f32 v71, v71, s25, -v122
  v_exp_f32 v70, v70
  v_mfma_f32_16x16x32_bf16 v[24:27], a[200:203], v[96:99], v[24:27]
  ds_read_b128 a[124:127], v115 offset:7168
  v_cvt_pk_bf16_f32 v66, v68, v69
  v_exp_f32 v71, v71
  v_mfma_f32_16x16x32_bf16 v[28:31], a[232:235], v[96:99], v[28:31]
  v_fma_f32 v72, v72, s25, -v123
  v_cvt_pk_bf16_f32 v67, v70, v71
  v_mfma_f32_16x16x32_bf16 v[32:35], v[160:163], v[96:99], v[32:35]
  ds_write_b128 v114, v[64:67] offset:26624
  v_fma_f32 v73, v73, s25, -v123
  v_exp_f32 v72, v72
  v_mfma_f32_16x16x32_bf16 v[36:39], v[164:167], v[96:99], v[36:39]
  v_fma_f32 v74, v74, s25, -v123
  v_exp_f32 v73, v73
  v_mfma_f32_16x16x32_bf16 v[40:43], v[168:171], v[96:99], v[40:43]
  v_fma_f32 v75, v75, s25, -v123
  v_exp_f32 v74, v74
  v_mfma_f32_16x16x32_bf16 v[44:47], v[172:175], v[96:99], v[44:47]
  s_waitcnt lgkmcnt(4)
  ds_read_b128 v[96:99], v112 offset:25664
  v_fma_f32 v76, v76, s25, -v123
  v_cvt_pk_bf16_f32 v72, v72, v73
  v_mfma_f32_16x16x32_bf16 v[24:27], a[204:207], v[100:103], v[24:27]
  ds_read_b128 a[128:131], v115 offset:8192
  v_exp_f32 v75, v75
  v_mfma_f32_16x16x32_bf16 v[28:31], a[236:239], v[100:103], v[28:31]
  v_fma_f32 v77, v77, s25, -v123
  v_exp_f32 v76, v76
  v_mfma_f32_16x16x32_bf16 v[32:35], v[176:179], v[100:103], v[32:35]
  v_fma_f32 v78, v78, s25, -v123
  v_cvt_pk_bf16_f32 v73, v74, v75
  v_mfma_f32_16x16x32_bf16 v[36:39], v[180:183], v[100:103], v[36:39]
  v_exp_f32 v77, v77
  v_mfma_f32_16x16x32_bf16 v[40:43], v[184:187], v[100:103], v[40:43]
  v_fma_f32 v79, v79, s25, -v123
  v_exp_f32 v78, v78
  v_mfma_f32_16x16x32_bf16 v[44:47], v[188:191], v[100:103], v[44:47]
  s_waitcnt lgkmcnt(4)
  ds_read_b128 v[100:103], v112 offset:25728
  v_cvt_pk_bf16_f32 v74, v76, v77
  v_exp_f32 v79, v79
  v_mfma_f32_16x16x32_bf16 v[24:27], a[208:211], v[104:107], v[24:27]
  ds_read_b128 a[132:135], v115 offset:9216
  v_fma_f32 v80, v80, s25, -v123
  v_cvt_pk_bf16_f32 v75, v78, v79
  v_mfma_f32_16x16x32_bf16 v[28:31], a[240:243], v[104:107], v[28:31]
  ds_write_b128 v114, v[72:75] offset:36864
  v_fma_f32 v81, v81, s25, -v123
  v_exp_f32 v80, v80
  v_mfma_f32_16x16x32_bf16 v[32:35], v[192:195], v[104:107], v[32:35]
  v_fma_f32 v82, v82, s25, -v123
  v_exp_f32 v81, v81
  v_mfma_f32_16x16x32_bf16 v[36:39], v[196:199], v[104:107], v[36:39]
  v_fma_f32 v83, v83, s25, -v123
  v_exp_f32 v82, v82
  v_mfma_f32_16x16x32_bf16 v[40:43], v[200:203], v[104:107], v[40:43]
  v_fma_f32 v84, v84, s25, -v123
  v_cvt_pk_bf16_f32 v80, v80, v81
  v_mfma_f32_16x16x32_bf16 v[44:47], v[204:207], v[104:107], v[44:47]
  s_waitcnt lgkmcnt(4)
  ds_read_b128 v[104:107], v112 offset:25792
  v_exp_f32 v83, v83
  v_mfma_f32_16x16x32_bf16 v[24:27], a[212:215], v[96:99], v[24:27]
  ds_read_b128 a[136:139], v115 offset:10240
  v_fma_f32 v85, v85, s25, -v123
  v_exp_f32 v84, v84
  v_mfma_f32_16x16x32_bf16 v[28:31], a[244:247], v[96:99], v[28:31]
  v_fma_f32 v86, v86, s25, -v123
  v_cvt_pk_bf16_f32 v81, v82, v83
  v_mfma_f32_16x16x32_bf16 v[32:35], v[208:211], v[96:99], v[32:35]
  v_exp_f32 v85, v85
  v_mfma_f32_16x16x32_bf16 v[36:39], v[212:215], v[96:99], v[36:39]
  v_fma_f32 v87, v87, s25, -v123
  v_exp_f32 v86, v86
  v_mfma_f32_16x16x32_bf16 v[40:43], v[216:219], v[96:99], v[40:43]
  v_cvt_pk_bf16_f32 v82, v84, v85
  v_exp_f32 v87, v87
  v_mfma_f32_16x16x32_bf16 v[44:47], v[220:223], v[96:99], v[44:47]
  s_waitcnt lgkmcnt(4)
  ds_read_b128 v[96:99], v112 offset:33792
  v_fma_f32 v88, v88, s25, -v123
  v_cvt_pk_bf16_f32 v83, v86, v87
  v_mfma_f32_16x16x32_bf16 v[24:27], a[216:219], v[100:103], v[24:27]
  ds_read_b128 a[140:143], v115 offset:11264
  v_fma_f32 v89, v89, s25, -v123
  v_exp_f32 v88, v88
  v_mfma_f32_16x16x32_bf16 v[28:31], a[248:251], v[100:103], v[28:31]
  ds_write_b128 v114, v[80:83] offset:37888
  v_fma_f32 v90, v90, s25, -v123
  v_exp_f32 v89, v89
  v_mfma_f32_16x16x32_bf16 v[32:35], v[224:227], v[100:103], v[32:35]
  v_fma_f32 v91, v91, s25, -v123
  v_exp_f32 v90, v90
  v_mfma_f32_16x16x32_bf16 v[36:39], v[228:231], v[100:103], v[36:39]
  v_fma_f32 v92, v92, s25, -v123
  v_cvt_pk_bf16_f32 v88, v88, v89
  v_mfma_f32_16x16x32_bf16 v[40:43], v[232:235], v[100:103], v[40:43]
  v_exp_f32 v91, v91
  v_mfma_f32_16x16x32_bf16 v[44:47], v[236:239], v[100:103], v[44:47]
  s_waitcnt lgkmcnt(4)
  ds_read_b128 v[100:103], v112 offset:33856
  v_fma_f32 v93, v93, s25, -v123
  v_exp_f32 v92, v92
  v_mfma_f32_16x16x32_bf16 v[24:27], a[220:223], v[104:107], v[24:27]
  v_fma_f32 v94, v94, s25, -v123
  v_cvt_pk_bf16_f32 v89, v90, v91
  v_mfma_f32_16x16x32_bf16 v[28:31], a[252:255], v[104:107], v[28:31]
  v_exp_f32 v93, v93
  v_mfma_f32_16x16x32_bf16 v[32:35], v[240:243], v[104:107], v[32:35]
  v_fma_f32 v95, v95, s25, -v123
  v_exp_f32 v94, v94
  v_mfma_f32_16x16x32_bf16 v[36:39], v[244:247], v[104:107], v[36:39]
  v_max3_f32 v125, v24, v25, v26
  v_cvt_pk_bf16_f32 v90, v92, v93
  v_mfma_f32_16x16x32_bf16 v[40:43], v[248:251], v[104:107], v[40:43]
  v_max3_f32 v125, v27, v28, v125
  v_max3_f32 v125, v29, v30, v125
  v_mfma_f32_16x16x32_bf16 v[44:47], v[252:255], v[104:107], v[44:47]
  s_waitcnt lgkmcnt(3)
  ds_read_b128 v[104:107], v112 offset:33920
  v_max3_f32 v125, v31, v32, v125
  v_max3_f32 v125, v33, v34, v125
  v_mfma_f32_16x16x32_bf16 v[48:51], a[192:195], v[96:99], 0
  v_max3_f32 v125, v35, v36, v125
  v_max3_f32 v125, v37, v38, v125
  v_mfma_f32_16x16x32_bf16 v[52:55], a[224:227], v[96:99], 0
  v_max3_f32 v125, v39, v40, v125
  v_max3_f32 v125, v41, v42, v125
  v_mfma_f32_16x16x32_bf16 v[56:59], v[128:131], v[96:99], 0
  v_max3_f32 v125, v43, v44, v125
  v_max3_f32 v125, v45, v46, v125
  v_mfma_f32_16x16x32_bf16 v[60:63], v[132:135], v[96:99], 0
  v_max_f32 v125, v47, v125
  v_exp_f32 v95, v95
  v_mfma_f32_16x16x32_bf16 v[64:67], v[136:139], v[96:99], 0
  v_permlane32_swap_b32 v124, v125
  v_mfma_f32_16x16x32_bf16 v[68:71], v[140:143], v[96:99], 0
  s_waitcnt lgkmcnt(1)
  ds_read_b128 v[96:99], v112 offset:33984
  v_max_f32 v126, v124, v125
  v_max_f32 v127, v124, v125
  v_mfma_f32_16x16x32_bf16 v[48:51], a[196:199], v[100:103], v[48:51]
  v_cvt_pk_bf16_f32 v91, v94, v95
  v_permlane16_swap_b32 v126, v127
  v_mfma_f32_16x16x32_bf16 v[52:55], a[228:231], v[100:103], v[52:55]
  ds_write_b128 v114, v[88:91] offset:38912
  v_max_f32 v126, v126, v127
  v_mfma_f32_16x16x32_bf16 v[56:59], v[144:147], v[100:103], v[56:59]
  ds_write_b32 v116, v126 offset:0
  v_mfma_f32_16x16x32_bf16 v[60:63], v[148:151], v[100:103], v[60:63]
  v_mfma_f32_16x16x32_bf16 v[64:67], v[152:155], v[100:103], v[64:67]
  v_mfma_f32_16x16x32_bf16 v[68:71], v[156:159], v[100:103], v[68:71]
  ds_read_b128 v[100:103], v112 offset:34048
  s_waitcnt vmcnt(5) lgkmcnt(1)
  s_barrier
  v_mfma_f32_16x16x32_bf16 v[48:51], a[200:203], v[104:107], v[48:51]
  ds_read_b128 v[108:111], v117 offset:0
  ds_read_b128 v[124:127], v117 offset:256
  s_mov_b32 s37, 188416
  v_mfma_f32_16x16x32_bf16 v[52:55], a[232:235], v[104:107], v[52:55]
  v_mfma_f32_16x16x32_bf16 v[56:59], v[160:163], v[104:107], v[56:59]
  s_add_u32 m0, s26, 16896
  v_mfma_f32_16x16x32_bf16 v[60:63], v[164:167], v[104:107], v[60:63]
  v_mfma_f32_16x16x32_bf16 v[64:67], v[168:171], v[104:107], v[64:67]
  buffer_load_dwordx4 v118, s[8:11], s37 offen offset:0 nt lds
  v_mfma_f32_16x16x32_bf16 v[68:71], v[172:175], v[104:107], v[68:71]
  ds_read_b128 v[104:107], v112 offset:34112
  v_mfma_f32_16x16x32_bf16 v[48:51], a[204:207], v[96:99], v[48:51]
  v_mfma_f32_16x16x32_bf16 v[52:55], a[236:239], v[96:99], v[52:55]
  s_waitcnt lgkmcnt(2)
  v_max3_f32 v108, v108, v109, v110
  v_max_f32 v108, v108, v111
  v_mfma_f32_16x16x32_bf16 v[56:59], v[176:179], v[96:99], v[56:59]
  s_waitcnt lgkmcnt(1)
  v_mul_f32 v120, s25, v108
  v_max3_f32 v124, v124, v125, v126
  v_mfma_f32_16x16x32_bf16 v[60:63], v[180:183], v[96:99], v[60:63]
  v_max_f32 v124, v124, v127
  v_mul_f32 v121, s25, v124
  v_mfma_f32_16x16x32_bf16 v[64:67], v[184:187], v[96:99], v[64:67]
  v_fma_f32 v0, v0, s25, -v120
  v_fma_f32 v1, v1, s25, -v120
  v_mfma_f32_16x16x32_bf16 v[68:71], v[188:191], v[96:99], v[68:71]
  ds_read_b128 v[96:99], v112 offset:34176
  v_exp_f32 v0, v0
  v_mfma_f32_16x16x32_bf16 v[48:51], a[208:211], v[100:103], v[48:51]
  s_add_u32 m0, s26, 16928
  v_fma_f32 v2, v2, s25, -v120
  v_exp_f32 v1, v1
  v_mfma_f32_16x16x32_bf16 v[52:55], a[240:243], v[100:103], v[52:55]
  v_fma_f32 v3, v3, s25, -v120
  v_exp_f32 v2, v2
  v_mfma_f32_16x16x32_bf16 v[56:59], v[192:195], v[100:103], v[56:59]
  buffer_load_dwordx4 v118, s[8:11], s37 offen offset:1024 nt lds
  v_fma_f32 v4, v4, s25, -v120
  v_cvt_pk_bf16_f32 v0, v0, v1
  v_mfma_f32_16x16x32_bf16 v[60:63], v[196:199], v[100:103], v[60:63]
  v_exp_f32 v3, v3
  v_mfma_f32_16x16x32_bf16 v[64:67], v[200:203], v[100:103], v[64:67]
  v_fma_f32 v5, v5, s25, -v120
  v_exp_f32 v4, v4
  v_mfma_f32_16x16x32_bf16 v[68:71], v[204:207], v[100:103], v[68:71]
  s_waitcnt lgkmcnt(1)
  ds_read_b128 v[100:103], v112 offset:34240
  v_fma_f32 v6, v6, s25, -v120
  v_cvt_pk_bf16_f32 v1, v2, v3
  v_mfma_f32_16x16x32_bf16 v[48:51], a[212:215], v[104:107], v[48:51]
  v_exp_f32 v5, v5
  v_mfma_f32_16x16x32_bf16 v[52:55], a[244:247], v[104:107], v[52:55]
  v_fma_f32 v7, v7, s25, -v120
  v_exp_f32 v6, v6
  v_mfma_f32_16x16x32_bf16 v[56:59], v[208:211], v[104:107], v[56:59]
  v_cvt_pk_bf16_f32 v2, v4, v5
  v_exp_f32 v7, v7
  v_mfma_f32_16x16x32_bf16 v[60:63], v[212:215], v[104:107], v[60:63]
  v_fma_f32 v8, v8, s25, -v120
  v_cvt_pk_bf16_f32 v3, v6, v7
  v_mfma_f32_16x16x32_bf16 v[64:67], v[216:219], v[104:107], v[64:67]
  ds_write_b128 v113, v[0:3] offset:0
  v_fma_f32 v9, v9, s25, -v120
  v_exp_f32 v8, v8
  v_mfma_f32_16x16x32_bf16 v[68:71], v[220:223], v[104:107], v[68:71]
  s_waitcnt lgkmcnt(2)
  ds_read_b128 v[104:107], v112 offset:42240
  s_mov_b32 s38, 16384
  v_fma_f32 v10, v10, s25, -v120
  v_exp_f32 v9, v9
  v_mfma_f32_16x16x32_bf16 v[48:51], a[216:219], v[96:99], v[48:51]
  s_add_u32 m0, s29, 25344
  v_fma_f32 v11, v11, s25, -v120
  v_exp_f32 v10, v10
  v_mfma_f32_16x16x32_bf16 v[52:55], a[248:251], v[96:99], v[52:55]
  v_fma_f32 v12, v12, s25, -v120
  v_cvt_pk_bf16_f32 v8, v8, v9
  v_mfma_f32_16x16x32_bf16 v[56:59], v[224:227], v[96:99], v[56:59]
  buffer_load_dwordx4 v119, s[16:19], s38 offen nt lds
  v_exp_f32 v11, v11
  v_mfma_f32_16x16x32_bf16 v[60:63], v[228:231], v[96:99], v[60:63]
  v_fma_f32 v13, v13, s25, -v120
  v_exp_f32 v12, v12
  v_mfma_f32_16x16x32_bf16 v[64:67], v[232:235], v[96:99], v[64:67]
  v_fma_f32 v14, v14, s25, -v120
  v_cvt_pk_bf16_f32 v9, v10, v11
  v_mfma_f32_16x16x32_bf16 v[68:71], v[236:239], v[96:99], v[68:71]
  s_waitcnt lgkmcnt(2)
  ds_read_b128 v[96:99], v112 offset:42304
  v_exp_f32 v13, v13
  v_mfma_f32_16x16x32_bf16 v[48:51], a[220:223], v[100:103], v[48:51]
  v_fma_f32 v15, v15, s25, -v120
  v_exp_f32 v14, v14
  v_mfma_f32_16x16x32_bf16 v[52:55], a[252:255], v[100:103], v[52:55]
  v_cvt_pk_bf16_f32 v10, v12, v13
  v_exp_f32 v15, v15
  v_mfma_f32_16x16x32_bf16 v[56:59], v[240:243], v[100:103], v[56:59]
  v_fma_f32 v16, v16, s25, -v120
  v_cvt_pk_bf16_f32 v11, v14, v15
  v_mfma_f32_16x16x32_bf16 v[60:63], v[244:247], v[100:103], v[60:63]
  ds_write_b128 v113, v[8:11] offset:1024
  s_mov_b32 s39, 32768
  v_max3_f32 v124, v48, v49, v50
  v_max3_f32 v124, v51, v52, v124
  v_mfma_f32_16x16x32_bf16 v[64:67], v[248:251], v[100:103], v[64:67]
  s_add_u32 m0, s29, 29440
  v_max3_f32 v124, v53, v54, v124
  v_max3_f32 v124, v55, v56, v124
  v_mfma_f32_16x16x32_bf16 v[68:71], v[252:255], v[100:103], v[68:71]
  s_waitcnt lgkmcnt(2)
  ds_read_b128 v[100:103], v112 offset:42368
  v_max3_f32 v124, v57, v58, v124
  v_max3_f32 v124, v59, v60, v124
  v_mfma_f32_16x16x32_bf16 v[72:75], a[192:195], v[104:107], 0
  buffer_load_dwordx4 v119, s[16:19], s39 offen nt lds
  v_max3_f32 v124, v61, v62, v124
  v_max3_f32 v124, v63, v64, v124
  v_mfma_f32_16x16x32_bf16 v[76:79], a[224:227], v[104:107], 0
  v_max3_f32 v124, v65, v66, v124
  v_max3_f32 v124, v67, v68, v124
  v_mfma_f32_16x16x32_bf16 v[80:83], v[128:131], v[104:107], 0
  v_max3_f32 v124, v69, v70, v124
  v_max_f32 v124, v71, v124
  v_mfma_f32_16x16x32_bf16 v[84:87], v[132:135], v[104:107], 0
  v_fma_f32 v17, v17, s25, -v120
  v_exp_f32 v16, v16
  v_mfma_f32_16x16x32_bf16 v[88:91], v[136:139], v[104:107], 0
  v_fma_f32 v18, v18, s25, -v120
  v_exp_f32 v17, v17
  v_mfma_f32_16x16x32_bf16 v[92:95], v[140:143], v[104:107], 0
  s_waitcnt lgkmcnt(2)
  ds_read_b128 v[104:107], v112 offset:42432
  v_fma_f32 v19, v19, s25, -v120
  v_exp_f32 v18, v18
  v_mfma_f32_16x16x32_bf16 v[72:75], a[196:199], v[96:99], v[72:75]
  v_fma_f32 v20, v20, s25, -v120
  v_cvt_pk_bf16_f32 v16, v16, v17
  v_mfma_f32_16x16x32_bf16 v[76:79], a[228:231], v[96:99], v[76:79]
  v_exp_f32 v19, v19
  v_mfma_f32_16x16x32_bf16 v[80:83], v[144:147], v[96:99], v[80:83]
  v_fma_f32 v21, v21, s25, -v120
  v_exp_f32 v20, v20
  v_mfma_f32_16x16x32_bf16 v[84:87], v[148:151], v[96:99], v[84:87]
  v_fma_f32 v22, v22, s25, -v120
  v_cvt_pk_bf16_f32 v17, v18, v19
  v_mfma_f32_16x16x32_bf16 v[88:91], v[152:155], v[96:99], v[88:91]
  v_exp_f32 v21, v21
  v_mfma_f32_16x16x32_bf16 v[92:95], v[156:159], v[96:99], v[92:95]
  s_waitcnt lgkmcnt(1)
  ds_read_b128 v[96:99], v112 offset:42496
  v_fma_f32 v23, v23, s25, -v120
  v_exp_f32 v22, v22
  v_mfma_f32_16x16x32_bf16 v[72:75], a[200:203], v[100:103], v[72:75]
  v_cvt_pk_bf16_f32 v18, v20, v21
  v_exp_f32 v23, v23
  v_mfma_f32_16x16x32_bf16 v[76:79], a[232:235], v[100:103], v[76:79]
  v_fma_f32 v24, v24, s25, -v121
  v_cvt_pk_bf16_f32 v19, v22, v23
  v_mfma_f32_16x16x32_bf16 v[80:83], v[160:163], v[100:103], v[80:83]
  ds_write_b128 v113, v[16:19] offset:2048
  v_fma_f32 v25, v25, s25, -v121
  v_exp_f32 v24, v24
  v_mfma_f32_16x16x32_bf16 v[84:87], v[164:167], v[100:103], v[84:87]
  v_fma_f32 v26, v26, s25, -v121
  v_exp_f32 v25, v25
  v_mfma_f32_16x16x32_bf16 v[88:91], v[168:171], v[100:103], v[88:91]
  v_fma_f32 v27, v27, s25, -v121
  v_exp_f32 v26, v26
  v_mfma_f32_16x16x32_bf16 v[92:95], v[172:175], v[100:103], v[92:95]
  s_waitcnt lgkmcnt(2)
  ds_read_b128 v[100:103], v112 offset:42560
  v_fma_f32 v28, v28, s25, -v121
  v_cvt_pk_bf16_f32 v24, v24, v25
  v_mfma_f32_16x16x32_bf16 v[72:75], a[204:207], v[104:107], v[72:75]
  v_exp_f32 v27, v27
  v_mfma_f32_16x16x32_bf16 v[76:79], a[236:239], v[104:107], v[76:79]
  v_fma_f32 v29, v29, s25, -v121
  v_exp_f32 v28, v28
  v_mfma_f32_16x16x32_bf16 v[80:83], v[176:179], v[104:107], v[80:83]
  v_fma_f32 v30, v30, s25, -v121
  v_cvt_pk_bf16_f32 v25, v26, v27
  v_mfma_f32_16x16x32_bf16 v[84:87], v[180:183], v[104:107], v[84:87]
  v_exp_f32 v29, v29
  v_mfma_f32_16x16x32_bf16 v[88:91], v[184:187], v[104:107], v[88:91]
  v_fma_f32 v31, v31, s25, -v121
  v_exp_f32 v30, v30
  v_mfma_f32_16x16x32_bf16 v[92:95], v[188:191], v[104:107], v[92:95]
  s_waitcnt lgkmcnt(2)
  ds_read_b128 v[104:107], v112 offset:42624
  v_cvt_pk_bf16_f32 v26, v28, v29
  v_exp_f32 v31, v31
  v_mfma_f32_16x16x32_bf16 v[72:75], a[208:211], v[96:99], v[72:75]
  v_fma_f32 v32, v32, s25, -v121
  v_cvt_pk_bf16_f32 v27, v30, v31
  v_mfma_f32_16x16x32_bf16 v[76:79], a[240:243], v[96:99], v[76:79]
  ds_write_b128 v113, v[24:27] offset:12288
  v_fma_f32 v33, v33, s25, -v121
  v_exp_f32 v32, v32
  v_mfma_f32_16x16x32_bf16 v[80:83], v[192:195], v[96:99], v[80:83]
  v_fma_f32 v34, v34, s25, -v121
  v_exp_f32 v33, v33
  v_mfma_f32_16x16x32_bf16 v[84:87], v[196:199], v[96:99], v[84:87]
  v_fma_f32 v35, v35, s25, -v121
  v_exp_f32 v34, v34
  v_mfma_f32_16x16x32_bf16 v[88:91], v[200:203], v[96:99], v[88:91]
  v_fma_f32 v36, v36, s25, -v121
  v_cvt_pk_bf16_f32 v32, v32, v33
  v_mfma_f32_16x16x32_bf16 v[92:95], v[204:207], v[96:99], v[92:95]
  s_waitcnt lgkmcnt(2)
  ds_read_b128 v[96:99], v112 offset:42688
  v_exp_f32 v35, v35
  v_mfma_f32_16x16x32_bf16 v[72:75], a[212:215], v[100:103], v[72:75]
  v_fma_f32 v37, v37, s25, -v121
  v_exp_f32 v36, v36
  v_mfma_f32_16x16x32_bf16 v[76:79], a[244:247], v[100:103], v[76:79]
  v_fma_f32 v38, v38, s25, -v121
  v_cvt_pk_bf16_f32 v33, v34, v35
  v_mfma_f32_16x16x32_bf16 v[80:83], v[208:211], v[100:103], v[80:83]
  v_exp_f32 v37, v37
  v_mfma_f32_16x16x32_bf16 v[84:87], v[212:215], v[100:103], v[84:87]
  v_fma_f32 v39, v39, s25, -v121
  v_exp_f32 v38, v38
  v_mfma_f32_16x16x32_bf16 v[88:91], v[216:219], v[100:103], v[88:91]
  v_cvt_pk_bf16_f32 v34, v36, v37
  v_exp_f32 v39, v39
  v_mfma_f32_16x16x32_bf16 v[92:95], v[220:223], v[100:103], v[92:95]
  s_waitcnt lgkmcnt(2)
  ds_read_b128 v[100:103], v112 offset:50688
  v_fma_f32 v40, v40, s25, -v121
  v_cvt_pk_bf16_f32 v35, v38, v39
  v_mfma_f32_16x16x32_bf16 v[72:75], a[216:219], v[104:107], v[72:75]
  ds_write_b128 v113, v[32:35] offset:13312
  v_fma_f32 v41, v41, s25, -v121
  v_exp_f32 v40, v40
  v_mfma_f32_16x16x32_bf16 v[76:79], a[248:251], v[104:107], v[76:79]
  v_fma_f32 v42, v42, s25, -v121
  v_exp_f32 v41, v41
  v_mfma_f32_16x16x32_bf16 v[80:83], v[224:227], v[104:107], v[80:83]
  v_fma_f32 v43, v43, s25, -v121
  v_exp_f32 v42, v42
  v_mfma_f32_16x16x32_bf16 v[84:87], v[228:231], v[104:107], v[84:87]
  v_fma_f32 v44, v44, s25, -v121
  v_cvt_pk_bf16_f32 v40, v40, v41
  v_mfma_f32_16x16x32_bf16 v[88:91], v[232:235], v[104:107], v[88:91]
  v_exp_f32 v43, v43
  v_mfma_f32_16x16x32_bf16 v[92:95], v[236:239], v[104:107], v[92:95]
  s_waitcnt lgkmcnt(2)
  ds_read_b128 v[104:107], v112 offset:50752
  v_fma_f32 v45, v45, s25, -v121
  v_exp_f32 v44, v44
  v_mfma_f32_16x16x32_bf16 v[72:75], a[220:223], v[96:99], v[72:75]
  v_fma_f32 v46, v46, s25, -v121
  v_cvt_pk_bf16_f32 v41, v42, v43
  v_mfma_f32_16x16x32_bf16 v[76:79], a[252:255], v[96:99], v[76:79]
  v_exp_f32 v45, v45
  v_mfma_f32_16x16x32_bf16 v[80:83], v[240:243], v[96:99], v[80:83]
  v_fma_f32 v47, v47, s25, -v121
  v_exp_f32 v46, v46
  v_mfma_f32_16x16x32_bf16 v[84:87], v[244:247], v[96:99], v[84:87]
  v_max3_f32 v125, v72, v73, v74
  v_cvt_pk_bf16_f32 v42, v44, v45
  v_mfma_f32_16x16x32_bf16 v[88:91], v[248:251], v[96:99], v[88:91]
  v_max3_f32 v125, v75, v76, v125
  v_max3_f32 v125, v77, v78, v125
  v_mfma_f32_16x16x32_bf16 v[92:95], v[252:255], v[96:99], v[92:95]
  s_waitcnt lgkmcnt(2)
  ds_read_b128 v[96:99], v112 offset:50816
  v_max3_f32 v125, v79, v80, v125
  v_max3_f32 v125, v81, v82, v125
  v_mfma_f32_16x16x32_bf16 v[0:3], a[192:195], v[100:103], 0
  v_max3_f32 v125, v83, v84, v125
  v_max3_f32 v125, v85, v86, v125
  v_mfma_f32_16x16x32_bf16 v[4:7], a[224:227], v[100:103], 0
  v_max3_f32 v125, v87, v88, v125
  v_max3_f32 v125, v89, v90, v125
  v_mfma_f32_16x16x32_bf16 v[8:11], v[128:131], v[100:103], 0
  v_max3_f32 v125, v91, v92, v125
  v_max3_f32 v125, v93, v94, v125
  v_mfma_f32_16x16x32_bf16 v[12:15], v[132:135], v[100:103], 0
  v_max_f32 v125, v95, v125
  v_exp_f32 v47, v47
  v_mfma_f32_16x16x32_bf16 v[16:19], v[136:139], v[100:103], 0
  v_permlane32_swap_b32 v124, v125
  v_mfma_f32_16x16x32_bf16 v[20:23], v[140:143], v[100:103], 0
  s_waitcnt lgkmcnt(1)
  ds_read_b128 v[100:103], v112 offset:50880
  v_max_f32 v126, v124, v125
  v_max_f32 v127, v124, v125
  v_mfma_f32_16x16x32_bf16 v[0:3], a[196:199], v[104:107], v[0:3]
  v_cvt_pk_bf16_f32 v43, v46, v47
  v_permlane16_swap_b32 v126, v127
  v_mfma_f32_16x16x32_bf16 v[4:7], a[228:231], v[104:107], v[4:7]
  ds_write_b128 v113, v[40:43] offset:14336
  v_max_f32 v126, v126, v127
  v_mfma_f32_16x16x32_bf16 v[8:11], v[144:147], v[104:107], v[8:11]
  ds_write_b32 v116, v126 offset:512
  v_mfma_f32_16x16x32_bf16 v[12:15], v[148:151], v[104:107], v[12:15]
  v_mfma_f32_16x16x32_bf16 v[16:19], v[152:155], v[104:107], v[16:19]
  v_mfma_f32_16x16x32_bf16 v[20:23], v[156:159], v[104:107], v[20:23]
  ds_read_b128 v[104:107], v112 offset:50944
  s_waitcnt lgkmcnt(1) vmcnt(5)
  s_barrier
  v_mfma_f32_16x16x32_bf16 v[0:3], a[200:203], v[96:99], v[0:3]
  ds_read_b128 v[108:111], v117 offset:512
  ds_read_b128 v[124:127], v117 offset:768
  v_mfma_f32_16x16x32_bf16 v[4:7], a[232:235], v[96:99], v[4:7]
  v_mfma_f32_16x16x32_bf16 v[8:11], v[160:163], v[96:99], v[8:11]
  v_mfma_f32_16x16x32_bf16 v[12:15], v[164:167], v[96:99], v[12:15]
  s_mov_b32 s40, 49152
  v_mfma_f32_16x16x32_bf16 v[16:19], v[168:171], v[96:99], v[16:19]
  s_add_u32 m0, s29, 33792
  v_mfma_f32_16x16x32_bf16 v[20:23], v[172:175], v[96:99], v[20:23]
  ds_read_b128 v[96:99], v112 offset:51008
  v_mfma_f32_16x16x32_bf16 v[0:3], a[204:207], v[100:103], v[0:3]
  buffer_load_dwordx4 v119, s[16:19], s40 offen nt lds
  v_mfma_f32_16x16x32_bf16 v[4:7], a[236:239], v[100:103], v[4:7]
  s_waitcnt lgkmcnt(2)
  v_max3_f32 v108, v108, v109, v110
  v_max_f32 v108, v108, v111
  v_mfma_f32_16x16x32_bf16 v[8:11], v[176:179], v[100:103], v[8:11]
  s_waitcnt lgkmcnt(1)
  ds_read_b128 a[144:147], v115 offset:49152
  v_mul_f32 v122, s25, v108
  v_max3_f32 v124, v124, v125, v126
  v_mfma_f32_16x16x32_bf16 v[12:15], v[180:183], v[100:103], v[12:15]
  v_max_f32 v124, v124, v127
  v_mul_f32 v123, s25, v124
  v_mfma_f32_16x16x32_bf16 v[16:19], v[184:187], v[100:103], v[16:19]
  v_fma_f32 v48, v48, s25, -v122
  v_fma_f32 v49, v49, s25, -v122
  v_mfma_f32_16x16x32_bf16 v[20:23], v[188:191], v[100:103], v[20:23]
  ds_read_b128 v[100:103], v112 offset:51072
  v_exp_f32 v48, v48
  v_mfma_f32_16x16x32_bf16 v[0:3], a[208:211], v[104:107], v[0:3]
  v_fma_f32 v50, v50, s25, -v122
  v_exp_f32 v49, v49
  v_mfma_f32_16x16x32_bf16 v[4:7], a[240:243], v[104:107], v[4:7]
  ds_read_b128 a[148:151], v115 offset:50176
  s_mov_b32 s41, 65536
  v_fma_f32 v51, v51, s25, -v122
  v_exp_f32 v50, v50
  v_mfma_f32_16x16x32_bf16 v[8:11], v[192:195], v[104:107], v[8:11]
  s_add_u32 m0, s29, 37888
  v_fma_f32 v52, v52, s25, -v122
  v_cvt_pk_bf16_f32 v48, v48, v49
  v_mfma_f32_16x16x32_bf16 v[12:15], v[196:199], v[104:107], v[12:15]
  v_exp_f32 v51, v51
  v_mfma_f32_16x16x32_bf16 v[16:19], v[200:203], v[104:107], v[16:19]
  buffer_load_dwordx4 v119, s[16:19], s41 offen nt lds
  v_fma_f32 v53, v53, s25, -v122
  v_exp_f32 v52, v52
  v_mfma_f32_16x16x32_bf16 v[20:23], v[204:207], v[104:107], v[20:23]
  s_waitcnt lgkmcnt(3)
  ds_read_b128 v[104:107], v112 offset:51136
  v_fma_f32 v54, v54, s25, -v122
  v_cvt_pk_bf16_f32 v49, v50, v51
  v_mfma_f32_16x16x32_bf16 v[0:3], a[212:215], v[96:99], v[0:3]
  v_exp_f32 v53, v53
  v_mfma_f32_16x16x32_bf16 v[4:7], a[244:247], v[96:99], v[4:7]
  ds_read_b128 a[152:155], v115 offset:51200
  v_fma_f32 v55, v55, s25, -v122
  v_exp_f32 v54, v54
  v_mfma_f32_16x16x32_bf16 v[8:11], v[208:211], v[96:99], v[8:11]
  v_cvt_pk_bf16_f32 v50, v52, v53
  v_exp_f32 v55, v55
  v_mfma_f32_16x16x32_bf16 v[12:15], v[212:215], v[96:99], v[12:15]
  v_fma_f32 v56, v56, s25, -v122
  v_cvt_pk_bf16_f32 v51, v54, v55
  v_mfma_f32_16x16x32_bf16 v[16:19], v[216:219], v[96:99], v[16:19]
  ds_write_b128 v113, v[48:51] offset:24576
  v_fma_f32 v57, v57, s25, -v122
  v_exp_f32 v56, v56
  v_mfma_f32_16x16x32_bf16 v[20:23], v[220:223], v[96:99], v[20:23]
  s_waitcnt lgkmcnt(4)
  ds_read_b128 v[96:99], v112 offset:0
  s_mov_b32 s42, 81920
  v_fma_f32 v58, v58, s25, -v122
  v_exp_f32 v57, v57
  v_mfma_f32_16x16x32_bf16 v[0:3], a[216:219], v[100:103], v[0:3]
  s_add_u32 m0, s29, 42240
  v_fma_f32 v59, v59, s25, -v122
  v_exp_f32 v58, v58
  v_mfma_f32_16x16x32_bf16 v[4:7], a[248:251], v[100:103], v[4:7]
  ds_read_b128 a[156:159], v115 offset:52224
  v_fma_f32 v60, v60, s25, -v122
  v_cvt_pk_bf16_f32 v56, v56, v57
  v_mfma_f32_16x16x32_bf16 v[8:11], v[224:227], v[100:103], v[8:11]
  buffer_load_dwordx4 v119, s[16:19], s42 offen nt lds
  v_exp_f32 v59, v59
  v_mfma_f32_16x16x32_bf16 v[12:15], v[228:231], v[100:103], v[12:15]
  v_fma_f32 v61, v61, s25, -v122
  v_exp_f32 v60, v60
  v_mfma_f32_16x16x32_bf16 v[16:19], v[232:235], v[100:103], v[16:19]
  v_fma_f32 v62, v62, s25, -v122
  v_cvt_pk_bf16_f32 v57, v58, v59
  v_mfma_f32_16x16x32_bf16 v[20:23], v[236:239], v[100:103], v[20:23]
  s_waitcnt lgkmcnt(4)
  ds_read_b128 v[100:103], v112 offset:64
  v_exp_f32 v61, v61
  v_mfma_f32_16x16x32_bf16 v[0:3], a[220:223], v[104:107], v[0:3]
  v_fma_f32 v63, v63, s25, -v122
  v_exp_f32 v62, v62
  v_mfma_f32_16x16x32_bf16 v[4:7], a[252:255], v[104:107], v[4:7]
  ds_read_b128 a[160:163], v115 offset:53248
  v_cvt_pk_bf16_f32 v58, v60, v61
  v_exp_f32 v63, v63
  v_mfma_f32_16x16x32_bf16 v[8:11], v[240:243], v[104:107], v[8:11]
  v_fma_f32 v64, v64, s25, -v122
  v_max3_f32 v124, v0, v1, v2
  v_mfma_f32_16x16x32_bf16 v[12:15], v[244:247], v[104:107], v[12:15]
  s_mov_b32 s43, 98304
  v_max3_f32 v124, v3, v4, v124
  v_max3_f32 v124, v5, v6, v124
  v_mfma_f32_16x16x32_bf16 v[16:19], v[248:251], v[104:107], v[16:19]
  s_add_u32 m0, s29, 46336
  v_max3_f32 v124, v7, v8, v124
  v_max3_f32 v124, v9, v10, v124
  v_mfma_f32_16x16x32_bf16 v[20:23], v[252:255], v[104:107], v[20:23]
  s_waitcnt lgkmcnt(3)
  ds_read_b128 v[104:107], v112 offset:128
  v_max3_f32 v124, v11, v12, v124
  v_max3_f32 v124, v13, v14, v124
  v_mfma_f32_16x16x32_bf16 v[24:27], a[192:195], v[96:99], 0
  buffer_load_dwordx4 v119, s[16:19], s43 offen nt lds
  v_max3_f32 v124, v15, v16, v124
  v_max3_f32 v124, v17, v18, v124
  v_mfma_f32_16x16x32_bf16 v[28:31], a[224:227], v[96:99], 0
  ds_read_b128 a[164:167], v115 offset:54272
  v_max3_f32 v124, v19, v20, v124
  v_max3_f32 v124, v21, v22, v124
  v_mfma_f32_16x16x32_bf16 v[32:35], v[128:131], v[96:99], 0
  v_max_f32 v124, v23, v124
  v_cvt_pk_bf16_f32 v59, v62, v63
  v_mfma_f32_16x16x32_bf16 v[36:39], v[132:135], v[96:99], 0
  ds_write_b128 v113, v[56:59] offset:25600
  v_fma_f32 v65, v65, s25, -v122
  v_exp_f32 v64, v64
  v_mfma_f32_16x16x32_bf16 v[40:43], v[136:139], v[96:99], 0
  v_fma_f32 v66, v66, s25, -v122
  v_exp_f32 v65, v65
  v_mfma_f32_16x16x32_bf16 v[44:47], v[140:143], v[96:99], 0
  s_waitcnt lgkmcnt(4)
  ds_read_b128 v[96:99], v112 offset:192
  v_fma_f32 v67, v67, s25, -v122
  v_exp_f32 v66, v66
  v_mfma_f32_16x16x32_bf16 v[24:27], a[196:199], v[100:103], v[24:27]
  v_fma_f32 v68, v68, s25, -v122
  v_cvt_pk_bf16_f32 v64, v64, v65
  v_mfma_f32_16x16x32_bf16 v[28:31], a[228:231], v[100:103], v[28:31]
  ds_read_b128 a[168:171], v115 offset:55296
  v_exp_f32 v67, v67
  v_mfma_f32_16x16x32_bf16 v[32:35], v[144:147], v[100:103], v[32:35]
  v_fma_f32 v69, v69, s25, -v122
  v_exp_f32 v68, v68
  v_mfma_f32_16x16x32_bf16 v[36:39], v[148:151], v[100:103], v[36:39]
  v_fma_f32 v70, v70, s25, -v122
  v_cvt_pk_bf16_f32 v65, v66, v67
  v_mfma_f32_16x16x32_bf16 v[40:43], v[152:155], v[100:103], v[40:43]
  v_exp_f32 v69, v69
  v_mfma_f32_16x16x32_bf16 v[44:47], v[156:159], v[100:103], v[44:47]
  s_waitcnt lgkmcnt(4)
  ds_read_b128 v[100:103], v112 offset:256
  v_fma_f32 v71, v71, s25, -v122
  v_exp_f32 v70, v70
  v_mfma_f32_16x16x32_bf16 v[24:27], a[200:203], v[104:107], v[24:27]
  ds_read_b128 a[172:175], v115 offset:56320
  v_cvt_pk_bf16_f32 v66, v68, v69
  v_exp_f32 v71, v71
  v_mfma_f32_16x16x32_bf16 v[28:31], a[232:235], v[104:107], v[28:31]
  v_fma_f32 v72, v72, s25, -v123
  v_cvt_pk_bf16_f32 v67, v70, v71
  v_mfma_f32_16x16x32_bf16 v[32:35], v[160:163], v[104:107], v[32:35]
  ds_write_b128 v113, v[64:67] offset:26624
  v_fma_f32 v73, v73, s25, -v123
  v_exp_f32 v72, v72
  v_mfma_f32_16x16x32_bf16 v[36:39], v[164:167], v[104:107], v[36:39]
  v_fma_f32 v74, v74, s25, -v123
  v_exp_f32 v73, v73
  v_mfma_f32_16x16x32_bf16 v[40:43], v[168:171], v[104:107], v[40:43]
  v_fma_f32 v75, v75, s25, -v123
  v_exp_f32 v74, v74
  v_mfma_f32_16x16x32_bf16 v[44:47], v[172:175], v[104:107], v[44:47]
  s_waitcnt lgkmcnt(4)
  ds_read_b128 v[104:107], v112 offset:320
  v_fma_f32 v76, v76, s25, -v123
  v_cvt_pk_bf16_f32 v72, v72, v73
  v_mfma_f32_16x16x32_bf16 v[24:27], a[204:207], v[96:99], v[24:27]
  ds_read_b128 a[176:179], v115 offset:57344
  v_exp_f32 v75, v75
  v_mfma_f32_16x16x32_bf16 v[28:31], a[236:239], v[96:99], v[28:31]
  v_fma_f32 v77, v77, s25, -v123
  v_exp_f32 v76, v76
  v_mfma_f32_16x16x32_bf16 v[32:35], v[176:179], v[96:99], v[32:35]
  v_fma_f32 v78, v78, s25, -v123
  v_cvt_pk_bf16_f32 v73, v74, v75
  v_mfma_f32_16x16x32_bf16 v[36:39], v[180:183], v[96:99], v[36:39]
  v_exp_f32 v77, v77
  v_mfma_f32_16x16x32_bf16 v[40:43], v[184:187], v[96:99], v[40:43]
  v_fma_f32 v79, v79, s25, -v123
  v_exp_f32 v78, v78
  v_mfma_f32_16x16x32_bf16 v[44:47], v[188:191], v[96:99], v[44:47]
  s_waitcnt lgkmcnt(4)
  ds_read_b128 v[96:99], v112 offset:384
  v_cvt_pk_bf16_f32 v74, v76, v77
  v_exp_f32 v79, v79
  v_mfma_f32_16x16x32_bf16 v[24:27], a[208:211], v[100:103], v[24:27]
  ds_read_b128 a[180:183], v115 offset:58368
  v_fma_f32 v80, v80, s25, -v123
  v_cvt_pk_bf16_f32 v75, v78, v79
  v_mfma_f32_16x16x32_bf16 v[28:31], a[240:243], v[100:103], v[28:31]
  ds_write_b128 v113, v[72:75] offset:36864
  v_fma_f32 v81, v81, s25, -v123
  v_exp_f32 v80, v80
  v_mfma_f32_16x16x32_bf16 v[32:35], v[192:195], v[100:103], v[32:35]
  v_fma_f32 v82, v82, s25, -v123
  v_exp_f32 v81, v81
  v_mfma_f32_16x16x32_bf16 v[36:39], v[196:199], v[100:103], v[36:39]
  v_fma_f32 v83, v83, s25, -v123
  v_exp_f32 v82, v82
  v_mfma_f32_16x16x32_bf16 v[40:43], v[200:203], v[100:103], v[40:43]
  v_fma_f32 v84, v84, s25, -v123
  v_cvt_pk_bf16_f32 v80, v80, v81
  v_mfma_f32_16x16x32_bf16 v[44:47], v[204:207], v[100:103], v[44:47]
  s_waitcnt lgkmcnt(4)
  ds_read_b128 v[100:103], v112 offset:448
  v_exp_f32 v83, v83
  v_mfma_f32_16x16x32_bf16 v[24:27], a[212:215], v[104:107], v[24:27]
  ds_read_b128 a[184:187], v115 offset:59392
  v_fma_f32 v85, v85, s25, -v123
  v_exp_f32 v84, v84
  v_mfma_f32_16x16x32_bf16 v[28:31], a[244:247], v[104:107], v[28:31]
  v_fma_f32 v86, v86, s25, -v123
  v_cvt_pk_bf16_f32 v81, v82, v83
  v_mfma_f32_16x16x32_bf16 v[32:35], v[208:211], v[104:107], v[32:35]
  v_exp_f32 v85, v85
  v_mfma_f32_16x16x32_bf16 v[36:39], v[212:215], v[104:107], v[36:39]
  v_fma_f32 v87, v87, s25, -v123
  v_exp_f32 v86, v86
  v_mfma_f32_16x16x32_bf16 v[40:43], v[216:219], v[104:107], v[40:43]
  v_cvt_pk_bf16_f32 v82, v84, v85
  v_exp_f32 v87, v87
  v_mfma_f32_16x16x32_bf16 v[44:47], v[220:223], v[104:107], v[44:47]
  s_waitcnt lgkmcnt(4)
  ds_read_b128 v[104:107], v112 offset:8448
  v_fma_f32 v88, v88, s25, -v123
  v_cvt_pk_bf16_f32 v83, v86, v87
  v_mfma_f32_16x16x32_bf16 v[24:27], a[216:219], v[96:99], v[24:27]
  ds_read_b128 a[188:191], v115 offset:60416
  v_fma_f32 v89, v89, s25, -v123
  v_exp_f32 v88, v88
  v_mfma_f32_16x16x32_bf16 v[28:31], a[248:251], v[96:99], v[28:31]
  ds_write_b128 v113, v[80:83] offset:37888
  v_fma_f32 v90, v90, s25, -v123
  v_exp_f32 v89, v89
  v_mfma_f32_16x16x32_bf16 v[32:35], v[224:227], v[96:99], v[32:35]
  v_fma_f32 v91, v91, s25, -v123
  v_exp_f32 v90, v90
  v_mfma_f32_16x16x32_bf16 v[36:39], v[228:231], v[96:99], v[36:39]
  v_fma_f32 v92, v92, s25, -v123
  v_cvt_pk_bf16_f32 v88, v88, v89
  v_mfma_f32_16x16x32_bf16 v[40:43], v[232:235], v[96:99], v[40:43]
  v_exp_f32 v91, v91
  v_mfma_f32_16x16x32_bf16 v[44:47], v[236:239], v[96:99], v[44:47]
  s_waitcnt lgkmcnt(4)
  ds_read_b128 v[96:99], v112 offset:8512
  v_fma_f32 v93, v93, s25, -v123
  v_exp_f32 v92, v92
  v_mfma_f32_16x16x32_bf16 v[24:27], a[220:223], v[100:103], v[24:27]
  v_fma_f32 v94, v94, s25, -v123
  v_cvt_pk_bf16_f32 v89, v90, v91
  v_mfma_f32_16x16x32_bf16 v[28:31], a[252:255], v[100:103], v[28:31]
  v_exp_f32 v93, v93
  v_mfma_f32_16x16x32_bf16 v[32:35], v[240:243], v[100:103], v[32:35]
  v_fma_f32 v95, v95, s25, -v123
  v_exp_f32 v94, v94
  v_mfma_f32_16x16x32_bf16 v[36:39], v[244:247], v[100:103], v[36:39]
  v_max3_f32 v125, v24, v25, v26
  v_cvt_pk_bf16_f32 v90, v92, v93
  v_mfma_f32_16x16x32_bf16 v[40:43], v[248:251], v[100:103], v[40:43]
  v_max3_f32 v125, v27, v28, v125
  v_max3_f32 v125, v29, v30, v125
  v_mfma_f32_16x16x32_bf16 v[44:47], v[252:255], v[100:103], v[44:47]
  s_waitcnt lgkmcnt(3)
  ds_read_b128 v[100:103], v112 offset:8576
  v_max3_f32 v125, v31, v32, v125
  v_max3_f32 v125, v33, v34, v125
  v_mfma_f32_16x16x32_bf16 v[48:51], a[192:195], v[104:107], 0
  v_max3_f32 v125, v35, v36, v125
  v_max3_f32 v125, v37, v38, v125
  v_mfma_f32_16x16x32_bf16 v[52:55], a[224:227], v[104:107], 0
  v_max3_f32 v125, v39, v40, v125
  v_max3_f32 v125, v41, v42, v125
  v_mfma_f32_16x16x32_bf16 v[56:59], v[128:131], v[104:107], 0
  v_max3_f32 v125, v43, v44, v125
  v_max3_f32 v125, v45, v46, v125
  v_mfma_f32_16x16x32_bf16 v[60:63], v[132:135], v[104:107], 0
  v_max_f32 v125, v47, v125
  v_exp_f32 v95, v95
  v_mfma_f32_16x16x32_bf16 v[64:67], v[136:139], v[104:107], 0
  v_permlane32_swap_b32 v124, v125
  v_mfma_f32_16x16x32_bf16 v[68:71], v[140:143], v[104:107], 0
  s_waitcnt lgkmcnt(1)
  ds_read_b128 v[104:107], v112 offset:8640
  v_max_f32 v126, v124, v125
  v_max_f32 v127, v124, v125
  v_mfma_f32_16x16x32_bf16 v[48:51], a[196:199], v[96:99], v[48:51]
  v_cvt_pk_bf16_f32 v91, v94, v95
  v_permlane16_swap_b32 v126, v127
  v_mfma_f32_16x16x32_bf16 v[52:55], a[228:231], v[96:99], v[52:55]
  ds_write_b128 v113, v[88:91] offset:38912
  v_max_f32 v126, v126, v127
  v_mfma_f32_16x16x32_bf16 v[56:59], v[144:147], v[96:99], v[56:59]
  ds_write_b32 v116, v126 offset:0
  v_mfma_f32_16x16x32_bf16 v[60:63], v[148:151], v[96:99], v[60:63]
  v_mfma_f32_16x16x32_bf16 v[64:67], v[152:155], v[96:99], v[64:67]
  v_mfma_f32_16x16x32_bf16 v[68:71], v[156:159], v[96:99], v[68:71]
  ds_read_b128 v[96:99], v112 offset:8704
  s_waitcnt vmcnt(4) lgkmcnt(1)
  s_barrier
  v_mfma_f32_16x16x32_bf16 v[48:51], a[200:203], v[100:103], v[48:51]
  ds_read_b128 v[108:111], v117 offset:0
  ds_read_b128 v[124:127], v117 offset:256
  v_mfma_f32_16x16x32_bf16 v[52:55], a[232:235], v[100:103], v[52:55]
  v_mfma_f32_16x16x32_bf16 v[56:59], v[160:163], v[100:103], v[56:59]
  v_mfma_f32_16x16x32_bf16 v[60:63], v[164:167], v[100:103], v[60:63]
  s_mov_b32 s44, 114688
  v_mfma_f32_16x16x32_bf16 v[64:67], v[168:171], v[100:103], v[64:67]
  s_add_u32 m0, s29, 50688
  v_mfma_f32_16x16x32_bf16 v[68:71], v[172:175], v[100:103], v[68:71]
  ds_read_b128 v[100:103], v112 offset:8768
  v_mfma_f32_16x16x32_bf16 v[48:51], a[204:207], v[104:107], v[48:51]
  buffer_load_dwordx4 v119, s[16:19], s44 offen nt lds
  v_mfma_f32_16x16x32_bf16 v[52:55], a[236:239], v[104:107], v[52:55]
  s_waitcnt lgkmcnt(2)
  v_max3_f32 v108, v108, v109, v110
  v_max_f32 v108, v108, v111
  v_mfma_f32_16x16x32_bf16 v[56:59], v[176:179], v[104:107], v[56:59]
  s_waitcnt lgkmcnt(1)
  v_mul_f32 v120, s25, v108
  v_max3_f32 v124, v124, v125, v126
  v_mfma_f32_16x16x32_bf16 v[60:63], v[180:183], v[104:107], v[60:63]
  v_max_f32 v124, v124, v127
  v_mul_f32 v121, s25, v124
  v_mfma_f32_16x16x32_bf16 v[64:67], v[184:187], v[104:107], v[64:67]
  v_fma_f32 v0, v0, s25, -v120
  v_fma_f32 v1, v1, s25, -v120
  v_mfma_f32_16x16x32_bf16 v[68:71], v[188:191], v[104:107], v[68:71]
  ds_read_b128 v[104:107], v112 offset:8832
  v_exp_f32 v0, v0
  v_mfma_f32_16x16x32_bf16 v[48:51], a[208:211], v[96:99], v[48:51]
  v_fma_f32 v2, v2, s25, -v120
  v_exp_f32 v1, v1
  v_mfma_f32_16x16x32_bf16 v[52:55], a[240:243], v[96:99], v[52:55]
  s_mov_b32 s45, 131072
  v_fma_f32 v3, v3, s25, -v120
  v_exp_f32 v2, v2
  v_mfma_f32_16x16x32_bf16 v[56:59], v[192:195], v[96:99], v[56:59]
  s_add_u32 m0, s29, 54784
  v_fma_f32 v4, v4, s25, -v120
  v_cvt_pk_bf16_f32 v0, v0, v1
  v_mfma_f32_16x16x32_bf16 v[60:63], v[196:199], v[96:99], v[60:63]
  v_exp_f32 v3, v3
  v_mfma_f32_16x16x32_bf16 v[64:67], v[200:203], v[96:99], v[64:67]
  buffer_load_dwordx4 v119, s[16:19], s45 offen nt lds
  v_fma_f32 v5, v5, s25, -v120
  v_exp_f32 v4, v4
  v_mfma_f32_16x16x32_bf16 v[68:71], v[204:207], v[96:99], v[68:71]
  s_waitcnt lgkmcnt(1)
  ds_read_b128 v[96:99], v112 offset:8896
  v_fma_f32 v6, v6, s25, -v120
  v_cvt_pk_bf16_f32 v1, v2, v3
  v_mfma_f32_16x16x32_bf16 v[48:51], a[212:215], v[100:103], v[48:51]
  v_exp_f32 v5, v5
  v_mfma_f32_16x16x32_bf16 v[52:55], a[244:247], v[100:103], v[52:55]
  v_fma_f32 v7, v7, s25, -v120
  v_exp_f32 v6, v6
  v_mfma_f32_16x16x32_bf16 v[56:59], v[208:211], v[100:103], v[56:59]
  v_cvt_pk_bf16_f32 v2, v4, v5
  v_exp_f32 v7, v7
  v_mfma_f32_16x16x32_bf16 v[60:63], v[212:215], v[100:103], v[60:63]
  v_fma_f32 v8, v8, s25, -v120
  v_cvt_pk_bf16_f32 v3, v6, v7
  v_mfma_f32_16x16x32_bf16 v[64:67], v[216:219], v[100:103], v[64:67]
  ds_write_b128 v114, v[0:3] offset:0
  v_fma_f32 v9, v9, s25, -v120
  v_exp_f32 v8, v8
  v_mfma_f32_16x16x32_bf16 v[68:71], v[220:223], v[100:103], v[68:71]
  s_waitcnt lgkmcnt(2)
  ds_read_b128 v[100:103], v112 offset:16896
  s_mov_b32 s46, 147456
  v_fma_f32 v10, v10, s25, -v120
  v_exp_f32 v9, v9
  v_mfma_f32_16x16x32_bf16 v[48:51], a[216:219], v[104:107], v[48:51]
  s_add_u32 m0, s29, 0
  v_fma_f32 v11, v11, s25, -v120
  v_exp_f32 v10, v10
  v_mfma_f32_16x16x32_bf16 v[52:55], a[248:251], v[104:107], v[52:55]
  v_fma_f32 v12, v12, s25, -v120
  v_cvt_pk_bf16_f32 v8, v8, v9
  v_mfma_f32_16x16x32_bf16 v[56:59], v[224:227], v[104:107], v[56:59]
  buffer_load_dwordx4 v119, s[16:19], s46 offen nt lds
  v_exp_f32 v11, v11
  v_mfma_f32_16x16x32_bf16 v[60:63], v[228:231], v[104:107], v[60:63]
  v_fma_f32 v13, v13, s25, -v120
  v_exp_f32 v12, v12
  v_mfma_f32_16x16x32_bf16 v[64:67], v[232:235], v[104:107], v[64:67]
  v_fma_f32 v14, v14, s25, -v120
  v_cvt_pk_bf16_f32 v9, v10, v11
  v_mfma_f32_16x16x32_bf16 v[68:71], v[236:239], v[104:107], v[68:71]
  s_waitcnt lgkmcnt(2)
  ds_read_b128 v[104:107], v112 offset:16960
  v_exp_f32 v13, v13
  v_mfma_f32_16x16x32_bf16 v[48:51], a[220:223], v[96:99], v[48:51]
  v_fma_f32 v15, v15, s25, -v120
  v_exp_f32 v14, v14
  v_mfma_f32_16x16x32_bf16 v[52:55], a[252:255], v[96:99], v[52:55]
  v_cvt_pk_bf16_f32 v10, v12, v13
  v_exp_f32 v15, v15
  v_mfma_f32_16x16x32_bf16 v[56:59], v[240:243], v[96:99], v[56:59]
  v_fma_f32 v16, v16, s25, -v120
  v_cvt_pk_bf16_f32 v11, v14, v15
  v_mfma_f32_16x16x32_bf16 v[60:63], v[244:247], v[96:99], v[60:63]
  ds_write_b128 v114, v[8:11] offset:1024
  s_mov_b32 s47, 163840
  v_max3_f32 v124, v48, v49, v50
  v_max3_f32 v124, v51, v52, v124
  v_mfma_f32_16x16x32_bf16 v[64:67], v[248:251], v[96:99], v[64:67]
  s_add_u32 m0, s29, 4096
  v_max3_f32 v124, v53, v54, v124
  v_max3_f32 v124, v55, v56, v124
  v_mfma_f32_16x16x32_bf16 v[68:71], v[252:255], v[96:99], v[68:71]
  s_waitcnt lgkmcnt(2)
  ds_read_b128 v[96:99], v112 offset:17024
  v_max3_f32 v124, v57, v58, v124
  v_max3_f32 v124, v59, v60, v124
  v_mfma_f32_16x16x32_bf16 v[72:75], a[192:195], v[100:103], 0
  buffer_load_dwordx4 v119, s[16:19], s47 offen nt lds
  v_max3_f32 v124, v61, v62, v124
  v_max3_f32 v124, v63, v64, v124
  v_mfma_f32_16x16x32_bf16 v[76:79], a[224:227], v[100:103], 0
  v_max3_f32 v124, v65, v66, v124
  v_max3_f32 v124, v67, v68, v124
  v_mfma_f32_16x16x32_bf16 v[80:83], v[128:131], v[100:103], 0
  v_max3_f32 v124, v69, v70, v124
  v_max_f32 v124, v71, v124
  v_mfma_f32_16x16x32_bf16 v[84:87], v[132:135], v[100:103], 0
  v_fma_f32 v17, v17, s25, -v120
  v_exp_f32 v16, v16
  v_mfma_f32_16x16x32_bf16 v[88:91], v[136:139], v[100:103], 0
  v_fma_f32 v18, v18, s25, -v120
  v_exp_f32 v17, v17
  v_mfma_f32_16x16x32_bf16 v[92:95], v[140:143], v[100:103], 0
  s_waitcnt lgkmcnt(2)
  ds_read_b128 v[100:103], v112 offset:17088
  v_fma_f32 v19, v19, s25, -v120
  v_exp_f32 v18, v18
  v_mfma_f32_16x16x32_bf16 v[72:75], a[196:199], v[104:107], v[72:75]
  v_fma_f32 v20, v20, s25, -v120
  v_cvt_pk_bf16_f32 v16, v16, v17
  v_mfma_f32_16x16x32_bf16 v[76:79], a[228:231], v[104:107], v[76:79]
  v_exp_f32 v19, v19
  v_mfma_f32_16x16x32_bf16 v[80:83], v[144:147], v[104:107], v[80:83]
  v_fma_f32 v21, v21, s25, -v120
  v_exp_f32 v20, v20
  v_mfma_f32_16x16x32_bf16 v[84:87], v[148:151], v[104:107], v[84:87]
  v_fma_f32 v22, v22, s25, -v120
  v_cvt_pk_bf16_f32 v17, v18, v19
  v_mfma_f32_16x16x32_bf16 v[88:91], v[152:155], v[104:107], v[88:91]
  v_exp_f32 v21, v21
  v_mfma_f32_16x16x32_bf16 v[92:95], v[156:159], v[104:107], v[92:95]
  s_waitcnt lgkmcnt(1)
  ds_read_b128 v[104:107], v112 offset:17152
  v_fma_f32 v23, v23, s25, -v120
  v_exp_f32 v22, v22
  v_mfma_f32_16x16x32_bf16 v[72:75], a[200:203], v[96:99], v[72:75]
  v_cvt_pk_bf16_f32 v18, v20, v21
  v_exp_f32 v23, v23
  v_mfma_f32_16x16x32_bf16 v[76:79], a[232:235], v[96:99], v[76:79]
  v_fma_f32 v24, v24, s25, -v121
  v_cvt_pk_bf16_f32 v19, v22, v23
  v_mfma_f32_16x16x32_bf16 v[80:83], v[160:163], v[96:99], v[80:83]
  ds_write_b128 v114, v[16:19] offset:2048
  v_fma_f32 v25, v25, s25, -v121
  v_exp_f32 v24, v24
  v_mfma_f32_16x16x32_bf16 v[84:87], v[164:167], v[96:99], v[84:87]
  v_fma_f32 v26, v26, s25, -v121
  v_exp_f32 v25, v25
  v_mfma_f32_16x16x32_bf16 v[88:91], v[168:171], v[96:99], v[88:91]
  v_fma_f32 v27, v27, s25, -v121
  v_exp_f32 v26, v26
  v_mfma_f32_16x16x32_bf16 v[92:95], v[172:175], v[96:99], v[92:95]
  s_waitcnt lgkmcnt(2)
  ds_read_b128 v[96:99], v112 offset:17216
  v_fma_f32 v28, v28, s25, -v121
  v_cvt_pk_bf16_f32 v24, v24, v25
  v_mfma_f32_16x16x32_bf16 v[72:75], a[204:207], v[100:103], v[72:75]
  v_exp_f32 v27, v27
  v_mfma_f32_16x16x32_bf16 v[76:79], a[236:239], v[100:103], v[76:79]
  v_fma_f32 v29, v29, s25, -v121
  v_exp_f32 v28, v28
  v_mfma_f32_16x16x32_bf16 v[80:83], v[176:179], v[100:103], v[80:83]
  v_mbcnt_lo_u32_b32 v168, -1, 0
  v_mbcnt_hi_u32_b32 v168, -1, v168
  v_mfma_f32_16x16x32_bf16 v[84:87], v[180:183], v[100:103], v[84:87]
  v_lshrrev_b32 v169, 2, v168
  v_lshlrev_b32 v169, 7, v169
  v_mfma_f32_16x16x32_bf16 v[88:91], v[184:187], v[100:103], v[88:91]
  v_and_b32 v172, 3, v168
  v_lshl_add_u32 v169, v172, 3, v169
  v_mfma_f32_16x16x32_bf16 v[92:95], v[188:191], v[100:103], v[92:95]
  s_waitcnt lgkmcnt(2)
  ds_read_b128 v[100:103], v112 offset:17280
  v_bfe_u32 v172, v168, 3, 2
  v_lshlrev_b32 v172, 5, v172
  v_mfma_f32_16x16x32_bf16 v[72:75], a[208:211], v[104:107], v[72:75]
  v_xor_b32 v160, 0, v172
  v_add_u32 v160, v160, v169
  v_mfma_f32_16x16x32_bf16 v[76:79], a[240:243], v[104:107], v[76:79]
  v_xor_b32 v161, 32, v172
  v_add_u32 v161, v161, v169
  v_mfma_f32_16x16x32_bf16 v[80:83], v[192:195], v[104:107], v[80:83]
  v_xor_b32 v162, 64, v172
  v_add_u32 v162, v162, v169
  v_mfma_f32_16x16x32_bf16 v[84:87], v[196:199], v[104:107], v[84:87]
  v_xor_b32 v163, 96, v172
  v_add_u32 v163, v163, v169
  v_mfma_f32_16x16x32_bf16 v[88:91], v[200:203], v[104:107], v[88:91]
  v_add_u32 v160, 158464, v160
  v_add_u32 v161, 158464, v161
  v_mfma_f32_16x16x32_bf16 v[92:95], v[204:207], v[104:107], v[92:95]
  s_waitcnt lgkmcnt(1)
  ds_read_b64_tr_b16 v[128:129], v160 offset:0
  v_add_u32 v162, 158464, v162
  v_add_u32 v163, 158464, v163
  v_mfma_f32_16x16x32_bf16 v[72:75], a[212:215], v[96:99], v[72:75]
  ds_read_b128 v[104:107], v112 offset:17344
  v_mov_b32 v172, 0x3f803f80
  v_mov_b32 v173, 0x3f803f80
  v_mfma_f32_16x16x32_bf16 v[76:79], a[244:247], v[96:99], v[76:79]
  ds_read_b64_tr_b16 v[130:131], v160 offset:2048
  v_mov_b32 v174, 0x3f803f80
  v_mov_b32 v175, 0x3f803f80
  v_mfma_f32_16x16x32_bf16 v[80:83], v[208:211], v[96:99], v[80:83]
  ds_read_b64_tr_b16 v[132:133], v161 offset:0
  v_fma_f32 v30, v30, s25, -v121
  v_cvt_pk_bf16_f32 v25, v26, v27
  v_mfma_f32_16x16x32_bf16 v[84:87], v[212:215], v[96:99], v[84:87]
  ds_read_b64_tr_b16 v[134:135], v161 offset:2048
  v_exp_f32 v29, v29
  v_mfma_f32_16x16x32_bf16 v[88:91], v[216:219], v[96:99], v[88:91]
  ds_read_b64_tr_b16 v[136:137], v162 offset:0
  v_fma_f32 v31, v31, s25, -v121
  v_exp_f32 v30, v30
  v_mfma_f32_16x16x32_bf16 v[92:95], v[220:223], v[96:99], v[92:95]
  s_waitcnt lgkmcnt(6)
  ds_read_b64_tr_b16 v[138:139], v162 offset:2048
  v_cvt_pk_bf16_f32 v26, v28, v29
  v_exp_f32 v31, v31
  v_mfma_f32_16x16x32_bf16 v[72:75], a[216:219], v[100:103], v[72:75]
  ds_read_b64_tr_b16 v[140:141], v163 offset:0
  v_fma_f32 v32, v32, s25, -v121
  v_cvt_pk_bf16_f32 v27, v30, v31
  v_mfma_f32_16x16x32_bf16 v[76:79], a[248:251], v[100:103], v[76:79]
  ds_read_b64_tr_b16 v[142:143], v163 offset:2048
  v_fma_f32 v33, v33, s25, -v121
  v_exp_f32 v32, v32
  v_mfma_f32_16x16x32_bf16 v[80:83], v[224:227], v[100:103], v[80:83]
  ds_write_b128 v114, v[24:27] offset:12288
  v_fma_f32 v34, v34, s25, -v121
  v_exp_f32 v33, v33
  v_mfma_f32_16x16x32_bf16 v[84:87], v[228:231], v[100:103], v[84:87]
  v_fma_f32 v35, v35, s25, -v121
  v_subrev_u32 v160, 133120, v160
  v_mfma_f32_16x16x32_bf16 v[88:91], v[232:235], v[100:103], v[88:91]
  ds_read_b64_tr_b16 v[144:145], v160 offset:0
  v_subrev_u32 v161, 133120, v161
  v_subrev_u32 v162, 133120, v162
  v_mfma_f32_16x16x32_bf16 v[92:95], v[236:239], v[100:103], v[92:95]
  s_waitcnt lgkmcnt(9)
  ds_read_b64_tr_b16 v[146:147], v160 offset:2048
  v_subrev_u32 v163, 133120, v163
  v_exp_f32 v34, v34
  v_mfma_f32_16x16x32_bf16 v[72:75], a[220:223], v[104:107], v[72:75]
  ds_read_b64_tr_b16 v[148:149], v161 offset:0
  v_fma_f32 v36, v36, s25, -v121
  v_cvt_pk_bf16_f32 v32, v32, v33
  v_mfma_f32_16x16x32_bf16 v[76:79], a[252:255], v[104:107], v[76:79]
  ds_read_b64_tr_b16 v[150:151], v161 offset:2048
  v_exp_f32 v35, v35
  v_mfma_f32_16x16x32_bf16 v[80:83], v[240:243], v[104:107], v[80:83]
  ds_read_b64_tr_b16 v[152:153], v162 offset:0
  v_max3_f32 v125, v72, v73, v74
  v_fma_f32 v37, v37, s25, -v121
  v_mfma_f32_16x16x32_bf16 v[84:87], v[244:247], v[104:107], v[84:87]
  ds_read_b64_tr_b16 v[154:155], v162 offset:2048
  v_max3_f32 v125, v75, v76, v125
  v_max3_f32 v125, v77, v78, v125
  v_mfma_f32_16x16x32_bf16 v[88:91], v[248:251], v[104:107], v[88:91]
  ds_read_b64_tr_b16 v[156:157], v163 offset:0
  v_max3_f32 v125, v79, v80, v125
  v_max3_f32 v125, v81, v82, v125
  v_mfma_f32_16x16x32_bf16 v[92:95], v[252:255], v[104:107], v[92:95]
  s_waitcnt lgkmcnt(14)
  ds_read_b64_tr_b16 v[158:159], v163 offset:2048
  v_max3_f32 v125, v83, v84, v125
  v_max3_f32 v125, v85, v86, v125
  v_mfma_f32_16x16x32_bf16 v[176:179], v[128:131], a[0:3], 0
  s_waitcnt lgkmcnt(13)
  v_max3_f32 v125, v87, v88, v125
  v_max3_f32 v125, v89, v90, v125
  v_mfma_f32_16x16x32_bf16 v[180:183], v[132:135], a[0:3], 0
  s_waitcnt lgkmcnt(11)
  v_exp_f32 v36, v36
  v_mfma_f32_16x16x32_bf16 v[184:187], v[136:139], a[0:3], 0
  s_waitcnt lgkmcnt(9)
  v_max3_f32 v125, v91, v92, v125
  v_max3_f32 v125, v93, v94, v125
  v_mfma_f32_16x16x32_bf16 v[188:191], v[140:143], a[0:3], 0
  v_max_f32 v125, v95, v125
  v_fma_f32 v38, v38, s25, -v121
  v_mfma_f32_16x16x32_bf16 v[192:195], v[172:175], a[0:3], 0
  v_permlane32_swap_b32 v124, v125
  v_mfma_f32_16x16x32_bf16 v[196:199], v[128:131], a[48:51], 0
  v_max_f32 v126, v124, v125
  v_max_f32 v127, v124, v125
  v_mfma_f32_16x16x32_bf16 v[200:203], v[132:135], a[48:51], 0
  v_cvt_pk_bf16_f32 v33, v34, v35
  v_permlane16_swap_b32 v126, v127
  v_mfma_f32_16x16x32_bf16 v[204:207], v[136:139], a[48:51], 0
  v_max_f32 v126, v126, v127
  v_exp_f32 v37, v37
  v_mfma_f32_16x16x32_bf16 v[208:211], v[140:143], a[48:51], 0
  ds_write_b32 v116, v126 offset:512
  v_fma_f32 v39, v39, s25, -v121
  v_exp_f32 v38, v38
  v_mfma_f32_16x16x32_bf16 v[212:215], v[172:175], a[48:51], 0
  v_cvt_pk_bf16_f32 v34, v36, v37
  v_exp_f32 v39, v39
  v_mfma_f32_16x16x32_bf16 v[216:219], v[128:131], a[96:99], 0
  v_fma_f32 v40, v40, s25, -v121
  v_cvt_pk_bf16_f32 v35, v38, v39
  v_mfma_f32_16x16x32_bf16 v[220:223], v[132:135], a[96:99], 0
  ds_write_b128 v114, v[32:35] offset:13312
  s_waitcnt vmcnt(0) lgkmcnt(1)
  s_barrier
  v_fma_f32 v41, v41, s25, -v121
  v_exp_f32 v40, v40
  v_mfma_f32_16x16x32_bf16 v[224:227], v[136:139], a[96:99], 0
  ds_read_b128 v[108:111], v117 offset:512
  ds_read_b128 v[124:127], v117 offset:768
  v_fma_f32 v42, v42, s25, -v121
  v_exp_f32 v41, v41
  v_mfma_f32_16x16x32_bf16 v[228:231], v[140:143], a[96:99], 0
  v_fma_f32 v43, v43, s25, -v121
  v_exp_f32 v42, v42
  v_mfma_f32_16x16x32_bf16 v[232:235], v[172:175], a[96:99], 0
  v_fma_f32 v44, v44, s25, -v121
  v_cvt_pk_bf16_f32 v40, v40, v41
  v_mfma_f32_16x16x32_bf16 v[236:239], v[128:131], a[144:147], 0
  ds_read_b64_tr_b16 v[128:129], v160 offset:4096
  s_mov_b32 s32, 180224
  v_exp_f32 v43, v43
  v_mfma_f32_16x16x32_bf16 v[240:243], v[132:135], a[144:147], 0
  ds_read_b64_tr_b16 v[130:131], v160 offset:6144
  s_add_u32 m0, s29, 8448
  v_fma_f32 v45, v45, s25, -v121
  v_exp_f32 v44, v44
  v_mfma_f32_16x16x32_bf16 v[244:247], v[136:139], a[144:147], 0
  ds_read_b64_tr_b16 v[132:133], v161 offset:4096
  v_fma_f32 v46, v46, s25, -v121
  v_cvt_pk_bf16_f32 v41, v42, v43
  v_mfma_f32_16x16x32_bf16 v[248:251], v[140:143], a[144:147], 0
  buffer_load_dwordx4 v119, s[16:19], s32 offen nt lds
  v_exp_f32 v45, v45
  v_mfma_f32_16x16x32_bf16 v[252:255], v[172:175], a[144:147], 0
  s_waitcnt lgkmcnt(4)
  ds_read_b64_tr_b16 v[134:135], v161 offset:6144
  v_max3_f32 v108, v108, v109, v110
  v_max_f32 v108, v108, v111
  v_mfma_f32_16x16x32_bf16 v[176:179], v[144:147], a[4:7], v[176:179]
  s_waitcnt lgkmcnt(4)
  ds_read_b128 a[192:195], v115 offset:0
  v_mul_f32 v122, s25, v108
  v_max3_f32 v124, v124, v125, v126
  v_mfma_f32_16x16x32_bf16 v[180:183], v[148:151], a[4:7], v[180:183]
  ds_read_b64_tr_b16 v[136:137], v162 offset:4096
  v_max_f32 v124, v124, v127
  v_mul_f32 v123, s25, v124
  v_mfma_f32_16x16x32_bf16 v[184:187], v[152:155], a[4:7], v[184:187]
  ds_read_b64_tr_b16 v[138:139], v162 offset:6144
  v_fma_f32 v47, v47, s25, -v121
  v_exp_f32 v46, v46
  v_mfma_f32_16x16x32_bf16 v[188:191], v[156:159], a[4:7], v[188:191]
  ds_read_b128 a[196:199], v115 offset:1024
  v_cvt_pk_bf16_f32 v42, v44, v45
  v_exp_f32 v47, v47
  v_mfma_f32_16x16x32_bf16 v[192:195], v[172:175], a[4:7], v[192:195]
  ds_read_b64_tr_b16 v[140:141], v163 offset:4096
  v_fma_f32 v48, v48, s25, -v122
  v_cvt_pk_bf16_f32 v43, v46, v47
  v_mfma_f32_16x16x32_bf16 v[196:199], v[144:147], a[52:55], v[196:199]
  ds_write_b128 v114, v[40:43] offset:14336
  s_mov_b32 s33, 128
  v_fma_f32 v49, v49, s25, -v122
  v_exp_f32 v48, v48
  v_mfma_f32_16x16x32_bf16 v[200:203], v[148:151], a[52:55], v[200:203]
  ds_read_b128 a[200:203], v115 offset:2048
  s_add_u32 m0, s29, 12544
  v_fma_f32 v50, v50, s25, -v122
  v_exp_f32 v49, v49
  v_mfma_f32_16x16x32_bf16 v[204:207], v[152:155], a[52:55], v[204:207]
  ds_read_b64_tr_b16 v[142:143], v163 offset:6144
  v_fma_f32 v51, v51, s25, -v122
  v_exp_f32 v50, v50
  v_mfma_f32_16x16x32_bf16 v[208:211], v[156:159], a[52:55], v[208:211]
  buffer_load_dwordx4 v119, s[16:19], s33 offen nt lds
  v_fma_f32 v52, v52, s25, -v122
  v_cvt_pk_bf16_f32 v48, v48, v49
  v_mfma_f32_16x16x32_bf16 v[212:215], v[172:175], a[52:55], v[212:215]
  v_exp_f32 v51, v51
  v_mfma_f32_16x16x32_bf16 v[216:219], v[144:147], a[100:103], v[216:219]
  ds_read_b128 a[204:207], v115 offset:3072
  v_fma_f32 v53, v53, s25, -v122
  v_exp_f32 v52, v52
  v_mfma_f32_16x16x32_bf16 v[220:223], v[148:151], a[100:103], v[220:223]
  v_fma_f32 v54, v54, s25, -v122
  v_cvt_pk_bf16_f32 v49, v50, v51
  v_mfma_f32_16x16x32_bf16 v[224:227], v[152:155], a[100:103], v[224:227]
  v_exp_f32 v53, v53
  v_mfma_f32_16x16x32_bf16 v[228:231], v[156:159], a[100:103], v[228:231]
  ds_read_b128 a[208:211], v115 offset:4096
  v_fma_f32 v55, v55, s25, -v122
  v_exp_f32 v54, v54
  v_mfma_f32_16x16x32_bf16 v[232:235], v[172:175], a[100:103], v[232:235]
  v_cvt_pk_bf16_f32 v50, v52, v53
  v_exp_f32 v55, v55
  v_mfma_f32_16x16x32_bf16 v[236:239], v[144:147], a[148:151], v[236:239]
  ds_read_b64_tr_b16 v[144:145], v160 offset:8448
  s_mov_b32 s34, 16512
  v_fma_f32 v56, v56, s25, -v122
  v_cvt_pk_bf16_f32 v51, v54, v55
  v_mfma_f32_16x16x32_bf16 v[240:243], v[148:151], a[148:151], v[240:243]
  ds_read_b128 a[212:215], v115 offset:5120
  s_add_u32 m0, s29, 16896
  v_fma_f32 v57, v57, s25, -v122
  v_exp_f32 v56, v56
  v_mfma_f32_16x16x32_bf16 v[244:247], v[152:155], a[148:151], v[244:247]
  ds_write_b128 v114, v[48:51] offset:24576
  v_fma_f32 v58, v58, s25, -v122
  v_exp_f32 v57, v57
  v_mfma_f32_16x16x32_bf16 v[248:251], v[156:159], a[148:151], v[248:251]
  buffer_load_dwordx4 v119, s[16:19], s34 offen nt lds
  v_fma_f32 v59, v59, s25, -v122
  v_exp_f32 v58, v58
  v_mfma_f32_16x16x32_bf16 v[252:255], v[172:175], a[148:151], v[252:255]
  s_waitcnt lgkmcnt(15)
  ds_read_b64_tr_b16 v[146:147], v160 offset:10496
  v_fma_f32 v60, v60, s25, -v122
  v_cvt_pk_bf16_f32 v56, v56, v57
  v_mfma_f32_16x16x32_bf16 v[176:179], v[128:131], a[8:11], v[176:179]
  s_waitcnt lgkmcnt(14)
  ds_read_b128 a[216:219], v115 offset:6144
  v_and_b32 v169, 7, v168
  v_lshlrev_b32 v169, 9, v169
  v_mfma_f32_16x16x32_bf16 v[180:183], v[132:135], a[8:11], v[180:183]
  s_waitcnt lgkmcnt(12)
  ds_read_b64_tr_b16 v[148:149], v161 offset:8448
  v_bfe_u32 v99, v168, 3, 1
  v_lshl_add_u32 v169, v99, 6, v169
  v_mfma_f32_16x16x32_bf16 v[184:187], v[136:139], a[8:11], v[184:187]
  s_waitcnt lgkmcnt(8)
  ds_read_b64_tr_b16 v[150:151], v161 offset:10496
  v_bfe_u32 v99, v168, 4, 1
  v_lshl_add_u32 v169, v99, 5, v169
  v_mfma_f32_16x16x32_bf16 v[188:191], v[140:143], a[8:11], v[188:191]
  ds_read_b128 a[220:223], v115 offset:7168
  v_bfe_u32 v99, v168, 5, 1
  v_lshl_add_u32 v169, v99, 4, v169
  v_mfma_f32_16x16x32_bf16 v[192:195], v[172:175], a[8:11], v[192:195]
  ds_read_b64_tr_b16 v[152:153], v162 offset:8448
  v_add_u32 v169, s58, v169
  v_exp_f32 v59, v59
  v_mfma_f32_16x16x32_bf16 v[196:199], v[128:131], a[56:59], v[196:199]
  ds_read_b64_tr_b16 v[154:155], v162 offset:10496
  s_mov_b32 s35, 32896
  v_fma_f32 v61, v61, s25, -v122
  v_exp_f32 v60, v60
  v_mfma_f32_16x16x32_bf16 v[200:203], v[132:135], a[56:59], v[200:203]
  ds_read_b128 a[224:227], v115 offset:8192
  s_add_u32 m0, s29, 20992
  v_fma_f32 v62, v62, s25, -v122
  v_cvt_pk_bf16_f32 v57, v58, v59
  v_mfma_f32_16x16x32_bf16 v[204:207], v[136:139], a[56:59], v[204:207]
  ds_read_b64_tr_b16 v[156:157], v163 offset:8448
  v_exp_f32 v61, v61
  v_mfma_f32_16x16x32_bf16 v[208:211], v[140:143], a[56:59], v[208:211]
  buffer_load_dwordx4 v119, s[16:19], s35 offen nt lds
  v_fma_f32 v63, v63, s25, -v122
  v_exp_f32 v62, v62
  v_mfma_f32_16x16x32_bf16 v[212:215], v[172:175], a[56:59], v[212:215]
  ds_read_b64_tr_b16 v[158:159], v163 offset:10496
  v_cvt_pk_bf16_f32 v58, v60, v61
  v_exp_f32 v63, v63
  v_mfma_f32_16x16x32_bf16 v[216:219], v[128:131], a[104:107], v[216:219]
  ds_read_b128 a[228:231], v115 offset:9216
  v_fma_f32 v64, v64, s25, -v122
  v_cvt_pk_bf16_f32 v59, v62, v63
  v_mfma_f32_16x16x32_bf16 v[220:223], v[132:135], a[104:107], v[220:223]
  ds_write_b128 v114, v[56:59] offset:25600
  v_fma_f32 v65, v65, s25, -v122
  v_exp_f32 v64, v64
  v_mfma_f32_16x16x32_bf16 v[224:227], v[136:139], a[104:107], v[224:227]
  v_fma_f32 v66, v66, s25, -v122
  v_exp_f32 v65, v65
  v_mfma_f32_16x16x32_bf16 v[228:231], v[140:143], a[104:107], v[228:231]
  ds_read_b128 a[232:235], v115 offset:10240
  v_fma_f32 v67, v67, s25, -v122
  v_exp_f32 v66, v66
  v_mfma_f32_16x16x32_bf16 v[232:235], v[172:175], a[104:107], v[232:235]
  v_fma_f32 v68, v68, s25, -v122
  v_cvt_pk_bf16_f32 v64, v64, v65
  v_mfma_f32_16x16x32_bf16 v[236:239], v[128:131], a[152:155], v[236:239]
  ds_read_b64_tr_b16 v[128:129], v160 offset:12544
  v_exp_f32 v67, v67
  v_mfma_f32_16x16x32_bf16 v[240:243], v[132:135], a[152:155], v[240:243]
  ds_read_b128 a[236:239], v115 offset:11264
  v_fma_f32 v69, v69, s25, -v122
  v_exp_f32 v68, v68
  v_mfma_f32_16x16x32_bf16 v[244:247], v[136:139], a[152:155], v[244:247]
  ds_read_b64_tr_b16 v[130:131], v160 offset:14592
  v_fma_f32 v70, v70, s25, -v122
  v_cvt_pk_bf16_f32 v65, v66, v67
  v_mfma_f32_16x16x32_bf16 v[248:251], v[140:143], a[152:155], v[248:251]
  ds_read_b64_tr_b16 v[132:133], v161 offset:12544
  v_exp_f32 v69, v69
  v_mfma_f32_16x16x32_bf16 v[252:255], v[172:175], a[152:155], v[252:255]
  s_waitcnt lgkmcnt(15)
  ds_read_b64_tr_b16 v[134:135], v161 offset:14592
  v_fma_f32 v71, v71, s25, -v122
  v_exp_f32 v70, v70
  v_mfma_f32_16x16x32_bf16 v[176:179], v[144:147], a[12:15], v[176:179]
  s_waitcnt lgkmcnt(14)
  ds_read_b64_tr_b16 v[136:137], v162 offset:12544
  v_cvt_pk_bf16_f32 v66, v68, v69
  v_exp_f32 v71, v71
  v_mfma_f32_16x16x32_bf16 v[180:183], v[148:151], a[12:15], v[180:183]
  s_waitcnt lgkmcnt(12)
  ds_read_b64_tr_b16 v[138:139], v162 offset:14592
  v_fma_f32 v72, v72, s25, -v123
  v_cvt_pk_bf16_f32 v67, v70, v71
  v_mfma_f32_16x16x32_bf16 v[184:187], v[152:155], a[12:15], v[184:187]
  s_waitcnt lgkmcnt(10)
  ds_read_b64_tr_b16 v[140:141], v163 offset:12544
  v_fma_f32 v73, v73, s25, -v123
  v_exp_f32 v72, v72
  v_mfma_f32_16x16x32_bf16 v[188:191], v[156:159], a[12:15], v[188:191]
  ds_read_b64_tr_b16 v[142:143], v163 offset:14592
  v_fma_f32 v74, v74, s25, -v123
  v_exp_f32 v73, v73
  v_mfma_f32_16x16x32_bf16 v[192:195], v[172:175], a[12:15], v[192:195]
  ds_write_b128 v114, v[64:67] offset:26624
  v_fma_f32 v75, v75, s25, -v123
  v_exp_f32 v74, v74
  v_mfma_f32_16x16x32_bf16 v[196:199], v[144:147], a[60:63], v[196:199]
  v_fma_f32 v76, v76, s25, -v123
  v_cvt_pk_bf16_f32 v72, v72, v73
  v_mfma_f32_16x16x32_bf16 v[200:203], v[148:151], a[60:63], v[200:203]
  v_exp_f32 v75, v75
  v_mfma_f32_16x16x32_bf16 v[204:207], v[152:155], a[60:63], v[204:207]
  v_fma_f32 v77, v77, s25, -v123
  v_exp_f32 v76, v76
  v_mfma_f32_16x16x32_bf16 v[208:211], v[156:159], a[60:63], v[208:211]
  v_fma_f32 v78, v78, s25, -v123
  v_cvt_pk_bf16_f32 v73, v74, v75
  v_mfma_f32_16x16x32_bf16 v[212:215], v[172:175], a[60:63], v[212:215]
  v_exp_f32 v77, v77
  v_mfma_f32_16x16x32_bf16 v[216:219], v[144:147], a[108:111], v[216:219]
  v_fma_f32 v79, v79, s25, -v123
  v_exp_f32 v78, v78
  v_mfma_f32_16x16x32_bf16 v[220:223], v[148:151], a[108:111], v[220:223]
  v_cvt_pk_bf16_f32 v74, v76, v77
  v_exp_f32 v79, v79
  v_mfma_f32_16x16x32_bf16 v[224:227], v[152:155], a[108:111], v[224:227]
  v_fma_f32 v80, v80, s25, -v123
  v_cvt_pk_bf16_f32 v75, v78, v79
  v_mfma_f32_16x16x32_bf16 v[228:231], v[156:159], a[108:111], v[228:231]
  ds_write_b128 v114, v[72:75] offset:36864
  v_fma_f32 v81, v81, s25, -v123
  v_exp_f32 v80, v80
  v_mfma_f32_16x16x32_bf16 v[232:235], v[172:175], a[108:111], v[232:235]
  v_fma_f32 v82, v82, s25, -v123
  v_exp_f32 v81, v81
  v_mfma_f32_16x16x32_bf16 v[236:239], v[144:147], a[156:159], v[236:239]
  ds_read_b64_tr_b16 v[144:145], v160 offset:16896
  v_fma_f32 v83, v83, s25, -v123
  v_exp_f32 v82, v82
  v_mfma_f32_16x16x32_bf16 v[240:243], v[148:151], a[156:159], v[240:243]
  ds_read_b64_tr_b16 v[146:147], v160 offset:18944
  v_fma_f32 v84, v84, s25, -v123
  v_cvt_pk_bf16_f32 v80, v80, v81
  v_mfma_f32_16x16x32_bf16 v[244:247], v[152:155], a[156:159], v[244:247]
  ds_read_b64_tr_b16 v[148:149], v161 offset:16896
  v_exp_f32 v83, v83
  v_mfma_f32_16x16x32_bf16 v[248:251], v[156:159], a[156:159], v[248:251]
  ds_read_b64_tr_b16 v[150:151], v161 offset:18944
  v_fma_f32 v85, v85, s25, -v123
  v_exp_f32 v84, v84
  v_mfma_f32_16x16x32_bf16 v[252:255], v[172:175], a[156:159], v[252:255]
  s_waitcnt lgkmcnt(12)
  ds_read_b64_tr_b16 v[152:153], v162 offset:16896
  v_fma_f32 v86, v86, s25, -v123
  v_cvt_pk_bf16_f32 v81, v82, v83
  v_mfma_f32_16x16x32_bf16 v[176:179], v[128:131], a[16:19], v[176:179]
  s_waitcnt lgkmcnt(11)
  ds_read_b64_tr_b16 v[154:155], v162 offset:18944
  v_exp_f32 v85, v85
  v_mfma_f32_16x16x32_bf16 v[180:183], v[132:135], a[16:19], v[180:183]
  s_waitcnt lgkmcnt(10)
  ds_read_b64_tr_b16 v[156:157], v163 offset:16896
  v_fma_f32 v87, v87, s25, -v123
  v_exp_f32 v86, v86
  v_mfma_f32_16x16x32_bf16 v[184:187], v[136:139], a[16:19], v[184:187]
  s_waitcnt lgkmcnt(9)
  ds_read_b64_tr_b16 v[158:159], v163 offset:18944
  v_cvt_pk_bf16_f32 v82, v84, v85
  v_exp_f32 v87, v87
  v_mfma_f32_16x16x32_bf16 v[188:191], v[140:143], a[16:19], v[188:191]
  v_fma_f32 v88, v88, s25, -v123
  v_cvt_pk_bf16_f32 v83, v86, v87
  v_mfma_f32_16x16x32_bf16 v[192:195], v[172:175], a[16:19], v[192:195]
  ds_write_b128 v114, v[80:83] offset:37888
  v_fma_f32 v89, v89, s25, -v123
  v_exp_f32 v88, v88
  v_mfma_f32_16x16x32_bf16 v[196:199], v[128:131], a[64:67], v[196:199]
  v_fma_f32 v90, v90, s25, -v123
  v_exp_f32 v89, v89
  v_mfma_f32_16x16x32_bf16 v[200:203], v[132:135], a[64:67], v[200:203]
  v_fma_f32 v91, v91, s25, -v123
  v_exp_f32 v90, v90
  v_mfma_f32_16x16x32_bf16 v[204:207], v[136:139], a[64:67], v[204:207]
  v_fma_f32 v92, v92, s25, -v123
  v_cvt_pk_bf16_f32 v88, v88, v89
  v_mfma_f32_16x16x32_bf16 v[208:211], v[140:143], a[64:67], v[208:211]
  v_exp_f32 v91, v91
  v_mfma_f32_16x16x32_bf16 v[212:215], v[172:175], a[64:67], v[212:215]
  v_fma_f32 v93, v93, s25, -v123
  v_exp_f32 v92, v92
  v_mfma_f32_16x16x32_bf16 v[216:219], v[128:131], a[112:115], v[216:219]
  v_fma_f32 v94, v94, s25, -v123
  v_cvt_pk_bf16_f32 v89, v90, v91
  v_mfma_f32_16x16x32_bf16 v[220:223], v[132:135], a[112:115], v[220:223]
  v_exp_f32 v93, v93
  v_mfma_f32_16x16x32_bf16 v[224:227], v[136:139], a[112:115], v[224:227]
  v_fma_f32 v95, v95, s25, -v123
  v_exp_f32 v94, v94
  v_mfma_f32_16x16x32_bf16 v[228:231], v[140:143], a[112:115], v[228:231]
  v_cvt_pk_bf16_f32 v90, v92, v93
  v_exp_f32 v95, v95
  v_mfma_f32_16x16x32_bf16 v[232:235], v[172:175], a[112:115], v[232:235]
  v_cvt_pk_bf16_f32 v91, v94, v95
  v_mfma_f32_16x16x32_bf16 v[236:239], v[128:131], a[160:163], v[236:239]
  ds_read_b64_tr_b16 v[128:129], v160 offset:20992
  v_mfma_f32_16x16x32_bf16 v[240:243], v[132:135], a[160:163], v[240:243]
  ds_read_b64_tr_b16 v[130:131], v160 offset:23040
  v_mfma_f32_16x16x32_bf16 v[244:247], v[136:139], a[160:163], v[244:247]
  ds_read_b64_tr_b16 v[132:133], v161 offset:20992
  v_mfma_f32_16x16x32_bf16 v[248:251], v[140:143], a[160:163], v[248:251]
  ds_read_b64_tr_b16 v[134:135], v161 offset:23040
  v_mfma_f32_16x16x32_bf16 v[252:255], v[172:175], a[160:163], v[252:255]
  s_waitcnt lgkmcnt(11)
  ds_read_b64_tr_b16 v[136:137], v162 offset:20992
  v_mfma_f32_16x16x32_bf16 v[176:179], v[144:147], a[20:23], v[176:179]
  s_waitcnt lgkmcnt(10)
  ds_read_b64_tr_b16 v[138:139], v162 offset:23040
  v_mfma_f32_16x16x32_bf16 v[180:183], v[148:151], a[20:23], v[180:183]
  s_waitcnt lgkmcnt(9)
  ds_read_b64_tr_b16 v[140:141], v163 offset:20992
  v_mfma_f32_16x16x32_bf16 v[184:187], v[152:155], a[20:23], v[184:187]
  s_waitcnt lgkmcnt(8)
  ds_read_b64_tr_b16 v[142:143], v163 offset:23040
  v_mfma_f32_16x16x32_bf16 v[188:191], v[156:159], a[20:23], v[188:191]
  ds_write_b128 v114, v[88:91] offset:38912
  v_mfma_f32_16x16x32_bf16 v[192:195], v[172:175], a[20:23], v[192:195]
  v_mfma_f32_16x16x32_bf16 v[196:199], v[144:147], a[68:71], v[196:199]
  v_mfma_f32_16x16x32_bf16 v[200:203], v[148:151], a[68:71], v[200:203]
  s_waitcnt lgkmcnt(0) vmcnt(0)
  s_barrier
  v_mfma_f32_16x16x32_bf16 v[204:207], v[152:155], a[68:71], v[204:207]
  v_mfma_f32_16x16x32_bf16 v[208:211], v[156:159], a[68:71], v[208:211]
  v_mfma_f32_16x16x32_bf16 v[212:215], v[172:175], a[68:71], v[212:215]
  v_mfma_f32_16x16x32_bf16 v[216:219], v[144:147], a[116:119], v[216:219]
  v_mfma_f32_16x16x32_bf16 v[220:223], v[148:151], a[116:119], v[220:223]
  v_mfma_f32_16x16x32_bf16 v[224:227], v[152:155], a[116:119], v[224:227]
  v_mfma_f32_16x16x32_bf16 v[228:231], v[156:159], a[116:119], v[228:231]
  v_mfma_f32_16x16x32_bf16 v[232:235], v[172:175], a[116:119], v[232:235]
  v_mfma_f32_16x16x32_bf16 v[236:239], v[144:147], a[164:167], v[236:239]
  ds_read_b64_tr_b16 v[144:145], v160 offset:25344
  v_mfma_f32_16x16x32_bf16 v[240:243], v[148:151], a[164:167], v[240:243]
  ds_read_b64_tr_b16 v[146:147], v160 offset:27392
  v_mfma_f32_16x16x32_bf16 v[244:247], v[152:155], a[164:167], v[244:247]
  ds_read_b64_tr_b16 v[148:149], v161 offset:25344
  v_mfma_f32_16x16x32_bf16 v[248:251], v[156:159], a[164:167], v[248:251]
  ds_read_b64_tr_b16 v[150:151], v161 offset:27392
  v_mfma_f32_16x16x32_bf16 v[252:255], v[172:175], a[164:167], v[252:255]
  ds_read_b64_tr_b16 v[152:153], v162 offset:25344
  v_mfma_f32_16x16x32_bf16 v[176:179], v[128:131], a[24:27], v[176:179]
  ds_read_b64_tr_b16 v[154:155], v162 offset:27392
  v_mfma_f32_16x16x32_bf16 v[180:183], v[132:135], a[24:27], v[180:183]
  ds_read_b64_tr_b16 v[156:157], v163 offset:25344
  v_mfma_f32_16x16x32_bf16 v[184:187], v[136:139], a[24:27], v[184:187]
  ds_read_b64_tr_b16 v[158:159], v163 offset:27392
  v_mfma_f32_16x16x32_bf16 v[188:191], v[140:143], a[24:27], v[188:191]
  s_mov_b32 s36, 49280
  v_mfma_f32_16x16x32_bf16 v[192:195], v[172:175], a[24:27], v[192:195]
  ds_read_b128 a[240:243], v115 offset:49152
  s_add_u32 m0, s29, 59136
  v_mfma_f32_16x16x32_bf16 v[196:199], v[128:131], a[72:75], v[196:199]
  v_mfma_f32_16x16x32_bf16 v[200:203], v[132:135], a[72:75], v[200:203]
  buffer_load_dwordx4 v119, s[16:19], s36 offen nt lds
  v_mfma_f32_16x16x32_bf16 v[204:207], v[136:139], a[72:75], v[204:207]
  ds_read_b128 a[244:247], v115 offset:50176
  v_mfma_f32_16x16x32_bf16 v[208:211], v[140:143], a[72:75], v[208:211]
  v_mfma_f32_16x16x32_bf16 v[212:215], v[172:175], a[72:75], v[212:215]
  v_mfma_f32_16x16x32_bf16 v[216:219], v[128:131], a[120:123], v[216:219]
  ds_read_b128 a[248:251], v115 offset:51200
  v_mfma_f32_16x16x32_bf16 v[220:223], v[132:135], a[120:123], v[220:223]
  v_mfma_f32_16x16x32_bf16 v[224:227], v[136:139], a[120:123], v[224:227]
  s_mov_b32 s37, 65664
  v_mfma_f32_16x16x32_bf16 v[228:231], v[140:143], a[120:123], v[228:231]
  s_add_u32 m0, s29, 63232
  v_mfma_f32_16x16x32_bf16 v[232:235], v[172:175], a[120:123], v[232:235]
  ds_read_b128 a[252:255], v115 offset:52224
  v_mfma_f32_16x16x32_bf16 v[236:239], v[128:131], a[168:171], v[236:239]
  buffer_load_dwordx4 v119, s[16:19], s37 offen nt lds
  v_mfma_f32_16x16x32_bf16 v[240:243], v[132:135], a[168:171], v[240:243]
  ds_read_b64_tr_b16 v[128:129], v160 offset:29440
  v_mfma_f32_16x16x32_bf16 v[244:247], v[136:139], a[168:171], v[244:247]
  ds_read_b128 v[0:3], v115 offset:53248
  v_mfma_f32_16x16x32_bf16 v[248:251], v[140:143], a[168:171], v[248:251]
  ds_read_b64_tr_b16 v[130:131], v160 offset:31488
  v_subrev_u32 v160, 25344, v160
  v_mfma_f32_16x16x32_bf16 v[252:255], v[172:175], a[168:171], v[252:255]
  s_waitcnt lgkmcnt(13)
  ds_read_b64_tr_b16 v[132:133], v161 offset:29440
  v_mfma_f32_16x16x32_bf16 v[176:179], v[144:147], a[28:31], v[176:179]
  s_waitcnt lgkmcnt(12)
  ds_read_b128 v[4:7], v115 offset:54272
  v_mfma_f32_16x16x32_bf16 v[180:183], v[148:151], a[28:31], v[180:183]
  s_waitcnt lgkmcnt(11)
  ds_read_b64_tr_b16 v[134:135], v161 offset:31488
  s_mov_b32 s38, 82048
  v_subrev_u32 v161, 25344, v161
  v_mfma_f32_16x16x32_bf16 v[184:187], v[152:155], a[28:31], v[184:187]
  s_waitcnt lgkmcnt(10)
  ds_read_b64_tr_b16 v[136:137], v162 offset:29440
  s_add_u32 m0, s29, 67328
  v_mfma_f32_16x16x32_bf16 v[188:191], v[156:159], a[28:31], v[188:191]
  ds_read_b64_tr_b16 v[138:139], v162 offset:31488
  v_subrev_u32 v162, 25344, v162
  v_mfma_f32_16x16x32_bf16 v[192:195], v[172:175], a[28:31], v[192:195]
  ds_read_b128 v[8:11], v115 offset:55296
  v_mfma_f32_16x16x32_bf16 v[196:199], v[144:147], a[76:79], v[196:199]
  buffer_load_dwordx4 v119, s[16:19], s38 offen nt lds
  v_mfma_f32_16x16x32_bf16 v[200:203], v[148:151], a[76:79], v[200:203]
  ds_read_b64_tr_b16 v[140:141], v163 offset:29440
  v_mfma_f32_16x16x32_bf16 v[204:207], v[152:155], a[76:79], v[204:207]
  ds_read_b128 v[12:15], v115 offset:56320
  v_mfma_f32_16x16x32_bf16 v[208:211], v[156:159], a[76:79], v[208:211]
  ds_read_b64_tr_b16 v[142:143], v163 offset:31488
  v_subrev_u32 v163, 25344, v163
  v_mfma_f32_16x16x32_bf16 v[212:215], v[172:175], a[76:79], v[212:215]
  v_mfma_f32_16x16x32_bf16 v[216:219], v[144:147], a[124:127], v[216:219]
  ds_read_b128 v[16:19], v115 offset:57344
  s_mov_b32 s39, 98432
  v_mfma_f32_16x16x32_bf16 v[220:223], v[148:151], a[124:127], v[220:223]
  s_add_u32 m0, s29, 71424
  v_mfma_f32_16x16x32_bf16 v[224:227], v[152:155], a[124:127], v[224:227]
  v_mfma_f32_16x16x32_bf16 v[228:231], v[156:159], a[124:127], v[228:231]
  buffer_load_dwordx4 v119, s[16:19], s39 offen nt lds
  v_mfma_f32_16x16x32_bf16 v[232:235], v[172:175], a[124:127], v[232:235]
  ds_read_b128 v[20:23], v115 offset:58368
  v_mfma_f32_16x16x32_bf16 v[236:239], v[144:147], a[172:175], v[236:239]
  ds_read_b64_tr_b16 v[144:145], v160 offset:0
  v_mfma_f32_16x16x32_bf16 v[240:243], v[148:151], a[172:175], v[240:243]
  ds_read_b64_tr_b16 v[146:147], v160 offset:2048
  v_mfma_f32_16x16x32_bf16 v[244:247], v[152:155], a[172:175], v[244:247]
  ds_read_b128 v[24:27], v115 offset:59392
  v_mfma_f32_16x16x32_bf16 v[248:251], v[156:159], a[172:175], v[248:251]
  ds_read_b64_tr_b16 v[148:149], v161 offset:0
  v_mfma_f32_16x16x32_bf16 v[252:255], v[172:175], a[172:175], v[252:255]
  s_waitcnt lgkmcnt(15)
  ds_read_b64_tr_b16 v[150:151], v161 offset:2048
  s_mov_b32 s40, 114816
  v_mfma_f32_16x16x32_bf16 v[176:179], v[128:131], a[32:35], v[176:179]
  s_waitcnt lgkmcnt(13)
  ds_read_b128 v[28:31], v115 offset:60416
  s_add_u32 m0, s29, 75520
  v_mfma_f32_16x16x32_bf16 v[180:183], v[132:135], a[32:35], v[180:183]
  s_waitcnt lgkmcnt(12)
  ds_read_b64_tr_b16 v[152:153], v162 offset:0
  v_mfma_f32_16x16x32_bf16 v[184:187], v[136:139], a[32:35], v[184:187]
  s_waitcnt lgkmcnt(9)
  buffer_load_dwordx4 v119, s[16:19], s40 offen nt lds
  v_mfma_f32_16x16x32_bf16 v[188:191], v[140:143], a[32:35], v[188:191]
  ds_read_b64_tr_b16 v[154:155], v162 offset:2048
  v_mfma_f32_16x16x32_bf16 v[192:195], v[172:175], a[32:35], v[192:195]
  ds_read_b64_tr_b16 v[156:157], v163 offset:0
  v_mfma_f32_16x16x32_bf16 v[196:199], v[128:131], a[80:83], v[196:199]
  ds_read_b64_tr_b16 v[158:159], v163 offset:2048
  v_mfma_f32_16x16x32_bf16 v[200:203], v[132:135], a[80:83], v[200:203]
  v_mfma_f32_16x16x32_bf16 v[204:207], v[136:139], a[80:83], v[204:207]
  s_waitcnt lgkmcnt(4)
  s_barrier
  v_mfma_f32_16x16x32_bf16 v[208:211], v[140:143], a[80:83], v[208:211]
  s_mov_b32 s41, 131200
  v_mfma_f32_16x16x32_bf16 v[212:215], v[172:175], a[80:83], v[212:215]
  s_add_u32 m0, s29, 79616
  v_mfma_f32_16x16x32_bf16 v[216:219], v[128:131], a[128:131], v[216:219]
  v_mfma_f32_16x16x32_bf16 v[220:223], v[132:135], a[128:131], v[220:223]
  buffer_load_dwordx4 v119, s[16:19], s41 offen nt lds
  v_mfma_f32_16x16x32_bf16 v[224:227], v[136:139], a[128:131], v[224:227]
  v_mfma_f32_16x16x32_bf16 v[228:231], v[140:143], a[128:131], v[228:231]
  v_mfma_f32_16x16x32_bf16 v[232:235], v[172:175], a[128:131], v[232:235]
  v_mfma_f32_16x16x32_bf16 v[236:239], v[128:131], a[176:179], v[236:239]
  ds_read_b64_tr_b16 v[128:129], v160 offset:4096
  v_mfma_f32_16x16x32_bf16 v[240:243], v[132:135], a[176:179], v[240:243]
  ds_read_b64_tr_b16 v[130:131], v160 offset:6144
  v_mfma_f32_16x16x32_bf16 v[244:247], v[136:139], a[176:179], v[244:247]
  ds_read_b64_tr_b16 v[132:133], v161 offset:4096
  s_mov_b32 s42, 147584
  v_mfma_f32_16x16x32_bf16 v[248:251], v[140:143], a[176:179], v[248:251]
  ds_read_b64_tr_b16 v[134:135], v161 offset:6144
  s_add_u32 m0, s29, 83712
  v_mfma_f32_16x16x32_bf16 v[252:255], v[172:175], a[176:179], v[252:255]
  ds_read_b64_tr_b16 v[136:137], v162 offset:4096
  v_mfma_f32_16x16x32_bf16 v[176:179], v[144:147], a[36:39], v[176:179]
  buffer_load_dwordx4 v119, s[16:19], s42 offen nt lds
  v_mfma_f32_16x16x32_bf16 v[180:183], v[148:151], a[36:39], v[180:183]
  s_waitcnt lgkmcnt(7)
  ds_read_b64_tr_b16 v[138:139], v162 offset:6144
  v_mfma_f32_16x16x32_bf16 v[184:187], v[152:155], a[36:39], v[184:187]
  s_waitcnt lgkmcnt(6)
  ds_read_b64_tr_b16 v[140:141], v163 offset:4096
  v_mfma_f32_16x16x32_bf16 v[188:191], v[156:159], a[36:39], v[188:191]
  ds_read_b64_tr_b16 v[142:143], v163 offset:6144
  v_mfma_f32_16x16x32_bf16 v[192:195], v[172:175], a[36:39], v[192:195]
  v_mfma_f32_16x16x32_bf16 v[196:199], v[144:147], a[84:87], v[196:199]
  v_mfma_f32_16x16x32_bf16 v[200:203], v[148:151], a[84:87], v[200:203]
  s_mov_b32 s43, 163968
  v_mfma_f32_16x16x32_bf16 v[204:207], v[152:155], a[84:87], v[204:207]
  s_add_u32 m0, s29, 87808
  v_mfma_f32_16x16x32_bf16 v[208:211], v[156:159], a[84:87], v[208:211]
  v_mfma_f32_16x16x32_bf16 v[212:215], v[172:175], a[84:87], v[212:215]
  buffer_load_dwordx4 v119, s[16:19], s43 offen nt lds
  v_mfma_f32_16x16x32_bf16 v[216:219], v[144:147], a[132:135], v[216:219]
  v_mfma_f32_16x16x32_bf16 v[220:223], v[148:151], a[132:135], v[220:223]
  v_mfma_f32_16x16x32_bf16 v[224:227], v[152:155], a[132:135], v[224:227]
  v_mfma_f32_16x16x32_bf16 v[228:231], v[156:159], a[132:135], v[228:231]
  v_mfma_f32_16x16x32_bf16 v[232:235], v[172:175], a[132:135], v[232:235]
  v_mfma_f32_16x16x32_bf16 v[236:239], v[144:147], a[180:183], v[236:239]
  ds_read_b64_tr_b16 v[144:145], v160 offset:8448
  s_mov_b32 s44, 180352
  v_mfma_f32_16x16x32_bf16 v[240:243], v[148:151], a[180:183], v[240:243]
  ds_read_b64_tr_b16 v[146:147], v160 offset:10496
  s_add_u32 m0, s29, 91904
  v_add_u32 v160, 158464, v160
  v_mfma_f32_16x16x32_bf16 v[244:247], v[152:155], a[180:183], v[244:247]
  ds_read_b64_tr_b16 v[148:149], v161 offset:8448
  v_mfma_f32_16x16x32_bf16 v[248:251], v[156:159], a[180:183], v[248:251]
  buffer_load_dwordx4 v119, s[16:19], s44 offen nt lds
  v_mfma_f32_16x16x32_bf16 v[252:255], v[172:175], a[180:183], v[252:255]
  s_waitcnt lgkmcnt(9)
  ds_read_b64_tr_b16 v[150:151], v161 offset:10496
  v_add_u32 v161, 158464, v161
  v_mfma_f32_16x16x32_bf16 v[176:179], v[128:131], a[40:43], v[176:179]
  s_waitcnt lgkmcnt(8)
  ds_read_b64_tr_b16 v[152:153], v162 offset:8448
  v_mfma_f32_16x16x32_bf16 v[180:183], v[132:135], a[40:43], v[180:183]
  s_waitcnt lgkmcnt(7)
  ds_read_b64_tr_b16 v[154:155], v162 offset:10496
  v_add_u32 v162, 158464, v162
  v_mfma_f32_16x16x32_bf16 v[184:187], v[136:139], a[40:43], v[184:187]
  s_waitcnt lgkmcnt(6)
  ds_read_b64_tr_b16 v[156:157], v163 offset:8448
  v_mfma_f32_16x16x32_bf16 v[188:191], v[140:143], a[40:43], v[188:191]
  ds_read_b64_tr_b16 v[158:159], v163 offset:10496
  v_add_u32 v163, 158464, v163
  v_mfma_f32_16x16x32_bf16 v[192:195], v[172:175], a[40:43], v[192:195]
  s_mov_b32 s45, 256
  v_mfma_f32_16x16x32_bf16 v[196:199], v[128:131], a[88:91], v[196:199]
  s_add_u32 m0, s29, 96000
  v_mfma_f32_16x16x32_bf16 v[200:203], v[132:135], a[88:91], v[200:203]
  v_mfma_f32_16x16x32_bf16 v[204:207], v[136:139], a[88:91], v[204:207]
  buffer_load_dwordx4 v119, s[16:19], s45 offen nt lds
  v_mfma_f32_16x16x32_bf16 v[208:211], v[140:143], a[88:91], v[208:211]
  v_mfma_f32_16x16x32_bf16 v[212:215], v[172:175], a[88:91], v[212:215]
  v_mfma_f32_16x16x32_bf16 v[216:219], v[128:131], a[136:139], v[216:219]
  v_mfma_f32_16x16x32_bf16 v[220:223], v[132:135], a[136:139], v[220:223]
  v_mfma_f32_16x16x32_bf16 v[224:227], v[136:139], a[136:139], v[224:227]
  v_mfma_f32_16x16x32_bf16 v[228:231], v[140:143], a[136:139], v[228:231]
  s_mov_b32 s46, 16640
  v_mfma_f32_16x16x32_bf16 v[232:235], v[172:175], a[136:139], v[232:235]
  s_add_u32 m0, s29, 100096
  v_mfma_f32_16x16x32_bf16 v[236:239], v[128:131], a[184:187], v[236:239]
  ds_read_b64_tr_b16 v[128:129], v160 offset:0
  v_mfma_f32_16x16x32_bf16 v[240:243], v[132:135], a[184:187], v[240:243]
  buffer_load_dwordx4 v119, s[16:19], s46 offen nt lds
  v_mfma_f32_16x16x32_bf16 v[244:247], v[136:139], a[184:187], v[244:247]
  ds_read_b64_tr_b16 v[130:131], v160 offset:2048
  v_subrev_u32 v160, 133120, v160
  v_mfma_f32_16x16x32_bf16 v[248:251], v[140:143], a[184:187], v[248:251]
  ds_read_b64_tr_b16 v[132:133], v161 offset:0
  v_mfma_f32_16x16x32_bf16 v[252:255], v[172:175], a[184:187], v[252:255]
  s_waitcnt lgkmcnt(9)
  ds_read_b64_tr_b16 v[134:135], v161 offset:2048
  v_subrev_u32 v161, 133120, v161
  v_mfma_f32_16x16x32_bf16 v[176:179], v[144:147], a[44:47], v[176:179]
  s_waitcnt lgkmcnt(8)
  ds_read_b64_tr_b16 v[136:137], v162 offset:0
  v_mfma_f32_16x16x32_bf16 v[180:183], v[148:151], a[44:47], v[180:183]
  s_waitcnt lgkmcnt(7)
  ds_read_b64_tr_b16 v[138:139], v162 offset:2048
  v_subrev_u32 v162, 133120, v162
  v_mfma_f32_16x16x32_bf16 v[184:187], v[152:155], a[44:47], v[184:187]
  s_waitcnt lgkmcnt(6)
  ds_read_b64_tr_b16 v[140:141], v163 offset:0
  s_mov_b32 s47, 33024
  v_mfma_f32_16x16x32_bf16 v[188:191], v[156:159], a[44:47], v[188:191]
  ds_read_b64_tr_b16 v[142:143], v163 offset:2048
  s_add_u32 m0, s29, 104192
  v_subrev_u32 v163, 133120, v163
  v_mfma_f32_16x16x32_bf16 v[192:195], v[172:175], a[44:47], v[192:195]
  v_mfma_f32_16x16x32_bf16 v[196:199], v[144:147], a[92:95], v[196:199]
  buffer_load_dwordx4 v119, s[16:19], s47 offen nt lds
  v_mfma_f32_16x16x32_bf16 v[200:203], v[148:151], a[92:95], v[200:203]
  v_mfma_f32_16x16x32_bf16 v[204:207], v[152:155], a[92:95], v[204:207]
  v_mfma_f32_16x16x32_bf16 v[208:211], v[156:159], a[92:95], v[208:211]
  v_mfma_f32_16x16x32_bf16 v[212:215], v[172:175], a[92:95], v[212:215]
  v_mfma_f32_16x16x32_bf16 v[216:219], v[144:147], a[140:143], v[216:219]
  v_mfma_f32_16x16x32_bf16 v[220:223], v[148:151], a[140:143], v[220:223]
  v_rcp_f32 v96, v192
  v_mfma_f32_16x16x32_bf16 v[224:227], v[152:155], a[140:143], v[224:227]
  v_mul_f32 v176, v176, v96
  v_mul_f32 v177, v177, v96
  v_mfma_f32_16x16x32_bf16 v[228:231], v[156:159], a[140:143], v[228:231]
  v_mul_f32 v178, v178, v96
  v_mul_f32 v179, v179, v96
  v_mfma_f32_16x16x32_bf16 v[232:235], v[172:175], a[140:143], v[232:235]
  v_cvt_pk_bf16_f32 v176, v176, v177
  v_cvt_pk_bf16_f32 v177, v178, v179
  v_mfma_f32_16x16x32_bf16 v[236:239], v[144:147], a[188:191], v[236:239]
  ds_read_b64_tr_b16 v[144:145], v160 offset:0
  v_mul_f32 v180, v180, v96
  v_mfma_f32_16x16x32_bf16 v[240:243], v[148:151], a[188:191], v[240:243]
  ds_read_b64_tr_b16 v[146:147], v160 offset:2048
  v_mul_f32 v181, v181, v96
  v_mfma_f32_16x16x32_bf16 v[244:247], v[152:155], a[188:191], v[244:247]
  ds_read_b64_tr_b16 v[148:149], v161 offset:0
  s_mov_b32 s32, 49408
  v_mul_f32 v182, v182, v96
  v_mfma_f32_16x16x32_bf16 v[248:251], v[156:159], a[188:191], v[248:251]
  ds_read_b64_tr_b16 v[150:151], v161 offset:2048
  s_add_u32 m0, s29, 108288
  v_mul_f32 v183, v183, v96
  v_mfma_f32_16x16x32_bf16 v[252:255], v[172:175], a[188:191], v[252:255]
  s_waitcnt lgkmcnt(10)
  ds_read_b64_tr_b16 v[152:153], v162 offset:0
  v_cvt_pk_bf16_f32 v178, v180, v181
  v_mfma_f32_16x16x32_bf16 v[164:167], v[128:131], a[192:195], 0
  s_waitcnt lgkmcnt(9)
  buffer_load_dwordx4 v119, s[16:19], s32 offen nt lds
  s_mov_b32 s44, 0
  v_cvt_pk_bf16_f32 v179, v182, v183
  v_mul_f32 v184, v184, v96
  v_mfma_f32_16x16x32_bf16 v[32:35], v[132:135], a[192:195], 0
  s_waitcnt lgkmcnt(7)
  ds_read_b64_tr_b16 v[154:155], v162 offset:2048
  v_mul_f32 v185, v185, v96
  v_mfma_f32_16x16x32_bf16 v[36:39], v[136:139], a[192:195], 0
  s_waitcnt lgkmcnt(6)
  ds_read_b64_tr_b16 v[156:157], v163 offset:0
  v_mul_f32 v186, v186, v96
  v_mfma_f32_16x16x32_bf16 v[40:43], v[140:143], a[192:195], 0
  ds_read_b64_tr_b16 v[158:159], v163 offset:2048
  v_mul_f32 v187, v187, v96
  v_mfma_f32_16x16x32_bf16 v[44:47], v[172:175], a[192:195], 0
  v_permlane16_swap_b32 v176, v178
  v_mfma_f32_16x16x32_bf16 v[48:51], v[128:131], a[240:243], 0
  ds_read_b64_tr_b16 v[128:129], v160 offset:4096
  v_cvt_pk_bf16_f32 v184, v184, v185
  v_mfma_f32_16x16x32_bf16 v[52:55], v[132:135], a[240:243], 0
  ds_read_b64_tr_b16 v[130:131], v160 offset:6144
  v_cvt_pk_bf16_f32 v185, v186, v187
  v_mfma_f32_16x16x32_bf16 v[56:59], v[136:139], a[240:243], 0
  ds_read_b64_tr_b16 v[132:133], v161 offset:4096
  v_mul_f32 v188, v188, v96
  v_mfma_f32_16x16x32_bf16 v[60:63], v[140:143], a[240:243], 0
  ds_read_b64_tr_b16 v[134:135], v161 offset:6144
  v_mul_f32 v189, v189, v96
  v_mfma_f32_16x16x32_bf16 v[64:67], v[172:175], a[240:243], 0
  s_waitcnt lgkmcnt(10)
  ds_read_b64_tr_b16 v[136:137], v162 offset:4096
  v_mul_f32 v190, v190, v96
  v_mfma_f32_16x16x32_bf16 v[164:167], v[144:147], a[196:199], v[164:167]
  s_waitcnt lgkmcnt(9)
  ds_read_b64_tr_b16 v[138:139], v162 offset:6144
  s_mov_b32 s33, 65792
  v_mul_f32 v191, v191, v96
  v_mfma_f32_16x16x32_bf16 v[32:35], v[148:151], a[196:199], v[32:35]
  s_waitcnt lgkmcnt(8)
  ds_read_b64_tr_b16 v[140:141], v163 offset:4096
  s_add_u32 m0, s29, 112384
  v_cvt_pk_bf16_f32 v186, v188, v189
  v_mfma_f32_16x16x32_bf16 v[36:39], v[152:155], a[196:199], v[36:39]
  s_waitcnt lgkmcnt(7)
  ds_read_b64_tr_b16 v[142:143], v163 offset:6144
  v_cvt_pk_bf16_f32 v187, v190, v191
  v_mfma_f32_16x16x32_bf16 v[40:43], v[156:159], a[196:199], v[40:43]
  buffer_load_dwordx4 v119, s[16:19], s33 offen nt lds
  v_permlane16_swap_b32 v177, v179
  v_mfma_f32_16x16x32_bf16 v[44:47], v[172:175], a[196:199], v[44:47]
  s_mov_b32 s45, 4096
  v_permlane16_swap_b32 v184, v186
  v_mfma_f32_16x16x32_bf16 v[48:51], v[144:147], a[244:247], v[48:51]
  ds_read_b64_tr_b16 v[144:145], v160 offset:8448
  v_mov_b32 v180, v184
  v_mfma_f32_16x16x32_bf16 v[52:55], v[148:151], a[244:247], v[52:55]
  ds_read_b64_tr_b16 v[146:147], v160 offset:10496
  v_mov_b32_dpp v184, v176 row_ror:8 row_mask:0xf bank_mask:0x3
  v_mfma_f32_16x16x32_bf16 v[56:59], v[152:155], a[244:247], v[56:59]
  ds_read_b64_tr_b16 v[148:149], v161 offset:8448
  v_mov_b32_dpp v176, v180 row_ror:8 row_mask:0xf bank_mask:0xc
  v_mfma_f32_16x16x32_bf16 v[60:63], v[156:159], a[244:247], v[60:63]
  ds_read_b64_tr_b16 v[150:151], v161 offset:10496
  v_mov_b32 v182, v186
  v_mfma_f32_16x16x32_bf16 v[64:67], v[172:175], a[244:247], v[64:67]
  s_waitcnt lgkmcnt(10)
  ds_read_b64_tr_b16 v[152:153], v162 offset:8448
  v_mov_b32_dpp v186, v178 row_ror:8 row_mask:0xf bank_mask:0x3
  v_mfma_f32_16x16x32_bf16 v[164:167], v[128:131], a[200:203], v[164:167]
  s_waitcnt lgkmcnt(9)
  ds_read_b64_tr_b16 v[154:155], v162 offset:10496
  v_mov_b32_dpp v178, v182 row_ror:8 row_mask:0xf bank_mask:0xc
  v_mfma_f32_16x16x32_bf16 v[32:35], v[132:135], a[200:203], v[32:35]
  s_waitcnt lgkmcnt(8)
  ds_read_b64_tr_b16 v[156:157], v163 offset:8448
  v_mfma_f32_16x16x32_bf16 v[36:39], v[136:139], a[200:203], v[36:39]
  s_waitcnt lgkmcnt(7)
  ds_read_b64_tr_b16 v[158:159], v163 offset:10496
  v_mfma_f32_16x16x32_bf16 v[40:43], v[140:143], a[200:203], v[40:43]
  v_permlane16_swap_b32 v185, v187
  v_mfma_f32_16x16x32_bf16 v[44:47], v[172:175], a[200:203], v[44:47]
  s_mov_b32 s34, 82176
  v_mov_b32 v181, v185
  v_mov_b32_dpp v185, v177 row_ror:8 row_mask:0xf bank_mask:0x3
  v_mfma_f32_16x16x32_bf16 v[48:51], v[128:131], a[248:251], v[48:51]
  ds_read_b64_tr_b16 v[128:129], v160 offset:12544
  s_add_u32 m0, s29, 116480
  v_mov_b32_dpp v177, v181 row_ror:8 row_mask:0xf bank_mask:0xc
  v_mfma_f32_16x16x32_bf16 v[52:55], v[132:135], a[248:251], v[52:55]
  ds_read_b64_tr_b16 v[130:131], v160 offset:14592
  v_mov_b32 v183, v187
  v_mfma_f32_16x16x32_bf16 v[56:59], v[136:139], a[248:251], v[56:59]
  buffer_load_dwordx4 v119, s[16:19], s34 offen nt lds
  v_mov_b32_dpp v187, v179 row_ror:8 row_mask:0xf bank_mask:0x3
  v_mov_b32_dpp v179, v183 row_ror:8 row_mask:0xf bank_mask:0xc
  v_mfma_f32_16x16x32_bf16 v[60:63], v[140:143], a[248:251], v[60:63]
  buffer_store_dwordx4 v[176:179], v169, s[20:23], s44 offen nt
  s_mov_b32 s46, 32768
  v_rcp_f32 v97, v212
  v_mfma_f32_16x16x32_bf16 v[64:67], v[172:175], a[248:251], v[64:67]
  s_waitcnt lgkmcnt(8)
  buffer_store_dwordx4 v[184:187], v169, s[20:23], s45 offen nt
  v_mul_f32 v196, v196, v97
  v_mul_f32 v197, v197, v97
  v_mfma_f32_16x16x32_bf16 v[164:167], v[144:147], a[204:207], v[164:167]
  s_waitcnt lgkmcnt(6)
  ds_read_b64_tr_b16 v[132:133], v161 offset:12544
  v_mul_f32 v198, v198, v97
  v_mfma_f32_16x16x32_bf16 v[32:35], v[148:151], a[204:207], v[32:35]
  s_waitcnt lgkmcnt(5)
  ds_read_b64_tr_b16 v[134:135], v161 offset:14592
  v_mul_f32 v199, v199, v97
  v_mfma_f32_16x16x32_bf16 v[36:39], v[152:155], a[204:207], v[36:39]
  s_waitcnt lgkmcnt(4)
  ds_read_b64_tr_b16 v[136:137], v162 offset:12544
  v_cvt_pk_bf16_f32 v196, v196, v197
  v_mfma_f32_16x16x32_bf16 v[40:43], v[156:159], a[204:207], v[40:43]
  ds_read_b64_tr_b16 v[138:139], v162 offset:14592
  v_cvt_pk_bf16_f32 v197, v198, v199
  v_mfma_f32_16x16x32_bf16 v[44:47], v[172:175], a[204:207], v[44:47]
  ds_read_b64_tr_b16 v[140:141], v163 offset:12544
  v_mul_f32 v200, v200, v97
  v_mfma_f32_16x16x32_bf16 v[48:51], v[144:147], a[252:255], v[48:51]
  ds_read_b64_tr_b16 v[142:143], v163 offset:14592
  v_mul_f32 v201, v201, v97
  v_mfma_f32_16x16x32_bf16 v[52:55], v[148:151], a[252:255], v[52:55]
  ds_read_b64_tr_b16 v[144:145], v160 offset:16896
  v_mul_f32 v202, v202, v97
  v_mfma_f32_16x16x32_bf16 v[56:59], v[152:155], a[252:255], v[56:59]
  ds_read_b64_tr_b16 v[146:147], v160 offset:18944
  s_mov_b32 s35, 98560
  v_mul_f32 v203, v203, v97
  v_mfma_f32_16x16x32_bf16 v[60:63], v[156:159], a[252:255], v[60:63]
  ds_read_b64_tr_b16 v[148:149], v161 offset:16896
  s_add_u32 m0, s29, 120576
  v_cvt_pk_bf16_f32 v198, v200, v201
  v_mfma_f32_16x16x32_bf16 v[64:67], v[172:175], a[252:255], v[64:67]
  s_waitcnt lgkmcnt(9)
  ds_read_b64_tr_b16 v[150:151], v161 offset:18944
  v_cvt_pk_bf16_f32 v199, v202, v203
  v_mfma_f32_16x16x32_bf16 v[164:167], v[128:131], a[208:211], v[164:167]
  s_waitcnt lgkmcnt(8)
  buffer_load_dwordx4 v119, s[16:19], s35 offen nt lds
  v_mul_f32 v204, v204, v97
  v_mul_f32 v205, v205, v97
  v_mfma_f32_16x16x32_bf16 v[32:35], v[132:135], a[208:211], v[32:35]
  s_waitcnt lgkmcnt(6)
  ds_read_b64_tr_b16 v[152:153], v162 offset:16896
  v_mul_f32 v206, v206, v97
  v_mfma_f32_16x16x32_bf16 v[36:39], v[136:139], a[208:211], v[36:39]
  s_waitcnt lgkmcnt(5)
  ds_read_b64_tr_b16 v[154:155], v162 offset:18944
  s_mov_b32 s47, 36864
  v_mul_f32 v207, v207, v97
  v_mfma_f32_16x16x32_bf16 v[40:43], v[140:143], a[208:211], v[40:43]
  ds_read_b64_tr_b16 v[156:157], v163 offset:16896
  v_cvt_pk_bf16_f32 v204, v204, v205
  v_mfma_f32_16x16x32_bf16 v[44:47], v[172:175], a[208:211], v[44:47]
  ds_read_b64_tr_b16 v[158:159], v163 offset:18944
  v_cvt_pk_bf16_f32 v205, v206, v207
  v_mfma_f32_16x16x32_bf16 v[48:51], v[128:131], v[0:3], v[48:51]
  ds_read_b64_tr_b16 v[128:129], v160 offset:20992
  v_mul_f32 v208, v208, v97
  v_mfma_f32_16x16x32_bf16 v[52:55], v[132:135], v[0:3], v[52:55]
  ds_read_b64_tr_b16 v[130:131], v160 offset:23040
  v_mul_f32 v209, v209, v97
  v_mfma_f32_16x16x32_bf16 v[56:59], v[136:139], v[0:3], v[56:59]
  ds_read_b64_tr_b16 v[132:133], v161 offset:20992
  v_mul_f32 v210, v210, v97
  v_mfma_f32_16x16x32_bf16 v[60:63], v[140:143], v[0:3], v[60:63]
  ds_read_b64_tr_b16 v[134:135], v161 offset:23040
  v_mul_f32 v211, v211, v97
  v_mfma_f32_16x16x32_bf16 v[64:67], v[172:175], v[0:3], v[64:67]
  s_waitcnt lgkmcnt(10)
  ds_read_b64_tr_b16 v[136:137], v162 offset:20992
  v_cvt_pk_bf16_f32 v206, v208, v209
  v_mfma_f32_16x16x32_bf16 v[164:167], v[144:147], a[212:215], v[164:167]
  s_waitcnt lgkmcnt(9)
  ds_read_b64_tr_b16 v[138:139], v162 offset:23040
  v_cvt_pk_bf16_f32 v207, v210, v211
  v_mfma_f32_16x16x32_bf16 v[32:35], v[148:151], a[212:215], v[32:35]
  s_waitcnt lgkmcnt(8)
  ds_read_b64_tr_b16 v[140:141], v163 offset:20992
  s_mov_b32 s36, 114944
  v_mfma_f32_16x16x32_bf16 v[36:39], v[152:155], a[212:215], v[36:39]
  s_waitcnt lgkmcnt(7)
  ds_read_b64_tr_b16 v[142:143], v163 offset:23040
  s_add_u32 m0, s29, 124672
  v_mfma_f32_16x16x32_bf16 v[40:43], v[156:159], a[212:215], v[40:43]
  v_permlane16_swap_b32 v196, v198
  v_mfma_f32_16x16x32_bf16 v[44:47], v[172:175], a[212:215], v[44:47]
  buffer_load_dwordx4 v119, s[16:19], s36 offen nt lds
  v_permlane16_swap_b32 v197, v199
  v_mfma_f32_16x16x32_bf16 v[48:51], v[144:147], v[4:7], v[48:51]
  ds_read_b64_tr_b16 v[144:145], v160 offset:25344
  v_mfma_f32_16x16x32_bf16 v[52:55], v[148:151], v[4:7], v[52:55]
  ds_read_b64_tr_b16 v[146:147], v160 offset:27392
  v_mfma_f32_16x16x32_bf16 v[56:59], v[152:155], v[4:7], v[56:59]
  ds_read_b64_tr_b16 v[148:149], v161 offset:25344
  s_mov_b32 s32, 65536
  v_mfma_f32_16x16x32_bf16 v[60:63], v[156:159], v[4:7], v[60:63]
  ds_read_b64_tr_b16 v[150:151], v161 offset:27392
  v_mfma_f32_16x16x32_bf16 v[64:67], v[172:175], v[4:7], v[64:67]
  s_waitcnt lgkmcnt(10)
  ds_read_b64_tr_b16 v[152:153], v162 offset:25344
  v_mfma_f32_16x16x32_bf16 v[164:167], v[128:131], a[216:219], v[164:167]
  s_waitcnt lgkmcnt(9)
  ds_read_b64_tr_b16 v[154:155], v162 offset:27392
  v_mfma_f32_16x16x32_bf16 v[32:35], v[132:135], a[216:219], v[32:35]
  s_waitcnt lgkmcnt(8)
  ds_read_b64_tr_b16 v[156:157], v163 offset:25344
  v_mfma_f32_16x16x32_bf16 v[36:39], v[136:139], a[216:219], v[36:39]
  s_waitcnt lgkmcnt(7)
  ds_read_b64_tr_b16 v[158:159], v163 offset:27392
  v_mfma_f32_16x16x32_bf16 v[40:43], v[140:143], a[216:219], v[40:43]
  v_permlane16_swap_b32 v204, v206
  v_mfma_f32_16x16x32_bf16 v[44:47], v[172:175], a[216:219], v[44:47]
  s_mov_b32 s37, 131328
  v_permlane16_swap_b32 v205, v207
  v_mfma_f32_16x16x32_bf16 v[48:51], v[128:131], v[8:11], v[48:51]
  ds_read_b64_tr_b16 v[128:129], v160 offset:29440
  s_add_u32 m0, s29, 128768
  v_mov_b32 v200, v204
  v_mfma_f32_16x16x32_bf16 v[52:55], v[132:135], v[8:11], v[52:55]
  ds_read_b64_tr_b16 v[130:131], v160 offset:31488
  v_mov_b32_dpp v204, v196 row_ror:8 row_mask:0xf bank_mask:0x3
  v_mfma_f32_16x16x32_bf16 v[56:59], v[136:139], v[8:11], v[56:59]
  buffer_load_dwordx4 v119, s[16:19], s37 offen nt lds
  v_mov_b32_dpp v196, v200 row_ror:8 row_mask:0xf bank_mask:0xc
  v_mov_b32 v201, v205
  v_mfma_f32_16x16x32_bf16 v[60:63], v[140:143], v[8:11], v[60:63]
  ds_read_b64_tr_b16 v[132:133], v161 offset:29440
  v_mov_b32_dpp v205, v197 row_ror:8 row_mask:0xf bank_mask:0x3
  v_mfma_f32_16x16x32_bf16 v[64:67], v[172:175], v[8:11], v[64:67]
  s_waitcnt lgkmcnt(9)
  ds_read_b64_tr_b16 v[134:135], v161 offset:31488
  v_mov_b32_dpp v197, v201 row_ror:8 row_mask:0xf bank_mask:0xc
  v_mfma_f32_16x16x32_bf16 v[164:167], v[144:147], a[220:223], v[164:167]
  s_waitcnt lgkmcnt(8)
  ds_read_b64_tr_b16 v[136:137], v162 offset:29440
  v_mov_b32 v202, v206
  v_mfma_f32_16x16x32_bf16 v[32:35], v[148:151], a[220:223], v[32:35]
  s_waitcnt lgkmcnt(7)
  ds_read_b64_tr_b16 v[138:139], v162 offset:31488
  s_mov_b32 s33, 69632
  v_mov_b32_dpp v206, v198 row_ror:8 row_mask:0xf bank_mask:0x3
  v_mfma_f32_16x16x32_bf16 v[36:39], v[152:155], a[220:223], v[36:39]
  s_waitcnt lgkmcnt(6)
  ds_read_b64_tr_b16 v[140:141], v163 offset:29440
  v_mov_b32_dpp v198, v202 row_ror:8 row_mask:0xf bank_mask:0xc
  v_mfma_f32_16x16x32_bf16 v[40:43], v[156:159], a[220:223], v[40:43]
  ds_read_b64_tr_b16 v[142:143], v163 offset:31488
  v_mov_b32 v203, v207
  v_mfma_f32_16x16x32_bf16 v[44:47], v[172:175], a[220:223], v[44:47]
  v_mov_b32_dpp v207, v199 row_ror:8 row_mask:0xf bank_mask:0x3
  v_mov_b32_dpp v199, v203 row_ror:8 row_mask:0xf bank_mask:0xc
  v_mfma_f32_16x16x32_bf16 v[48:51], v[144:147], v[12:15], v[48:51]
  buffer_store_dwordx4 v[196:199], v169, s[20:23], s46 offen nt
  v_rcp_f32 v98, v232
  v_mfma_f32_16x16x32_bf16 v[52:55], v[148:151], v[12:15], v[52:55]
  buffer_store_dwordx4 v[204:207], v169, s[20:23], s47 offen nt
  v_mul_f32 v216, v216, v98
  v_mul_f32 v217, v217, v98
  v_mfma_f32_16x16x32_bf16 v[56:59], v[152:155], v[12:15], v[56:59]
  v_mul_f32 v218, v218, v98
  v_mul_f32 v219, v219, v98
  v_mfma_f32_16x16x32_bf16 v[60:63], v[156:159], v[12:15], v[60:63]
  s_mov_b32 s38, 147712
  v_cvt_pk_bf16_f32 v216, v216, v217
  v_cvt_pk_bf16_f32 v217, v218, v219
  v_mfma_f32_16x16x32_bf16 v[64:67], v[172:175], v[12:15], v[64:67]
  s_waitcnt lgkmcnt(6)
  s_add_u32 m0, s29, 132864
  v_mul_f32 v220, v220, v98
  v_mul_f32 v221, v221, v98
  v_mfma_f32_16x16x32_bf16 v[164:167], v[128:131], a[224:227], v[164:167]
  s_waitcnt vmcnt(10) lgkmcnt(0)
  s_barrier
  v_mul_f32 v222, v222, v98
  v_mul_f32 v223, v223, v98
  v_mfma_f32_16x16x32_bf16 v[32:35], v[132:135], a[224:227], v[32:35]
  buffer_load_dwordx4 v119, s[16:19], s38 offen nt lds
  v_cvt_pk_bf16_f32 v218, v220, v221
  v_cvt_pk_bf16_f32 v219, v222, v223
  v_mfma_f32_16x16x32_bf16 v[36:39], v[136:139], a[224:227], v[36:39]
  v_mul_f32 v224, v224, v98
  v_mul_f32 v225, v225, v98
  v_mfma_f32_16x16x32_bf16 v[40:43], v[140:143], a[224:227], v[40:43]
  v_mul_f32 v226, v226, v98
  v_mul_f32 v227, v227, v98
  v_mfma_f32_16x16x32_bf16 v[44:47], v[172:175], a[224:227], v[44:47]
  v_permlane16_swap_b32 v216, v218
  v_mfma_f32_16x16x32_bf16 v[48:51], v[128:131], v[16:19], v[48:51]
  s_mov_b32 s34, 98304
  v_cvt_pk_bf16_f32 v224, v224, v225
  v_cvt_pk_bf16_f32 v225, v226, v227
  v_mfma_f32_16x16x32_bf16 v[52:55], v[132:135], v[16:19], v[52:55]
  v_permlane16_swap_b32 v217, v219
  v_mfma_f32_16x16x32_bf16 v[56:59], v[136:139], v[16:19], v[56:59]
  v_mul_f32 v228, v228, v98
  v_mul_f32 v229, v229, v98
  v_mfma_f32_16x16x32_bf16 v[60:63], v[140:143], v[16:19], v[60:63]
  v_mul_f32 v230, v230, v98
  v_mul_f32 v231, v231, v98
  v_mfma_f32_16x16x32_bf16 v[64:67], v[172:175], v[16:19], v[64:67]
  v_cvt_pk_bf16_f32 v226, v228, v229
  v_cvt_pk_bf16_f32 v227, v230, v231
  v_subrev_u32 v160, 25344, v160
  ds_read_b64_tr_b16 v[144:145], v160 offset:0
  ds_read_b64_tr_b16 v[146:147], v160 offset:2048
  s_waitcnt lgkmcnt(0)
  v_mfma_f32_16x16x32_bf16 v[164:167], v[144:147], a[228:231], v[164:167]
  ds_read_b64_tr_b16 v[128:129], v160 offset:4096
  v_subrev_u32 v161, 25344, v161
  ds_read_b64_tr_b16 v[148:149], v161 offset:0
  ds_read_b64_tr_b16 v[150:151], v161 offset:2048
  s_waitcnt lgkmcnt(0)
  v_mfma_f32_16x16x32_bf16 v[32:35], v[148:151], a[228:231], v[32:35]
  ds_read_b64_tr_b16 v[130:131], v160 offset:6144
  s_mov_b32 s39, 164096
  v_subrev_u32 v162, 25344, v162
  ds_read_b64_tr_b16 v[152:153], v162 offset:0
  ds_read_b64_tr_b16 v[154:155], v162 offset:2048
  s_waitcnt lgkmcnt(0)
  v_mfma_f32_16x16x32_bf16 v[36:39], v[152:155], a[228:231], v[36:39]
  ds_read_b64_tr_b16 v[132:133], v161 offset:4096
  s_add_u32 m0, s29, 136960
  v_subrev_u32 v163, 25344, v163
  ds_read_b64_tr_b16 v[156:157], v163 offset:0
  ds_read_b64_tr_b16 v[158:159], v163 offset:2048
  s_waitcnt lgkmcnt(0)
  v_mfma_f32_16x16x32_bf16 v[40:43], v[156:159], a[228:231], v[40:43]
  ds_read_b64_tr_b16 v[134:135], v161 offset:6144
  v_mfma_f32_16x16x32_bf16 v[44:47], v[172:175], a[228:231], v[44:47]
  ds_read_b64_tr_b16 v[136:137], v162 offset:4096
  v_mfma_f32_16x16x32_bf16 v[48:51], v[144:147], v[20:23], v[48:51]
  buffer_load_dwordx4 v119, s[16:19], s39 offen nt lds
  v_permlane16_swap_b32 v224, v226
  v_mfma_f32_16x16x32_bf16 v[52:55], v[148:151], v[20:23], v[52:55]
  ds_read_b64_tr_b16 v[138:139], v162 offset:6144
  v_mov_b32 v220, v224
  v_mfma_f32_16x16x32_bf16 v[56:59], v[152:155], v[20:23], v[56:59]
  ds_read_b64_tr_b16 v[140:141], v163 offset:4096
  v_mov_b32_dpp v224, v216 row_ror:8 row_mask:0xf bank_mask:0x3
  v_mfma_f32_16x16x32_bf16 v[60:63], v[156:159], v[20:23], v[60:63]
  ds_read_b64_tr_b16 v[142:143], v163 offset:6144
  v_mov_b32_dpp v216, v220 row_ror:8 row_mask:0xf bank_mask:0xc
  v_mfma_f32_16x16x32_bf16 v[64:67], v[172:175], v[20:23], v[64:67]
  ds_read_b64_tr_b16 v[144:145], v160 offset:8448
  s_mov_b32 s35, 102400
  v_mov_b32 v222, v226
  v_mfma_f32_16x16x32_bf16 v[164:167], v[128:131], a[232:235], v[164:167]
  s_waitcnt lgkmcnt(5)
  ds_read_b64_tr_b16 v[146:147], v160 offset:10496
  v_mov_b32_dpp v226, v218 row_ror:8 row_mask:0xf bank_mask:0x3
  v_mfma_f32_16x16x32_bf16 v[32:35], v[132:135], a[232:235], v[32:35]
  s_waitcnt lgkmcnt(4)
  ds_read_b64_tr_b16 v[148:149], v161 offset:8448
  v_mov_b32_dpp v218, v222 row_ror:8 row_mask:0xf bank_mask:0xc
  v_mfma_f32_16x16x32_bf16 v[36:39], v[136:139], a[232:235], v[36:39]
  s_waitcnt lgkmcnt(3)
  ds_read_b64_tr_b16 v[150:151], v161 offset:10496
  v_mfma_f32_16x16x32_bf16 v[40:43], v[140:143], a[232:235], v[40:43]
  ds_read_b64_tr_b16 v[152:153], v162 offset:8448
  v_mfma_f32_16x16x32_bf16 v[44:47], v[172:175], a[232:235], v[44:47]
  ds_read_b64_tr_b16 v[154:155], v162 offset:10496
  v_mfma_f32_16x16x32_bf16 v[48:51], v[128:131], v[24:27], v[48:51]
  ds_read_b64_tr_b16 v[128:129], v160 offset:12544
  ds_read_b64_tr_b16 v[130:131], v160 offset:14592
  s_mov_b32 s40, 180480
  v_mfma_f32_16x16x32_bf16 v[52:55], v[132:135], v[24:27], v[52:55]
  ds_read_b64_tr_b16 v[132:133], v161 offset:12544
  ds_read_b64_tr_b16 v[134:135], v161 offset:14592
  s_add_u32 m0, s29, 141056
  v_mfma_f32_16x16x32_bf16 v[56:59], v[136:139], v[24:27], v[56:59]
  ds_read_b64_tr_b16 v[136:137], v162 offset:12544
  ds_read_b64_tr_b16 v[138:139], v162 offset:14592
  v_mfma_f32_16x16x32_bf16 v[60:63], v[140:143], v[24:27], v[60:63]
  ds_read_b64_tr_b16 v[140:141], v163 offset:12544
  ds_read_b64_tr_b16 v[142:143], v163 offset:14592
  v_mfma_f32_16x16x32_bf16 v[64:67], v[172:175], v[24:27], v[64:67]
  s_waitcnt lgkmcnt(12)
  ds_read_b64_tr_b16 v[156:157], v163 offset:8448
  ds_read_b64_tr_b16 v[158:159], v163 offset:10496
  v_mfma_f32_16x16x32_bf16 v[164:167], v[144:147], a[236:239], v[164:167]
  s_waitcnt lgkmcnt(12)
  buffer_load_dwordx4 v119, s[16:19], s40 offen nt lds
  v_permlane16_swap_b32 v225, v227
  v_mfma_f32_16x16x32_bf16 v[32:35], v[148:151], a[236:239], v[32:35]
  s_waitcnt lgkmcnt(10)
  v_mov_b32 v221, v225
  v_mov_b32_dpp v225, v217 row_ror:8 row_mask:0xf bank_mask:0x3
  v_mfma_f32_16x16x32_bf16 v[36:39], v[152:155], a[236:239], v[36:39]
  s_waitcnt lgkmcnt(0)
  v_mov_b32_dpp v217, v221 row_ror:8 row_mask:0xf bank_mask:0xc
  v_mov_b32 v223, v227
  v_mfma_f32_16x16x32_bf16 v[40:43], v[156:159], a[236:239], v[40:43]
  v_mov_b32_dpp v227, v219 row_ror:8 row_mask:0xf bank_mask:0x3
  v_mov_b32_dpp v219, v223 row_ror:8 row_mask:0xf bank_mask:0xc
  v_mfma_f32_16x16x32_bf16 v[44:47], v[172:175], a[236:239], v[44:47]
  buffer_store_dwordx4 v[216:219], v169, s[20:23], s32 offen nt
  v_rcp_f32 v99, v252
  v_mfma_f32_16x16x32_bf16 v[48:51], v[144:147], v[28:31], v[48:51]
  buffer_store_dwordx4 v[224:227], v169, s[20:23], s33 offen nt
  v_mul_f32 v236, v236, v99
  v_mul_f32 v237, v237, v99
  v_mfma_f32_16x16x32_bf16 v[52:55], v[148:151], v[28:31], v[52:55]
  ds_read_b64_tr_b16 v[144:145], v160 offset:16896
  v_mul_f32 v238, v238, v99
  v_mfma_f32_16x16x32_bf16 v[56:59], v[152:155], v[28:31], v[56:59]
  ds_read_b64_tr_b16 v[146:147], v160 offset:18944
  v_mul_f32 v239, v239, v99
  v_mfma_f32_16x16x32_bf16 v[60:63], v[156:159], v[28:31], v[60:63]
  ds_read_b64_tr_b16 v[148:149], v161 offset:16896
  s_mov_b32 s41, 384
  v_cvt_pk_bf16_f32 v236, v236, v237
  v_mfma_f32_16x16x32_bf16 v[64:67], v[172:175], v[28:31], v[64:67]
  ds_read_b64_tr_b16 v[150:151], v161 offset:18944
  s_add_u32 m0, s29, 145152
  v_cvt_pk_bf16_f32 v237, v238, v239
  v_mfma_f32_16x16x32_bf16 v[68:71], v[128:131], a[0:3], 0
  ds_read_b64_tr_b16 v[152:153], v162 offset:16896
  s_mov_b32 s36, 131072
  v_mul_f32 v240, v240, v99
  v_mfma_f32_16x16x32_bf16 v[72:75], v[132:135], a[0:3], 0
  buffer_load_dwordx4 v119, s[16:19], s41 offen nt lds
  v_mul_f32 v241, v241, v99
  v_mul_f32 v242, v242, v99
  v_mfma_f32_16x16x32_bf16 v[76:79], v[136:139], a[0:3], 0
  ds_read_b64_tr_b16 v[154:155], v162 offset:18944
  v_mul_f32 v243, v243, v99
  v_mfma_f32_16x16x32_bf16 v[80:83], v[140:143], a[0:3], 0
  ds_read_b64_tr_b16 v[156:157], v163 offset:16896
  v_cvt_pk_bf16_f32 v238, v240, v241
  v_mfma_f32_16x16x32_bf16 v[84:87], v[128:131], a[48:51], 0
  ds_read_b64_tr_b16 v[158:159], v163 offset:18944
  v_cvt_pk_bf16_f32 v239, v242, v243
  v_mfma_f32_16x16x32_bf16 v[88:91], v[132:135], a[48:51], 0
  v_mul_f32 v244, v244, v99
  v_mul_f32 v245, v245, v99
  v_mfma_f32_16x16x32_bf16 v[92:95], v[136:139], a[48:51], 0
  v_mul_f32 v246, v246, v99
  v_mul_f32 v247, v247, v99
  v_mfma_f32_16x16x32_bf16 v[104:107], v[140:143], a[48:51], 0
  v_permlane16_swap_b32 v236, v238
  v_mfma_f32_16x16x32_bf16 v[108:111], v[128:131], a[96:99], 0
  v_cvt_pk_bf16_f32 v244, v244, v245
  v_cvt_pk_bf16_f32 v245, v246, v247
  v_mfma_f32_16x16x32_bf16 v[120:123], v[132:135], a[96:99], 0
  v_permlane16_swap_b32 v237, v239
  v_mfma_f32_16x16x32_bf16 v[124:127], v[136:139], a[96:99], 0
  v_mul_f32 v248, v248, v99
  v_mul_f32 v249, v249, v99
  v_mfma_f32_16x16x32_bf16 v[112:115], v[140:143], a[96:99], 0
  v_mul_f32 v250, v250, v99
  v_mul_f32 v251, v251, v99
  v_mfma_f32_16x16x32_bf16 v[192:195], v[128:131], a[144:147], 0
  s_mov_b32 s42, 16768
  v_cvt_pk_bf16_f32 v246, v248, v249
  v_cvt_pk_bf16_f32 v247, v250, v251
  v_mfma_f32_16x16x32_bf16 v[188:191], v[132:135], a[144:147], 0
  s_add_u32 m0, s29, 149248
  v_permlane16_swap_b32 v244, v246
  v_mfma_f32_16x16x32_bf16 v[180:183], v[136:139], a[144:147], 0
  v_permlane16_swap_b32 v245, v247
  v_mfma_f32_16x16x32_bf16 v[212:215], v[140:143], a[144:147], 0
  buffer_load_dwordx4 v119, s[16:19], s42 offen nt lds
  v_mov_b32 v240, v244
  v_mov_b32_dpp v244, v236 row_ror:8 row_mask:0xf bank_mask:0x3
  v_mfma_f32_16x16x32_bf16 v[208:211], v[128:131], a[192:195], 0
  v_mov_b32_dpp v236, v240 row_ror:8 row_mask:0xf bank_mask:0xc
  v_mov_b32 v241, v245
  v_mfma_f32_16x16x32_bf16 v[200:203], v[132:135], a[192:195], 0
  v_mov_b32_dpp v245, v237 row_ror:8 row_mask:0xf bank_mask:0x3
  v_mov_b32_dpp v237, v241 row_ror:8 row_mask:0xf bank_mask:0xc
  v_mfma_f32_16x16x32_bf16 v[232:235], v[136:139], a[192:195], 0
  v_mov_b32 v242, v246
  v_mov_b32_dpp v246, v238 row_ror:8 row_mask:0xf bank_mask:0x3
  v_mfma_f32_16x16x32_bf16 v[228:231], v[140:143], a[192:195], 0
  v_mov_b32_dpp v238, v242 row_ror:8 row_mask:0xf bank_mask:0xc
  v_mov_b32 v243, v247
  v_mfma_f32_16x16x32_bf16 v[220:223], v[128:131], a[240:243], 0
  ds_read_b64_tr_b16 v[128:129], v160 offset:20992
  v_mov_b32_dpp v247, v239 row_ror:8 row_mask:0xf bank_mask:0x3
  v_mfma_f32_16x16x32_bf16 v[252:255], v[132:135], a[240:243], 0
  buffer_store_dwordx4 v[244:247], v169, s[20:23], s35 offen nt
  v_mov_b32_dpp v239, v243 row_ror:8 row_mask:0xf bank_mask:0xc
  v_mfma_f32_16x16x32_bf16 v[248:251], v[136:139], a[240:243], 0
  buffer_store_dwordx4 v[236:239], v169, s[20:23], s34 offen nt
  v_rcp_f32 v100, v44
  v_mfma_f32_16x16x32_bf16 v[240:243], v[140:143], a[240:243], 0
  s_waitcnt lgkmcnt(7)
  ds_read_b64_tr_b16 v[130:131], v160 offset:23040
  v_mul_f32 v164, v164, v100
  v_mfma_f32_16x16x32_bf16 v[68:71], v[144:147], a[4:7], v[68:71]
  s_waitcnt lgkmcnt(6)
  ds_read_b64_tr_b16 v[132:133], v161 offset:20992
  v_mul_f32 v165, v165, v100
  v_mfma_f32_16x16x32_bf16 v[72:75], v[148:151], a[4:7], v[72:75]
  s_waitcnt lgkmcnt(5)
  ds_read_b64_tr_b16 v[134:135], v161 offset:23040
  s_mov_b32 s43, 33152
  v_mul_f32 v166, v166, v100
  v_mfma_f32_16x16x32_bf16 v[76:79], v[152:155], a[4:7], v[76:79]
  s_waitcnt lgkmcnt(4)
  ds_read_b64_tr_b16 v[136:137], v162 offset:20992
  s_add_u32 m0, s29, 153344
  v_mul_f32 v167, v167, v100
  v_mfma_f32_16x16x32_bf16 v[80:83], v[156:159], a[4:7], v[80:83]
  ds_read_b64_tr_b16 v[138:139], v162 offset:23040
  v_cvt_pk_bf16_f32 v164, v164, v165
  v_mfma_f32_16x16x32_bf16 v[84:87], v[144:147], a[52:55], v[84:87]
  buffer_load_dwordx4 v119, s[16:19], s43 offen nt lds
  v_cvt_pk_bf16_f32 v165, v166, v167
  v_mul_f32 v32, v32, v100
  v_mfma_f32_16x16x32_bf16 v[88:91], v[148:151], a[52:55], v[88:91]
  ds_read_b64_tr_b16 v[140:141], v163 offset:20992
  v_mul_f32 v33, v33, v100
  v_mfma_f32_16x16x32_bf16 v[92:95], v[152:155], a[52:55], v[92:95]
  ds_read_b64_tr_b16 v[142:143], v163 offset:23040
  v_mul_f32 v34, v34, v100
  v_mfma_f32_16x16x32_bf16 v[104:107], v[156:159], a[52:55], v[104:107]
  v_mul_f32 v35, v35, v100
  v_cvt_pk_bf16_f32 v166, v32, v33
  v_mfma_f32_16x16x32_bf16 v[108:111], v[144:147], a[100:103], v[108:111]
  v_cvt_pk_bf16_f32 v167, v34, v35
  v_mul_f32 v36, v36, v100
  v_mfma_f32_16x16x32_bf16 v[120:123], v[148:151], a[100:103], v[120:123]
  v_mul_f32 v37, v37, v100
  v_mul_f32 v38, v38, v100
  v_mfma_f32_16x16x32_bf16 v[124:127], v[152:155], a[100:103], v[124:127]
  v_mul_f32 v39, v39, v100
  v_cvt_pk_bf16_f32 v36, v36, v37
  v_mfma_f32_16x16x32_bf16 v[112:115], v[156:159], a[100:103], v[112:115]
  v_permlane16_swap_b32 v164, v166
  v_mfma_f32_16x16x32_bf16 v[192:195], v[144:147], a[148:151], v[192:195]
  v_permlane16_swap_b32 v165, v167
  v_mfma_f32_16x16x32_bf16 v[188:191], v[148:151], a[148:151], v[188:191]
  v_cvt_pk_bf16_f32 v37, v38, v39
  v_mul_f32 v40, v40, v100
  v_mfma_f32_16x16x32_bf16 v[180:183], v[152:155], a[148:151], v[180:183]
  v_mul_f32 v41, v41, v100
  v_mul_f32 v42, v42, v100
  v_mfma_f32_16x16x32_bf16 v[212:215], v[156:159], a[148:151], v[212:215]
  v_mul_f32 v43, v43, v100
  v_cvt_pk_bf16_f32 v38, v40, v41
  v_mfma_f32_16x16x32_bf16 v[208:211], v[144:147], a[196:199], v[208:211]
  v_cvt_pk_bf16_f32 v39, v42, v43
  v_mfma_f32_16x16x32_bf16 v[200:203], v[148:151], a[196:199], v[200:203]
  v_permlane16_swap_b32 v36, v38
  v_mfma_f32_16x16x32_bf16 v[232:235], v[152:155], a[196:199], v[232:235]
  v_permlane16_swap_b32 v37, v39
  v_mfma_f32_16x16x32_bf16 v[228:231], v[156:159], a[196:199], v[228:231]
  v_mov_b32 v32, v36
  v_mov_b32_dpp v36, v164 row_ror:8 row_mask:0xf bank_mask:0x3
  v_mfma_f32_16x16x32_bf16 v[220:223], v[144:147], a[244:247], v[220:223]
  ds_read_b64_tr_b16 v[144:145], v160 offset:59136
  v_mov_b32_dpp v164, v32 row_ror:8 row_mask:0xf bank_mask:0xc
  v_mfma_f32_16x16x32_bf16 v[252:255], v[148:151], a[244:247], v[252:255]
  ds_read_b64_tr_b16 v[146:147], v160 offset:61184
  v_mov_b32 v33, v37
  v_mfma_f32_16x16x32_bf16 v[248:251], v[152:155], a[244:247], v[248:251]
  ds_read_b64_tr_b16 v[148:149], v161 offset:59136
  v_mov_b32_dpp v37, v165 row_ror:8 row_mask:0xf bank_mask:0x3
  v_mfma_f32_16x16x32_bf16 v[240:243], v[156:159], a[244:247], v[240:243]
  s_waitcnt lgkmcnt(9)
  ds_read_b64_tr_b16 v[150:151], v161 offset:61184
  v_mov_b32_dpp v165, v33 row_ror:8 row_mask:0xf bank_mask:0xc
  v_mfma_f32_16x16x32_bf16 v[68:71], v[128:131], a[8:11], v[68:71]
  s_waitcnt lgkmcnt(8)
  ds_read_b64_tr_b16 v[152:153], v162 offset:59136
  v_mov_b32 v34, v38
  v_mfma_f32_16x16x32_bf16 v[72:75], v[132:135], a[8:11], v[72:75]
  s_waitcnt lgkmcnt(7)
  ds_read_b64_tr_b16 v[154:155], v162 offset:61184
  v_mov_b32_dpp v38, v166 row_ror:8 row_mask:0xf bank_mask:0x3
  v_mfma_f32_16x16x32_bf16 v[76:79], v[136:139], a[8:11], v[76:79]
  s_waitcnt lgkmcnt(6)
  ds_read_b64_tr_b16 v[156:157], v163 offset:59136
  v_mov_b32_dpp v166, v34 row_ror:8 row_mask:0xf bank_mask:0xc
  v_mfma_f32_16x16x32_bf16 v[80:83], v[140:143], a[8:11], v[80:83]
  ds_read_b64_tr_b16 v[158:159], v163 offset:61184
  v_mov_b32 v35, v39
  v_mfma_f32_16x16x32_bf16 v[84:87], v[128:131], a[56:59], v[84:87]
  v_mov_b32_dpp v39, v167 row_ror:8 row_mask:0xf bank_mask:0x3
  v_mov_b32_dpp v167, v35 row_ror:8 row_mask:0xf bank_mask:0xc
  v_mfma_f32_16x16x32_bf16 v[88:91], v[132:135], a[56:59], v[88:91]
  buffer_store_dwordx4 v[164:167], v169, s[20:23], s36 offen nt
  v_rcp_f32 v101, v64
  v_mfma_f32_16x16x32_bf16 v[92:95], v[136:139], a[56:59], v[92:95]
  v_mul_f32 v48, v48, v101
  v_mul_f32 v49, v49, v101
  v_mfma_f32_16x16x32_bf16 v[104:107], v[140:143], a[56:59], v[104:107]
  v_mul_f32 v50, v50, v101
  v_mul_f32 v51, v51, v101
  v_mfma_f32_16x16x32_bf16 v[108:111], v[128:131], a[104:107], v[108:111]
  v_cvt_pk_bf16_f32 v48, v48, v49
  v_cvt_pk_bf16_f32 v49, v50, v51
  v_mfma_f32_16x16x32_bf16 v[120:123], v[132:135], a[104:107], v[120:123]
  v_mul_f32 v52, v52, v101
  v_mul_f32 v53, v53, v101
  v_mfma_f32_16x16x32_bf16 v[124:127], v[136:139], a[104:107], v[124:127]
  v_mul_f32 v54, v54, v101
  v_mul_f32 v55, v55, v101
  v_mfma_f32_16x16x32_bf16 v[112:115], v[140:143], a[104:107], v[112:115]
  v_cvt_pk_bf16_f32 v50, v52, v53
  v_cvt_pk_bf16_f32 v51, v54, v55
  v_mfma_f32_16x16x32_bf16 v[192:195], v[128:131], a[152:155], v[192:195]
  v_mul_f32 v56, v56, v101
  v_mul_f32 v57, v57, v101
  v_mfma_f32_16x16x32_bf16 v[188:191], v[132:135], a[152:155], v[188:191]
  v_mul_f32 v58, v58, v101
  v_mul_f32 v59, v59, v101
  v_mfma_f32_16x16x32_bf16 v[180:183], v[136:139], a[152:155], v[180:183]
  v_permlane16_swap_b32 v48, v50
  v_mfma_f32_16x16x32_bf16 v[212:215], v[140:143], a[152:155], v[212:215]
  v_cvt_pk_bf16_f32 v56, v56, v57
  v_cvt_pk_bf16_f32 v57, v58, v59
  v_mfma_f32_16x16x32_bf16 v[208:211], v[128:131], a[200:203], v[208:211]
  v_permlane16_swap_b32 v49, v51
  v_mfma_f32_16x16x32_bf16 v[200:203], v[132:135], a[200:203], v[200:203]
  v_mul_f32 v60, v60, v101
  v_mul_f32 v61, v61, v101
  v_mfma_f32_16x16x32_bf16 v[232:235], v[136:139], a[200:203], v[232:235]
  v_mul_f32 v62, v62, v101
  v_mul_f32 v63, v63, v101
  v_mfma_f32_16x16x32_bf16 v[228:231], v[140:143], a[200:203], v[228:231]
  v_cvt_pk_bf16_f32 v58, v60, v61
  v_cvt_pk_bf16_f32 v59, v62, v63
  v_mfma_f32_16x16x32_bf16 v[220:223], v[128:131], a[248:251], v[220:223]
  ds_read_b64_tr_b16 v[128:129], v160 offset:63232
  s_mov_b32 s37, 135168
  v_mfma_f32_16x16x32_bf16 v[252:255], v[132:135], a[248:251], v[252:255]
  ds_read_b64_tr_b16 v[130:131], v160 offset:65280
  v_add_u32 v160, 67328, v160
  v_mfma_f32_16x16x32_bf16 v[248:251], v[136:139], a[248:251], v[248:251]
  ds_read_b64_tr_b16 v[132:133], v161 offset:63232
  v_mfma_f32_16x16x32_bf16 v[240:243], v[140:143], a[248:251], v[240:243]
  s_waitcnt lgkmcnt(9)
  ds_read_b64_tr_b16 v[134:135], v161 offset:65280
  v_add_u32 v161, 67328, v161
  v_mfma_f32_16x16x32_bf16 v[68:71], v[144:147], a[12:15], v[68:71]
  s_waitcnt lgkmcnt(8)
  buffer_store_dwordx4 v[36:39], v169, s[20:23], s37 offen nt
  v_permlane16_swap_b32 v56, v58
  v_mfma_f32_16x16x32_bf16 v[72:75], v[148:151], a[12:15], v[72:75]
  s_waitcnt lgkmcnt(6)
  ds_read_b64_tr_b16 v[136:137], v162 offset:63232
  v_mov_b32 v52, v56
  v_mfma_f32_16x16x32_bf16 v[76:79], v[152:155], a[12:15], v[76:79]
  s_waitcnt lgkmcnt(5)
  ds_read_b64_tr_b16 v[138:139], v162 offset:65280
  v_mov_b32_dpp v56, v48 row_ror:8 row_mask:0xf bank_mask:0x3
  v_mfma_f32_16x16x32_bf16 v[80:83], v[156:159], a[12:15], v[80:83]
  ds_read_b64_tr_b16 v[140:141], v163 offset:63232
  v_mov_b32_dpp v48, v52 row_ror:8 row_mask:0xf bank_mask:0xc
  v_mfma_f32_16x16x32_bf16 v[84:87], v[144:147], a[60:63], v[84:87]
  ds_read_b64_tr_b16 v[142:143], v163 offset:65280
  v_mov_b32 v54, v58
  v_mfma_f32_16x16x32_bf16 v[88:91], v[148:151], a[60:63], v[88:91]
  v_permlane16_swap_b32 v57, v59
  v_mfma_f32_16x16x32_bf16 v[92:95], v[152:155], a[60:63], v[92:95]
  v_mov_b32 v53, v57
  v_mov_b32_dpp v57, v49 row_ror:8 row_mask:0xf bank_mask:0x3
  v_mfma_f32_16x16x32_bf16 v[104:107], v[156:159], a[60:63], v[104:107]
  v_mov_b32_dpp v49, v53 row_ror:8 row_mask:0xf bank_mask:0xc
  v_mov_b32_dpp v58, v50 row_ror:8 row_mask:0xf bank_mask:0x3
  v_mfma_f32_16x16x32_bf16 v[108:111], v[144:147], a[108:111], v[108:111]
  v_mov_b32_dpp v50, v54 row_ror:8 row_mask:0xf bank_mask:0xc
  v_mov_b32 v55, v59
  v_mfma_f32_16x16x32_bf16 v[120:123], v[148:151], a[108:111], v[120:123]
  v_mov_b32_dpp v59, v51 row_ror:8 row_mask:0xf bank_mask:0x3
  v_mov_b32_dpp v51, v55 row_ror:8 row_mask:0xf bank_mask:0xc
  v_mfma_f32_16x16x32_bf16 v[124:127], v[152:155], a[108:111], v[124:127]
  v_add_u32 v162, 67328, v162
  v_add_u32 v163, 67328, v163
  v_mfma_f32_16x16x32_bf16 v[112:115], v[156:159], a[108:111], v[112:115]
  v_mfma_f32_16x16x32_bf16 v[192:195], v[144:147], a[156:159], v[192:195]
  v_mfma_f32_16x16x32_bf16 v[188:191], v[148:151], a[156:159], v[188:191]
  v_mfma_f32_16x16x32_bf16 v[180:183], v[152:155], a[156:159], v[180:183]
  v_mfma_f32_16x16x32_bf16 v[212:215], v[156:159], a[156:159], v[212:215]
  v_mfma_f32_16x16x32_bf16 v[208:211], v[144:147], a[204:207], v[208:211]
  v_mfma_f32_16x16x32_bf16 v[200:203], v[148:151], a[204:207], v[200:203]
  v_mfma_f32_16x16x32_bf16 v[232:235], v[152:155], a[204:207], v[232:235]
  v_mfma_f32_16x16x32_bf16 v[228:231], v[156:159], a[204:207], v[228:231]
  v_mfma_f32_16x16x32_bf16 v[220:223], v[144:147], a[252:255], v[220:223]
  ds_read_b64_tr_b16 v[144:145], v160 offset:0
  v_mfma_f32_16x16x32_bf16 v[252:255], v[148:151], a[252:255], v[252:255]
  ds_read_b64_tr_b16 v[146:147], v160 offset:2048
  v_mfma_f32_16x16x32_bf16 v[248:251], v[152:155], a[252:255], v[248:251]
  ds_read_b64_tr_b16 v[148:149], v161 offset:0
  v_mfma_f32_16x16x32_bf16 v[240:243], v[156:159], a[252:255], v[240:243]
  s_waitcnt lgkmcnt(9)
  ds_read_b64_tr_b16 v[150:151], v161 offset:2048
  v_mfma_f32_16x16x32_bf16 v[68:71], v[128:131], a[16:19], v[68:71]
  s_waitcnt lgkmcnt(8)
  ds_read_b64_tr_b16 v[152:153], v162 offset:0
  v_mfma_f32_16x16x32_bf16 v[72:75], v[132:135], a[16:19], v[72:75]
  s_waitcnt lgkmcnt(7)
  ds_read_b64_tr_b16 v[154:155], v162 offset:2048
  v_mfma_f32_16x16x32_bf16 v[76:79], v[136:139], a[16:19], v[76:79]
  s_waitcnt lgkmcnt(6)
  ds_read_b64_tr_b16 v[156:157], v163 offset:0
  v_mfma_f32_16x16x32_bf16 v[80:83], v[140:143], a[16:19], v[80:83]
  ds_read_b64_tr_b16 v[158:159], v163 offset:2048
  v_mfma_f32_16x16x32_bf16 v[84:87], v[128:131], a[64:67], v[84:87]
  v_mfma_f32_16x16x32_bf16 v[88:91], v[132:135], a[64:67], v[88:91]
  v_mfma_f32_16x16x32_bf16 v[92:95], v[136:139], a[64:67], v[92:95]
  v_mfma_f32_16x16x32_bf16 v[104:107], v[140:143], a[64:67], v[104:107]
  v_mfma_f32_16x16x32_bf16 v[108:111], v[128:131], a[112:115], v[108:111]
  v_mfma_f32_16x16x32_bf16 v[120:123], v[132:135], a[112:115], v[120:123]
  s_mov_b32 s40, 49536
  v_mfma_f32_16x16x32_bf16 v[124:127], v[136:139], a[112:115], v[124:127]
  s_add_u32 m0, s29, 158464
  v_mfma_f32_16x16x32_bf16 v[112:115], v[140:143], a[112:115], v[112:115]
  v_mfma_f32_16x16x32_bf16 v[192:195], v[128:131], a[160:163], v[192:195]
  buffer_load_dwordx4 v119, s[16:19], s40 offen nt lds
  v_mfma_f32_16x16x32_bf16 v[188:191], v[132:135], a[160:163], v[188:191]
  v_mfma_f32_16x16x32_bf16 v[180:183], v[136:139], a[160:163], v[180:183]
  v_mfma_f32_16x16x32_bf16 v[212:215], v[140:143], a[160:163], v[212:215]
  v_mfma_f32_16x16x32_bf16 v[208:211], v[128:131], a[208:211], v[208:211]
  v_mfma_f32_16x16x32_bf16 v[200:203], v[132:135], a[208:211], v[200:203]
  v_mfma_f32_16x16x32_bf16 v[232:235], v[136:139], a[208:211], v[232:235]
  v_mfma_f32_16x16x32_bf16 v[228:231], v[140:143], a[208:211], v[228:231]
  v_mfma_f32_16x16x32_bf16 v[220:223], v[128:131], v[0:3], v[220:223]
  ds_read_b64_tr_b16 v[128:129], v160 offset:4096
  v_mfma_f32_16x16x32_bf16 v[252:255], v[132:135], v[0:3], v[252:255]
  ds_read_b64_tr_b16 v[130:131], v160 offset:6144
  v_mfma_f32_16x16x32_bf16 v[248:251], v[136:139], v[0:3], v[248:251]
  ds_read_b64_tr_b16 v[132:133], v161 offset:4096
  s_mov_b32 s41, 65920
  v_mfma_f32_16x16x32_bf16 v[240:243], v[140:143], v[0:3], v[240:243]
  s_waitcnt lgkmcnt(9)
  ds_read_b64_tr_b16 v[134:135], v161 offset:6144
  s_add_u32 m0, s29, 25344
  v_mfma_f32_16x16x32_bf16 v[68:71], v[144:147], a[20:23], v[68:71]
  s_waitcnt lgkmcnt(8)
  ds_read_b64_tr_b16 v[136:137], v162 offset:4096
  v_mfma_f32_16x16x32_bf16 v[72:75], v[148:151], a[20:23], v[72:75]
  s_waitcnt lgkmcnt(7)
  buffer_load_dwordx4 v119, s[16:19], s41 offen nt lds
  v_mfma_f32_16x16x32_bf16 v[76:79], v[152:155], a[20:23], v[76:79]
  s_waitcnt lgkmcnt(5)
  ds_read_b64_tr_b16 v[138:139], v162 offset:6144
  v_mfma_f32_16x16x32_bf16 v[80:83], v[156:159], a[20:23], v[80:83]
  ds_read_b64_tr_b16 v[140:141], v163 offset:4096
  v_mfma_f32_16x16x32_bf16 v[84:87], v[144:147], a[68:71], v[84:87]
  ds_read_b64_tr_b16 v[142:143], v163 offset:6144
  v_mfma_f32_16x16x32_bf16 v[88:91], v[148:151], a[68:71], v[88:91]
  v_mfma_f32_16x16x32_bf16 v[92:95], v[152:155], a[68:71], v[92:95]
  v_mfma_f32_16x16x32_bf16 v[104:107], v[156:159], a[68:71], v[104:107]
  v_mfma_f32_16x16x32_bf16 v[108:111], v[144:147], a[116:119], v[108:111]
  v_mfma_f32_16x16x32_bf16 v[120:123], v[148:151], a[116:119], v[120:123]
  v_mfma_f32_16x16x32_bf16 v[124:127], v[152:155], a[116:119], v[124:127]
  v_mfma_f32_16x16x32_bf16 v[112:115], v[156:159], a[116:119], v[112:115]
  v_mfma_f32_16x16x32_bf16 v[192:195], v[144:147], a[164:167], v[192:195]
  s_mov_b32 s42, 82304
  v_mfma_f32_16x16x32_bf16 v[188:191], v[148:151], a[164:167], v[188:191]
  s_add_u32 m0, s29, 29440
  v_mfma_f32_16x16x32_bf16 v[180:183], v[152:155], a[164:167], v[180:183]
  v_mfma_f32_16x16x32_bf16 v[212:215], v[156:159], a[164:167], v[212:215]
  buffer_load_dwordx4 v119, s[16:19], s42 offen nt lds
  v_mfma_f32_16x16x32_bf16 v[208:211], v[144:147], a[212:215], v[208:211]
  s_mov_b32 s38, 163840
  v_mfma_f32_16x16x32_bf16 v[200:203], v[148:151], a[212:215], v[200:203]
  v_mfma_f32_16x16x32_bf16 v[232:235], v[152:155], a[212:215], v[232:235]
  v_mfma_f32_16x16x32_bf16 v[228:231], v[156:159], a[212:215], v[228:231]
  v_mfma_f32_16x16x32_bf16 v[220:223], v[144:147], v[4:7], v[220:223]
  buffer_store_dwordx4 v[48:51], v169, s[20:23], s38 offen nt
  v_mfma_f32_16x16x32_bf16 v[252:255], v[148:151], v[4:7], v[252:255]
  ds_read_b64_tr_b16 v[144:145], v160 offset:8192
  v_mfma_f32_16x16x32_bf16 v[248:251], v[152:155], v[4:7], v[248:251]
  ds_read_b64_tr_b16 v[146:147], v160 offset:10240
  v_mfma_f32_16x16x32_bf16 v[240:243], v[156:159], v[4:7], v[240:243]
  s_waitcnt lgkmcnt(8)
  ds_read_b64_tr_b16 v[148:149], v161 offset:8192
  v_mfma_f32_16x16x32_bf16 v[68:71], v[128:131], a[24:27], v[68:71]
  s_waitcnt lgkmcnt(7)
  ds_read_b64_tr_b16 v[150:151], v161 offset:10240
  v_mfma_f32_16x16x32_bf16 v[72:75], v[132:135], a[24:27], v[72:75]
  s_waitcnt lgkmcnt(6)
  ds_read_b64_tr_b16 v[152:153], v162 offset:8192
  s_mov_b32 s43, 98688
  v_mfma_f32_16x16x32_bf16 v[76:79], v[136:139], a[24:27], v[76:79]
  s_waitcnt lgkmcnt(5)
  ds_read_b64_tr_b16 v[154:155], v162 offset:10240
  s_add_u32 m0, s29, 33792
  v_mfma_f32_16x16x32_bf16 v[80:83], v[140:143], a[24:27], v[80:83]
  ds_read_b64_tr_b16 v[156:157], v163 offset:8192
  v_mfma_f32_16x16x32_bf16 v[84:87], v[128:131], a[72:75], v[84:87]
  buffer_load_dwordx4 v119, s[16:19], s43 offen nt lds
  v_mfma_f32_16x16x32_bf16 v[88:91], v[132:135], a[72:75], v[88:91]
  ds_read_b64_tr_b16 v[158:159], v163 offset:10240
  v_mfma_f32_16x16x32_bf16 v[92:95], v[136:139], a[72:75], v[92:95]
  v_mfma_f32_16x16x32_bf16 v[104:107], v[140:143], a[72:75], v[104:107]
  v_mfma_f32_16x16x32_bf16 v[108:111], v[128:131], a[120:123], v[108:111]
  v_mfma_f32_16x16x32_bf16 v[120:123], v[132:135], a[120:123], v[120:123]
  v_mfma_f32_16x16x32_bf16 v[124:127], v[136:139], a[120:123], v[124:127]
  v_mfma_f32_16x16x32_bf16 v[112:115], v[140:143], a[120:123], v[112:115]
  v_mfma_f32_16x16x32_bf16 v[192:195], v[128:131], a[168:171], v[192:195]
  v_mfma_f32_16x16x32_bf16 v[188:191], v[132:135], a[168:171], v[188:191]
  v_mfma_f32_16x16x32_bf16 v[180:183], v[136:139], a[168:171], v[180:183]
  v_mfma_f32_16x16x32_bf16 v[212:215], v[140:143], a[168:171], v[212:215]
  s_mov_b32 s44, 115072
  v_mfma_f32_16x16x32_bf16 v[208:211], v[128:131], a[216:219], v[208:211]
  s_add_u32 m0, s29, 37888
  v_mfma_f32_16x16x32_bf16 v[200:203], v[132:135], a[216:219], v[200:203]
  v_mfma_f32_16x16x32_bf16 v[232:235], v[136:139], a[216:219], v[232:235]
  buffer_load_dwordx4 v119, s[16:19], s44 offen nt lds
  v_mfma_f32_16x16x32_bf16 v[228:231], v[140:143], a[216:219], v[228:231]
  v_mfma_f32_16x16x32_bf16 v[220:223], v[128:131], v[8:11], v[220:223]
  ds_read_b64_tr_b16 v[128:129], v160 offset:12288
  v_mfma_f32_16x16x32_bf16 v[252:255], v[132:135], v[8:11], v[252:255]
  ds_read_b64_tr_b16 v[130:131], v160 offset:14336
  v_mfma_f32_16x16x32_bf16 v[248:251], v[136:139], v[8:11], v[248:251]
  ds_read_b64_tr_b16 v[132:133], v161 offset:12288
  v_mfma_f32_16x16x32_bf16 v[240:243], v[140:143], v[8:11], v[240:243]
  s_waitcnt lgkmcnt(9)
  ds_read_b64_tr_b16 v[134:135], v161 offset:14336
  v_mfma_f32_16x16x32_bf16 v[68:71], v[144:147], a[28:31], v[68:71]
  s_waitcnt lgkmcnt(8)
  ds_read_b64_tr_b16 v[136:137], v162 offset:12288
  v_mfma_f32_16x16x32_bf16 v[72:75], v[148:151], a[28:31], v[72:75]
  s_waitcnt lgkmcnt(7)
  ds_read_b64_tr_b16 v[138:139], v162 offset:14336
  v_mfma_f32_16x16x32_bf16 v[76:79], v[152:155], a[28:31], v[76:79]
  s_waitcnt lgkmcnt(6)
  ds_read_b64_tr_b16 v[140:141], v163 offset:12288
  v_mfma_f32_16x16x32_bf16 v[80:83], v[156:159], a[28:31], v[80:83]
  ds_read_b64_tr_b16 v[142:143], v163 offset:14336
  v_mfma_f32_16x16x32_bf16 v[84:87], v[144:147], a[76:79], v[84:87]
  s_mov_b32 s45, 131456
  v_mfma_f32_16x16x32_bf16 v[88:91], v[148:151], a[76:79], v[88:91]
  s_add_u32 m0, s29, 42240
  v_mfma_f32_16x16x32_bf16 v[92:95], v[152:155], a[76:79], v[92:95]
  v_mfma_f32_16x16x32_bf16 v[104:107], v[156:159], a[76:79], v[104:107]
  buffer_load_dwordx4 v119, s[16:19], s45 offen nt lds
  v_mfma_f32_16x16x32_bf16 v[108:111], v[144:147], a[124:127], v[108:111]
  v_mfma_f32_16x16x32_bf16 v[120:123], v[148:151], a[124:127], v[120:123]
  v_mfma_f32_16x16x32_bf16 v[124:127], v[152:155], a[124:127], v[124:127]
  v_mfma_f32_16x16x32_bf16 v[112:115], v[156:159], a[124:127], v[112:115]
  v_mfma_f32_16x16x32_bf16 v[192:195], v[144:147], a[172:175], v[192:195]
  v_mfma_f32_16x16x32_bf16 v[188:191], v[148:151], a[172:175], v[188:191]
  v_mfma_f32_16x16x32_bf16 v[180:183], v[152:155], a[172:175], v[180:183]
  v_mfma_f32_16x16x32_bf16 v[212:215], v[156:159], a[172:175], v[212:215]
  v_mfma_f32_16x16x32_bf16 v[208:211], v[144:147], a[220:223], v[208:211]
  v_mfma_f32_16x16x32_bf16 v[200:203], v[148:151], a[220:223], v[200:203]
  v_mfma_f32_16x16x32_bf16 v[232:235], v[152:155], a[220:223], v[232:235]
  s_mov_b32 s46, 147840
  v_mfma_f32_16x16x32_bf16 v[228:231], v[156:159], a[220:223], v[228:231]
  s_add_u32 m0, s29, 46336
  v_mfma_f32_16x16x32_bf16 v[220:223], v[144:147], v[12:15], v[220:223]
  ds_read_b64_tr_b16 v[144:145], v160 offset:16384
  v_mfma_f32_16x16x32_bf16 v[252:255], v[148:151], v[12:15], v[252:255]
  buffer_load_dwordx4 v119, s[16:19], s46 offen nt lds
  v_mfma_f32_16x16x32_bf16 v[248:251], v[152:155], v[12:15], v[248:251]
  ds_read_b64_tr_b16 v[146:147], v160 offset:18432
  v_mfma_f32_16x16x32_bf16 v[240:243], v[156:159], v[12:15], v[240:243]
  s_waitcnt lgkmcnt(8)
  ds_read_b64_tr_b16 v[148:149], v161 offset:16384
  v_mfma_f32_16x16x32_bf16 v[68:71], v[128:131], a[32:35], v[68:71]
  s_waitcnt lgkmcnt(7)
  ds_read_b64_tr_b16 v[150:151], v161 offset:18432
  v_mfma_f32_16x16x32_bf16 v[72:75], v[132:135], a[32:35], v[72:75]
  s_waitcnt lgkmcnt(6)
  ds_read_b64_tr_b16 v[152:153], v162 offset:16384
  v_mfma_f32_16x16x32_bf16 v[76:79], v[136:139], a[32:35], v[76:79]
  s_waitcnt lgkmcnt(5)
  ds_read_b64_tr_b16 v[154:155], v162 offset:18432
  v_mfma_f32_16x16x32_bf16 v[80:83], v[140:143], a[32:35], v[80:83]
  ds_read_b64_tr_b16 v[156:157], v163 offset:16384
  v_mfma_f32_16x16x32_bf16 v[84:87], v[128:131], a[80:83], v[84:87]
  ds_read_b64_tr_b16 v[158:159], v163 offset:18432
  v_mfma_f32_16x16x32_bf16 v[88:91], v[132:135], a[80:83], v[88:91]
  v_mfma_f32_16x16x32_bf16 v[92:95], v[136:139], a[80:83], v[92:95]
  v_mfma_f32_16x16x32_bf16 v[104:107], v[140:143], a[80:83], v[104:107]
  s_mov_b32 s47, 164224
  v_mfma_f32_16x16x32_bf16 v[108:111], v[128:131], a[128:131], v[108:111]
  s_add_u32 m0, s29, 50688
  v_mfma_f32_16x16x32_bf16 v[120:123], v[132:135], a[128:131], v[120:123]
  v_mfma_f32_16x16x32_bf16 v[124:127], v[136:139], a[128:131], v[124:127]
  buffer_load_dwordx4 v119, s[16:19], s47 offen nt lds
  v_mfma_f32_16x16x32_bf16 v[112:115], v[140:143], a[128:131], v[112:115]
  v_mfma_f32_16x16x32_bf16 v[192:195], v[128:131], a[176:179], v[192:195]
  v_mfma_f32_16x16x32_bf16 v[188:191], v[132:135], a[176:179], v[188:191]
  s_mov_b32 s39, 167936
  v_mfma_f32_16x16x32_bf16 v[180:183], v[136:139], a[176:179], v[180:183]
  v_mfma_f32_16x16x32_bf16 v[212:215], v[140:143], a[176:179], v[212:215]
  v_mfma_f32_16x16x32_bf16 v[208:211], v[128:131], a[224:227], v[208:211]
  v_mfma_f32_16x16x32_bf16 v[200:203], v[132:135], a[224:227], v[200:203]
  buffer_store_dwordx4 v[56:59], v169, s[20:23], s39 offen nt
  v_mfma_f32_16x16x32_bf16 v[232:235], v[136:139], a[224:227], v[232:235]
  v_mfma_f32_16x16x32_bf16 v[228:231], v[140:143], a[224:227], v[228:231]
  v_mfma_f32_16x16x32_bf16 v[220:223], v[128:131], v[16:19], v[220:223]
  ds_read_b64_tr_b16 v[128:129], v160 offset:20480
  v_mfma_f32_16x16x32_bf16 v[252:255], v[132:135], v[16:19], v[252:255]
  ds_read_b64_tr_b16 v[130:131], v160 offset:22528
  s_mov_b32 s32, 180608
  v_mfma_f32_16x16x32_bf16 v[248:251], v[136:139], v[16:19], v[248:251]
  ds_read_b64_tr_b16 v[132:133], v161 offset:20480
  s_add_u32 m0, s29, 54784
  v_mfma_f32_16x16x32_bf16 v[240:243], v[140:143], v[16:19], v[240:243]
  s_waitcnt lgkmcnt(9)
  ds_read_b64_tr_b16 v[134:135], v161 offset:22528
  v_mfma_f32_16x16x32_bf16 v[68:71], v[144:147], a[36:39], v[68:71]
  s_waitcnt lgkmcnt(8)
  buffer_load_dwordx4 v119, s[16:19], s32 offen nt lds
  v_mfma_f32_16x16x32_bf16 v[72:75], v[148:151], a[36:39], v[72:75]
  s_waitcnt lgkmcnt(6)
  ds_read_b64_tr_b16 v[136:137], v162 offset:20480
  v_mfma_f32_16x16x32_bf16 v[76:79], v[152:155], a[36:39], v[76:79]
  s_waitcnt lgkmcnt(5)
  ds_read_b64_tr_b16 v[138:139], v162 offset:22528
  v_mfma_f32_16x16x32_bf16 v[80:83], v[156:159], a[36:39], v[80:83]
  ds_read_b64_tr_b16 v[140:141], v163 offset:20480
  v_mfma_f32_16x16x32_bf16 v[84:87], v[144:147], a[84:87], v[84:87]
  ds_read_b64_tr_b16 v[142:143], v163 offset:22528
  v_mfma_f32_16x16x32_bf16 v[88:91], v[148:151], a[84:87], v[88:91]
  v_mfma_f32_16x16x32_bf16 v[92:95], v[152:155], a[84:87], v[92:95]
  v_mfma_f32_16x16x32_bf16 v[104:107], v[156:159], a[84:87], v[104:107]
  v_mfma_f32_16x16x32_bf16 v[108:111], v[144:147], a[132:135], v[108:111]
  v_mfma_f32_16x16x32_bf16 v[120:123], v[148:151], a[132:135], v[120:123]
  v_mfma_f32_16x16x32_bf16 v[124:127], v[152:155], a[132:135], v[124:127]
  v_mfma_f32_16x16x32_bf16 v[112:115], v[156:159], a[132:135], v[112:115]
  v_mfma_f32_16x16x32_bf16 v[192:195], v[144:147], a[180:183], v[192:195]
  v_mfma_f32_16x16x32_bf16 v[188:191], v[148:151], a[180:183], v[188:191]
  v_mfma_f32_16x16x32_bf16 v[180:183], v[152:155], a[180:183], v[180:183]
  v_mfma_f32_16x16x32_bf16 v[212:215], v[156:159], a[180:183], v[212:215]
  v_mfma_f32_16x16x32_bf16 v[208:211], v[144:147], a[228:231], v[208:211]
  v_mfma_f32_16x16x32_bf16 v[200:203], v[148:151], a[228:231], v[200:203]
  v_mfma_f32_16x16x32_bf16 v[232:235], v[152:155], a[228:231], v[232:235]
  v_mfma_f32_16x16x32_bf16 v[228:231], v[156:159], a[228:231], v[228:231]
  v_mfma_f32_16x16x32_bf16 v[220:223], v[144:147], v[20:23], v[220:223]
  ds_read_b64_tr_b16 v[144:145], v160 offset:24576
  v_mfma_f32_16x16x32_bf16 v[252:255], v[148:151], v[20:23], v[252:255]
  ds_read_b64_tr_b16 v[146:147], v160 offset:26624
  v_mfma_f32_16x16x32_bf16 v[248:251], v[152:155], v[20:23], v[248:251]
  ds_read_b64_tr_b16 v[148:149], v161 offset:24576
  v_mfma_f32_16x16x32_bf16 v[240:243], v[156:159], v[20:23], v[240:243]
  s_waitcnt lgkmcnt(9)
  ds_read_b64_tr_b16 v[150:151], v161 offset:26624
  v_mfma_f32_16x16x32_bf16 v[68:71], v[128:131], a[40:43], v[68:71]
  s_waitcnt lgkmcnt(8)
  ds_read_b64_tr_b16 v[152:153], v162 offset:24576
  v_mfma_f32_16x16x32_bf16 v[72:75], v[132:135], a[40:43], v[72:75]
  s_waitcnt lgkmcnt(7)
  ds_read_b64_tr_b16 v[154:155], v162 offset:26624
  v_mfma_f32_16x16x32_bf16 v[76:79], v[136:139], a[40:43], v[76:79]
  s_waitcnt lgkmcnt(6)
  ds_read_b64_tr_b16 v[156:157], v163 offset:24576
  v_mfma_f32_16x16x32_bf16 v[80:83], v[140:143], a[40:43], v[80:83]
  ds_read_b64_tr_b16 v[158:159], v163 offset:26624
  v_mfma_f32_16x16x32_bf16 v[84:87], v[128:131], a[88:91], v[84:87]
  v_mfma_f32_16x16x32_bf16 v[88:91], v[132:135], a[88:91], v[88:91]
  v_mfma_f32_16x16x32_bf16 v[92:95], v[136:139], a[88:91], v[92:95]
  v_mfma_f32_16x16x32_bf16 v[104:107], v[140:143], a[88:91], v[104:107]
  v_mfma_f32_16x16x32_bf16 v[108:111], v[128:131], a[136:139], v[108:111]
  v_mfma_f32_16x16x32_bf16 v[120:123], v[132:135], a[136:139], v[120:123]
  v_mfma_f32_16x16x32_bf16 v[124:127], v[136:139], a[136:139], v[124:127]
  v_mfma_f32_16x16x32_bf16 v[112:115], v[140:143], a[136:139], v[112:115]
  v_mfma_f32_16x16x32_bf16 v[192:195], v[128:131], a[184:187], v[192:195]
  v_mfma_f32_16x16x32_bf16 v[188:191], v[132:135], a[184:187], v[188:191]
  v_mfma_f32_16x16x32_bf16 v[180:183], v[136:139], a[184:187], v[180:183]
  v_mfma_f32_16x16x32_bf16 v[212:215], v[140:143], a[184:187], v[212:215]
  v_mfma_f32_16x16x32_bf16 v[208:211], v[128:131], a[232:235], v[208:211]
  v_mfma_f32_16x16x32_bf16 v[200:203], v[132:135], a[232:235], v[200:203]
  v_mfma_f32_16x16x32_bf16 v[232:235], v[136:139], a[232:235], v[232:235]
  v_mfma_f32_16x16x32_bf16 v[228:231], v[140:143], a[232:235], v[228:231]
  v_mfma_f32_16x16x32_bf16 v[220:223], v[128:131], v[24:27], v[220:223]
  ds_read_b64_tr_b16 v[128:129], v160 offset:28672
  v_mfma_f32_16x16x32_bf16 v[252:255], v[132:135], v[24:27], v[252:255]
  ds_read_b64_tr_b16 v[130:131], v160 offset:30720
  v_mfma_f32_16x16x32_bf16 v[248:251], v[136:139], v[24:27], v[248:251]
  ds_read_b64_tr_b16 v[132:133], v161 offset:28672
  v_mfma_f32_16x16x32_bf16 v[240:243], v[140:143], v[24:27], v[240:243]
  s_waitcnt lgkmcnt(9)
  ds_read_b64_tr_b16 v[134:135], v161 offset:30720
  v_mfma_f32_16x16x32_bf16 v[68:71], v[144:147], a[44:47], v[68:71]
  s_waitcnt lgkmcnt(8)
  ds_read_b64_tr_b16 v[136:137], v162 offset:28672
  v_mfma_f32_16x16x32_bf16 v[72:75], v[148:151], a[44:47], v[72:75]
  s_waitcnt lgkmcnt(7)
  ds_read_b64_tr_b16 v[138:139], v162 offset:30720
  v_mfma_f32_16x16x32_bf16 v[76:79], v[152:155], a[44:47], v[76:79]
  s_waitcnt lgkmcnt(6)
  ds_read_b64_tr_b16 v[140:141], v163 offset:28672
  v_mfma_f32_16x16x32_bf16 v[80:83], v[156:159], a[44:47], v[80:83]
  ds_read_b64_tr_b16 v[142:143], v163 offset:30720
  v_mfma_f32_16x16x32_bf16 v[84:87], v[144:147], a[92:95], v[84:87]
  v_mul_f32 v68, v68, v96
  v_mul_f32 v69, v69, v96
  v_mfma_f32_16x16x32_bf16 v[88:91], v[148:151], a[92:95], v[88:91]
  v_mul_f32 v70, v70, v96
  v_mul_f32 v71, v71, v96
  v_mfma_f32_16x16x32_bf16 v[92:95], v[152:155], a[92:95], v[92:95]
  v_cvt_pk_bf16_f32 v68, v68, v69
  v_cvt_pk_bf16_f32 v69, v70, v71
  v_mfma_f32_16x16x32_bf16 v[104:107], v[156:159], a[92:95], v[104:107]
  v_mul_f32 v72, v72, v96
  v_mul_f32 v73, v73, v96
  v_mfma_f32_16x16x32_bf16 v[108:111], v[144:147], a[140:143], v[108:111]
  v_mul_f32 v74, v74, v96
  v_mul_f32 v75, v75, v96
  v_mfma_f32_16x16x32_bf16 v[120:123], v[148:151], a[140:143], v[120:123]
  v_cvt_pk_bf16_f32 v70, v72, v73
  v_cvt_pk_bf16_f32 v71, v74, v75
  v_mfma_f32_16x16x32_bf16 v[124:127], v[152:155], a[140:143], v[124:127]
  v_mul_f32 v76, v76, v96
  v_mul_f32 v77, v77, v96
  v_mfma_f32_16x16x32_bf16 v[112:115], v[156:159], a[140:143], v[112:115]
  v_mul_f32 v78, v78, v96
  v_mul_f32 v79, v79, v96
  v_mfma_f32_16x16x32_bf16 v[192:195], v[144:147], a[188:191], v[192:195]
  v_permlane16_swap_b32 v68, v70
  v_mfma_f32_16x16x32_bf16 v[188:191], v[148:151], a[188:191], v[188:191]
  v_cvt_pk_bf16_f32 v76, v76, v77
  v_cvt_pk_bf16_f32 v77, v78, v79
  v_mfma_f32_16x16x32_bf16 v[180:183], v[152:155], a[188:191], v[180:183]
  v_permlane16_swap_b32 v69, v71
  v_mfma_f32_16x16x32_bf16 v[212:215], v[156:159], a[188:191], v[212:215]
  v_mul_f32 v80, v80, v96
  v_mul_f32 v81, v81, v96
  v_mfma_f32_16x16x32_bf16 v[208:211], v[144:147], a[236:239], v[208:211]
  v_mul_f32 v82, v82, v96
  v_mul_f32 v83, v83, v96
  v_mfma_f32_16x16x32_bf16 v[200:203], v[148:151], a[236:239], v[200:203]
  v_cvt_pk_bf16_f32 v78, v80, v81
  v_cvt_pk_bf16_f32 v79, v82, v83
  v_mfma_f32_16x16x32_bf16 v[232:235], v[152:155], a[236:239], v[232:235]
  v_permlane16_swap_b32 v76, v78
  v_mfma_f32_16x16x32_bf16 v[228:231], v[156:159], a[236:239], v[228:231]
  v_permlane16_swap_b32 v77, v79
  v_mfma_f32_16x16x32_bf16 v[220:223], v[144:147], v[28:31], v[220:223]
  ds_read_b64_tr_b16 v[144:145], v160 offset:32768
  v_mov_b32 v72, v76
  v_mfma_f32_16x16x32_bf16 v[252:255], v[148:151], v[28:31], v[252:255]
  ds_read_b64_tr_b16 v[146:147], v160 offset:34816
  v_mov_b32_dpp v76, v68 row_ror:8 row_mask:0xf bank_mask:0x3
  v_mfma_f32_16x16x32_bf16 v[248:251], v[152:155], v[28:31], v[248:251]
  ds_read_b64_tr_b16 v[148:149], v161 offset:32768
  v_mov_b32_dpp v68, v72 row_ror:8 row_mask:0xf bank_mask:0xc
  v_mfma_f32_16x16x32_bf16 v[240:243], v[156:159], v[28:31], v[240:243]
  s_waitcnt lgkmcnt(9)
  ds_read_b64_tr_b16 v[150:151], v161 offset:34816
  v_mov_b32 v73, v77
  v_mfma_f32_16x16x32_bf16 v[176:179], v[128:131], a[0:3], 0
  s_waitcnt lgkmcnt(8)
  ds_read_b64_tr_b16 v[152:153], v162 offset:32768
  s_mov_b32 s33, 128
  v_mov_b32_dpp v77, v69 row_ror:8 row_mask:0xf bank_mask:0x3
  v_mfma_f32_16x16x32_bf16 v[184:187], v[132:135], a[0:3], 0
  s_waitcnt lgkmcnt(7)
  ds_read_b64_tr_b16 v[154:155], v162 offset:34816
  v_mov_b32_dpp v69, v73 row_ror:8 row_mask:0xf bank_mask:0xc
  v_mfma_f32_16x16x32_bf16 v[196:199], v[136:139], a[0:3], 0
  s_waitcnt lgkmcnt(6)
  ds_read_b64_tr_b16 v[156:157], v163 offset:32768
  v_mov_b32 v74, v78
  v_mfma_f32_16x16x32_bf16 v[204:207], v[140:143], a[0:3], 0
  ds_read_b64_tr_b16 v[158:159], v163 offset:34816
  v_mov_b32_dpp v78, v70 row_ror:8 row_mask:0xf bank_mask:0x3
  v_mfma_f32_16x16x32_bf16 v[216:219], v[128:131], a[48:51], 0
  v_mov_b32_dpp v70, v74 row_ror:8 row_mask:0xf bank_mask:0xc
  v_mov_b32 v75, v79
  v_mfma_f32_16x16x32_bf16 v[224:227], v[132:135], a[48:51], 0
  v_mov_b32_dpp v79, v71 row_ror:8 row_mask:0xf bank_mask:0x3
  v_mov_b32_dpp v71, v75 row_ror:8 row_mask:0xf bank_mask:0xc
  v_mfma_f32_16x16x32_bf16 v[236:239], v[136:139], a[48:51], 0
  buffer_store_dwordx4 v[68:71], v169, s[20:23], s33 offen nt
  v_mul_f32 v84, v84, v97
  v_mul_f32 v85, v85, v97
  v_mfma_f32_16x16x32_bf16 v[244:247], v[140:143], a[48:51], 0
  v_mul_f32 v86, v86, v97
  v_mul_f32 v87, v87, v97
  v_mfma_f32_16x16x32_bf16 v[172:175], v[128:131], a[96:99], 0
  v_cvt_pk_bf16_f32 v84, v84, v85
  v_cvt_pk_bf16_f32 v85, v86, v87
  v_mfma_f32_16x16x32_bf16 v[44:47], v[132:135], a[96:99], 0
  v_mul_f32 v88, v88, v97
  v_mul_f32 v89, v89, v97
  v_mfma_f32_16x16x32_bf16 v[40:43], v[136:139], a[96:99], 0
  v_mul_f32 v90, v90, v97
  v_mul_f32 v91, v91, v97
  v_mfma_f32_16x16x32_bf16 v[32:35], v[140:143], a[96:99], 0
  v_cvt_pk_bf16_f32 v86, v88, v89
  v_cvt_pk_bf16_f32 v87, v90, v91
  v_mfma_f32_16x16x32_bf16 v[64:67], v[128:131], a[144:147], 0
  v_mul_f32 v92, v92, v97
  v_mul_f32 v93, v93, v97
  v_mfma_f32_16x16x32_bf16 v[60:63], v[132:135], a[144:147], 0
  v_mul_f32 v94, v94, v97
  v_mul_f32 v95, v95, v97
  v_mfma_f32_16x16x32_bf16 v[52:55], v[136:139], a[144:147], 0
  v_permlane16_swap_b32 v84, v86
  v_mfma_f32_16x16x32_bf16 v[164:167], v[140:143], a[144:147], 0
  v_cvt_pk_bf16_f32 v92, v92, v93
  v_cvt_pk_bf16_f32 v93, v94, v95
  v_mfma_f32_16x16x32_bf16 v[36:39], v[128:131], a[192:195], 0
  v_permlane16_swap_b32 v85, v87
  v_mfma_f32_16x16x32_bf16 v[48:51], v[132:135], a[192:195], 0
  v_mul_f32 v104, v104, v97
  v_mul_f32 v105, v105, v97
  v_mfma_f32_16x16x32_bf16 v[56:59], v[136:139], a[192:195], 0
  v_mul_f32 v106, v106, v97
  v_mul_f32 v107, v107, v97
  v_mfma_f32_16x16x32_bf16 v[80:83], v[140:143], a[192:195], 0
  v_cvt_pk_bf16_f32 v94, v104, v105
  v_cvt_pk_bf16_f32 v95, v106, v107
  v_mfma_f32_16x16x32_bf16 v[72:75], v[128:131], a[240:243], 0
  ds_read_b64_tr_b16 v[128:129], v160 offset:36864
  v_mul_f32 v108, v108, v98
  v_mfma_f32_16x16x32_bf16 v[104:107], v[132:135], a[240:243], 0
  ds_read_b64_tr_b16 v[130:131], v160 offset:38912
  v_mul_f32 v109, v109, v98
  v_permlane16_swap_b32 v92, v94
  v_mov_b32 v88, v92
  s_nop 0
  v_mov_b32_dpp v92, v84 row_ror:8 row_mask:0xf bank_mask:0x3
  v_mov_b32_dpp v84, v88 row_ror:8 row_mask:0xf bank_mask:0xc
  v_permlane16_swap_b32 v93, v95
  v_mov_b32 v89, v93
  s_nop 0
  v_mov_b32_dpp v93, v85 row_ror:8 row_mask:0xf bank_mask:0x3
  v_mov_b32_dpp v85, v89 row_ror:8 row_mask:0xf bank_mask:0xc
  v_mov_b32 v90, v94
  v_mov_b32_dpp v94, v86 row_ror:8 row_mask:0xf bank_mask:0x3
  s_nop 0
  v_mov_b32_dpp v86, v90 row_ror:8 row_mask:0xf bank_mask:0xc
  v_mov_b32 v91, v95
  v_mov_b32_dpp v95, v87 row_ror:8 row_mask:0xf bank_mask:0x3
  s_nop 0
  v_mov_b32_dpp v87, v91 row_ror:8 row_mask:0xf bank_mask:0xc
  v_mfma_f32_16x16x32_bf16 v[88:91], v[136:139], a[240:243], 0
  ds_read_b64_tr_b16 v[132:133], v161 offset:36864
  s_mov_b32 s34, 4224
  v_mul_f32 v110, v110, v98
  v_mul_f32 v112, v112, v98
  v_mul_f32 v113, v113, v98
  v_mul_f32 v114, v114, v98
  v_mul_f32 v115, v115, v98
  v_mul_f32 v126, v126, v98
  v_mul_f32 v125, v125, v98
  v_mul_f32 v127, v127, v98
  v_mul_f32 v124, v124, v98
  v_cvt_pk_bf16_f32 v124, v124, v125
  v_cvt_pk_bf16_f32 v125, v126, v127
  v_cvt_pk_bf16_f32 v126, v112, v113
  v_cvt_pk_bf16_f32 v127, v114, v115
  v_mfma_f32_16x16x32_bf16 v[112:115], v[140:143], a[240:243], 0
  s_waitcnt lgkmcnt(9)
  ds_read_b64_tr_b16 v[134:135], v161 offset:38912
  v_mul_f32 v111, v111, v98
  v_mfma_f32_16x16x32_bf16 v[176:179], v[144:147], a[4:7], v[176:179]
  s_waitcnt lgkmcnt(8)
  ds_read_b64_tr_b16 v[136:137], v162 offset:36864
  s_waitcnt vmcnt(14)
  s_barrier
  v_cvt_pk_bf16_f32 v108, v108, v109
  v_mfma_f32_16x16x32_bf16 v[184:187], v[148:151], a[4:7], v[184:187]
  s_waitcnt lgkmcnt(7)
  ds_read_b64_tr_b16 v[138:139], v162 offset:38912
  v_cvt_pk_bf16_f32 v109, v110, v111
  v_mfma_f32_16x16x32_bf16 v[196:199], v[152:155], a[4:7], v[196:199]
  s_waitcnt lgkmcnt(6)
  buffer_store_dwordx4 v[76:79], v169, s[20:23], s34 offen nt
  v_mul_f32 v120, v120, v98
  v_mul_f32 v121, v121, v98
  v_mfma_f32_16x16x32_bf16 v[204:207], v[156:159], a[4:7], v[204:207]
  ds_read_b64_tr_b16 v[140:141], v163 offset:36864
  v_mul_f32 v122, v122, v98
  v_mfma_f32_16x16x32_bf16 v[216:219], v[144:147], a[52:55], v[216:219]
  ds_read_b64_tr_b16 v[142:143], v163 offset:38912
  v_mul_f32 v123, v123, v98
  v_mfma_f32_16x16x32_bf16 v[224:227], v[148:151], a[52:55], v[224:227]
  v_cvt_pk_bf16_f32 v110, v120, v121
  v_cvt_pk_bf16_f32 v111, v122, v123
  v_mfma_f32_16x16x32_bf16 v[236:239], v[152:155], a[52:55], v[236:239]
  v_permlane16_swap_b32 v108, v110
  v_mfma_f32_16x16x32_bf16 v[244:247], v[156:159], a[52:55], v[244:247]
  v_permlane16_swap_b32 v109, v111
  v_mfma_f32_16x16x32_bf16 v[172:175], v[144:147], a[100:103], v[172:175]
  v_permlane16_swap_b32 v124, v126
  v_mfma_f32_16x16x32_bf16 v[44:47], v[148:151], a[100:103], v[44:47]
  v_permlane16_swap_b32 v125, v127
  v_mfma_f32_16x16x32_bf16 v[40:43], v[152:155], a[100:103], v[40:43]
  v_mov_b32 v120, v124
  v_mov_b32_dpp v124, v108 row_ror:8 row_mask:0xf bank_mask:0x3
  v_mfma_f32_16x16x32_bf16 v[32:35], v[156:159], a[100:103], v[32:35]
  v_mov_b32_dpp v108, v120 row_ror:8 row_mask:0xf bank_mask:0xc
  v_mov_b32 v121, v125
  v_mfma_f32_16x16x32_bf16 v[64:67], v[144:147], a[148:151], v[64:67]
  v_mov_b32_dpp v125, v109 row_ror:8 row_mask:0xf bank_mask:0x3
  v_mov_b32_dpp v109, v121 row_ror:8 row_mask:0xf bank_mask:0xc
  v_mfma_f32_16x16x32_bf16 v[60:63], v[148:151], a[148:151], v[60:63]
  v_mov_b32 v122, v126
  v_mov_b32_dpp v126, v110 row_ror:8 row_mask:0xf bank_mask:0x3
  v_mfma_f32_16x16x32_bf16 v[52:55], v[152:155], a[148:151], v[52:55]
  v_mov_b32_dpp v110, v122 row_ror:8 row_mask:0xf bank_mask:0xc
  v_mov_b32 v123, v127
  v_mfma_f32_16x16x32_bf16 v[164:167], v[156:159], a[148:151], v[164:167]
  v_mov_b32_dpp v127, v111 row_ror:8 row_mask:0xf bank_mask:0x3
  v_mov_b32_dpp v111, v123 row_ror:8 row_mask:0xf bank_mask:0xc
  v_mfma_f32_16x16x32_bf16 v[36:39], v[144:147], a[196:199], v[36:39]
  v_mul_f32 v192, v192, v99
  v_mul_f32 v193, v193, v99
  v_mfma_f32_16x16x32_bf16 v[48:51], v[148:151], a[196:199], v[48:51]
  v_mul_f32 v194, v194, v99
  v_mul_f32 v195, v195, v99
  v_mfma_f32_16x16x32_bf16 v[56:59], v[152:155], a[196:199], v[56:59]
  v_cvt_pk_bf16_f32 v192, v192, v193
  v_cvt_pk_bf16_f32 v193, v194, v195
  v_mfma_f32_16x16x32_bf16 v[80:83], v[156:159], a[196:199], v[80:83]
  v_mul_f32 v188, v188, v99
  v_mul_f32 v189, v189, v99
  v_mfma_f32_16x16x32_bf16 v[72:75], v[144:147], a[244:247], v[72:75]
  ds_read_b64_tr_b16 v[144:145], v160 offset:40960
  v_mul_f32 v190, v190, v99
  v_mfma_f32_16x16x32_bf16 v[104:107], v[148:151], a[244:247], v[104:107]
  ds_read_b64_tr_b16 v[146:147], v160 offset:43008
  s_mov_b32 s35, 32896
  v_mul_f32 v191, v191, v99
  v_mfma_f32_16x16x32_bf16 v[88:91], v[152:155], a[244:247], v[88:91]
  ds_read_b64_tr_b16 v[148:149], v161 offset:40960
  v_cvt_pk_bf16_f32 v194, v188, v189
  v_mfma_f32_16x16x32_bf16 v[112:115], v[156:159], a[244:247], v[112:115]
  s_waitcnt lgkmcnt(9)
  ds_read_b64_tr_b16 v[150:151], v161 offset:43008
  v_cvt_pk_bf16_f32 v195, v190, v191
  v_mfma_f32_16x16x32_bf16 v[176:179], v[128:131], a[8:11], v[176:179]
  s_waitcnt lgkmcnt(8)
  ds_read_b64_tr_b16 v[152:153], v162 offset:40960
  v_mul_f32 v180, v180, v99
  v_mfma_f32_16x16x32_bf16 v[184:187], v[132:135], a[8:11], v[184:187]
  s_waitcnt lgkmcnt(7)
  buffer_store_dwordx4 v[84:87], v169, s[20:23], s35 offen nt
  v_mul_f32 v181, v181, v99
  v_mul_f32 v182, v182, v99
  v_mfma_f32_16x16x32_bf16 v[196:199], v[136:139], a[8:11], v[196:199]
  s_waitcnt lgkmcnt(5)
  ds_read_b64_tr_b16 v[154:155], v162 offset:43008
  v_mul_f32 v183, v183, v99
  v_mfma_f32_16x16x32_bf16 v[204:207], v[140:143], a[8:11], v[204:207]
  ds_read_b64_tr_b16 v[156:157], v163 offset:40960
  v_cvt_pk_bf16_f32 v180, v180, v181
  v_mfma_f32_16x16x32_bf16 v[216:219], v[128:131], a[56:59], v[216:219]
  ds_read_b64_tr_b16 v[158:159], v163 offset:43008
  v_cvt_pk_bf16_f32 v181, v182, v183
  v_mfma_f32_16x16x32_bf16 v[224:227], v[132:135], a[56:59], v[224:227]
  v_permlane16_swap_b32 v192, v194
  v_mfma_f32_16x16x32_bf16 v[236:239], v[136:139], a[56:59], v[236:239]
  v_permlane16_swap_b32 v193, v195
  v_mfma_f32_16x16x32_bf16 v[244:247], v[140:143], a[56:59], v[244:247]
  v_mul_f32 v212, v212, v99
  v_mul_f32 v213, v213, v99
  v_mfma_f32_16x16x32_bf16 v[172:175], v[128:131], a[104:107], v[172:175]
  v_mul_f32 v214, v214, v99
  v_mul_f32 v215, v215, v99
  v_mfma_f32_16x16x32_bf16 v[44:47], v[132:135], a[104:107], v[44:47]
  v_cvt_pk_bf16_f32 v182, v212, v213
  v_cvt_pk_bf16_f32 v183, v214, v215
  v_mfma_f32_16x16x32_bf16 v[40:43], v[136:139], a[104:107], v[40:43]
  v_permlane16_swap_b32 v180, v182
  v_mfma_f32_16x16x32_bf16 v[32:35], v[140:143], a[104:107], v[32:35]
  v_permlane16_swap_b32 v181, v183
  v_mfma_f32_16x16x32_bf16 v[64:67], v[128:131], a[152:155], v[64:67]
  v_mov_b32 v188, v180
  v_mov_b32_dpp v180, v192 row_ror:8 row_mask:0xf bank_mask:0x3
  v_mfma_f32_16x16x32_bf16 v[60:63], v[132:135], a[152:155], v[60:63]
  v_mov_b32_dpp v192, v188 row_ror:8 row_mask:0xf bank_mask:0xc
  v_mov_b32 v189, v181
  v_mfma_f32_16x16x32_bf16 v[52:55], v[136:139], a[152:155], v[52:55]
  v_mov_b32_dpp v181, v193 row_ror:8 row_mask:0xf bank_mask:0x3
  v_mov_b32_dpp v193, v189 row_ror:8 row_mask:0xf bank_mask:0xc
  v_mfma_f32_16x16x32_bf16 v[164:167], v[140:143], a[152:155], v[164:167]
  v_mov_b32 v190, v182
  v_mov_b32_dpp v182, v194 row_ror:8 row_mask:0xf bank_mask:0x3
  v_mfma_f32_16x16x32_bf16 v[36:39], v[128:131], a[200:203], v[36:39]
  v_mov_b32_dpp v194, v190 row_ror:8 row_mask:0xf bank_mask:0xc
  v_mov_b32 v191, v183
  v_mfma_f32_16x16x32_bf16 v[48:51], v[132:135], a[200:203], v[48:51]
  v_mov_b32_dpp v183, v195 row_ror:8 row_mask:0xf bank_mask:0x3
  v_mov_b32_dpp v195, v191 row_ror:8 row_mask:0xf bank_mask:0xc
  v_mfma_f32_16x16x32_bf16 v[56:59], v[136:139], a[200:203], v[56:59]
  v_mul_f32 v208, v208, v100
  v_mul_f32 v209, v209, v100
  v_mfma_f32_16x16x32_bf16 v[80:83], v[140:143], a[200:203], v[80:83]
  v_mul_f32 v210, v210, v100
  v_mul_f32 v211, v211, v100
  v_mfma_f32_16x16x32_bf16 v[72:75], v[128:131], a[248:251], v[72:75]
  ds_read_b64_tr_b16 v[128:129], v160 offset:45056
  s_mov_b32 s36, 36992
  v_cvt_pk_bf16_f32 v208, v208, v209
  v_mfma_f32_16x16x32_bf16 v[104:107], v[132:135], a[248:251], v[104:107]
  ds_read_b64_tr_b16 v[130:131], v160 offset:47104
  v_cvt_pk_bf16_f32 v209, v210, v211
  v_mfma_f32_16x16x32_bf16 v[88:91], v[136:139], a[248:251], v[88:91]
  ds_read_b64_tr_b16 v[132:133], v161 offset:45056
  v_mul_f32 v200, v200, v100
  v_mfma_f32_16x16x32_bf16 v[112:115], v[140:143], a[248:251], v[112:115]
  s_waitcnt lgkmcnt(9)
  ds_read_b64_tr_b16 v[134:135], v161 offset:47104
  v_mul_f32 v201, v201, v100
  v_mfma_f32_16x16x32_bf16 v[176:179], v[144:147], a[12:15], v[176:179]
  s_waitcnt lgkmcnt(8)
  buffer_store_dwordx4 v[92:95], v169, s[20:23], s36 offen nt
  v_mul_f32 v202, v202, v100
  v_mul_f32 v203, v203, v100
  v_mfma_f32_16x16x32_bf16 v[184:187], v[148:151], a[12:15], v[184:187]
  s_waitcnt lgkmcnt(6)
  ds_read_b64_tr_b16 v[136:137], v162 offset:45056
  v_cvt_pk_bf16_f32 v210, v200, v201
  v_mfma_f32_16x16x32_bf16 v[196:199], v[152:155], a[12:15], v[196:199]
  s_waitcnt lgkmcnt(5)
  ds_read_b64_tr_b16 v[138:139], v162 offset:47104
  v_cvt_pk_bf16_f32 v211, v202, v203
  v_mfma_f32_16x16x32_bf16 v[204:207], v[156:159], a[12:15], v[204:207]
  ds_read_b64_tr_b16 v[140:141], v163 offset:45056
  v_mul_f32 v232, v232, v100
  v_mfma_f32_16x16x32_bf16 v[216:219], v[144:147], a[60:63], v[216:219]
  ds_read_b64_tr_b16 v[142:143], v163 offset:47104
  v_mul_f32 v233, v233, v100
  v_mfma_f32_16x16x32_bf16 v[224:227], v[148:151], a[60:63], v[224:227]
  v_mul_f32 v234, v234, v100
  v_mul_f32 v235, v235, v100
  v_mfma_f32_16x16x32_bf16 v[236:239], v[152:155], a[60:63], v[236:239]
  v_permlane16_swap_b32 v208, v210
  v_mfma_f32_16x16x32_bf16 v[244:247], v[156:159], a[60:63], v[244:247]
  v_cvt_pk_bf16_f32 v232, v232, v233
  v_cvt_pk_bf16_f32 v233, v234, v235
  v_mfma_f32_16x16x32_bf16 v[172:175], v[144:147], a[108:111], v[172:175]
  v_permlane16_swap_b32 v209, v211
  v_mfma_f32_16x16x32_bf16 v[44:47], v[148:151], a[108:111], v[44:47]
  v_mul_f32 v228, v228, v100
  v_mul_f32 v229, v229, v100
  v_mfma_f32_16x16x32_bf16 v[40:43], v[152:155], a[108:111], v[40:43]
  v_mul_f32 v230, v230, v100
  v_mul_f32 v231, v231, v100
  v_mfma_f32_16x16x32_bf16 v[32:35], v[156:159], a[108:111], v[32:35]
  v_cvt_pk_bf16_f32 v234, v228, v229
  v_cvt_pk_bf16_f32 v235, v230, v231
  v_mfma_f32_16x16x32_bf16 v[64:67], v[144:147], a[156:159], v[64:67]
  v_permlane16_swap_b32 v232, v234
  v_mfma_f32_16x16x32_bf16 v[60:63], v[148:151], a[156:159], v[60:63]
  v_permlane16_swap_b32 v233, v235
  v_mfma_f32_16x16x32_bf16 v[52:55], v[152:155], a[156:159], v[52:55]
  v_mov_b32 v200, v232
  v_mov_b32_dpp v232, v208 row_ror:8 row_mask:0xf bank_mask:0x3
  v_mfma_f32_16x16x32_bf16 v[164:167], v[156:159], a[156:159], v[164:167]
  v_mov_b32_dpp v208, v200 row_ror:8 row_mask:0xf bank_mask:0xc
  v_mov_b32 v201, v233
  v_mfma_f32_16x16x32_bf16 v[36:39], v[144:147], a[204:207], v[36:39]
  v_mov_b32_dpp v233, v209 row_ror:8 row_mask:0xf bank_mask:0x3
  v_mov_b32_dpp v209, v201 row_ror:8 row_mask:0xf bank_mask:0xc
  v_mfma_f32_16x16x32_bf16 v[48:51], v[148:151], a[204:207], v[48:51]
  v_mov_b32 v202, v234
  v_mov_b32_dpp v234, v210 row_ror:8 row_mask:0xf bank_mask:0x3
  v_mfma_f32_16x16x32_bf16 v[56:59], v[152:155], a[204:207], v[56:59]
  v_mov_b32_dpp v210, v202 row_ror:8 row_mask:0xf bank_mask:0xc
  v_mov_b32 v203, v235
  v_mfma_f32_16x16x32_bf16 v[80:83], v[156:159], a[204:207], v[80:83]
  s_mov_b32 s37, 65664
  v_mov_b32_dpp v235, v211 row_ror:8 row_mask:0xf bank_mask:0x3
  v_mov_b32_dpp v211, v203 row_ror:8 row_mask:0xf bank_mask:0xc
  v_mfma_f32_16x16x32_bf16 v[72:75], v[144:147], a[252:255], v[72:75]
  ds_read_b64_tr_b16 v[144:145], v160 offset:49152
  v_mul_f32 v220, v220, v101
  v_mfma_f32_16x16x32_bf16 v[104:107], v[148:151], a[252:255], v[104:107]
  ds_read_b64_tr_b16 v[146:147], v160 offset:51200
  v_mul_f32 v221, v221, v101
  v_mfma_f32_16x16x32_bf16 v[88:91], v[152:155], a[252:255], v[88:91]
  ds_read_b64_tr_b16 v[148:149], v161 offset:49152
  v_mul_f32 v222, v222, v101
  v_mfma_f32_16x16x32_bf16 v[112:115], v[156:159], a[252:255], v[112:115]
  s_waitcnt lgkmcnt(9)
  buffer_store_dwordx4 v[108:111], v169, s[20:23], s37 offen nt
  v_mul_f32 v223, v223, v101
  v_cvt_pk_bf16_f32 v220, v220, v221
  v_mfma_f32_16x16x32_bf16 v[176:179], v[128:131], a[16:19], v[176:179]
  s_waitcnt lgkmcnt(7)
  ds_read_b64_tr_b16 v[150:151], v161 offset:51200
  v_cvt_pk_bf16_f32 v221, v222, v223
  v_mfma_f32_16x16x32_bf16 v[184:187], v[132:135], a[16:19], v[184:187]
  s_waitcnt lgkmcnt(6)
  ds_read_b64_tr_b16 v[152:153], v162 offset:49152
  v_mul_f32 v252, v252, v101
  v_mfma_f32_16x16x32_bf16 v[196:199], v[136:139], a[16:19], v[196:199]
  s_waitcnt lgkmcnt(5)
  ds_read_b64_tr_b16 v[154:155], v162 offset:51200
  v_mul_f32 v253, v253, v101
  v_mfma_f32_16x16x32_bf16 v[204:207], v[140:143], a[16:19], v[204:207]
  ds_read_b64_tr_b16 v[156:157], v163 offset:49152
  v_mul_f32 v254, v254, v101
  v_mfma_f32_16x16x32_bf16 v[216:219], v[128:131], a[64:67], v[216:219]
  ds_read_b64_tr_b16 v[158:159], v163 offset:51200
  v_mul_f32 v255, v255, v101
  v_mfma_f32_16x16x32_bf16 v[224:227], v[132:135], a[64:67], v[224:227]
  v_cvt_pk_bf16_f32 v222, v252, v253
  v_cvt_pk_bf16_f32 v223, v254, v255
  v_mfma_f32_16x16x32_bf16 v[236:239], v[136:139], a[64:67], v[236:239]
  v_mul_f32 v248, v248, v101
  v_mul_f32 v249, v249, v101
  v_mfma_f32_16x16x32_bf16 v[244:247], v[140:143], a[64:67], v[244:247]
  v_mul_f32 v250, v250, v101
  v_mul_f32 v251, v251, v101
  v_mfma_f32_16x16x32_bf16 v[172:175], v[128:131], a[112:115], v[172:175]
  v_permlane16_swap_b32 v220, v222
  v_mfma_f32_16x16x32_bf16 v[44:47], v[132:135], a[112:115], v[44:47]
  v_cvt_pk_bf16_f32 v248, v248, v249
  v_cvt_pk_bf16_f32 v249, v250, v251
  v_mfma_f32_16x16x32_bf16 v[40:43], v[136:139], a[112:115], v[40:43]
  v_permlane16_swap_b32 v221, v223
  v_mfma_f32_16x16x32_bf16 v[32:35], v[140:143], a[112:115], v[32:35]
  v_mul_f32 v240, v240, v101
  v_mul_f32 v241, v241, v101
  v_mfma_f32_16x16x32_bf16 v[64:67], v[128:131], a[160:163], v[64:67]
  v_mul_f32 v242, v242, v101
  v_mul_f32 v243, v243, v101
  v_mfma_f32_16x16x32_bf16 v[60:63], v[132:135], a[160:163], v[60:63]
  v_cvt_pk_bf16_f32 v250, v240, v241
  v_cvt_pk_bf16_f32 v251, v242, v243
  v_mfma_f32_16x16x32_bf16 v[52:55], v[136:139], a[160:163], v[52:55]
  v_permlane16_swap_b32 v248, v250
  v_mfma_f32_16x16x32_bf16 v[164:167], v[140:143], a[160:163], v[164:167]
  v_permlane16_swap_b32 v249, v251
  v_mfma_f32_16x16x32_bf16 v[36:39], v[128:131], a[208:211], v[36:39]
  v_mov_b32 v252, v248
  v_mov_b32_dpp v248, v220 row_ror:8 row_mask:0xf bank_mask:0x3
  v_mfma_f32_16x16x32_bf16 v[48:51], v[132:135], a[208:211], v[48:51]
  v_mov_b32_dpp v220, v252 row_ror:8 row_mask:0xf bank_mask:0xc
  v_mov_b32 v253, v249
  v_mfma_f32_16x16x32_bf16 v[56:59], v[136:139], a[208:211], v[56:59]
  s_mov_b32 s38, 69760
  v_mov_b32_dpp v249, v221 row_ror:8 row_mask:0xf bank_mask:0x3
  v_mov_b32_dpp v221, v253 row_ror:8 row_mask:0xf bank_mask:0xc
  v_mfma_f32_16x16x32_bf16 v[80:83], v[140:143], a[208:211], v[80:83]
  v_mov_b32 v254, v250
  v_mov_b32_dpp v250, v222 row_ror:8 row_mask:0xf bank_mask:0x3
  v_mfma_f32_16x16x32_bf16 v[72:75], v[128:131], v[0:3], v[72:75]
  ds_read_b64_tr_b16 v[128:129], v160 offset:53248
  v_mov_b32_dpp v222, v254 row_ror:8 row_mask:0xf bank_mask:0xc
  v_mfma_f32_16x16x32_bf16 v[104:107], v[132:135], v[0:3], v[104:107]
  ds_read_b64_tr_b16 v[130:131], v160 offset:55296
  v_mov_b32 v255, v251
  v_mfma_f32_16x16x32_bf16 v[88:91], v[136:139], v[0:3], v[88:91]
  buffer_store_dwordx4 v[124:127], v169, s[20:23], s38 offen nt
  v_mov_b32_dpp v251, v223 row_ror:8 row_mask:0xf bank_mask:0x3
  v_mov_b32_dpp v223, v255 row_ror:8 row_mask:0xf bank_mask:0xc
  v_mfma_f32_16x16x32_bf16 v[112:115], v[140:143], v[0:3], v[112:115]
  s_waitcnt lgkmcnt(8)
  ds_read_b64_tr_b16 v[132:133], v161 offset:53248
  v_mfma_f32_16x16x32_bf16 v[176:179], v[144:147], a[20:23], v[176:179]
  s_waitcnt lgkmcnt(7)
  ds_read_b64_tr_b16 v[134:135], v161 offset:55296
  v_mfma_f32_16x16x32_bf16 v[184:187], v[148:151], a[20:23], v[184:187]
  s_waitcnt lgkmcnt(6)
  ds_read_b64_tr_b16 v[136:137], v162 offset:53248
  v_mfma_f32_16x16x32_bf16 v[196:199], v[152:155], a[20:23], v[196:199]
  s_waitcnt lgkmcnt(5)
  ds_read_b64_tr_b16 v[138:139], v162 offset:55296
  v_mfma_f32_16x16x32_bf16 v[204:207], v[156:159], a[20:23], v[204:207]
  ds_read_b64_tr_b16 v[140:141], v163 offset:53248
  v_mfma_f32_16x16x32_bf16 v[216:219], v[144:147], a[68:71], v[216:219]
  ds_read_b64_tr_b16 v[142:143], v163 offset:55296
  v_mfma_f32_16x16x32_bf16 v[224:227], v[148:151], a[68:71], v[224:227]
  v_mfma_f32_16x16x32_bf16 v[236:239], v[152:155], a[68:71], v[236:239]
  v_mfma_f32_16x16x32_bf16 v[244:247], v[156:159], a[68:71], v[244:247]
  v_mfma_f32_16x16x32_bf16 v[172:175], v[144:147], a[116:119], v[172:175]
  v_mfma_f32_16x16x32_bf16 v[44:47], v[148:151], a[116:119], v[44:47]
  v_mfma_f32_16x16x32_bf16 v[40:43], v[152:155], a[116:119], v[40:43]
  v_mfma_f32_16x16x32_bf16 v[32:35], v[156:159], a[116:119], v[32:35]
  v_mfma_f32_16x16x32_bf16 v[64:67], v[144:147], a[164:167], v[64:67]
  v_mfma_f32_16x16x32_bf16 v[60:63], v[148:151], a[164:167], v[60:63]
  v_mfma_f32_16x16x32_bf16 v[52:55], v[152:155], a[164:167], v[52:55]
  v_mfma_f32_16x16x32_bf16 v[164:167], v[156:159], a[164:167], v[164:167]
  v_mfma_f32_16x16x32_bf16 v[36:39], v[144:147], a[212:215], v[36:39]
  s_mov_b32 s39, 98432
  v_mfma_f32_16x16x32_bf16 v[48:51], v[148:151], a[212:215], v[48:51]
  v_mfma_f32_16x16x32_bf16 v[56:59], v[152:155], a[212:215], v[56:59]
  v_mfma_f32_16x16x32_bf16 v[80:83], v[156:159], a[212:215], v[80:83]
  v_mfma_f32_16x16x32_bf16 v[72:75], v[144:147], v[4:7], v[72:75]
  buffer_store_dwordx4 v[192:195], v169, s[20:23], s39 offen nt
  v_mfma_f32_16x16x32_bf16 v[104:107], v[148:151], v[4:7], v[104:107]
  ds_read_b64_tr_b16 v[144:145], v160 offset:57344
  v_mfma_f32_16x16x32_bf16 v[88:91], v[152:155], v[4:7], v[88:91]
  ds_read_b64_tr_b16 v[146:147], v160 offset:59392
  v_mfma_f32_16x16x32_bf16 v[112:115], v[156:159], v[4:7], v[112:115]
  s_waitcnt lgkmcnt(8)
  ds_read_b64_tr_b16 v[148:149], v161 offset:57344
  v_mfma_f32_16x16x32_bf16 v[176:179], v[128:131], a[24:27], v[176:179]
  s_waitcnt lgkmcnt(7)
  ds_read_b64_tr_b16 v[150:151], v161 offset:59392
  v_mfma_f32_16x16x32_bf16 v[184:187], v[132:135], a[24:27], v[184:187]
  s_waitcnt lgkmcnt(6)
  ds_read_b64_tr_b16 v[152:153], v162 offset:57344
  v_mfma_f32_16x16x32_bf16 v[196:199], v[136:139], a[24:27], v[196:199]
  s_waitcnt lgkmcnt(5)
  ds_read_b64_tr_b16 v[154:155], v162 offset:59392
  v_mfma_f32_16x16x32_bf16 v[204:207], v[140:143], a[24:27], v[204:207]
  ds_read_b64_tr_b16 v[156:157], v163 offset:57344
  v_mfma_f32_16x16x32_bf16 v[216:219], v[128:131], a[72:75], v[216:219]
  ds_read_b64_tr_b16 v[158:159], v163 offset:59392
  v_mfma_f32_16x16x32_bf16 v[224:227], v[132:135], a[72:75], v[224:227]
  v_mfma_f32_16x16x32_bf16 v[236:239], v[136:139], a[72:75], v[236:239]
  v_mfma_f32_16x16x32_bf16 v[244:247], v[140:143], a[72:75], v[244:247]
  v_mfma_f32_16x16x32_bf16 v[172:175], v[128:131], a[120:123], v[172:175]
  v_mfma_f32_16x16x32_bf16 v[44:47], v[132:135], a[120:123], v[44:47]
  v_mfma_f32_16x16x32_bf16 v[40:43], v[136:139], a[120:123], v[40:43]
  v_mfma_f32_16x16x32_bf16 v[32:35], v[140:143], a[120:123], v[32:35]
  v_mfma_f32_16x16x32_bf16 v[64:67], v[128:131], a[168:171], v[64:67]
  v_mfma_f32_16x16x32_bf16 v[60:63], v[132:135], a[168:171], v[60:63]
  v_mfma_f32_16x16x32_bf16 v[52:55], v[136:139], a[168:171], v[52:55]
  v_mfma_f32_16x16x32_bf16 v[164:167], v[140:143], a[168:171], v[164:167]
  s_mov_b32 s40, 102528
  v_mfma_f32_16x16x32_bf16 v[36:39], v[128:131], a[216:219], v[36:39]
  v_mfma_f32_16x16x32_bf16 v[48:51], v[132:135], a[216:219], v[48:51]
  v_mfma_f32_16x16x32_bf16 v[56:59], v[136:139], a[216:219], v[56:59]
  v_mfma_f32_16x16x32_bf16 v[80:83], v[140:143], a[216:219], v[80:83]
  buffer_store_dwordx4 v[180:183], v169, s[20:23], s40 offen nt
  v_mfma_f32_16x16x32_bf16 v[72:75], v[128:131], v[8:11], v[72:75]
  ds_read_b64_tr_b16 v[128:129], v160 offset:61440
  v_mfma_f32_16x16x32_bf16 v[104:107], v[132:135], v[8:11], v[104:107]
  ds_read_b64_tr_b16 v[130:131], v160 offset:63488
  v_add_u32 v160, 65536, v160
  v_mfma_f32_16x16x32_bf16 v[88:91], v[136:139], v[8:11], v[88:91]
  ds_read_b64_tr_b16 v[132:133], v161 offset:61440
  v_mfma_f32_16x16x32_bf16 v[112:115], v[140:143], v[8:11], v[112:115]
  s_waitcnt lgkmcnt(9)
  ds_read_b64_tr_b16 v[134:135], v161 offset:63488
  v_add_u32 v161, 65536, v161
  v_mfma_f32_16x16x32_bf16 v[176:179], v[144:147], a[28:31], v[176:179]
  s_waitcnt lgkmcnt(8)
  ds_read_b64_tr_b16 v[136:137], v162 offset:61440
  v_mfma_f32_16x16x32_bf16 v[184:187], v[148:151], a[28:31], v[184:187]
  s_waitcnt lgkmcnt(7)
  ds_read_b64_tr_b16 v[138:139], v162 offset:63488
  v_add_u32 v162, 65536, v162
  v_mfma_f32_16x16x32_bf16 v[196:199], v[152:155], a[28:31], v[196:199]
  s_waitcnt lgkmcnt(6)
  ds_read_b64_tr_b16 v[140:141], v163 offset:61440
  v_mfma_f32_16x16x32_bf16 v[204:207], v[156:159], a[28:31], v[204:207]
  ds_read_b64_tr_b16 v[142:143], v163 offset:63488
  v_add_u32 v163, 65536, v163
  v_mfma_f32_16x16x32_bf16 v[216:219], v[144:147], a[76:79], v[216:219]
  v_mfma_f32_16x16x32_bf16 v[224:227], v[148:151], a[76:79], v[224:227]
  v_mfma_f32_16x16x32_bf16 v[236:239], v[152:155], a[76:79], v[236:239]
  v_mfma_f32_16x16x32_bf16 v[244:247], v[156:159], a[76:79], v[244:247]
  v_mfma_f32_16x16x32_bf16 v[172:175], v[144:147], a[124:127], v[172:175]
  v_mfma_f32_16x16x32_bf16 v[44:47], v[148:151], a[124:127], v[44:47]
  v_mfma_f32_16x16x32_bf16 v[40:43], v[152:155], a[124:127], v[40:43]
  v_mfma_f32_16x16x32_bf16 v[32:35], v[156:159], a[124:127], v[32:35]
  v_mfma_f32_16x16x32_bf16 v[64:67], v[144:147], a[172:175], v[64:67]
  v_mfma_f32_16x16x32_bf16 v[60:63], v[148:151], a[172:175], v[60:63]
  v_mfma_f32_16x16x32_bf16 v[52:55], v[152:155], a[172:175], v[52:55]
  s_mov_b32 s41, 131200
  v_mfma_f32_16x16x32_bf16 v[164:167], v[156:159], a[172:175], v[164:167]
  v_mfma_f32_16x16x32_bf16 v[36:39], v[144:147], a[220:223], v[36:39]
  v_mfma_f32_16x16x32_bf16 v[48:51], v[148:151], a[220:223], v[48:51]
  v_mfma_f32_16x16x32_bf16 v[56:59], v[152:155], a[220:223], v[56:59]
  buffer_store_dwordx4 v[208:211], v169, s[20:23], s41 offen nt
  v_mfma_f32_16x16x32_bf16 v[80:83], v[156:159], a[220:223], v[80:83]
  v_mfma_f32_16x16x32_bf16 v[72:75], v[144:147], v[12:15], v[72:75]
  ds_read_b64_tr_b16 v[144:145], v160 offset:0
  v_mfma_f32_16x16x32_bf16 v[104:107], v[148:151], v[12:15], v[104:107]
  ds_read_b64_tr_b16 v[146:147], v160 offset:2048
  v_mfma_f32_16x16x32_bf16 v[88:91], v[152:155], v[12:15], v[88:91]
  ds_read_b64_tr_b16 v[148:149], v161 offset:0
  v_mfma_f32_16x16x32_bf16 v[112:115], v[156:159], v[12:15], v[112:115]
  s_waitcnt lgkmcnt(9)
  ds_read_b64_tr_b16 v[150:151], v161 offset:2048
  v_mfma_f32_16x16x32_bf16 v[176:179], v[128:131], a[32:35], v[176:179]
  s_waitcnt lgkmcnt(8)
  ds_read_b64_tr_b16 v[152:153], v162 offset:0
  v_mfma_f32_16x16x32_bf16 v[184:187], v[132:135], a[32:35], v[184:187]
  s_waitcnt lgkmcnt(7)
  ds_read_b64_tr_b16 v[154:155], v162 offset:2048
  v_mfma_f32_16x16x32_bf16 v[196:199], v[136:139], a[32:35], v[196:199]
  s_waitcnt lgkmcnt(6)
  ds_read_b64_tr_b16 v[156:157], v163 offset:0
  v_mfma_f32_16x16x32_bf16 v[204:207], v[140:143], a[32:35], v[204:207]
  ds_read_b64_tr_b16 v[158:159], v163 offset:2048
  v_mfma_f32_16x16x32_bf16 v[216:219], v[128:131], a[80:83], v[216:219]
  v_mfma_f32_16x16x32_bf16 v[224:227], v[132:135], a[80:83], v[224:227]
  v_mfma_f32_16x16x32_bf16 v[236:239], v[136:139], a[80:83], v[236:239]
  v_mfma_f32_16x16x32_bf16 v[244:247], v[140:143], a[80:83], v[244:247]
  v_mfma_f32_16x16x32_bf16 v[172:175], v[128:131], a[128:131], v[172:175]
  v_mfma_f32_16x16x32_bf16 v[44:47], v[132:135], a[128:131], v[44:47]
  v_mfma_f32_16x16x32_bf16 v[40:43], v[136:139], a[128:131], v[40:43]
  v_mfma_f32_16x16x32_bf16 v[32:35], v[140:143], a[128:131], v[32:35]
  v_mfma_f32_16x16x32_bf16 v[64:67], v[128:131], a[176:179], v[64:67]
  v_mfma_f32_16x16x32_bf16 v[60:63], v[132:135], a[176:179], v[60:63]
  s_mov_b32 s42, 135296
  v_mfma_f32_16x16x32_bf16 v[52:55], v[136:139], a[176:179], v[52:55]
  v_mfma_f32_16x16x32_bf16 v[164:167], v[140:143], a[176:179], v[164:167]
  v_mfma_f32_16x16x32_bf16 v[36:39], v[128:131], a[224:227], v[36:39]
  v_mfma_f32_16x16x32_bf16 v[48:51], v[132:135], a[224:227], v[48:51]
  buffer_store_dwordx4 v[232:235], v169, s[20:23], s42 offen nt
  v_mfma_f32_16x16x32_bf16 v[56:59], v[136:139], a[224:227], v[56:59]
  v_mfma_f32_16x16x32_bf16 v[80:83], v[140:143], a[224:227], v[80:83]
  v_mfma_f32_16x16x32_bf16 v[72:75], v[128:131], v[16:19], v[72:75]
  ds_read_b64_tr_b16 v[128:129], v160 offset:4096
  v_mfma_f32_16x16x32_bf16 v[104:107], v[132:135], v[16:19], v[104:107]
  ds_read_b64_tr_b16 v[130:131], v160 offset:6144
  v_mfma_f32_16x16x32_bf16 v[88:91], v[136:139], v[16:19], v[88:91]
  ds_read_b64_tr_b16 v[132:133], v161 offset:4096
  v_mfma_f32_16x16x32_bf16 v[112:115], v[140:143], v[16:19], v[112:115]
  s_waitcnt lgkmcnt(9)
  ds_read_b64_tr_b16 v[134:135], v161 offset:6144
  v_mfma_f32_16x16x32_bf16 v[176:179], v[144:147], a[36:39], v[176:179]
  s_waitcnt lgkmcnt(8)
  ds_read_b64_tr_b16 v[136:137], v162 offset:4096
  v_mfma_f32_16x16x32_bf16 v[184:187], v[148:151], a[36:39], v[184:187]
  s_waitcnt lgkmcnt(7)
  ds_read_b64_tr_b16 v[138:139], v162 offset:6144
  v_mfma_f32_16x16x32_bf16 v[196:199], v[152:155], a[36:39], v[196:199]
  s_waitcnt lgkmcnt(6)
  ds_read_b64_tr_b16 v[140:141], v163 offset:4096
  v_mfma_f32_16x16x32_bf16 v[204:207], v[156:159], a[36:39], v[204:207]
  ds_read_b64_tr_b16 v[142:143], v163 offset:6144
  v_mfma_f32_16x16x32_bf16 v[216:219], v[144:147], a[84:87], v[216:219]
  v_mfma_f32_16x16x32_bf16 v[224:227], v[148:151], a[84:87], v[224:227]
  v_mfma_f32_16x16x32_bf16 v[236:239], v[152:155], a[84:87], v[236:239]
  v_mfma_f32_16x16x32_bf16 v[244:247], v[156:159], a[84:87], v[244:247]
  v_mfma_f32_16x16x32_bf16 v[172:175], v[144:147], a[132:135], v[172:175]
  v_mfma_f32_16x16x32_bf16 v[44:47], v[148:151], a[132:135], v[44:47]
  v_mfma_f32_16x16x32_bf16 v[40:43], v[152:155], a[132:135], v[40:43]
  v_mfma_f32_16x16x32_bf16 v[32:35], v[156:159], a[132:135], v[32:35]
  v_mfma_f32_16x16x32_bf16 v[64:67], v[144:147], a[180:183], v[64:67]
  s_mov_b32 s43, 163968
  v_mfma_f32_16x16x32_bf16 v[60:63], v[148:151], a[180:183], v[60:63]
  v_mfma_f32_16x16x32_bf16 v[52:55], v[152:155], a[180:183], v[52:55]
  v_mfma_f32_16x16x32_bf16 v[164:167], v[156:159], a[180:183], v[164:167]
  v_mfma_f32_16x16x32_bf16 v[36:39], v[144:147], a[228:231], v[36:39]
  buffer_store_dwordx4 v[220:223], v169, s[20:23], s43 offen nt
  v_mfma_f32_16x16x32_bf16 v[48:51], v[148:151], a[228:231], v[48:51]
  v_mfma_f32_16x16x32_bf16 v[56:59], v[152:155], a[228:231], v[56:59]
  v_mfma_f32_16x16x32_bf16 v[80:83], v[156:159], a[228:231], v[80:83]
  v_mfma_f32_16x16x32_bf16 v[72:75], v[144:147], v[20:23], v[72:75]
  ds_read_b64_tr_b16 v[144:145], v160 offset:8192
  v_mfma_f32_16x16x32_bf16 v[104:107], v[148:151], v[20:23], v[104:107]
  ds_read_b64_tr_b16 v[146:147], v160 offset:10240
  v_mfma_f32_16x16x32_bf16 v[88:91], v[152:155], v[20:23], v[88:91]
  ds_read_b64_tr_b16 v[148:149], v161 offset:8192
  v_mfma_f32_16x16x32_bf16 v[112:115], v[156:159], v[20:23], v[112:115]
  s_waitcnt lgkmcnt(9)
  ds_read_b64_tr_b16 v[150:151], v161 offset:10240
  v_mfma_f32_16x16x32_bf16 v[176:179], v[128:131], a[40:43], v[176:179]
  s_waitcnt lgkmcnt(8)
  ds_read_b64_tr_b16 v[152:153], v162 offset:8192
  v_mfma_f32_16x16x32_bf16 v[184:187], v[132:135], a[40:43], v[184:187]
  s_waitcnt lgkmcnt(7)
  ds_read_b64_tr_b16 v[154:155], v162 offset:10240
  v_mfma_f32_16x16x32_bf16 v[196:199], v[136:139], a[40:43], v[196:199]
  s_waitcnt lgkmcnt(6)
  ds_read_b64_tr_b16 v[156:157], v163 offset:8192
  v_mfma_f32_16x16x32_bf16 v[204:207], v[140:143], a[40:43], v[204:207]
  ds_read_b64_tr_b16 v[158:159], v163 offset:10240
  v_mfma_f32_16x16x32_bf16 v[216:219], v[128:131], a[88:91], v[216:219]
  v_mfma_f32_16x16x32_bf16 v[224:227], v[132:135], a[88:91], v[224:227]
  v_mfma_f32_16x16x32_bf16 v[236:239], v[136:139], a[88:91], v[236:239]
  v_mfma_f32_16x16x32_bf16 v[244:247], v[140:143], a[88:91], v[244:247]
  v_mfma_f32_16x16x32_bf16 v[172:175], v[128:131], a[136:139], v[172:175]
  v_mfma_f32_16x16x32_bf16 v[44:47], v[132:135], a[136:139], v[44:47]
  v_mfma_f32_16x16x32_bf16 v[40:43], v[136:139], a[136:139], v[40:43]
  s_mov_b32 s44, 168064
  v_mfma_f32_16x16x32_bf16 v[32:35], v[140:143], a[136:139], v[32:35]
  v_mfma_f32_16x16x32_bf16 v[64:67], v[128:131], a[184:187], v[64:67]
  v_mfma_f32_16x16x32_bf16 v[60:63], v[132:135], a[184:187], v[60:63]
  v_mfma_f32_16x16x32_bf16 v[52:55], v[136:139], a[184:187], v[52:55]
  buffer_store_dwordx4 v[248:251], v169, s[20:23], s44 offen nt
  v_mfma_f32_16x16x32_bf16 v[164:167], v[140:143], a[184:187], v[164:167]
  v_mfma_f32_16x16x32_bf16 v[36:39], v[128:131], a[232:235], v[36:39]
  v_mfma_f32_16x16x32_bf16 v[48:51], v[132:135], a[232:235], v[48:51]
  v_mfma_f32_16x16x32_bf16 v[56:59], v[136:139], a[232:235], v[56:59]
  v_mfma_f32_16x16x32_bf16 v[80:83], v[140:143], a[232:235], v[80:83]
  v_mfma_f32_16x16x32_bf16 v[72:75], v[128:131], v[24:27], v[72:75]
  ds_read_b64_tr_b16 v[128:129], v160 offset:12288
  v_mfma_f32_16x16x32_bf16 v[104:107], v[132:135], v[24:27], v[104:107]
  ds_read_b64_tr_b16 v[130:131], v160 offset:14336
  v_mfma_f32_16x16x32_bf16 v[88:91], v[136:139], v[24:27], v[88:91]
  ds_read_b64_tr_b16 v[132:133], v161 offset:12288
  v_mfma_f32_16x16x32_bf16 v[112:115], v[140:143], v[24:27], v[112:115]
  s_waitcnt lgkmcnt(9)
  ds_read_b64_tr_b16 v[134:135], v161 offset:14336
  v_mfma_f32_16x16x32_bf16 v[176:179], v[144:147], a[44:47], v[176:179]
  s_waitcnt lgkmcnt(8)
  ds_read_b64_tr_b16 v[136:137], v162 offset:12288
  s_waitcnt vmcnt(12)
  s_barrier
  v_mfma_f32_16x16x32_bf16 v[184:187], v[148:151], a[44:47], v[184:187]
  s_waitcnt lgkmcnt(7)
  ds_read_b64_tr_b16 v[138:139], v162 offset:14336
  v_mfma_f32_16x16x32_bf16 v[196:199], v[152:155], a[44:47], v[196:199]
  s_waitcnt lgkmcnt(6)
  ds_read_b64_tr_b16 v[140:141], v163 offset:12288
  v_mfma_f32_16x16x32_bf16 v[204:207], v[156:159], a[44:47], v[204:207]
  ds_read_b64_tr_b16 v[142:143], v163 offset:14336
  v_mul_f32 v176, v176, v96
  v_mfma_f32_16x16x32_bf16 v[216:219], v[144:147], a[92:95], v[216:219]
  v_mul_f32 v177, v177, v96
  v_mul_f32 v178, v178, v96
  v_mfma_f32_16x16x32_bf16 v[224:227], v[148:151], a[92:95], v[224:227]
  v_mul_f32 v179, v179, v96
  v_cvt_pk_bf16_f32 v176, v176, v177
  v_mfma_f32_16x16x32_bf16 v[236:239], v[152:155], a[92:95], v[236:239]
  v_cvt_pk_bf16_f32 v177, v178, v179
  v_mul_f32 v184, v184, v96
  v_mfma_f32_16x16x32_bf16 v[244:247], v[156:159], a[92:95], v[244:247]
  v_mul_f32 v185, v185, v96
  v_mul_f32 v186, v186, v96
  v_mfma_f32_16x16x32_bf16 v[172:175], v[144:147], a[140:143], v[172:175]
  v_mul_f32 v187, v187, v96
  v_cvt_pk_bf16_f32 v178, v184, v185
  v_mfma_f32_16x16x32_bf16 v[44:47], v[148:151], a[140:143], v[44:47]
  v_cvt_pk_bf16_f32 v179, v186, v187
  v_mul_f32 v196, v196, v96
  v_mfma_f32_16x16x32_bf16 v[40:43], v[152:155], a[140:143], v[40:43]
  v_mul_f32 v197, v197, v96
  v_mul_f32 v198, v198, v96
  v_mfma_f32_16x16x32_bf16 v[32:35], v[156:159], a[140:143], v[32:35]
  v_mul_f32 v199, v199, v96
  v_cvt_pk_bf16_f32 v196, v196, v197
  v_mfma_f32_16x16x32_bf16 v[64:67], v[144:147], a[188:191], v[64:67]
  v_permlane16_swap_b32 v176, v178
  v_mfma_f32_16x16x32_bf16 v[60:63], v[148:151], a[188:191], v[60:63]
  v_permlane16_swap_b32 v177, v179
  v_mfma_f32_16x16x32_bf16 v[52:55], v[152:155], a[188:191], v[52:55]
  v_cvt_pk_bf16_f32 v197, v198, v199
  v_mul_f32 v204, v204, v96
  v_mfma_f32_16x16x32_bf16 v[164:167], v[156:159], a[188:191], v[164:167]
  v_mul_f32 v205, v205, v96
  v_mul_f32 v206, v206, v96
  v_mfma_f32_16x16x32_bf16 v[36:39], v[144:147], a[236:239], v[36:39]
  v_mul_f32 v207, v207, v96
  v_cvt_pk_bf16_f32 v198, v204, v205
  v_mfma_f32_16x16x32_bf16 v[48:51], v[148:151], a[236:239], v[48:51]
  v_cvt_pk_bf16_f32 v199, v206, v207
  v_mul_f32 v216, v216, v97
  v_mfma_f32_16x16x32_bf16 v[56:59], v[152:155], a[236:239], v[56:59]
  v_permlane16_swap_b32 v196, v198
  v_mfma_f32_16x16x32_bf16 v[80:83], v[156:159], a[236:239], v[80:83]
  v_permlane16_swap_b32 v197, v199
  v_mfma_f32_16x16x32_bf16 v[72:75], v[144:147], v[28:31], v[72:75]
  ds_read_b64_tr_b16 v[144:145], v160 offset:16384
  v_mov_b32 v184, v196
  v_mfma_f32_16x16x32_bf16 v[104:107], v[148:151], v[28:31], v[104:107]
  ds_read_b64_tr_b16 v[146:147], v160 offset:18432
  v_mov_b32_dpp v196, v176 row_ror:8 row_mask:0xf bank_mask:0x3
  v_mfma_f32_16x16x32_bf16 v[88:91], v[152:155], v[28:31], v[88:91]
  ds_read_b64_tr_b16 v[148:149], v161 offset:16384
  v_mov_b32_dpp v176, v184 row_ror:8 row_mask:0xf bank_mask:0xc
  v_mfma_f32_16x16x32_bf16 v[112:115], v[156:159], v[28:31], v[112:115]
  s_waitcnt lgkmcnt(9)
  ds_read_b64_tr_b16 v[150:151], v161 offset:18432
  v_mov_b32 v185, v197
  v_mfma_f32_16x16x32_bf16 v[120:123], v[128:131], a[0:3], 0
  s_waitcnt lgkmcnt(8)
  ds_read_b64_tr_b16 v[152:153], v162 offset:16384
  s_mov_b32 s45, 256
  v_mov_b32_dpp v197, v177 row_ror:8 row_mask:0xf bank_mask:0x3
  v_mfma_f32_16x16x32_bf16 v[212:215], v[132:135], a[0:3], 0
  s_waitcnt lgkmcnt(7)
  ds_read_b64_tr_b16 v[154:155], v162 offset:18432
  v_mov_b32_dpp v177, v185 row_ror:8 row_mask:0xf bank_mask:0xc
  v_mfma_f32_16x16x32_bf16 v[188:191], v[136:139], a[0:3], 0
  s_waitcnt lgkmcnt(6)
  ds_read_b64_tr_b16 v[156:157], v163 offset:16384
  v_mov_b32 v186, v198
  v_mfma_f32_16x16x32_bf16 v[228:231], v[140:143], a[0:3], 0
  ds_read_b64_tr_b16 v[158:159], v163 offset:18432
  v_mov_b32_dpp v198, v178 row_ror:8 row_mask:0xf bank_mask:0x3
  v_mfma_f32_16x16x32_bf16 v[200:203], v[128:131], a[48:51], 0
  v_mov_b32_dpp v178, v186 row_ror:8 row_mask:0xf bank_mask:0xc
  v_mov_b32 v187, v199
  v_mfma_f32_16x16x32_bf16 v[240:243], v[132:135], a[48:51], 0
  v_mov_b32_dpp v199, v179 row_ror:8 row_mask:0xf bank_mask:0x3
  v_mov_b32_dpp v179, v187 row_ror:8 row_mask:0xf bank_mask:0xc
  v_mfma_f32_16x16x32_bf16 v[252:255], v[136:139], a[48:51], 0
  buffer_store_dwordx4 v[176:179], v169, s[20:23], s45 offen nt
  v_mul_f32 v217, v217, v97
  v_mul_f32 v218, v218, v97
  v_mfma_f32_16x16x32_bf16 v[68:71], v[140:143], a[48:51], 0
  v_mul_f32 v219, v219, v97
  v_cvt_pk_bf16_f32 v216, v216, v217
  v_mfma_f32_16x16x32_bf16 v[76:79], v[128:131], a[96:99], 0
  v_cvt_pk_bf16_f32 v217, v218, v219
  v_mul_f32 v224, v224, v97
  v_mfma_f32_16x16x32_bf16 v[84:87], v[132:135], a[96:99], 0
  v_mul_f32 v225, v225, v97
  v_mul_f32 v226, v226, v97
  v_mfma_f32_16x16x32_bf16 v[92:95], v[136:139], a[96:99], 0
  v_mul_f32 v227, v227, v97
  v_cvt_pk_bf16_f32 v218, v224, v225
  v_mfma_f32_16x16x32_bf16 v[108:111], v[140:143], a[96:99], 0
  v_cvt_pk_bf16_f32 v219, v226, v227
  v_mul_f32 v236, v236, v97
  v_mfma_f32_16x16x32_bf16 v[124:127], v[128:131], a[144:147], 0
  ds_read_b64_tr_b16 v[128:129], v160 offset:20480
  v_mul_f32 v237, v237, v97
  v_mfma_f32_16x16x32_bf16 v[192:195], v[132:135], a[144:147], 0
  ds_read_b64_tr_b16 v[130:131], v160 offset:22528
  v_mul_f32 v238, v238, v97
  v_mfma_f32_16x16x32_bf16 v[180:183], v[136:139], a[144:147], 0
  ds_read_b64_tr_b16 v[132:133], v161 offset:20480
  v_mul_f32 v239, v239, v97
  v_mfma_f32_16x16x32_bf16 v[208:211], v[140:143], a[144:147], 0
  s_waitcnt lgkmcnt(9)
  ds_read_b64_tr_b16 v[134:135], v161 offset:22528
  s_mov_b32 s46, 4352
  v_cvt_pk_bf16_f32 v236, v236, v237
  v_mfma_f32_16x16x32_bf16 v[120:123], v[144:147], a[4:7], v[120:123]
  s_waitcnt lgkmcnt(8)
  ds_read_b64_tr_b16 v[136:137], v162 offset:20480
  v_cvt_pk_bf16_f32 v237, v238, v239
  v_mfma_f32_16x16x32_bf16 v[212:215], v[148:151], a[4:7], v[212:215]
  s_waitcnt lgkmcnt(7)
  ds_read_b64_tr_b16 v[138:139], v162 offset:22528
  v_mul_f32 v244, v244, v97
  v_mfma_f32_16x16x32_bf16 v[188:191], v[152:155], a[4:7], v[188:191]
  s_waitcnt lgkmcnt(6)
  ds_read_b64_tr_b16 v[140:141], v163 offset:20480
  v_mul_f32 v245, v245, v97
  v_mfma_f32_16x16x32_bf16 v[228:231], v[156:159], a[4:7], v[228:231]
  buffer_store_dwordx4 v[196:199], v169, s[20:23], s46 offen nt
  v_permlane16_swap_b32 v216, v218
  v_mfma_f32_16x16x32_bf16 v[200:203], v[144:147], a[52:55], v[200:203]
  ds_read_b64_tr_b16 v[142:143], v163 offset:22528
  v_mul_f32 v246, v246, v97
  v_mfma_f32_16x16x32_bf16 v[240:243], v[148:151], a[52:55], v[240:243]
  v_permlane16_swap_b32 v217, v219
  v_mfma_f32_16x16x32_bf16 v[252:255], v[152:155], a[52:55], v[252:255]
  v_mul_f32 v247, v247, v97
  v_cvt_pk_bf16_f32 v238, v244, v245
  v_mfma_f32_16x16x32_bf16 v[68:71], v[156:159], a[52:55], v[68:71]
  v_cvt_pk_bf16_f32 v239, v246, v247
  v_mul_f32 v172, v172, v98
  v_mfma_f32_16x16x32_bf16 v[76:79], v[144:147], a[100:103], v[76:79]
  v_permlane16_swap_b32 v236, v238
  v_mfma_f32_16x16x32_bf16 v[84:87], v[148:151], a[100:103], v[84:87]
  v_permlane16_swap_b32 v237, v239
  v_mfma_f32_16x16x32_bf16 v[92:95], v[152:155], a[100:103], v[92:95]
  v_mov_b32 v224, v236
  v_mov_b32_dpp v236, v216 row_ror:8 row_mask:0xf bank_mask:0x3
  v_mfma_f32_16x16x32_bf16 v[108:111], v[156:159], a[100:103], v[108:111]
  v_mov_b32_dpp v216, v224 row_ror:8 row_mask:0xf bank_mask:0xc
  v_mov_b32 v225, v237
  v_mfma_f32_16x16x32_bf16 v[124:127], v[144:147], a[148:151], v[124:127]
  ds_read_b64_tr_b16 v[144:145], v160 offset:25600
  v_mov_b32_dpp v237, v217 row_ror:8 row_mask:0xf bank_mask:0x3
  v_mfma_f32_16x16x32_bf16 v[192:195], v[148:151], a[148:151], v[192:195]
  ds_read_b64_tr_b16 v[146:147], v160 offset:27648
  v_mov_b32_dpp v217, v225 row_ror:8 row_mask:0xf bank_mask:0xc
  v_mfma_f32_16x16x32_bf16 v[180:183], v[152:155], a[148:151], v[180:183]
  ds_read_b64_tr_b16 v[148:149], v161 offset:25600
  s_mov_b32 s47, 33024
  v_mov_b32 v226, v238
  v_mfma_f32_16x16x32_bf16 v[208:211], v[156:159], a[148:151], v[208:211]
  s_waitcnt lgkmcnt(9)
  ds_read_b64_tr_b16 v[150:151], v161 offset:27648
  v_mov_b32_dpp v238, v218 row_ror:8 row_mask:0xf bank_mask:0x3
  v_mfma_f32_16x16x32_bf16 v[120:123], v[128:131], a[8:11], v[120:123]
  s_waitcnt lgkmcnt(8)
  ds_read_b64_tr_b16 v[152:153], v162 offset:25600
  v_mov_b32_dpp v218, v226 row_ror:8 row_mask:0xf bank_mask:0xc
  v_mfma_f32_16x16x32_bf16 v[212:215], v[132:135], a[8:11], v[212:215]
  s_waitcnt lgkmcnt(7)
  ds_read_b64_tr_b16 v[154:155], v162 offset:27648
  v_mov_b32 v227, v239
  v_mfma_f32_16x16x32_bf16 v[188:191], v[136:139], a[8:11], v[188:191]
  s_waitcnt lgkmcnt(6)
  ds_read_b64_tr_b16 v[156:157], v163 offset:25600
  v_mov_b32_dpp v239, v219 row_ror:8 row_mask:0xf bank_mask:0x3
  v_mfma_f32_16x16x32_bf16 v[228:231], v[140:143], a[8:11], v[228:231]
  ds_read_b64_tr_b16 v[158:159], v163 offset:27648
  v_mov_b32_dpp v219, v227 row_ror:8 row_mask:0xf bank_mask:0xc
  v_mfma_f32_16x16x32_bf16 v[200:203], v[128:131], a[56:59], v[200:203]
  buffer_store_dwordx4 v[216:219], v169, s[20:23], s47 offen nt
  v_mul_f32 v173, v173, v98
  v_mul_f32 v174, v174, v98
  v_mfma_f32_16x16x32_bf16 v[240:243], v[132:135], a[56:59], v[240:243]
  v_mul_f32 v175, v175, v98
  v_cvt_pk_bf16_f32 v172, v172, v173
  v_mfma_f32_16x16x32_bf16 v[252:255], v[136:139], a[56:59], v[252:255]
  v_cvt_pk_bf16_f32 v173, v174, v175
  v_mul_f32 v44, v44, v98
  v_mfma_f32_16x16x32_bf16 v[68:71], v[140:143], a[56:59], v[68:71]
  v_mul_f32 v45, v45, v98
  v_subrev_u32 v160, 107520, v160
  v_mfma_f32_16x16x32_bf16 v[76:79], v[128:131], a[104:107], v[76:79]
  v_subrev_u32 v161, 107520, v161
  v_subrev_u32 v162, 107520, v162
  v_mfma_f32_16x16x32_bf16 v[84:87], v[132:135], a[104:107], v[84:87]
  v_subrev_u32 v163, 107520, v163
  v_mul_f32 v46, v46, v98
  v_mfma_f32_16x16x32_bf16 v[92:95], v[136:139], a[104:107], v[92:95]
  v_mul_f32 v47, v47, v98
  v_cvt_pk_bf16_f32 v174, v44, v45
  v_mfma_f32_16x16x32_bf16 v[108:111], v[140:143], a[104:107], v[108:111]
  v_cvt_pk_bf16_f32 v175, v46, v47
  v_mul_f32 v40, v40, v98
  v_mfma_f32_16x16x32_bf16 v[124:127], v[128:131], a[152:155], v[124:127]
  ds_read_b64_tr_b16 v[128:129], v160 offset:0
  v_mul_f32 v41, v41, v98
  v_mfma_f32_16x16x32_bf16 v[192:195], v[132:135], a[152:155], v[192:195]
  ds_read_b64_tr_b16 v[130:131], v160 offset:2048
  s_mov_b32 s32, 37120
  v_mul_f32 v42, v42, v98
  v_mfma_f32_16x16x32_bf16 v[180:183], v[136:139], a[152:155], v[180:183]
  ds_read_b64_tr_b16 v[132:133], v161 offset:0
  v_mul_f32 v43, v43, v98
  v_mfma_f32_16x16x32_bf16 v[208:211], v[140:143], a[152:155], v[208:211]
  s_waitcnt lgkmcnt(9)
  ds_read_b64_tr_b16 v[134:135], v161 offset:2048
  v_cvt_pk_bf16_f32 v40, v40, v41
  v_mfma_f32_16x16x32_bf16 v[120:123], v[144:147], a[12:15], v[120:123]
  s_waitcnt lgkmcnt(8)
  ds_read_b64_tr_b16 v[136:137], v162 offset:0
  v_cvt_pk_bf16_f32 v41, v42, v43
  v_mfma_f32_16x16x32_bf16 v[212:215], v[148:151], a[12:15], v[212:215]
  s_waitcnt lgkmcnt(7)
  buffer_store_dwordx4 v[236:239], v169, s[20:23], s32 offen nt
  v_permlane16_swap_b32 v172, v174
  v_mfma_f32_16x16x32_bf16 v[188:191], v[152:155], a[12:15], v[188:191]
  s_waitcnt lgkmcnt(5)
  ds_read_b64_tr_b16 v[138:139], v162 offset:2048
  v_mul_f32 v32, v32, v98
  v_mfma_f32_16x16x32_bf16 v[228:231], v[156:159], a[12:15], v[228:231]
  ds_read_b64_tr_b16 v[140:141], v163 offset:0
  v_mul_f32 v33, v33, v98
  v_mfma_f32_16x16x32_bf16 v[200:203], v[144:147], a[60:63], v[200:203]
  ds_read_b64_tr_b16 v[142:143], v163 offset:2048
  v_mul_f32 v34, v34, v98
  v_mfma_f32_16x16x32_bf16 v[240:243], v[148:151], a[60:63], v[240:243]
  v_permlane16_swap_b32 v173, v175
  v_mfma_f32_16x16x32_bf16 v[252:255], v[152:155], a[60:63], v[252:255]
  v_mul_f32 v35, v35, v98
  v_cvt_pk_bf16_f32 v42, v32, v33
  v_mfma_f32_16x16x32_bf16 v[68:71], v[156:159], a[60:63], v[68:71]
  v_cvt_pk_bf16_f32 v43, v34, v35
  v_mul_f32 v64, v64, v99
  v_mfma_f32_16x16x32_bf16 v[76:79], v[144:147], a[108:111], v[76:79]
  v_permlane16_swap_b32 v40, v42
  v_mfma_f32_16x16x32_bf16 v[84:87], v[148:151], a[108:111], v[84:87]
  v_permlane16_swap_b32 v41, v43
  v_mfma_f32_16x16x32_bf16 v[92:95], v[152:155], a[108:111], v[92:95]
  v_mov_b32 v44, v40
  v_mov_b32_dpp v40, v172 row_ror:8 row_mask:0xf bank_mask:0x3
  v_mfma_f32_16x16x32_bf16 v[108:111], v[156:159], a[108:111], v[108:111]
  v_mov_b32_dpp v172, v44 row_ror:8 row_mask:0xf bank_mask:0xc
  v_mov_b32 v45, v41
  v_mfma_f32_16x16x32_bf16 v[124:127], v[144:147], a[156:159], v[124:127]
  ds_read_b64_tr_b16 v[144:145], v160 offset:4096
  s_mov_b32 s33, 65792
  v_mov_b32_dpp v41, v173 row_ror:8 row_mask:0xf bank_mask:0x3
  v_mfma_f32_16x16x32_bf16 v[192:195], v[148:151], a[156:159], v[192:195]
  ds_read_b64_tr_b16 v[146:147], v160 offset:6144
  v_mov_b32_dpp v173, v45 row_ror:8 row_mask:0xf bank_mask:0xc
  v_mfma_f32_16x16x32_bf16 v[180:183], v[152:155], a[156:159], v[180:183]
  ds_read_b64_tr_b16 v[148:149], v161 offset:4096
  v_mov_b32 v46, v42
  v_mfma_f32_16x16x32_bf16 v[208:211], v[156:159], a[156:159], v[208:211]
  s_waitcnt lgkmcnt(9)
  ds_read_b64_tr_b16 v[150:151], v161 offset:6144
  v_mov_b32_dpp v42, v174 row_ror:8 row_mask:0xf bank_mask:0x3
  v_mfma_f32_16x16x32_bf16 v[120:123], v[128:131], a[16:19], v[120:123]
  s_waitcnt lgkmcnt(8)
  ds_read_b64_tr_b16 v[152:153], v162 offset:4096
  v_mov_b32_dpp v174, v46 row_ror:8 row_mask:0xf bank_mask:0xc
  v_mfma_f32_16x16x32_bf16 v[212:215], v[132:135], a[16:19], v[212:215]
  s_waitcnt lgkmcnt(7)
  ds_read_b64_tr_b16 v[154:155], v162 offset:6144
  v_mov_b32 v47, v43
  v_mfma_f32_16x16x32_bf16 v[188:191], v[136:139], a[16:19], v[188:191]
  s_waitcnt lgkmcnt(6)
  ds_read_b64_tr_b16 v[156:157], v163 offset:4096
  v_mov_b32_dpp v43, v175 row_ror:8 row_mask:0xf bank_mask:0x3
  v_mfma_f32_16x16x32_bf16 v[228:231], v[140:143], a[16:19], v[228:231]
  ds_read_b64_tr_b16 v[158:159], v163 offset:6144
  v_mov_b32_dpp v175, v47 row_ror:8 row_mask:0xf bank_mask:0xc
  v_mfma_f32_16x16x32_bf16 v[200:203], v[128:131], a[64:67], v[200:203]
  buffer_store_dwordx4 v[172:175], v169, s[20:23], s33 offen nt
  v_mul_f32 v65, v65, v99
  v_mul_f32 v66, v66, v99
  v_mfma_f32_16x16x32_bf16 v[240:243], v[132:135], a[64:67], v[240:243]
  v_mul_f32 v67, v67, v99
  v_cvt_pk_bf16_f32 v64, v64, v65
  v_mfma_f32_16x16x32_bf16 v[252:255], v[136:139], a[64:67], v[252:255]
  v_cvt_pk_bf16_f32 v65, v66, v67
  v_mul_f32 v60, v60, v99
  v_mfma_f32_16x16x32_bf16 v[68:71], v[140:143], a[64:67], v[68:71]
  v_mul_f32 v61, v61, v99
  v_mul_f32 v62, v62, v99
  v_mfma_f32_16x16x32_bf16 v[76:79], v[128:131], a[112:115], v[76:79]
  v_mul_f32 v63, v63, v99
  v_cvt_pk_bf16_f32 v66, v60, v61
  v_mfma_f32_16x16x32_bf16 v[84:87], v[132:135], a[112:115], v[84:87]
  v_cvt_pk_bf16_f32 v67, v62, v63
  v_mul_f32 v52, v52, v99
  v_mfma_f32_16x16x32_bf16 v[92:95], v[136:139], a[112:115], v[92:95]
  v_mul_f32 v53, v53, v99
  v_mul_f32 v54, v54, v99
  v_mfma_f32_16x16x32_bf16 v[108:111], v[140:143], a[112:115], v[108:111]
  v_mul_f32 v55, v55, v99
  v_cvt_pk_bf16_f32 v52, v52, v53
  v_mfma_f32_16x16x32_bf16 v[124:127], v[128:131], a[160:163], v[124:127]
  ds_read_b64_tr_b16 v[128:129], v160 offset:8448
  s_mov_b32 s34, 69888
  v_cvt_pk_bf16_f32 v53, v54, v55
  v_mfma_f32_16x16x32_bf16 v[192:195], v[132:135], a[160:163], v[192:195]
  ds_read_b64_tr_b16 v[130:131], v160 offset:10496
  v_mul_f32 v164, v164, v99
  v_mfma_f32_16x16x32_bf16 v[180:183], v[136:139], a[160:163], v[180:183]
  ds_read_b64_tr_b16 v[132:133], v161 offset:8448
  v_mul_f32 v165, v165, v99
  v_mfma_f32_16x16x32_bf16 v[208:211], v[140:143], a[160:163], v[208:211]
  s_waitcnt lgkmcnt(9)
  ds_read_b64_tr_b16 v[134:135], v161 offset:10496
  v_mul_f32 v166, v166, v99
  v_mfma_f32_16x16x32_bf16 v[120:123], v[144:147], a[20:23], v[120:123]
  s_waitcnt lgkmcnt(8)
  buffer_store_dwordx4 v[40:43], v169, s[20:23], s34 offen nt
  v_permlane16_swap_b32 v64, v66
  v_mfma_f32_16x16x32_bf16 v[212:215], v[148:151], a[20:23], v[212:215]
  s_waitcnt lgkmcnt(6)
  ds_read_b64_tr_b16 v[136:137], v162 offset:8448
  v_mul_f32 v167, v167, v99
  v_mfma_f32_16x16x32_bf16 v[188:191], v[152:155], a[20:23], v[188:191]
  s_waitcnt lgkmcnt(5)
  ds_read_b64_tr_b16 v[138:139], v162 offset:10496
  v_cvt_pk_bf16_f32 v54, v164, v165
  v_mfma_f32_16x16x32_bf16 v[228:231], v[156:159], a[20:23], v[228:231]
  ds_read_b64_tr_b16 v[140:141], v163 offset:8448
  v_cvt_pk_bf16_f32 v55, v166, v167
  v_mfma_f32_16x16x32_bf16 v[200:203], v[144:147], a[68:71], v[200:203]
  ds_read_b64_tr_b16 v[142:143], v163 offset:10496
  v_mul_f32 v36, v36, v100
  v_mfma_f32_16x16x32_bf16 v[240:243], v[148:151], a[68:71], v[240:243]
  v_permlane16_swap_b32 v65, v67
  v_mfma_f32_16x16x32_bf16 v[252:255], v[152:155], a[68:71], v[252:255]
  v_permlane16_swap_b32 v52, v54
  v_mfma_f32_16x16x32_bf16 v[68:71], v[156:159], a[68:71], v[68:71]
  v_permlane16_swap_b32 v53, v55
  v_mfma_f32_16x16x32_bf16 v[76:79], v[144:147], a[116:119], v[76:79]
  v_mov_b32 v60, v52
  v_mov_b32_dpp v52, v64 row_ror:8 row_mask:0xf bank_mask:0x3
  v_mfma_f32_16x16x32_bf16 v[84:87], v[148:151], a[116:119], v[84:87]
  v_mov_b32_dpp v64, v60 row_ror:8 row_mask:0xf bank_mask:0xc
  v_mov_b32 v61, v53
  v_mfma_f32_16x16x32_bf16 v[92:95], v[152:155], a[116:119], v[92:95]
  v_mov_b32_dpp v53, v65 row_ror:8 row_mask:0xf bank_mask:0x3
  v_mov_b32_dpp v65, v61 row_ror:8 row_mask:0xf bank_mask:0xc
  v_mfma_f32_16x16x32_bf16 v[108:111], v[156:159], a[116:119], v[108:111]
  s_mov_b32 s35, 98560
  v_mov_b32 v62, v54
  v_mov_b32_dpp v54, v66 row_ror:8 row_mask:0xf bank_mask:0x3
  v_mfma_f32_16x16x32_bf16 v[124:127], v[144:147], a[164:167], v[124:127]
  ds_read_b64_tr_b16 v[144:145], v160 offset:12544
  v_mov_b32_dpp v66, v62 row_ror:8 row_mask:0xf bank_mask:0xc
  v_mfma_f32_16x16x32_bf16 v[192:195], v[148:151], a[164:167], v[192:195]
  ds_read_b64_tr_b16 v[146:147], v160 offset:14592
  v_mov_b32 v63, v55
  v_mfma_f32_16x16x32_bf16 v[180:183], v[152:155], a[164:167], v[180:183]
  ds_read_b64_tr_b16 v[148:149], v161 offset:12544
  v_mov_b32_dpp v55, v67 row_ror:8 row_mask:0xf bank_mask:0x3
  v_mfma_f32_16x16x32_bf16 v[208:211], v[156:159], a[164:167], v[208:211]
  s_waitcnt lgkmcnt(9)
  ds_read_b64_tr_b16 v[150:151], v161 offset:14592
  v_mov_b32_dpp v67, v63 row_ror:8 row_mask:0xf bank_mask:0xc
  v_mfma_f32_16x16x32_bf16 v[120:123], v[128:131], a[24:27], v[120:123]
  s_waitcnt lgkmcnt(8)
  buffer_store_dwordx4 v[64:67], v169, s[20:23], s35 offen nt
  v_mul_f32 v37, v37, v100
  v_mul_f32 v38, v38, v100
  v_mfma_f32_16x16x32_bf16 v[212:215], v[132:135], a[24:27], v[212:215]
  s_waitcnt lgkmcnt(6)
  ds_read_b64_tr_b16 v[152:153], v162 offset:12544
  v_mul_f32 v39, v39, v100
  v_mfma_f32_16x16x32_bf16 v[188:191], v[136:139], a[24:27], v[188:191]
  s_waitcnt lgkmcnt(5)
  ds_read_b64_tr_b16 v[154:155], v162 offset:14592
  v_cvt_pk_bf16_f32 v36, v36, v37
  v_mfma_f32_16x16x32_bf16 v[228:231], v[140:143], a[24:27], v[228:231]
  ds_read_b64_tr_b16 v[156:157], v163 offset:12544
  v_cvt_pk_bf16_f32 v37, v38, v39
  v_mfma_f32_16x16x32_bf16 v[200:203], v[128:131], a[72:75], v[200:203]
  ds_read_b64_tr_b16 v[158:159], v163 offset:14592
  v_mul_f32 v48, v48, v100
  v_mfma_f32_16x16x32_bf16 v[240:243], v[132:135], a[72:75], v[240:243]
  v_mul_f32 v49, v49, v100
  v_mul_f32 v50, v50, v100
  v_mfma_f32_16x16x32_bf16 v[252:255], v[136:139], a[72:75], v[252:255]
  v_mul_f32 v51, v51, v100
  v_cvt_pk_bf16_f32 v38, v48, v49
  v_mfma_f32_16x16x32_bf16 v[68:71], v[140:143], a[72:75], v[68:71]
  v_cvt_pk_bf16_f32 v39, v50, v51
  v_mul_f32 v56, v56, v100
  v_mfma_f32_16x16x32_bf16 v[76:79], v[128:131], a[120:123], v[76:79]
  v_mul_f32 v57, v57, v100
  v_mul_f32 v58, v58, v100
  v_mfma_f32_16x16x32_bf16 v[84:87], v[132:135], a[120:123], v[84:87]
  v_mul_f32 v59, v59, v100
  v_cvt_pk_bf16_f32 v56, v56, v57
  v_mfma_f32_16x16x32_bf16 v[92:95], v[136:139], a[120:123], v[92:95]
  s_mov_b32 s36, 102656
  v_permlane16_swap_b32 v36, v38
  v_mfma_f32_16x16x32_bf16 v[108:111], v[140:143], a[120:123], v[108:111]
  v_permlane16_swap_b32 v37, v39
  v_mfma_f32_16x16x32_bf16 v[124:127], v[128:131], a[168:171], v[124:127]
  ds_read_b64_tr_b16 v[128:129], v160 offset:16896
  v_cvt_pk_bf16_f32 v57, v58, v59
  v_mfma_f32_16x16x32_bf16 v[192:195], v[132:135], a[168:171], v[192:195]
  ds_read_b64_tr_b16 v[130:131], v160 offset:18944
  v_mul_f32 v80, v80, v100
  v_mfma_f32_16x16x32_bf16 v[180:183], v[136:139], a[168:171], v[180:183]
  buffer_store_dwordx4 v[52:55], v169, s[20:23], s36 offen nt
  v_mul_f32 v81, v81, v100
  v_mul_f32 v82, v82, v100
  v_mfma_f32_16x16x32_bf16 v[208:211], v[140:143], a[168:171], v[208:211]
  s_waitcnt lgkmcnt(8)
  ds_read_b64_tr_b16 v[132:133], v161 offset:16896
  v_mul_f32 v83, v83, v100
  v_mfma_f32_16x16x32_bf16 v[120:123], v[144:147], a[28:31], v[120:123]
  s_waitcnt lgkmcnt(7)
  ds_read_b64_tr_b16 v[134:135], v161 offset:18944
  v_cvt_pk_bf16_f32 v58, v80, v81
  v_mfma_f32_16x16x32_bf16 v[212:215], v[148:151], a[28:31], v[212:215]
  s_waitcnt lgkmcnt(6)
  ds_read_b64_tr_b16 v[136:137], v162 offset:16896
  v_cvt_pk_bf16_f32 v59, v82, v83
  v_mfma_f32_16x16x32_bf16 v[188:191], v[152:155], a[28:31], v[188:191]
  s_waitcnt lgkmcnt(5)
  ds_read_b64_tr_b16 v[138:139], v162 offset:18944
  v_mul_f32 v72, v72, v101
  v_mfma_f32_16x16x32_bf16 v[228:231], v[156:159], a[28:31], v[228:231]
  ds_read_b64_tr_b16 v[140:141], v163 offset:16896
  v_mul_f32 v73, v73, v101
  v_mfma_f32_16x16x32_bf16 v[200:203], v[144:147], a[76:79], v[200:203]
  ds_read_b64_tr_b16 v[142:143], v163 offset:18944
  v_mul_f32 v74, v74, v101
  v_mfma_f32_16x16x32_bf16 v[240:243], v[148:151], a[76:79], v[240:243]
  v_permlane16_swap_b32 v56, v58
  v_mfma_f32_16x16x32_bf16 v[252:255], v[152:155], a[76:79], v[252:255]
  v_permlane16_swap_b32 v57, v59
  v_mfma_f32_16x16x32_bf16 v[68:71], v[156:159], a[76:79], v[68:71]
  v_mov_b32 v48, v56
  v_mov_b32_dpp v56, v36 row_ror:8 row_mask:0xf bank_mask:0x3
  v_mfma_f32_16x16x32_bf16 v[76:79], v[144:147], a[124:127], v[76:79]
  v_mov_b32_dpp v36, v48 row_ror:8 row_mask:0xf bank_mask:0xc
  v_mov_b32 v49, v57
  v_mfma_f32_16x16x32_bf16 v[84:87], v[148:151], a[124:127], v[84:87]
  s_mov_b32 s37, 131328
  v_mov_b32_dpp v57, v37 row_ror:8 row_mask:0xf bank_mask:0x3
  v_mov_b32_dpp v37, v49 row_ror:8 row_mask:0xf bank_mask:0xc
  v_mfma_f32_16x16x32_bf16 v[92:95], v[152:155], a[124:127], v[92:95]
  v_mov_b32 v50, v58
  v_mov_b32_dpp v58, v38 row_ror:8 row_mask:0xf bank_mask:0x3
  v_mfma_f32_16x16x32_bf16 v[108:111], v[156:159], a[124:127], v[108:111]
  v_mov_b32_dpp v38, v50 row_ror:8 row_mask:0xf bank_mask:0xc
  v_mov_b32 v51, v59
  v_mfma_f32_16x16x32_bf16 v[124:127], v[144:147], a[172:175], v[124:127]
  ds_read_b64_tr_b16 v[144:145], v160 offset:20992
  v_mov_b32_dpp v59, v39 row_ror:8 row_mask:0xf bank_mask:0x3
  v_mfma_f32_16x16x32_bf16 v[192:195], v[148:151], a[172:175], v[192:195]
  ds_read_b64_tr_b16 v[146:147], v160 offset:23040
  v_mov_b32_dpp v39, v51 row_ror:8 row_mask:0xf bank_mask:0xc
  v_mfma_f32_16x16x32_bf16 v[180:183], v[152:155], a[172:175], v[180:183]
  buffer_store_dwordx4 v[36:39], v169, s[20:23], s37 offen nt
  v_mul_f32 v75, v75, v101
  v_cvt_pk_bf16_f32 v72, v72, v73
  v_mfma_f32_16x16x32_bf16 v[208:211], v[156:159], a[172:175], v[208:211]
  s_waitcnt lgkmcnt(8)
  ds_read_b64_tr_b16 v[148:149], v161 offset:20992
  v_cvt_pk_bf16_f32 v73, v74, v75
  v_mfma_f32_16x16x32_bf16 v[120:123], v[128:131], a[32:35], v[120:123]
  s_waitcnt lgkmcnt(7)
  ds_read_b64_tr_b16 v[150:151], v161 offset:23040
  v_mul_f32 v104, v104, v101
  v_mfma_f32_16x16x32_bf16 v[212:215], v[132:135], a[32:35], v[212:215]
  s_waitcnt lgkmcnt(6)
  ds_read_b64_tr_b16 v[152:153], v162 offset:20992
  v_mul_f32 v105, v105, v101
  v_mfma_f32_16x16x32_bf16 v[188:191], v[136:139], a[32:35], v[188:191]
  s_waitcnt lgkmcnt(5)
  ds_read_b64_tr_b16 v[154:155], v162 offset:23040
  v_mul_f32 v106, v106, v101
  v_mfma_f32_16x16x32_bf16 v[228:231], v[140:143], a[32:35], v[228:231]
  ds_read_b64_tr_b16 v[156:157], v163 offset:20992
  v_mul_f32 v107, v107, v101
  v_mfma_f32_16x16x32_bf16 v[200:203], v[128:131], a[80:83], v[200:203]
  ds_read_b64_tr_b16 v[158:159], v163 offset:23040
  v_cvt_pk_bf16_f32 v74, v104, v105
  v_mfma_f32_16x16x32_bf16 v[240:243], v[132:135], a[80:83], v[240:243]
  v_cvt_pk_bf16_f32 v75, v106, v107
  v_mul_f32 v88, v88, v101
  v_mfma_f32_16x16x32_bf16 v[252:255], v[136:139], a[80:83], v[252:255]
  v_mul_f32 v89, v89, v101
  v_mul_f32 v90, v90, v101
  v_mfma_f32_16x16x32_bf16 v[68:71], v[140:143], a[80:83], v[68:71]
  v_mul_f32 v91, v91, v101
  v_cvt_pk_bf16_f32 v88, v88, v89
  v_mfma_f32_16x16x32_bf16 v[76:79], v[128:131], a[128:131], v[76:79]
  s_mov_b32 s38, 135424
  v_permlane16_swap_b32 v72, v74
  v_mfma_f32_16x16x32_bf16 v[84:87], v[132:135], a[128:131], v[84:87]
  v_permlane16_swap_b32 v73, v75
  v_mfma_f32_16x16x32_bf16 v[92:95], v[136:139], a[128:131], v[92:95]
  v_cvt_pk_bf16_f32 v89, v90, v91
  v_mul_f32 v112, v112, v101
  v_mfma_f32_16x16x32_bf16 v[108:111], v[140:143], a[128:131], v[108:111]
  v_mul_f32 v113, v113, v101
  v_mul_f32 v114, v114, v101
  v_mfma_f32_16x16x32_bf16 v[124:127], v[128:131], a[176:179], v[124:127]
  buffer_store_dwordx4 v[56:59], v169, s[20:23], s38 offen nt
  v_mul_f32 v115, v115, v101
  v_cvt_pk_bf16_f32 v90, v112, v113
  v_mfma_f32_16x16x32_bf16 v[192:195], v[132:135], a[176:179], v[192:195]
  ds_read_b64_tr_b16 v[128:129], v160 offset:25344
  v_cvt_pk_bf16_f32 v91, v114, v115
  v_mfma_f32_16x16x32_bf16 v[180:183], v[136:139], a[176:179], v[180:183]
  ds_read_b64_tr_b16 v[130:131], v160 offset:27392
  v_mfma_f32_16x16x32_bf16 v[208:211], v[140:143], a[176:179], v[208:211]
  s_waitcnt lgkmcnt(8)
  ds_read_b64_tr_b16 v[132:133], v161 offset:25344
  v_mfma_f32_16x16x32_bf16 v[120:123], v[144:147], a[36:39], v[120:123]
  s_waitcnt lgkmcnt(7)
  ds_read_b64_tr_b16 v[134:135], v161 offset:27392
  v_mfma_f32_16x16x32_bf16 v[212:215], v[148:151], a[36:39], v[212:215]
  s_waitcnt lgkmcnt(6)
  ds_read_b64_tr_b16 v[136:137], v162 offset:25344
  v_mfma_f32_16x16x32_bf16 v[188:191], v[152:155], a[36:39], v[188:191]
  s_waitcnt lgkmcnt(5)
  ds_read_b64_tr_b16 v[138:139], v162 offset:27392
  v_mfma_f32_16x16x32_bf16 v[228:231], v[156:159], a[36:39], v[228:231]
  ds_read_b64_tr_b16 v[140:141], v163 offset:25344
  v_mfma_f32_16x16x32_bf16 v[200:203], v[144:147], a[84:87], v[200:203]
  ds_read_b64_tr_b16 v[142:143], v163 offset:27392
  v_mfma_f32_16x16x32_bf16 v[240:243], v[148:151], a[84:87], v[240:243]
  v_permlane16_swap_b32 v88, v90
  v_mfma_f32_16x16x32_bf16 v[252:255], v[152:155], a[84:87], v[252:255]
  v_permlane16_swap_b32 v89, v91
  v_mfma_f32_16x16x32_bf16 v[68:71], v[156:159], a[84:87], v[68:71]
  v_mov_b32 v104, v88
  v_mov_b32_dpp v88, v72 row_ror:8 row_mask:0xf bank_mask:0x3
  v_mfma_f32_16x16x32_bf16 v[76:79], v[144:147], a[132:135], v[76:79]
  s_mov_b32 s39, 164096
  v_mov_b32_dpp v72, v104 row_ror:8 row_mask:0xf bank_mask:0xc
  v_mov_b32 v105, v89
  v_mfma_f32_16x16x32_bf16 v[84:87], v[148:151], a[132:135], v[84:87]
  v_mov_b32_dpp v89, v73 row_ror:8 row_mask:0xf bank_mask:0x3
  v_mov_b32_dpp v73, v105 row_ror:8 row_mask:0xf bank_mask:0xc
  v_mfma_f32_16x16x32_bf16 v[92:95], v[152:155], a[132:135], v[92:95]
  v_mov_b32 v106, v90
  v_mov_b32_dpp v90, v74 row_ror:8 row_mask:0xf bank_mask:0x3
  v_mfma_f32_16x16x32_bf16 v[108:111], v[156:159], a[132:135], v[108:111]
  v_mov_b32_dpp v74, v106 row_ror:8 row_mask:0xf bank_mask:0xc
  v_mov_b32 v107, v91
  v_mfma_f32_16x16x32_bf16 v[124:127], v[144:147], a[180:183], v[124:127]
  ds_read_b64_tr_b16 v[144:145], v160 offset:29440
  v_mov_b32_dpp v91, v75 row_ror:8 row_mask:0xf bank_mask:0x3
  v_mfma_f32_16x16x32_bf16 v[192:195], v[148:151], a[180:183], v[192:195]
  ds_read_b64_tr_b16 v[146:147], v160 offset:31488
  v_mov_b32_dpp v75, v107 row_ror:8 row_mask:0xf bank_mask:0xc
  v_mfma_f32_16x16x32_bf16 v[180:183], v[152:155], a[180:183], v[180:183]
  buffer_store_dwordx4 v[72:75], v169, s[20:23], s39 offen nt
  v_add_u32 v160, 119808, v160
  v_mfma_f32_16x16x32_bf16 v[208:211], v[156:159], a[180:183], v[208:211]
  s_waitcnt lgkmcnt(8)
  ds_read_b64_tr_b16 v[148:149], v161 offset:29440
  v_mfma_f32_16x16x32_bf16 v[120:123], v[128:131], a[40:43], v[120:123]
  s_waitcnt lgkmcnt(7)
  ds_read_b64_tr_b16 v[150:151], v161 offset:31488
  v_add_u32 v161, 119808, v161
  v_mfma_f32_16x16x32_bf16 v[212:215], v[132:135], a[40:43], v[212:215]
  s_waitcnt lgkmcnt(6)
  ds_read_b64_tr_b16 v[152:153], v162 offset:29440
  v_mfma_f32_16x16x32_bf16 v[188:191], v[136:139], a[40:43], v[188:191]
  s_waitcnt lgkmcnt(5)
  ds_read_b64_tr_b16 v[154:155], v162 offset:31488
  v_add_u32 v162, 119808, v162
  v_mfma_f32_16x16x32_bf16 v[228:231], v[140:143], a[40:43], v[228:231]
  ds_read_b64_tr_b16 v[156:157], v163 offset:29440
  v_mfma_f32_16x16x32_bf16 v[200:203], v[128:131], a[88:91], v[200:203]
  ds_read_b64_tr_b16 v[158:159], v163 offset:31488
  v_add_u32 v163, 119808, v163
  v_mfma_f32_16x16x32_bf16 v[240:243], v[132:135], a[88:91], v[240:243]
  v_mfma_f32_16x16x32_bf16 v[252:255], v[136:139], a[88:91], v[252:255]
  v_mfma_f32_16x16x32_bf16 v[68:71], v[140:143], a[88:91], v[68:71]
  s_mov_b32 s40, 168192
  v_mfma_f32_16x16x32_bf16 v[76:79], v[128:131], a[136:139], v[76:79]
  v_mfma_f32_16x16x32_bf16 v[84:87], v[132:135], a[136:139], v[84:87]
  v_mfma_f32_16x16x32_bf16 v[92:95], v[136:139], a[136:139], v[92:95]
  v_mfma_f32_16x16x32_bf16 v[108:111], v[140:143], a[136:139], v[108:111]
  buffer_store_dwordx4 v[88:91], v169, s[20:23], s40 offen nt
  v_mfma_f32_16x16x32_bf16 v[124:127], v[128:131], a[184:187], v[124:127]
  ds_read_b64_tr_b16 v[128:129], v160 offset:0
  v_mfma_f32_16x16x32_bf16 v[192:195], v[132:135], a[184:187], v[192:195]
  ds_read_b64_tr_b16 v[130:131], v160 offset:2048
  v_mfma_f32_16x16x32_bf16 v[180:183], v[136:139], a[184:187], v[180:183]
  ds_read_b64_tr_b16 v[132:133], v161 offset:0
  v_mfma_f32_16x16x32_bf16 v[208:211], v[140:143], a[184:187], v[208:211]
  s_waitcnt lgkmcnt(9)
  ds_read_b64_tr_b16 v[134:135], v161 offset:2048
  v_mfma_f32_16x16x32_bf16 v[120:123], v[144:147], a[44:47], v[120:123]
  s_waitcnt lgkmcnt(8)
  ds_read_b64_tr_b16 v[136:137], v162 offset:0
  v_mfma_f32_16x16x32_bf16 v[212:215], v[148:151], a[44:47], v[212:215]
  s_waitcnt lgkmcnt(7)
  ds_read_b64_tr_b16 v[138:139], v162 offset:2048
  v_mfma_f32_16x16x32_bf16 v[188:191], v[152:155], a[44:47], v[188:191]
  s_waitcnt lgkmcnt(6)
  ds_read_b64_tr_b16 v[140:141], v163 offset:0
  v_mfma_f32_16x16x32_bf16 v[228:231], v[156:159], a[44:47], v[228:231]
  ds_read_b64_tr_b16 v[142:143], v163 offset:2048
  v_mfma_f32_16x16x32_bf16 v[200:203], v[144:147], a[92:95], v[200:203]
  v_mul_f32 v120, v120, v96
  v_mul_f32 v121, v121, v96
  v_mfma_f32_16x16x32_bf16 v[240:243], v[148:151], a[92:95], v[240:243]
  v_mul_f32 v122, v122, v96
  v_mul_f32 v123, v123, v96
  v_mfma_f32_16x16x32_bf16 v[252:255], v[152:155], a[92:95], v[252:255]
  v_cvt_pk_bf16_f32 v120, v120, v121
  v_cvt_pk_bf16_f32 v121, v122, v123
  v_mfma_f32_16x16x32_bf16 v[68:71], v[156:159], a[92:95], v[68:71]
  v_mul_f32 v212, v212, v96
  v_mul_f32 v213, v213, v96
  v_mfma_f32_16x16x32_bf16 v[76:79], v[144:147], a[140:143], v[76:79]
  v_mul_f32 v214, v214, v96
  v_mul_f32 v215, v215, v96
  v_cvt_pk_bf16_f32 v122, v212, v213
  v_cvt_pk_bf16_f32 v123, v214, v215
  v_mfma_f32_16x16x32_bf16 v[84:87], v[148:151], a[140:143], v[84:87]
  v_mul_f32 v188, v188, v96
  v_mul_f32 v189, v189, v96
  v_mul_f32 v190, v190, v96
  v_mul_f32 v191, v191, v96
  v_mfma_f32_16x16x32_bf16 v[92:95], v[152:155], a[140:143], v[92:95]
  v_permlane16_swap_b32 v120, v122
  v_cvt_pk_bf16_f32 v188, v188, v189
  v_cvt_pk_bf16_f32 v189, v190, v191
  v_mfma_f32_16x16x32_bf16 v[108:111], v[156:159], a[140:143], v[108:111]
  v_permlane16_swap_b32 v121, v123
  v_mul_f32 v228, v228, v96
  v_mul_f32 v229, v229, v96
  v_mfma_f32_16x16x32_bf16 v[124:127], v[144:147], a[188:191], v[124:127]
  ds_read_b64_tr_b16 v[144:145], v160 offset:4096
  v_mul_f32 v230, v230, v96
  v_mul_f32 v231, v231, v96
  v_cvt_pk_bf16_f32 v190, v228, v229
  v_mfma_f32_16x16x32_bf16 v[192:195], v[148:151], a[188:191], v[192:195]
  ds_read_b64_tr_b16 v[146:147], v160 offset:6144
  v_cvt_pk_bf16_f32 v191, v230, v231
  v_permlane16_swap_b32 v188, v190
  v_mfma_f32_16x16x32_bf16 v[180:183], v[152:155], a[188:191], v[180:183]
  ds_read_b64_tr_b16 v[148:149], v161 offset:4096
  v_permlane16_swap_b32 v189, v191
  v_mov_b32 v212, v188
  v_mfma_f32_16x16x32_bf16 v[208:211], v[156:159], a[188:191], v[208:211]
  s_waitcnt lgkmcnt(9)
  ds_read_b64_tr_b16 v[150:151], v161 offset:6144
  v_mov_b32_dpp v188, v120 row_ror:8 row_mask:0xf bank_mask:0x3
  v_mov_b32_dpp v120, v212 row_ror:8 row_mask:0xf bank_mask:0xc
  v_mov_b32 v213, v189
  v_mfma_f32_16x16x32_bf16 v[232:235], v[128:131], a[192:195], 0
  s_waitcnt lgkmcnt(8)
  ds_read_b64_tr_b16 v[152:153], v162 offset:4096
  s_mov_b32 s41, 384
  v_mov_b32_dpp v189, v121 row_ror:8 row_mask:0xf bank_mask:0x3
  v_mov_b32_dpp v121, v213 row_ror:8 row_mask:0xf bank_mask:0xc
  v_mov_b32 v214, v190
  v_mfma_f32_16x16x32_bf16 v[220:223], v[132:135], a[192:195], 0
  s_waitcnt lgkmcnt(7)
  ds_read_b64_tr_b16 v[154:155], v162 offset:6144
  v_mov_b32_dpp v190, v122 row_ror:8 row_mask:0xf bank_mask:0x3
  v_mov_b32_dpp v122, v214 row_ror:8 row_mask:0xf bank_mask:0xc
  v_mov_b32 v215, v191
  v_mfma_f32_16x16x32_bf16 v[248:251], v[136:139], a[192:195], 0
  s_waitcnt lgkmcnt(6)
  ds_read_b64_tr_b16 v[156:157], v163 offset:4096
  v_mov_b32_dpp v191, v123 row_ror:8 row_mask:0xf bank_mask:0x3
  v_mov_b32_dpp v123, v215 row_ror:8 row_mask:0xf bank_mask:0xc
  v_mul_f32 v200, v200, v97
  v_mfma_f32_16x16x32_bf16 v[204:207], v[140:143], a[192:195], 0
  ds_read_b64_tr_b16 v[158:159], v163 offset:6144
  v_mul_f32 v201, v201, v97
  v_mul_f32 v202, v202, v97
  v_mul_f32 v203, v203, v97
  v_mfma_f32_16x16x32_bf16 v[184:187], v[128:131], a[240:243], 0
  buffer_store_dwordx4 v[120:123], v169, s[20:23], s41 offen nt
  v_cvt_pk_bf16_f32 v200, v200, v201
  v_cvt_pk_bf16_f32 v201, v202, v203
  v_mul_f32 v240, v240, v97
  v_mul_f32 v241, v241, v97
  v_mfma_f32_16x16x32_bf16 v[244:247], v[132:135], a[240:243], 0
  ds_read_b64_tr_b16 v[128:129], v160 offset:8192
  v_mul_f32 v242, v242, v97
  v_mul_f32 v243, v243, v97
  v_cvt_pk_bf16_f32 v202, v240, v241
  v_mfma_f32_16x16x32_bf16 v[224:227], v[136:139], a[240:243], 0
  ds_read_b64_tr_b16 v[130:131], v160 offset:10240
  v_cvt_pk_bf16_f32 v203, v242, v243
  v_mul_f32 v252, v252, v97
  v_mul_f32 v253, v253, v97
  v_mfma_f32_16x16x32_bf16 v[32:35], v[140:143], a[240:243], 0
  s_waitcnt lgkmcnt(8)
  ds_read_b64_tr_b16 v[132:133], v161 offset:8192
  v_mul_f32 v254, v254, v97
  v_mul_f32 v255, v255, v97
  v_cvt_pk_bf16_f32 v252, v252, v253
  v_mfma_f32_16x16x32_bf16 v[232:235], v[144:147], a[196:199], v[232:235]
  s_waitcnt lgkmcnt(7)
  ds_read_b64_tr_b16 v[134:135], v161 offset:10240
  v_permlane16_swap_b32 v200, v202
  v_cvt_pk_bf16_f32 v253, v254, v255
  v_mfma_f32_16x16x32_bf16 v[220:223], v[148:151], a[196:199], v[220:223]
  s_waitcnt lgkmcnt(6)
  ds_read_b64_tr_b16 v[136:137], v162 offset:8192
  v_permlane16_swap_b32 v201, v203
  v_mul_f32 v68, v68, v97
  v_mfma_f32_16x16x32_bf16 v[248:251], v[152:155], a[196:199], v[248:251]
  s_waitcnt lgkmcnt(5)
  ds_read_b64_tr_b16 v[138:139], v162 offset:10240
  s_mov_b32 s42, 4480
  v_mul_f32 v69, v69, v97
  v_mul_f32 v70, v70, v97
  v_mul_f32 v71, v71, v97
  v_mfma_f32_16x16x32_bf16 v[204:207], v[156:159], a[196:199], v[204:207]
  ds_read_b64_tr_b16 v[140:141], v163 offset:8192
  v_cvt_pk_bf16_f32 v254, v68, v69
  v_cvt_pk_bf16_f32 v255, v70, v71
  v_mul_f32 v76, v76, v98
  v_mfma_f32_16x16x32_bf16 v[184:187], v[144:147], a[244:247], v[184:187]
  ds_read_b64_tr_b16 v[142:143], v163 offset:10240
  v_permlane16_swap_b32 v252, v254
  v_mov_b32 v240, v252
  v_mfma_f32_16x16x32_bf16 v[244:247], v[148:151], a[244:247], v[244:247]
  ds_read_b64_tr_b16 v[144:145], v160 offset:13312
  v_permlane16_swap_b32 v253, v255
  v_mov_b32_dpp v252, v200 row_ror:8 row_mask:0xf bank_mask:0x3
  v_mfma_f32_16x16x32_bf16 v[224:227], v[152:155], a[244:247], v[224:227]
  buffer_store_dwordx4 v[188:191], v169, s[20:23], s42 offen nt
  v_mov_b32_dpp v200, v240 row_ror:8 row_mask:0xf bank_mask:0xc
  v_mov_b32 v241, v253
  v_mov_b32_dpp v253, v201 row_ror:8 row_mask:0xf bank_mask:0x3
  v_mov_b32 v242, v254
  v_mfma_f32_16x16x32_bf16 v[32:35], v[156:159], a[244:247], v[32:35]
  s_waitcnt lgkmcnt(7)
  ds_read_b64_tr_b16 v[146:147], v160 offset:15360
  v_subrev_u32 v160, 119808, v160
  v_mov_b32_dpp v201, v241 row_ror:8 row_mask:0xf bank_mask:0xc
  v_mov_b32_dpp v254, v202 row_ror:8 row_mask:0xf bank_mask:0x3
  v_mfma_f32_16x16x32_bf16 v[232:235], v[128:131], a[200:203], v[232:235]
  s_waitcnt lgkmcnt(6)
  ds_read_b64_tr_b16 v[148:149], v161 offset:13312
  v_mov_b32_dpp v202, v242 row_ror:8 row_mask:0xf bank_mask:0xc
  v_mov_b32 v243, v255
  v_mov_b32_dpp v255, v203 row_ror:8 row_mask:0xf bank_mask:0x3
  v_mfma_f32_16x16x32_bf16 v[220:223], v[132:135], a[200:203], v[220:223]
  s_waitcnt lgkmcnt(5)
  ds_read_b64_tr_b16 v[150:151], v161 offset:15360
  v_subrev_u32 v161, 119808, v161
  v_mov_b32_dpp v203, v243 row_ror:8 row_mask:0xf bank_mask:0xc
  v_mul_f32 v77, v77, v98
  v_mfma_f32_16x16x32_bf16 v[248:251], v[136:139], a[200:203], v[248:251]
  s_waitcnt lgkmcnt(4)
  ds_read_b64_tr_b16 v[152:153], v162 offset:13312
  v_mul_f32 v78, v78, v98
  v_mul_f32 v79, v79, v98
  v_cvt_pk_bf16_f32 v76, v76, v77
  v_mfma_f32_16x16x32_bf16 v[204:207], v[140:143], a[200:203], v[204:207]
  ds_read_b64_tr_b16 v[154:155], v162 offset:15360
  v_subrev_u32 v162, 119808, v162
  v_cvt_pk_bf16_f32 v77, v78, v79
  v_mul_f32 v84, v84, v98
  v_mfma_f32_16x16x32_bf16 v[184:187], v[128:131], a[248:251], v[184:187]
  ds_read_b64_tr_b16 v[156:157], v163 offset:13312
  s_mov_b32 s43, 33152
  v_mul_f32 v85, v85, v98
  v_mul_f32 v86, v86, v98
  v_mul_f32 v87, v87, v98
  v_mfma_f32_16x16x32_bf16 v[244:247], v[132:135], a[248:251], v[244:247]
  ds_read_b64_tr_b16 v[158:159], v163 offset:15360
  v_subrev_u32 v163, 119808, v163
  v_cvt_pk_bf16_f32 v78, v84, v85
  v_cvt_pk_bf16_f32 v79, v86, v87
  v_mfma_f32_16x16x32_bf16 v[224:227], v[136:139], a[248:251], v[224:227]
  ds_read_b64_tr_b16 v[128:129], v160 offset:0
  v_mul_f32 v92, v92, v98
  v_mul_f32 v93, v93, v98
  v_mul_f32 v94, v94, v98
  v_mfma_f32_16x16x32_bf16 v[32:35], v[140:143], a[248:251], v[32:35]
  s_waitcnt lgkmcnt(7)
  ds_read_b64_tr_b16 v[130:131], v160 offset:2048
  v_mul_f32 v95, v95, v98
  v_permlane16_swap_b32 v76, v78
  v_mfma_f32_16x16x32_bf16 v[232:235], v[144:147], a[204:207], v[232:235]
  s_waitcnt lgkmcnt(6)
  buffer_store_dwordx4 v[200:203], v169, s[20:23], s43 offen nt
  v_cvt_pk_bf16_f32 v92, v92, v93
  v_permlane16_swap_b32 v77, v79
  v_cvt_pk_bf16_f32 v93, v94, v95
  v_mfma_f32_16x16x32_bf16 v[220:223], v[148:151], a[204:207], v[220:223]
  s_waitcnt lgkmcnt(4)
  ds_read_b64_tr_b16 v[132:133], v161 offset:0
  v_mul_f32 v108, v108, v98
  v_mul_f32 v109, v109, v98
  v_mul_f32 v110, v110, v98
  v_mfma_f32_16x16x32_bf16 v[248:251], v[152:155], a[204:207], v[248:251]
  s_waitcnt lgkmcnt(3)
  ds_read_b64_tr_b16 v[134:135], v161 offset:2048
  v_mul_f32 v111, v111, v98
  v_cvt_pk_bf16_f32 v94, v108, v109
  v_cvt_pk_bf16_f32 v95, v110, v111
  v_mfma_f32_16x16x32_bf16 v[204:207], v[156:159], a[204:207], v[204:207]
  ds_read_b64_tr_b16 v[136:137], v162 offset:0
  v_permlane16_swap_b32 v92, v94
  v_mov_b32 v84, v92
  v_mfma_f32_16x16x32_bf16 v[184:187], v[144:147], a[252:255], v[184:187]
  ds_read_b64_tr_b16 v[138:139], v162 offset:2048
  v_permlane16_swap_b32 v93, v95
  v_mov_b32_dpp v92, v76 row_ror:8 row_mask:0xf bank_mask:0x3
  v_mfma_f32_16x16x32_bf16 v[244:247], v[148:151], a[252:255], v[244:247]
  ds_read_b64_tr_b16 v[140:141], v163 offset:0
  v_mov_b32_dpp v76, v84 row_ror:8 row_mask:0xf bank_mask:0xc
  v_mov_b32 v85, v93
  v_mov_b32_dpp v93, v77 row_ror:8 row_mask:0xf bank_mask:0x3
  v_mfma_f32_16x16x32_bf16 v[224:227], v[152:155], a[252:255], v[224:227]
  ds_read_b64_tr_b16 v[142:143], v163 offset:2048
  s_mov_b32 s44, 37248
  v_mov_b32_dpp v77, v85 row_ror:8 row_mask:0xf bank_mask:0xc
  v_mov_b32 v86, v94
  v_mov_b32_dpp v94, v78 row_ror:8 row_mask:0xf bank_mask:0x3
  v_mfma_f32_16x16x32_bf16 v[32:35], v[156:159], a[252:255], v[32:35]
  s_waitcnt lgkmcnt(6)
  ds_read_b64_tr_b16 v[144:145], v160 offset:4096
  v_mov_b32_dpp v78, v86 row_ror:8 row_mask:0xf bank_mask:0xc
  v_mov_b32 v87, v95
  v_mov_b32_dpp v95, v79 row_ror:8 row_mask:0xf bank_mask:0x3
  v_mfma_f32_16x16x32_bf16 v[232:235], v[128:131], a[208:211], v[232:235]
  s_waitcnt lgkmcnt(5)
  ds_read_b64_tr_b16 v[146:147], v160 offset:6144
  v_mov_b32_dpp v79, v87 row_ror:8 row_mask:0xf bank_mask:0xc
  v_mul_f32 v124, v124, v99
  v_mul_f32 v125, v125, v99
  v_mfma_f32_16x16x32_bf16 v[220:223], v[132:135], a[208:211], v[220:223]
  s_waitcnt lgkmcnt(4)
  ds_read_b64_tr_b16 v[148:149], v161 offset:4096
  v_mul_f32 v126, v126, v99
  v_mul_f32 v127, v127, v99
  v_cvt_pk_bf16_f32 v124, v124, v125
  v_mfma_f32_16x16x32_bf16 v[248:251], v[136:139], a[208:211], v[248:251]
  s_waitcnt lgkmcnt(3)
  ds_read_b64_tr_b16 v[150:151], v161 offset:6144
  v_cvt_pk_bf16_f32 v125, v126, v127
  v_mul_f32 v192, v192, v99
  v_mul_f32 v193, v193, v99
  v_mfma_f32_16x16x32_bf16 v[204:207], v[140:143], a[208:211], v[204:207]
  buffer_store_dwordx4 v[252:255], v169, s[20:23], s44 offen nt
  v_mul_f32 v194, v194, v99
  v_mul_f32 v195, v195, v99
  v_cvt_pk_bf16_f32 v126, v192, v193
  v_cvt_pk_bf16_f32 v127, v194, v195
  v_mfma_f32_16x16x32_bf16 v[184:187], v[128:131], v[0:3], v[184:187]
  ds_read_b64_tr_b16 v[152:153], v162 offset:4096
  v_mul_f32 v180, v180, v99
  v_mul_f32 v181, v181, v99
  v_mul_f32 v182, v182, v99
  v_mfma_f32_16x16x32_bf16 v[244:247], v[132:135], v[0:3], v[244:247]
  ds_read_b64_tr_b16 v[154:155], v162 offset:6144
  v_mul_f32 v183, v183, v99
  v_permlane16_swap_b32 v124, v126
  v_mfma_f32_16x16x32_bf16 v[224:227], v[136:139], v[0:3], v[224:227]
  ds_read_b64_tr_b16 v[156:157], v163 offset:4096
  v_cvt_pk_bf16_f32 v180, v180, v181
  v_permlane16_swap_b32 v125, v127
  v_mfma_f32_16x16x32_bf16 v[32:35], v[140:143], v[0:3], v[32:35]
  s_waitcnt lgkmcnt(5)
  ds_read_b64_tr_b16 v[158:159], v163 offset:6144
  v_cvt_pk_bf16_f32 v181, v182, v183
  v_mul_f32 v208, v208, v99
  v_mul_f32 v209, v209, v99
  v_mfma_f32_16x16x32_bf16 v[232:235], v[144:147], a[212:215], v[232:235]
  s_waitcnt lgkmcnt(4)
  ds_read_b64_tr_b16 v[128:129], v160 offset:8448
  s_mov_b32 s45, 65920
  v_mul_f32 v210, v210, v99
  v_mul_f32 v211, v211, v99
  v_cvt_pk_bf16_f32 v182, v208, v209
  v_mfma_f32_16x16x32_bf16 v[220:223], v[148:151], a[212:215], v[220:223]
  s_waitcnt lgkmcnt(3)
  ds_read_b64_tr_b16 v[130:131], v160 offset:10496
  v_cvt_pk_bf16_f32 v183, v210, v211
  v_permlane16_swap_b32 v180, v182
  v_mfma_f32_16x16x32_bf16 v[248:251], v[152:155], a[212:215], v[248:251]
  s_waitcnt lgkmcnt(2)
  ds_read_b64_tr_b16 v[132:133], v161 offset:8448
  v_permlane16_swap_b32 v181, v183
  v_mov_b32 v192, v180
  v_mfma_f32_16x16x32_bf16 v[204:207], v[156:159], a[212:215], v[204:207]
  ds_read_b64_tr_b16 v[134:135], v161 offset:10496
  v_mov_b32_dpp v180, v124 row_ror:8 row_mask:0xf bank_mask:0x3
  v_mov_b32_dpp v124, v192 row_ror:8 row_mask:0xf bank_mask:0xc
  v_mov_b32 v193, v181
  v_mfma_f32_16x16x32_bf16 v[184:187], v[144:147], v[4:7], v[184:187]
  ds_read_b64_tr_b16 v[136:137], v162 offset:8448
  v_mov_b32_dpp v181, v125 row_ror:8 row_mask:0xf bank_mask:0x3
  v_mov_b32_dpp v125, v193 row_ror:8 row_mask:0xf bank_mask:0xc
  v_mov_b32 v194, v182
  v_mfma_f32_16x16x32_bf16 v[244:247], v[148:151], v[4:7], v[244:247]
  ds_read_b64_tr_b16 v[138:139], v162 offset:10496
  v_mov_b32_dpp v182, v126 row_ror:8 row_mask:0xf bank_mask:0x3
  v_mov_b32_dpp v126, v194 row_ror:8 row_mask:0xf bank_mask:0xc
  v_mov_b32 v195, v183
  v_mfma_f32_16x16x32_bf16 v[224:227], v[152:155], v[4:7], v[224:227]
  buffer_store_dwordx4 v[76:79], v169, s[20:23], s45 offen nt
  v_mov_b32_dpp v183, v127 row_ror:8 row_mask:0xf bank_mask:0x3
  v_mov_b32_dpp v127, v195 row_ror:8 row_mask:0xf bank_mask:0xc
  v_mfma_f32_16x16x32_bf16 v[32:35], v[156:159], v[4:7], v[32:35]
  s_waitcnt lgkmcnt(4)
  ds_read_b64_tr_b16 v[140:141], v163 offset:8448
  ds_read_b64_tr_b16 v[142:143], v163 offset:10496
  v_mfma_f32_16x16x32_bf16 v[232:235], v[128:131], a[216:219], v[232:235]
  s_waitcnt lgkmcnt(4)
  ds_read_b64_tr_b16 v[144:145], v160 offset:12544
  v_mfma_f32_16x16x32_bf16 v[220:223], v[132:135], a[216:219], v[220:223]
  s_waitcnt lgkmcnt(3)
  ds_read_b64_tr_b16 v[146:147], v160 offset:14592
  v_mfma_f32_16x16x32_bf16 v[248:251], v[136:139], a[216:219], v[248:251]
  s_waitcnt lgkmcnt(2)
  ds_read_b64_tr_b16 v[148:149], v161 offset:12544
  s_mov_b32 s46, 70016
  v_mfma_f32_16x16x32_bf16 v[204:207], v[140:143], a[216:219], v[204:207]
  ds_read_b64_tr_b16 v[150:151], v161 offset:14592
  v_mfma_f32_16x16x32_bf16 v[184:187], v[128:131], v[8:11], v[184:187]
  ds_read_b64_tr_b16 v[152:153], v162 offset:12544
  s_mov_b32 s33, 131456
  v_mfma_f32_16x16x32_bf16 v[244:247], v[132:135], v[8:11], v[244:247]
  ds_read_b64_tr_b16 v[154:155], v162 offset:14592
  s_mov_b32 s34, 135552
  v_mfma_f32_16x16x32_bf16 v[224:227], v[136:139], v[8:11], v[224:227]
  ds_read_b64_tr_b16 v[156:157], v163 offset:12544
  s_mov_b32 s35, 164224
  v_mfma_f32_16x16x32_bf16 v[32:35], v[140:143], v[8:11], v[32:35]
  s_waitcnt lgkmcnt(5)
  ds_read_b64_tr_b16 v[158:159], v163 offset:14592
  s_mov_b32 s36, 168320
  v_mfma_f32_16x16x32_bf16 v[232:235], v[144:147], a[220:223], v[232:235]
  s_waitcnt lgkmcnt(4)
  buffer_store_dwordx4 v[92:95], v169, s[20:23], s46 offen nt
  v_mfma_f32_16x16x32_bf16 v[220:223], v[148:151], a[220:223], v[220:223]
  s_waitcnt lgkmcnt(2)
  ds_read_b64_tr_b16 v[128:129], v160 offset:16896
  ds_read_b64_tr_b16 v[130:131], v160 offset:18944
  v_mfma_f32_16x16x32_bf16 v[248:251], v[152:155], a[220:223], v[248:251]
  s_waitcnt lgkmcnt(2)
  ds_read_b64_tr_b16 v[132:133], v161 offset:16896
  v_mfma_f32_16x16x32_bf16 v[204:207], v[156:159], a[220:223], v[204:207]
  ds_read_b64_tr_b16 v[134:135], v161 offset:18944
  v_mfma_f32_16x16x32_bf16 v[184:187], v[144:147], v[12:15], v[184:187]
  ds_read_b64_tr_b16 v[136:137], v162 offset:16896
  s_mov_b32 s47, 98688
  v_mfma_f32_16x16x32_bf16 v[244:247], v[148:151], v[12:15], v[244:247]
  ds_read_b64_tr_b16 v[138:139], v162 offset:18944
  v_mfma_f32_16x16x32_bf16 v[224:227], v[152:155], v[12:15], v[224:227]
  ds_read_b64_tr_b16 v[140:141], v163 offset:16896
  v_mfma_f32_16x16x32_bf16 v[32:35], v[156:159], v[12:15], v[32:35]
  s_waitcnt lgkmcnt(5)
  ds_read_b64_tr_b16 v[142:143], v163 offset:18944
  v_mfma_f32_16x16x32_bf16 v[232:235], v[128:131], a[224:227], v[232:235]
  s_waitcnt lgkmcnt(4)
  ds_read_b64_tr_b16 v[144:145], v160 offset:20992
  v_mfma_f32_16x16x32_bf16 v[220:223], v[132:135], a[224:227], v[220:223]
  s_waitcnt lgkmcnt(3)
  ds_read_b64_tr_b16 v[146:147], v160 offset:23040
  v_mfma_f32_16x16x32_bf16 v[248:251], v[136:139], a[224:227], v[248:251]
  s_waitcnt lgkmcnt(2)
  buffer_store_dwordx4 v[124:127], v169, s[20:23], s47 offen nt
  v_mfma_f32_16x16x32_bf16 v[204:207], v[140:143], a[224:227], v[204:207]
  ds_read_b64_tr_b16 v[148:149], v161 offset:20992
  ds_read_b64_tr_b16 v[150:151], v161 offset:23040
  v_mfma_f32_16x16x32_bf16 v[184:187], v[128:131], v[16:19], v[184:187]
  ds_read_b64_tr_b16 v[152:153], v162 offset:20992
  v_mfma_f32_16x16x32_bf16 v[244:247], v[132:135], v[16:19], v[244:247]
  ds_read_b64_tr_b16 v[154:155], v162 offset:23040
  v_mfma_f32_16x16x32_bf16 v[224:227], v[136:139], v[16:19], v[224:227]
  ds_read_b64_tr_b16 v[156:157], v163 offset:20992
  s_mov_b32 s32, 102784
  v_mfma_f32_16x16x32_bf16 v[32:35], v[140:143], v[16:19], v[32:35]
  s_waitcnt lgkmcnt(5)
  ds_read_b64_tr_b16 v[158:159], v163 offset:23040
  v_mfma_f32_16x16x32_bf16 v[232:235], v[144:147], a[228:231], v[232:235]
  s_waitcnt lgkmcnt(4)
  ds_read_b64_tr_b16 v[128:129], v160 offset:25344
  v_mfma_f32_16x16x32_bf16 v[220:223], v[148:151], a[228:231], v[220:223]
  s_waitcnt lgkmcnt(3)
  ds_read_b64_tr_b16 v[130:131], v160 offset:27392
  v_mfma_f32_16x16x32_bf16 v[248:251], v[152:155], a[228:231], v[248:251]
  s_waitcnt lgkmcnt(2)
  ds_read_b64_tr_b16 v[132:133], v161 offset:25344
  v_mfma_f32_16x16x32_bf16 v[204:207], v[156:159], a[228:231], v[204:207]
  ds_read_b64_tr_b16 v[134:135], v161 offset:27392
  v_mfma_f32_16x16x32_bf16 v[184:187], v[144:147], v[20:23], v[184:187]
  buffer_store_dwordx4 v[180:183], v169, s[20:23], s32 offen nt
  v_mfma_f32_16x16x32_bf16 v[244:247], v[148:151], v[20:23], v[244:247]
  ds_read_b64_tr_b16 v[136:137], v162 offset:25344
  ds_read_b64_tr_b16 v[138:139], v162 offset:27392
  v_mfma_f32_16x16x32_bf16 v[224:227], v[152:155], v[20:23], v[224:227]
  ds_read_b64_tr_b16 v[140:141], v163 offset:25344
  v_mfma_f32_16x16x32_bf16 v[32:35], v[156:159], v[20:23], v[32:35]
  s_waitcnt lgkmcnt(5)
  ds_read_b64_tr_b16 v[142:143], v163 offset:27392
  v_mfma_f32_16x16x32_bf16 v[232:235], v[128:131], a[232:235], v[232:235]
  s_waitcnt lgkmcnt(4)
  ds_read_b64_tr_b16 v[144:145], v160 offset:29440
  v_mfma_f32_16x16x32_bf16 v[220:223], v[132:135], a[232:235], v[220:223]
  s_waitcnt lgkmcnt(3)
  ds_read_b64_tr_b16 v[146:147], v160 offset:31488
  v_mfma_f32_16x16x32_bf16 v[248:251], v[136:139], a[232:235], v[248:251]
  s_waitcnt lgkmcnt(2)
  ds_read_b64_tr_b16 v[148:149], v161 offset:29440
  v_mfma_f32_16x16x32_bf16 v[204:207], v[140:143], a[232:235], v[204:207]
  ds_read_b64_tr_b16 v[150:151], v161 offset:31488
  v_mfma_f32_16x16x32_bf16 v[184:187], v[128:131], v[24:27], v[184:187]
  ds_read_b64_tr_b16 v[152:153], v162 offset:29440
  v_mfma_f32_16x16x32_bf16 v[244:247], v[132:135], v[24:27], v[244:247]
  ds_read_b64_tr_b16 v[154:155], v162 offset:31488
  v_mfma_f32_16x16x32_bf16 v[224:227], v[136:139], v[24:27], v[224:227]
  ds_read_b64_tr_b16 v[156:157], v163 offset:29440
  v_mfma_f32_16x16x32_bf16 v[32:35], v[140:143], v[24:27], v[32:35]
  s_waitcnt lgkmcnt(5)
  ds_read_b64_tr_b16 v[158:159], v163 offset:31488
  v_mfma_f32_16x16x32_bf16 v[232:235], v[144:147], a[236:239], v[232:235]
  s_waitcnt lgkmcnt(4)
  v_mfma_f32_16x16x32_bf16 v[220:223], v[148:151], a[236:239], v[220:223]
  s_waitcnt lgkmcnt(2)
  v_mfma_f32_16x16x32_bf16 v[248:251], v[152:155], a[236:239], v[248:251]
  s_waitcnt lgkmcnt(0)
  v_mfma_f32_16x16x32_bf16 v[204:207], v[156:159], a[236:239], v[204:207]
  v_mfma_f32_16x16x32_bf16 v[184:187], v[144:147], v[28:31], v[184:187]
  v_mfma_f32_16x16x32_bf16 v[244:247], v[148:151], v[28:31], v[244:247]
  v_mfma_f32_16x16x32_bf16 v[224:227], v[152:155], v[28:31], v[224:227]
  v_mfma_f32_16x16x32_bf16 v[32:35], v[156:159], v[28:31], v[32:35]
  v_mul_f32 v232, v232, v100
  v_mul_f32 v233, v233, v100
  v_cvt_pk_bf16_f32 v232, v232, v233
  v_mul_f32 v234, v234, v100
  v_mul_f32 v235, v235, v100
  v_cvt_pk_bf16_f32 v233, v234, v235
  v_mul_f32 v220, v220, v100
  v_mul_f32 v221, v221, v100
  v_cvt_pk_bf16_f32 v234, v220, v221
  s_nop 1
  v_permlane16_swap_b32 v232, v234
  v_mul_f32 v248, v248, v100
  v_mul_f32 v249, v249, v100
  v_cvt_pk_bf16_f32 v248, v248, v249
  v_mul_f32 v250, v250, v100
  v_mul_f32 v251, v251, v100
  v_cvt_pk_bf16_f32 v249, v250, v251
  v_mul_f32 v204, v204, v100
  v_mul_f32 v205, v205, v100
  v_cvt_pk_bf16_f32 v250, v204, v205
  s_nop 1
  v_permlane16_swap_b32 v248, v250
  v_mov_b32 v220, v248
  s_nop 0
  v_mov_b32_dpp v248, v232 row_ror:8 row_mask:0xf bank_mask:0x3
  v_mov_b32_dpp v232, v220 row_ror:8 row_mask:0xf bank_mask:0xc
  v_mul_f32 v222, v222, v100
  v_mul_f32 v223, v223, v100
  v_cvt_pk_bf16_f32 v235, v222, v223
  s_nop 1
  v_permlane16_swap_b32 v233, v235
  v_mul_f32 v206, v206, v100
  v_mul_f32 v207, v207, v100
  v_cvt_pk_bf16_f32 v251, v206, v207
  s_nop 1
  v_permlane16_swap_b32 v249, v251
  v_mov_b32 v221, v249
  s_nop 0
  v_mov_b32_dpp v249, v233 row_ror:8 row_mask:0xf bank_mask:0x3
  v_mov_b32_dpp v233, v221 row_ror:8 row_mask:0xf bank_mask:0xc
  v_mov_b32 v222, v250
  v_mov_b32_dpp v250, v234 row_ror:8 row_mask:0xf bank_mask:0x3
  s_nop 0
  v_mov_b32_dpp v234, v222 row_ror:8 row_mask:0xf bank_mask:0xc
  v_mov_b32 v223, v251
  v_mov_b32_dpp v251, v235 row_ror:8 row_mask:0xf bank_mask:0x3
  s_nop 0
  v_mov_b32_dpp v235, v223 row_ror:8 row_mask:0xf bank_mask:0xc
  buffer_store_dwordx4 v[232:235], v169, s[20:23], s33 offen nt
  buffer_store_dwordx4 v[248:251], v169, s[20:23], s34 offen nt
  v_mul_f32 v184, v184, v101
  v_mul_f32 v185, v185, v101
  v_mul_f32 v186, v186, v101
  v_mul_f32 v187, v187, v101
  v_cvt_pk_bf16_f32 v184, v184, v185
  v_cvt_pk_bf16_f32 v185, v186, v187
  v_mul_f32 v244, v244, v101
  v_mul_f32 v245, v245, v101
  v_mul_f32 v246, v246, v101
  v_mul_f32 v247, v247, v101
  v_cvt_pk_bf16_f32 v186, v244, v245
  v_cvt_pk_bf16_f32 v187, v246, v247
  v_mul_f32 v224, v224, v101
  v_mul_f32 v225, v225, v101
  v_mul_f32 v226, v226, v101
  v_mul_f32 v227, v227, v101
  v_permlane16_swap_b32 v184, v186
  v_cvt_pk_bf16_f32 v224, v224, v225
  v_permlane16_swap_b32 v185, v187
  v_cvt_pk_bf16_f32 v225, v226, v227
  v_mul_f32 v32, v32, v101
  v_mul_f32 v33, v33, v101
  v_mul_f32 v34, v34, v101
  v_mul_f32 v35, v35, v101
  v_cvt_pk_bf16_f32 v226, v32, v33
  v_cvt_pk_bf16_f32 v227, v34, v35
  s_nop 0
  v_permlane16_swap_b32 v224, v226
  v_mov_b32 v244, v224
  s_nop 0
  v_mov_b32_dpp v224, v184 row_ror:8 row_mask:0xf bank_mask:0x3
  v_mov_b32_dpp v184, v244 row_ror:8 row_mask:0xf bank_mask:0xc
  v_permlane16_swap_b32 v225, v227
  v_mov_b32 v245, v225
  s_nop 0
  v_mov_b32_dpp v225, v185 row_ror:8 row_mask:0xf bank_mask:0x3
  v_mov_b32_dpp v185, v245 row_ror:8 row_mask:0xf bank_mask:0xc
  v_mov_b32 v246, v226
  v_mov_b32_dpp v226, v186 row_ror:8 row_mask:0xf bank_mask:0x3
  s_nop 0
  v_mov_b32_dpp v186, v246 row_ror:8 row_mask:0xf bank_mask:0xc
  v_mov_b32 v247, v227
  v_mov_b32_dpp v227, v187 row_ror:8 row_mask:0xf bank_mask:0x3
  s_nop 0
  v_mov_b32_dpp v187, v247 row_ror:8 row_mask:0xf bank_mask:0xc
  buffer_store_dwordx4 v[184:187], v169, s[20:23], s35 offen nt
  buffer_store_dwordx4 v[224:227], v169, s[20:23], s36 offen nt
L_fins:
  s_endpgm
.section .rodata,"a"
.p2align 6
.amdhsa_kernel standalone__gqa_softmax__near_ridge_kernel
  .amdhsa_next_free_vgpr 512
  .amdhsa_next_free_sgpr 102
  .amdhsa_accum_offset 256
  .amdhsa_group_segment_fixed_size 0
  .amdhsa_kernarg_size 48
  .amdhsa_user_sgpr_count 2
  .amdhsa_user_sgpr_kernarg_segment_ptr 1
  .amdhsa_system_sgpr_workgroup_id_x 1
.end_amdhsa_kernel
```
